```python
import torch

def _softmax(x, axis=-1):
    return torch.softmax(x, dim=axis)
def _gelu(x):
    return torch.nn.functional.gelu(x, approximate="tanh")
def _silu(x):
    return torch.nn.functional.silu(x)
def _sigmoid(x):
    return torch.sigmoid(x)
def _layernorm(x, axis=-1, eps=1e-5):
    m = x.mean(dim=axis, keepdim=True)
    v = x.var(dim=axis, keepdim=True, unbiased=False)
    return (x - m) / torch.sqrt(v + eps)
def _scatter_add(tgt, idx, src, axis=0):
    return tgt.clone().index_add_(axis, idx, src)
def _segment_sum(src, seg, n):
    out = torch.zeros((n,) + src.shape[1:], dtype=src.dtype)
    return out.index_add_(0, seg, src)
def _pad(x, pw):
    flat = tuple(v for pair in reversed(pw) for v in pair)
    return torch.nn.functional.pad(x, flat)

kernel_name = 'sequential_preLN__sliding_block__dense_activation_silu__prompt'

def setup_inputs():

    _w = (lambda a: (lambda t: t.to(torch.bfloat16) if t.is_floating_point() else t)(torch.as_tensor(a)))
    def _A_setup():
        B, S, D = 1, 2048, 1024
        return {
            "x": _w((lambda *s: torch.randn(*s, dtype=torch.bfloat16) * 0.05)(B, S, D)),
            "wqkv": _w((lambda *s: torch.randn(*s, dtype=torch.bfloat16) * 0.05)(D, 3 * D)),
            "wo": _w((lambda *s: torch.randn(*s, dtype=torch.bfloat16) * 0.05)(D, D)),
        }
    _A_in = _A_setup()

    def _B_setup():
        B, S, D, F = 1, 2048, 1024, 3584
        return {
            "x": _w((lambda *s: torch.randn(*s, dtype=torch.bfloat16) * 0.05)(B, S, D)),
            "w1": _w((lambda *s: torch.randn(*s, dtype=torch.bfloat16) * 3.2)(D, F) * (D ** -0.5)),
            "w2": _w((lambda *s: torch.randn(*s, dtype=torch.bfloat16) * 0.4)(F, D) * (F ** -0.5)),
        }
    _B_in = _B_setup()

    return {
        "A_x": _A_in["x"],
        "A_wqkv": _A_in["wqkv"],
        "A_wo": _A_in["wo"],
        "B_x": _B_in["x"],
        "B_w1": _B_in["w1"],
        "B_w2": _B_in["w2"],
    }

def reference(A_x, A_wqkv, A_wo, B_x, B_w1, B_w2):
    def _A_ref(x, wqkv, wo):
        B, S, D = x.shape
        H = 32; Dh = D // H; W = 256
        qkv = (lambda x, *d: x.permute(*d))((x @ wqkv).reshape(B, S, 3, H, Dh), 2, 0, 3, 1, 4)
        q, k, v = qkv[0], qkv[1], qkv[2]
        scores = torch.einsum("bhqd,bhkd->bhqk", q, k) * (Dh ** -0.5)
        idx = torch.arange(S)
        mask = (idx[:, None] - idx[None, :] >= 0) & (idx[:, None] - idx[None, :] < W)
        scores = torch.where(mask[None, None], scores, -1e9)
        p = _softmax(scores, axis=-1)
        o = torch.einsum("bhqk,bhkd->bhqd", p, v)
        return (lambda x, *d: x.permute(*d))(o, 0, 2, 1, 3).reshape(B, S, D) @ wo

    def _B_ref(x, w1, w2):
        h = torch.einsum("bsd,df->bsf", x, w1)
        h = _silu(h)
        out = torch.einsum("bsf,fd->bsd", h, w2)
        return out

    x = A_x
    h = x + _A_ref(_layernorm(x, axis=-1), A_wqkv, A_wo)
    h2 = h + _B_ref(_layernorm(h, axis=-1), B_w1, B_w2)
    return h2
```

```asm
; @launch grid=(256,1,1) block=(512,1,1) lds=163840
.amdgcn_target "amdgcn-amd-amdhsa--gfx950"
.text
.globl sequential_preLN__sliding_block__dense_activation_silu__prompt_kernel
.p2align 8
.type sequential_preLN__sliding_block__dense_activation_silu__prompt_kernel,@function
sequential_preLN__sliding_block__dense_activation_silu__prompt_kernel:

    s_cmp_ge_u32 s2, 256
    s_cbranch_scc1 L_end
    s_load_dwordx16 s[48:63], s[0:1], 0
    s_load_dwordx2 s[64:65], s[0:1], 64
    v_lshrrev_b32 v2, 6, v0
    v_and_b32 v1, 63, v0
    v_readfirstlane_b32 s20, v2
    v_lshrrev_b32 v3, 4, v1
    v_and_b32 v4, 15, v1
    s_and_b32 s22, s2, 7
    s_mov_b32 s3, 0
    s_lshr_b32 s23, s2, 3
    s_and_b32 s21, s20, 3
    s_lshr_b32 s28, s21, 1
    s_and_b32 s29, s21, 1

    s_lshr_b32 s24, s23, 1
    s_and_b32 s30, s23, 1
    s_lshl_b32 s25, s22, 1
    s_add_u32 s25, s25, s30
    s_lshl_b32 s100, s25, 4
    s_add_u32 s100, s100, s24
    s_lshl_b32 s100, s100, 16
    s_add_u32 s101, s24, s25
    s_and_b32 s101, s101, 0
    s_lshl_b32 s26, s25, 7
    s_mov_b32 s67, 0
    s_lshl_b32 s66, s24, 18

    s_lshl_b32 s68, s21, 13
    v_lshrrev_b32 v246, 3, v1
    s_lshl_b32 s30, s21, 6
    v_add_u32 v246, s30, v246
    v_lshlrev_b32 v246, 11, v246
    v_and_b32 v247, 7, v1
    v_xor_b32 v247, v247, v3
    v_lshl_add_u32 v232, v247, 4, v246
    v_xor_b32 v247, 4, v247
    v_lshl_add_u32 v233, v247, 4, v246
    v_add_u32 v233, 15360, v233
    v_add_u32 v234, 30720, v232
    v_add_u32 v235, 30720, v233

    s_lshl_b32 s69, s21, 12
    s_lshl_b32 s70, s21, 11
    v_lshrrev_b32 v246, 3, v1
    s_lshl_b32 s30, s21, 5
    v_add_u32 v246, s30, v246
    v_mul_u32_u24 v246, 6144, v246
    v_and_b32 v247, 1, v1
    v_lshl_add_u32 v246, v247, 4, v246
    v_add_u32 v246, s26, v246
    v_bfe_u32 v247, v1, 1, 2

    v_and_b32 v245, 1, v3
    v_xor_b32 v245, v247, v245
    v_lshl_add_u32 v236, v245, 5, v246
    v_xor_b32 v245, 2, v245
    v_lshl_add_u32 v237, v245, 5, v246
    v_add_u32 v237, 48128, v237
    v_add_u32 v238, 96256, v236
    v_add_u32 v239, 96256, v237
    s_lshl_b32 s30, s21, 8
    s_add_u32 s30, s30, 159744
    v_lshl_add_u32 v252, v1, 2, s30
    v_and_b32 v253, 3, v1
    v_mul_u32_u24 v253, 260, v253
    v_add_u32 v253, 159744, v253
    s_waitcnt lgkmcnt(0)
    s_mov_b32 s4, s48
    s_and_b32 s5, s49, 0xffff
    s_mov_b32 s6, 4194304
    s_mov_b32 s7, 0x20000
    s_mov_b32 s12, s50
    s_and_b32 s13, s51, 0xffff
    s_mov_b32 s14, 6291456
    s_mov_b32 s15, 0x20000
    s_mov_b32 s8, s64
    s_and_b32 s9, s65, 0xffff
    s_mov_b32 s10, 268435456
    s_mov_b32 s11, 0x20000
    s_mov_b32 s16, s62
    s_and_b32 s17, s63, 0xffff
    s_mov_b32 s18, 256
    s_mov_b32 s19, 0x20000
    s_cmp_lt_u32 s20, 4
    s_cbranch_scc1 L_cons
    s_mov_b64 s[96:97], s[60:61]
    s_mov_b32 s44, s52
    s_and_b32 s45, s53, 0xffff
    s_mov_b32 s46, 2097152
    s_mov_b32 s47, 0x20000
    s_lshl_b32 s61, s2, 2
    s_add_u32 s61, s61, s21
    s_lshl_b32 s61, s61, 8
    s_mov_b32 s73, s61
    s_mov_b32 s60, 2097152
    s_mov_b32 s55, 1
    s_cmp_eq_u32 s21, 2
    s_cbranch_scc1 L_h0
    s_cmp_eq_u32 s21, 3
    s_cbranch_scc1 L_h1
    s_add_u32 s99, s67, 0
    s_add_u32 m0, s69, 49152
    s_add_u32 s31, s99, 0
    buffer_load_dwordx4 v236, s[12:15], s31 offen offset:0  lds
    buffer_load_dwordx4 v237, s[12:15], s31 offen offset:1024  lds
    buffer_load_dwordx4 v238, s[12:15], s31 offen offset:2048  lds
    buffer_load_dwordx4 v239, s[12:15], s31 offen offset:3072  lds
    s_add_u32 m0, s69, 73728
    s_add_u32 s31, s99, 2048
    buffer_load_dwordx4 v236, s[12:15], s31 offen offset:0  lds
    buffer_load_dwordx4 v237, s[12:15], s31 offen offset:1024  lds
    buffer_load_dwordx4 v238, s[12:15], s31 offen offset:2048  lds
    buffer_load_dwordx4 v239, s[12:15], s31 offen offset:3072  lds
    s_add_u32 m0, s69, 98304
    s_add_u32 s31, s99, 4096
    buffer_load_dwordx4 v236, s[12:15], s31 offen offset:0  lds
    buffer_load_dwordx4 v237, s[12:15], s31 offen offset:1024  lds
    buffer_load_dwordx4 v238, s[12:15], s31 offen offset:2048  lds
    buffer_load_dwordx4 v239, s[12:15], s31 offen offset:3072  lds
    s_add_u32 s98, s66, 0
    s_add_u32 m0, s68, 0
    s_add_u32 s31, s98, 0
    buffer_load_dwordx4 v232, s[4:7], s31 offen offset:0 lds
    buffer_load_dwordx4 v233, s[4:7], s31 offen offset:1024 lds
    buffer_load_dwordx4 v234, s[4:7], s31 offen offset:2048 lds
    buffer_load_dwordx4 v235, s[4:7], s31 offen offset:3072 lds
    s_add_u32 m0, s68, 4096
    s_add_u32 s31, s98, 65536
    buffer_load_dwordx4 v232, s[4:7], s31 offen offset:0 lds
    buffer_load_dwordx4 v233, s[4:7], s31 offen offset:1024 lds
    buffer_load_dwordx4 v234, s[4:7], s31 offen offset:2048 lds
    buffer_load_dwordx4 v235, s[4:7], s31 offen offset:3072 lds
    s_add_u32 s99, s67, 393216
    s_add_u32 m0, s69, 57344
    s_add_u32 s31, s99, 0
    buffer_load_dwordx4 v236, s[12:15], s31 offen offset:0  lds
    buffer_load_dwordx4 v237, s[12:15], s31 offen offset:1024  lds
    buffer_load_dwordx4 v238, s[12:15], s31 offen offset:2048  lds
    buffer_load_dwordx4 v239, s[12:15], s31 offen offset:3072  lds
    s_add_u32 m0, s69, 81920
    s_add_u32 s31, s99, 2048
    buffer_load_dwordx4 v236, s[12:15], s31 offen offset:0  lds
    buffer_load_dwordx4 v237, s[12:15], s31 offen offset:1024  lds
    buffer_load_dwordx4 v238, s[12:15], s31 offen offset:2048  lds
    buffer_load_dwordx4 v239, s[12:15], s31 offen offset:3072  lds
    s_waitcnt vmcnt(8)
    s_barrier
    s_add_u32 m0, s69, 106496
    s_add_u32 s31, s99, 4096
    buffer_load_dwordx4 v236, s[12:15], s31 offen offset:0  lds
    buffer_load_dwordx4 v237, s[12:15], s31 offen offset:1024  lds
    buffer_load_dwordx4 v238, s[12:15], s31 offen offset:2048  lds
    buffer_load_dwordx4 v239, s[12:15], s31 offen offset:3072  lds
    s_add_u32 s98, s66, 128
    s_add_u32 m0, s68, 16384
    s_add_u32 s31, s98, 0
    buffer_load_dwordx4 v232, s[4:7], s31 offen offset:0 lds
    buffer_load_dwordx4 v233, s[4:7], s31 offen offset:1024 lds
    buffer_load_dwordx4 v234, s[4:7], s31 offen offset:2048 lds
    buffer_load_dwordx4 v235, s[4:7], s31 offen offset:3072 lds
    s_add_u32 m0, s68, 20480
    s_add_u32 s31, s98, 65536
    buffer_load_dwordx4 v232, s[4:7], s31 offen offset:0 lds
    buffer_load_dwordx4 v233, s[4:7], s31 offen offset:1024 lds
    buffer_load_dwordx4 v234, s[4:7], s31 offen offset:2048 lds
    buffer_load_dwordx4 v235, s[4:7], s31 offen offset:3072 lds
    s_add_u32 s99, s67, 786432
    s_add_u32 m0, s69, 65536
    s_add_u32 s31, s99, 0
    buffer_load_dwordx4 v236, s[12:15], s31 offen offset:0  lds
    buffer_load_dwordx4 v237, s[12:15], s31 offen offset:1024  lds
    buffer_load_dwordx4 v238, s[12:15], s31 offen offset:2048  lds
    buffer_load_dwordx4 v239, s[12:15], s31 offen offset:3072  lds
    s_add_u32 m0, s69, 90112
    s_add_u32 s31, s99, 2048
    buffer_load_dwordx4 v236, s[12:15], s31 offen offset:0  lds
    buffer_load_dwordx4 v237, s[12:15], s31 offen offset:1024  lds
    buffer_load_dwordx4 v238, s[12:15], s31 offen offset:2048  lds
    buffer_load_dwordx4 v239, s[12:15], s31 offen offset:3072  lds
    s_add_u32 m0, s69, 114688
    s_add_u32 s31, s99, 4096
    buffer_load_dwordx4 v236, s[12:15], s31 offen offset:0  lds
    buffer_load_dwordx4 v237, s[12:15], s31 offen offset:1024  lds
    buffer_load_dwordx4 v238, s[12:15], s31 offen offset:2048  lds
    buffer_load_dwordx4 v239, s[12:15], s31 offen offset:3072  lds
    s_add_u32 s98, s66, 256
    s_add_u32 m0, s68, 32768
    s_add_u32 s31, s98, 0
    buffer_load_dwordx4 v232, s[4:7], s31 offen offset:0 lds
    buffer_load_dwordx4 v233, s[4:7], s31 offen offset:1024 lds
    buffer_load_dwordx4 v234, s[4:7], s31 offen offset:2048 lds
    buffer_load_dwordx4 v235, s[4:7], s31 offen offset:3072 lds
    s_add_u32 m0, s68, 36864
    s_add_u32 s31, s98, 65536
    buffer_load_dwordx4 v232, s[4:7], s31 offen offset:0 lds
    buffer_load_dwordx4 v233, s[4:7], s31 offen offset:1024 lds
    buffer_load_dwordx4 v234, s[4:7], s31 offen offset:2048 lds
    buffer_load_dwordx4 v235, s[4:7], s31 offen offset:3072 lds
    s_getpc_b64 s[42:43]
pc_1:
    s_sub_u32 s42, s42, pc_1-sequential_preLN__sliding_block__dense_activation_silu__prompt_kernel
    s_subb_u32 s43, s43, 0
    s_lshl_b32 s75, s23, 2
    s_add_u32 s75, s75, s21
    s_lshl_b32 s75, s75, 6
    s_load_dword s74, s[42:43], s75 offset:0
    s_load_dword s74, s[42:43], s75 offset:8192
    s_load_dword s74, s[42:43], s75 offset:16384
    s_load_dword s74, s[42:43], s75 offset:24576
    s_load_dword s74, s[42:43], s75 offset:32768
    s_load_dword s74, s[42:43], s75 offset:40960
    s_load_dword s74, s[42:43], s75 offset:49152
    s_load_dword s74, s[42:43], s75 offset:57344
    s_load_dword s74, s[42:43], s75 offset:65536
    s_load_dword s74, s[42:43], s75 offset:73728
    s_load_dword s74, s[42:43], s75 offset:81920
    s_waitcnt vmcnt(20)
    s_barrier
    s_add_u32 s99, s67, 1179648
    s_add_u32 m0, s69, 49152
    s_add_u32 s31, s99, 0
    buffer_load_dwordx4 v236, s[12:15], s31 offen offset:0  lds
    buffer_load_dwordx4 v237, s[12:15], s31 offen offset:1024  lds
    buffer_load_dwordx4 v238, s[12:15], s31 offen offset:2048  lds
    buffer_load_dwordx4 v239, s[12:15], s31 offen offset:3072  lds
    s_add_u32 m0, s69, 73728
    s_add_u32 s31, s99, 2048
    buffer_load_dwordx4 v236, s[12:15], s31 offen offset:0  lds
    buffer_load_dwordx4 v237, s[12:15], s31 offen offset:1024  lds
    buffer_load_dwordx4 v238, s[12:15], s31 offen offset:2048  lds
    buffer_load_dwordx4 v239, s[12:15], s31 offen offset:3072  lds
    s_add_u32 m0, s69, 98304
    s_add_u32 s31, s99, 4096
    buffer_load_dwordx4 v236, s[12:15], s31 offen offset:0  lds
    buffer_load_dwordx4 v237, s[12:15], s31 offen offset:1024  lds
    buffer_load_dwordx4 v238, s[12:15], s31 offen offset:2048  lds
    buffer_load_dwordx4 v239, s[12:15], s31 offen offset:3072  lds
    s_add_u32 s98, s66, 384
    s_add_u32 m0, s68, 0
    s_add_u32 s31, s98, 0
    buffer_load_dwordx4 v232, s[4:7], s31 offen offset:0 lds
    buffer_load_dwordx4 v233, s[4:7], s31 offen offset:1024 lds
    buffer_load_dwordx4 v234, s[4:7], s31 offen offset:2048 lds
    buffer_load_dwordx4 v235, s[4:7], s31 offen offset:3072 lds
    s_add_u32 m0, s68, 4096
    s_add_u32 s31, s98, 65536
    buffer_load_dwordx4 v232, s[4:7], s31 offen offset:0 lds
    buffer_load_dwordx4 v233, s[4:7], s31 offen offset:1024 lds
    buffer_load_dwordx4 v234, s[4:7], s31 offen offset:2048 lds
    buffer_load_dwordx4 v235, s[4:7], s31 offen offset:3072 lds
    s_waitcnt vmcnt(20)
    s_barrier
    s_add_u32 s99, s67, 1572864
    s_add_u32 m0, s69, 57344
    s_add_u32 s31, s99, 0
    buffer_load_dwordx4 v236, s[12:15], s31 offen offset:0  lds
    buffer_load_dwordx4 v237, s[12:15], s31 offen offset:1024  lds
    buffer_load_dwordx4 v238, s[12:15], s31 offen offset:2048  lds
    buffer_load_dwordx4 v239, s[12:15], s31 offen offset:3072  lds
    s_add_u32 m0, s69, 81920
    s_add_u32 s31, s99, 2048
    buffer_load_dwordx4 v236, s[12:15], s31 offen offset:0  lds
    buffer_load_dwordx4 v237, s[12:15], s31 offen offset:1024  lds
    buffer_load_dwordx4 v238, s[12:15], s31 offen offset:2048  lds
    buffer_load_dwordx4 v239, s[12:15], s31 offen offset:3072  lds
    s_add_u32 m0, s69, 106496
    s_add_u32 s31, s99, 4096
    buffer_load_dwordx4 v236, s[12:15], s31 offen offset:0  lds
    buffer_load_dwordx4 v237, s[12:15], s31 offen offset:1024  lds
    buffer_load_dwordx4 v238, s[12:15], s31 offen offset:2048  lds
    buffer_load_dwordx4 v239, s[12:15], s31 offen offset:3072  lds
    s_add_u32 s98, s66, 512
    s_add_u32 m0, s68, 16384
    s_add_u32 s31, s98, 0
    buffer_load_dwordx4 v232, s[4:7], s31 offen offset:0 lds
    buffer_load_dwordx4 v233, s[4:7], s31 offen offset:1024 lds
    buffer_load_dwordx4 v234, s[4:7], s31 offen offset:2048 lds
    buffer_load_dwordx4 v235, s[4:7], s31 offen offset:3072 lds
    s_add_u32 m0, s68, 20480
    s_add_u32 s31, s98, 65536
    buffer_load_dwordx4 v232, s[4:7], s31 offen offset:0 lds
    buffer_load_dwordx4 v233, s[4:7], s31 offen offset:1024 lds
    buffer_load_dwordx4 v234, s[4:7], s31 offen offset:2048 lds
    buffer_load_dwordx4 v235, s[4:7], s31 offen offset:3072 lds
    s_waitcnt vmcnt(20)
    s_barrier
    s_add_u32 s99, s67, 1966080
    s_add_u32 m0, s69, 65536
    s_add_u32 s31, s99, 0
    buffer_load_dwordx4 v236, s[12:15], s31 offen offset:0  lds
    buffer_load_dwordx4 v237, s[12:15], s31 offen offset:1024  lds
    buffer_load_dwordx4 v238, s[12:15], s31 offen offset:2048  lds
    buffer_load_dwordx4 v239, s[12:15], s31 offen offset:3072  lds
    s_add_u32 m0, s69, 90112
    s_add_u32 s31, s99, 2048
    buffer_load_dwordx4 v236, s[12:15], s31 offen offset:0  lds
    buffer_load_dwordx4 v237, s[12:15], s31 offen offset:1024  lds
    buffer_load_dwordx4 v238, s[12:15], s31 offen offset:2048  lds
    buffer_load_dwordx4 v239, s[12:15], s31 offen offset:3072  lds
    s_add_u32 m0, s69, 114688
    s_add_u32 s31, s99, 4096
    buffer_load_dwordx4 v236, s[12:15], s31 offen offset:0  lds
    buffer_load_dwordx4 v237, s[12:15], s31 offen offset:1024  lds
    buffer_load_dwordx4 v238, s[12:15], s31 offen offset:2048  lds
    buffer_load_dwordx4 v239, s[12:15], s31 offen offset:3072  lds
    s_add_u32 s98, s66, 640
    s_add_u32 m0, s68, 32768
    s_add_u32 s31, s98, 0
    buffer_load_dwordx4 v232, s[4:7], s31 offen offset:0 lds
    buffer_load_dwordx4 v233, s[4:7], s31 offen offset:1024 lds
    buffer_load_dwordx4 v234, s[4:7], s31 offen offset:2048 lds
    buffer_load_dwordx4 v235, s[4:7], s31 offen offset:3072 lds
    s_add_u32 m0, s68, 36864
    s_add_u32 s31, s98, 65536
    buffer_load_dwordx4 v232, s[4:7], s31 offen offset:0 lds
    buffer_load_dwordx4 v233, s[4:7], s31 offen offset:1024 lds
    buffer_load_dwordx4 v234, s[4:7], s31 offen offset:2048 lds
    buffer_load_dwordx4 v235, s[4:7], s31 offen offset:3072 lds
    s_cmp_lt_u32 s73, s60
    s_cbranch_scc1 pfg_2
    s_cmp_ge_u32 s55, 2
    s_cbranch_scc1 pfx_3
    s_mov_b32 s73, s61
    s_mov_b32 s60, 7340032
    s_add_u32 s55, s55, 1
    s_cmp_eq_u32 s55, 2
    s_cbranch_scc1 pfw2_4
    s_mov_b32 s44, s56
    s_and_b32 s45, s57, 0xffff
    s_mov_b32 s46, 7340032
    s_mov_b32 s47, 0x20000
    s_branch pfg_2
pfw2_4:
    s_mov_b32 s44, s58
    s_and_b32 s45, s59, 0xffff
    s_mov_b32 s46, 7340032
    s_mov_b32 s47, 0x20000
pfg_2:
    s_buffer_load_dword s74, s[44:47], s73 offset:0
    s_buffer_load_dword s74, s[44:47], s73 offset:64
    s_buffer_load_dword s74, s[44:47], s73 offset:128
    s_buffer_load_dword s74, s[44:47], s73 offset:192
    s_add_u32 s73, s73, 262144
pfx_3:
    s_waitcnt vmcnt(20)
    s_barrier
    s_add_u32 s99, s67, 2359296
    s_add_u32 m0, s69, 49152
    s_add_u32 s31, s99, 0
    buffer_load_dwordx4 v236, s[12:15], s31 offen offset:0  lds
    buffer_load_dwordx4 v237, s[12:15], s31 offen offset:1024  lds
    buffer_load_dwordx4 v238, s[12:15], s31 offen offset:2048  lds
    buffer_load_dwordx4 v239, s[12:15], s31 offen offset:3072  lds
    s_add_u32 m0, s69, 73728
    s_add_u32 s31, s99, 2048
    buffer_load_dwordx4 v236, s[12:15], s31 offen offset:0  lds
    buffer_load_dwordx4 v237, s[12:15], s31 offen offset:1024  lds
    buffer_load_dwordx4 v238, s[12:15], s31 offen offset:2048  lds
    buffer_load_dwordx4 v239, s[12:15], s31 offen offset:3072  lds
    s_add_u32 m0, s69, 98304
    s_add_u32 s31, s99, 4096
    buffer_load_dwordx4 v236, s[12:15], s31 offen offset:0  lds
    buffer_load_dwordx4 v237, s[12:15], s31 offen offset:1024  lds
    buffer_load_dwordx4 v238, s[12:15], s31 offen offset:2048  lds
    buffer_load_dwordx4 v239, s[12:15], s31 offen offset:3072  lds
    s_add_u32 s98, s66, 768
    s_add_u32 m0, s68, 0
    s_add_u32 s31, s98, 0
    buffer_load_dwordx4 v232, s[4:7], s31 offen offset:0 lds
    buffer_load_dwordx4 v233, s[4:7], s31 offen offset:1024 lds
    buffer_load_dwordx4 v234, s[4:7], s31 offen offset:2048 lds
    buffer_load_dwordx4 v235, s[4:7], s31 offen offset:3072 lds
    s_add_u32 m0, s68, 4096
    s_add_u32 s31, s98, 65536
    buffer_load_dwordx4 v232, s[4:7], s31 offen offset:0 lds
    buffer_load_dwordx4 v233, s[4:7], s31 offen offset:1024 lds
    buffer_load_dwordx4 v234, s[4:7], s31 offen offset:2048 lds
    buffer_load_dwordx4 v235, s[4:7], s31 offen offset:3072 lds
    s_cmp_lt_u32 s73, s60
    s_cbranch_scc1 pfg_5
    s_cmp_ge_u32 s55, 2
    s_cbranch_scc1 pfx_6
    s_mov_b32 s73, s61
    s_mov_b32 s60, 7340032
    s_add_u32 s55, s55, 1
    s_cmp_eq_u32 s55, 2
    s_cbranch_scc1 pfw2_7
    s_mov_b32 s44, s56
    s_and_b32 s45, s57, 0xffff
    s_mov_b32 s46, 7340032
    s_mov_b32 s47, 0x20000
    s_branch pfg_5
pfw2_7:
    s_mov_b32 s44, s58
    s_and_b32 s45, s59, 0xffff
    s_mov_b32 s46, 7340032
    s_mov_b32 s47, 0x20000
pfg_5:
    s_buffer_load_dword s74, s[44:47], s73 offset:0
    s_buffer_load_dword s74, s[44:47], s73 offset:64
    s_buffer_load_dword s74, s[44:47], s73 offset:128
    s_buffer_load_dword s74, s[44:47], s73 offset:192
    s_add_u32 s73, s73, 262144
pfx_6:
    s_waitcnt vmcnt(20)
    s_barrier
    s_add_u32 s99, s67, 2752512
    s_add_u32 m0, s69, 57344
    s_add_u32 s31, s99, 0
    buffer_load_dwordx4 v236, s[12:15], s31 offen offset:0  lds
    buffer_load_dwordx4 v237, s[12:15], s31 offen offset:1024  lds
    buffer_load_dwordx4 v238, s[12:15], s31 offen offset:2048  lds
    buffer_load_dwordx4 v239, s[12:15], s31 offen offset:3072  lds
    s_add_u32 m0, s69, 81920
    s_add_u32 s31, s99, 2048
    buffer_load_dwordx4 v236, s[12:15], s31 offen offset:0  lds
    buffer_load_dwordx4 v237, s[12:15], s31 offen offset:1024  lds
    buffer_load_dwordx4 v238, s[12:15], s31 offen offset:2048  lds
    buffer_load_dwordx4 v239, s[12:15], s31 offen offset:3072  lds
    s_add_u32 m0, s69, 106496
    s_add_u32 s31, s99, 4096
    buffer_load_dwordx4 v236, s[12:15], s31 offen offset:0  lds
    buffer_load_dwordx4 v237, s[12:15], s31 offen offset:1024  lds
    buffer_load_dwordx4 v238, s[12:15], s31 offen offset:2048  lds
    buffer_load_dwordx4 v239, s[12:15], s31 offen offset:3072  lds
    s_add_u32 s98, s66, 896
    s_add_u32 m0, s68, 16384
    s_add_u32 s31, s98, 0
    buffer_load_dwordx4 v232, s[4:7], s31 offen offset:0 lds
    buffer_load_dwordx4 v233, s[4:7], s31 offen offset:1024 lds
    buffer_load_dwordx4 v234, s[4:7], s31 offen offset:2048 lds
    buffer_load_dwordx4 v235, s[4:7], s31 offen offset:3072 lds
    s_add_u32 m0, s68, 20480
    s_add_u32 s31, s98, 65536
    buffer_load_dwordx4 v232, s[4:7], s31 offen offset:0 lds
    buffer_load_dwordx4 v233, s[4:7], s31 offen offset:1024 lds
    buffer_load_dwordx4 v234, s[4:7], s31 offen offset:2048 lds
    buffer_load_dwordx4 v235, s[4:7], s31 offen offset:3072 lds
    s_cmp_lt_u32 s73, s60
    s_cbranch_scc1 pfg_8
    s_cmp_ge_u32 s55, 2
    s_cbranch_scc1 pfx_9
    s_mov_b32 s73, s61
    s_mov_b32 s60, 7340032
    s_add_u32 s55, s55, 1
    s_cmp_eq_u32 s55, 2
    s_cbranch_scc1 pfw2_10
    s_mov_b32 s44, s56
    s_and_b32 s45, s57, 0xffff
    s_mov_b32 s46, 7340032
    s_mov_b32 s47, 0x20000
    s_branch pfg_8
pfw2_10:
    s_mov_b32 s44, s58
    s_and_b32 s45, s59, 0xffff
    s_mov_b32 s46, 7340032
    s_mov_b32 s47, 0x20000
pfg_8:
    s_buffer_load_dword s74, s[44:47], s73 offset:0
    s_buffer_load_dword s74, s[44:47], s73 offset:64
    s_buffer_load_dword s74, s[44:47], s73 offset:128
    s_buffer_load_dword s74, s[44:47], s73 offset:192
    s_add_u32 s73, s73, 262144
pfx_9:
    s_waitcnt vmcnt(20)
    s_barrier
    s_add_u32 s99, s67, 3145728
    s_add_u32 m0, s69, 65536
    s_add_u32 s31, s99, 0
    buffer_load_dwordx4 v236, s[12:15], s31 offen offset:0  lds
    buffer_load_dwordx4 v237, s[12:15], s31 offen offset:1024  lds
    buffer_load_dwordx4 v238, s[12:15], s31 offen offset:2048  lds
    buffer_load_dwordx4 v239, s[12:15], s31 offen offset:3072  lds
    s_add_u32 m0, s69, 90112
    s_add_u32 s31, s99, 2048
    buffer_load_dwordx4 v236, s[12:15], s31 offen offset:0  lds
    buffer_load_dwordx4 v237, s[12:15], s31 offen offset:1024  lds
    buffer_load_dwordx4 v238, s[12:15], s31 offen offset:2048  lds
    buffer_load_dwordx4 v239, s[12:15], s31 offen offset:3072  lds
    s_add_u32 m0, s69, 114688
    s_add_u32 s31, s99, 4096
    buffer_load_dwordx4 v236, s[12:15], s31 offen offset:0  lds
    buffer_load_dwordx4 v237, s[12:15], s31 offen offset:1024  lds
    buffer_load_dwordx4 v238, s[12:15], s31 offen offset:2048  lds
    buffer_load_dwordx4 v239, s[12:15], s31 offen offset:3072  lds
    s_add_u32 s98, s66, 1024
    s_add_u32 m0, s68, 32768
    s_add_u32 s31, s98, 0
    buffer_load_dwordx4 v232, s[4:7], s31 offen offset:0 lds
    buffer_load_dwordx4 v233, s[4:7], s31 offen offset:1024 lds
    buffer_load_dwordx4 v234, s[4:7], s31 offen offset:2048 lds
    buffer_load_dwordx4 v235, s[4:7], s31 offen offset:3072 lds
    s_add_u32 m0, s68, 36864
    s_add_u32 s31, s98, 65536
    buffer_load_dwordx4 v232, s[4:7], s31 offen offset:0 lds
    buffer_load_dwordx4 v233, s[4:7], s31 offen offset:1024 lds
    buffer_load_dwordx4 v234, s[4:7], s31 offen offset:2048 lds
    buffer_load_dwordx4 v235, s[4:7], s31 offen offset:3072 lds
    s_cmp_lt_u32 s73, s60
    s_cbranch_scc1 pfg_11
    s_cmp_ge_u32 s55, 2
    s_cbranch_scc1 pfx_12
    s_mov_b32 s73, s61
    s_mov_b32 s60, 7340032
    s_add_u32 s55, s55, 1
    s_cmp_eq_u32 s55, 2
    s_cbranch_scc1 pfw2_13
    s_mov_b32 s44, s56
    s_and_b32 s45, s57, 0xffff
    s_mov_b32 s46, 7340032
    s_mov_b32 s47, 0x20000
    s_branch pfg_11
pfw2_13:
    s_mov_b32 s44, s58
    s_and_b32 s45, s59, 0xffff
    s_mov_b32 s46, 7340032
    s_mov_b32 s47, 0x20000
pfg_11:
    s_buffer_load_dword s74, s[44:47], s73 offset:0
    s_buffer_load_dword s74, s[44:47], s73 offset:64
    s_buffer_load_dword s74, s[44:47], s73 offset:128
    s_buffer_load_dword s74, s[44:47], s73 offset:192
    s_add_u32 s73, s73, 262144
pfx_12:
    s_waitcnt vmcnt(20)
    s_barrier
    s_add_u32 s99, s67, 3538944
    s_add_u32 m0, s69, 49152
    s_add_u32 s31, s99, 0
    buffer_load_dwordx4 v236, s[12:15], s31 offen offset:0  lds
    buffer_load_dwordx4 v237, s[12:15], s31 offen offset:1024  lds
    buffer_load_dwordx4 v238, s[12:15], s31 offen offset:2048  lds
    buffer_load_dwordx4 v239, s[12:15], s31 offen offset:3072  lds
    s_add_u32 m0, s69, 73728
    s_add_u32 s31, s99, 2048
    buffer_load_dwordx4 v236, s[12:15], s31 offen offset:0  lds
    buffer_load_dwordx4 v237, s[12:15], s31 offen offset:1024  lds
    buffer_load_dwordx4 v238, s[12:15], s31 offen offset:2048  lds
    buffer_load_dwordx4 v239, s[12:15], s31 offen offset:3072  lds
    s_add_u32 m0, s69, 98304
    s_add_u32 s31, s99, 4096
    buffer_load_dwordx4 v236, s[12:15], s31 offen offset:0  lds
    buffer_load_dwordx4 v237, s[12:15], s31 offen offset:1024  lds
    buffer_load_dwordx4 v238, s[12:15], s31 offen offset:2048  lds
    buffer_load_dwordx4 v239, s[12:15], s31 offen offset:3072  lds
    s_add_u32 s98, s66, 1152
    s_add_u32 m0, s68, 0
    s_add_u32 s31, s98, 0
    buffer_load_dwordx4 v232, s[4:7], s31 offen offset:0 lds
    buffer_load_dwordx4 v233, s[4:7], s31 offen offset:1024 lds
    buffer_load_dwordx4 v234, s[4:7], s31 offen offset:2048 lds
    buffer_load_dwordx4 v235, s[4:7], s31 offen offset:3072 lds
    s_add_u32 m0, s68, 4096
    s_add_u32 s31, s98, 65536
    buffer_load_dwordx4 v232, s[4:7], s31 offen offset:0 lds
    buffer_load_dwordx4 v233, s[4:7], s31 offen offset:1024 lds
    buffer_load_dwordx4 v234, s[4:7], s31 offen offset:2048 lds
    buffer_load_dwordx4 v235, s[4:7], s31 offen offset:3072 lds
    s_cmp_lt_u32 s73, s60
    s_cbranch_scc1 pfg_14
    s_cmp_ge_u32 s55, 2
    s_cbranch_scc1 pfx_15
    s_mov_b32 s73, s61
    s_mov_b32 s60, 7340032
    s_add_u32 s55, s55, 1
    s_cmp_eq_u32 s55, 2
    s_cbranch_scc1 pfw2_16
    s_mov_b32 s44, s56
    s_and_b32 s45, s57, 0xffff
    s_mov_b32 s46, 7340032
    s_mov_b32 s47, 0x20000
    s_branch pfg_14
pfw2_16:
    s_mov_b32 s44, s58
    s_and_b32 s45, s59, 0xffff
    s_mov_b32 s46, 7340032
    s_mov_b32 s47, 0x20000
pfg_14:
    s_buffer_load_dword s74, s[44:47], s73 offset:0
    s_buffer_load_dword s74, s[44:47], s73 offset:64
    s_buffer_load_dword s74, s[44:47], s73 offset:128
    s_buffer_load_dword s74, s[44:47], s73 offset:192
    s_add_u32 s73, s73, 262144
pfx_15:
    s_waitcnt vmcnt(20)
    s_barrier
    s_add_u32 s99, s67, 3932160
    s_add_u32 m0, s69, 57344
    s_add_u32 s31, s99, 0
    buffer_load_dwordx4 v236, s[12:15], s31 offen offset:0  lds
    buffer_load_dwordx4 v237, s[12:15], s31 offen offset:1024  lds
    buffer_load_dwordx4 v238, s[12:15], s31 offen offset:2048  lds
    buffer_load_dwordx4 v239, s[12:15], s31 offen offset:3072  lds
    s_add_u32 m0, s69, 81920
    s_add_u32 s31, s99, 2048
    buffer_load_dwordx4 v236, s[12:15], s31 offen offset:0  lds
    buffer_load_dwordx4 v237, s[12:15], s31 offen offset:1024  lds
    buffer_load_dwordx4 v238, s[12:15], s31 offen offset:2048  lds
    buffer_load_dwordx4 v239, s[12:15], s31 offen offset:3072  lds
    s_add_u32 m0, s69, 106496
    s_add_u32 s31, s99, 4096
    buffer_load_dwordx4 v236, s[12:15], s31 offen offset:0  lds
    buffer_load_dwordx4 v237, s[12:15], s31 offen offset:1024  lds
    buffer_load_dwordx4 v238, s[12:15], s31 offen offset:2048  lds
    buffer_load_dwordx4 v239, s[12:15], s31 offen offset:3072  lds
    s_add_u32 s98, s66, 1280
    s_add_u32 m0, s68, 16384
    s_add_u32 s31, s98, 0
    buffer_load_dwordx4 v232, s[4:7], s31 offen offset:0 lds
    buffer_load_dwordx4 v233, s[4:7], s31 offen offset:1024 lds
    buffer_load_dwordx4 v234, s[4:7], s31 offen offset:2048 lds
    buffer_load_dwordx4 v235, s[4:7], s31 offen offset:3072 lds
    s_add_u32 m0, s68, 20480
    s_add_u32 s31, s98, 65536
    buffer_load_dwordx4 v232, s[4:7], s31 offen offset:0 lds
    buffer_load_dwordx4 v233, s[4:7], s31 offen offset:1024 lds
    buffer_load_dwordx4 v234, s[4:7], s31 offen offset:2048 lds
    buffer_load_dwordx4 v235, s[4:7], s31 offen offset:3072 lds
    s_cmp_lt_u32 s73, s60
    s_cbranch_scc1 pfg_17
    s_cmp_ge_u32 s55, 2
    s_cbranch_scc1 pfx_18
    s_mov_b32 s73, s61
    s_mov_b32 s60, 7340032
    s_add_u32 s55, s55, 1
    s_cmp_eq_u32 s55, 2
    s_cbranch_scc1 pfw2_19
    s_mov_b32 s44, s56
    s_and_b32 s45, s57, 0xffff
    s_mov_b32 s46, 7340032
    s_mov_b32 s47, 0x20000
    s_branch pfg_17
pfw2_19:
    s_mov_b32 s44, s58
    s_and_b32 s45, s59, 0xffff
    s_mov_b32 s46, 7340032
    s_mov_b32 s47, 0x20000
pfg_17:
    s_buffer_load_dword s74, s[44:47], s73 offset:0
    s_buffer_load_dword s74, s[44:47], s73 offset:64
    s_buffer_load_dword s74, s[44:47], s73 offset:128
    s_buffer_load_dword s74, s[44:47], s73 offset:192
    s_add_u32 s73, s73, 262144
pfx_18:
    s_waitcnt vmcnt(20)
    s_barrier
    s_add_u32 s99, s67, 4325376
    s_add_u32 m0, s69, 65536
    s_add_u32 s31, s99, 0
    buffer_load_dwordx4 v236, s[12:15], s31 offen offset:0  lds
    buffer_load_dwordx4 v237, s[12:15], s31 offen offset:1024  lds
    buffer_load_dwordx4 v238, s[12:15], s31 offen offset:2048  lds
    buffer_load_dwordx4 v239, s[12:15], s31 offen offset:3072  lds
    s_add_u32 m0, s69, 90112
    s_add_u32 s31, s99, 2048
    buffer_load_dwordx4 v236, s[12:15], s31 offen offset:0  lds
    buffer_load_dwordx4 v237, s[12:15], s31 offen offset:1024  lds
    buffer_load_dwordx4 v238, s[12:15], s31 offen offset:2048  lds
    buffer_load_dwordx4 v239, s[12:15], s31 offen offset:3072  lds
    s_add_u32 m0, s69, 114688
    s_add_u32 s31, s99, 4096
    buffer_load_dwordx4 v236, s[12:15], s31 offen offset:0  lds
    buffer_load_dwordx4 v237, s[12:15], s31 offen offset:1024  lds
    buffer_load_dwordx4 v238, s[12:15], s31 offen offset:2048  lds
    buffer_load_dwordx4 v239, s[12:15], s31 offen offset:3072  lds
    s_add_u32 s98, s66, 1408
    s_add_u32 m0, s68, 32768
    s_add_u32 s31, s98, 0
    buffer_load_dwordx4 v232, s[4:7], s31 offen offset:0 lds
    buffer_load_dwordx4 v233, s[4:7], s31 offen offset:1024 lds
    buffer_load_dwordx4 v234, s[4:7], s31 offen offset:2048 lds
    buffer_load_dwordx4 v235, s[4:7], s31 offen offset:3072 lds
    s_add_u32 m0, s68, 36864
    s_add_u32 s31, s98, 65536
    buffer_load_dwordx4 v232, s[4:7], s31 offen offset:0 lds
    buffer_load_dwordx4 v233, s[4:7], s31 offen offset:1024 lds
    buffer_load_dwordx4 v234, s[4:7], s31 offen offset:2048 lds
    buffer_load_dwordx4 v235, s[4:7], s31 offen offset:3072 lds
    s_cmp_lt_u32 s73, s60
    s_cbranch_scc1 pfg_20
    s_cmp_ge_u32 s55, 2
    s_cbranch_scc1 pfx_21
    s_mov_b32 s73, s61
    s_mov_b32 s60, 7340032
    s_add_u32 s55, s55, 1
    s_cmp_eq_u32 s55, 2
    s_cbranch_scc1 pfw2_22
    s_mov_b32 s44, s56
    s_and_b32 s45, s57, 0xffff
    s_mov_b32 s46, 7340032
    s_mov_b32 s47, 0x20000
    s_branch pfg_20
pfw2_22:
    s_mov_b32 s44, s58
    s_and_b32 s45, s59, 0xffff
    s_mov_b32 s46, 7340032
    s_mov_b32 s47, 0x20000
pfg_20:
    s_buffer_load_dword s74, s[44:47], s73 offset:0
    s_buffer_load_dword s74, s[44:47], s73 offset:64
    s_buffer_load_dword s74, s[44:47], s73 offset:128
    s_buffer_load_dword s74, s[44:47], s73 offset:192
    s_add_u32 s73, s73, 262144
pfx_21:
    s_waitcnt vmcnt(20)
    s_barrier
    s_add_u32 s99, s67, 4718592
    s_add_u32 m0, s69, 49152
    s_add_u32 s31, s99, 0
    buffer_load_dwordx4 v236, s[12:15], s31 offen offset:0  lds
    buffer_load_dwordx4 v237, s[12:15], s31 offen offset:1024  lds
    buffer_load_dwordx4 v238, s[12:15], s31 offen offset:2048  lds
    buffer_load_dwordx4 v239, s[12:15], s31 offen offset:3072  lds
    s_add_u32 m0, s69, 73728
    s_add_u32 s31, s99, 2048
    buffer_load_dwordx4 v236, s[12:15], s31 offen offset:0  lds
    buffer_load_dwordx4 v237, s[12:15], s31 offen offset:1024  lds
    buffer_load_dwordx4 v238, s[12:15], s31 offen offset:2048  lds
    buffer_load_dwordx4 v239, s[12:15], s31 offen offset:3072  lds
    s_add_u32 m0, s69, 98304
    s_add_u32 s31, s99, 4096
    buffer_load_dwordx4 v236, s[12:15], s31 offen offset:0  lds
    buffer_load_dwordx4 v237, s[12:15], s31 offen offset:1024  lds
    buffer_load_dwordx4 v238, s[12:15], s31 offen offset:2048  lds
    buffer_load_dwordx4 v239, s[12:15], s31 offen offset:3072  lds
    s_add_u32 s98, s66, 1536
    s_add_u32 m0, s68, 0
    s_add_u32 s31, s98, 0
    buffer_load_dwordx4 v232, s[4:7], s31 offen offset:0 lds
    buffer_load_dwordx4 v233, s[4:7], s31 offen offset:1024 lds
    buffer_load_dwordx4 v234, s[4:7], s31 offen offset:2048 lds
    buffer_load_dwordx4 v235, s[4:7], s31 offen offset:3072 lds
    s_add_u32 m0, s68, 4096
    s_add_u32 s31, s98, 65536
    buffer_load_dwordx4 v232, s[4:7], s31 offen offset:0 lds
    buffer_load_dwordx4 v233, s[4:7], s31 offen offset:1024 lds
    buffer_load_dwordx4 v234, s[4:7], s31 offen offset:2048 lds
    buffer_load_dwordx4 v235, s[4:7], s31 offen offset:3072 lds
    s_cmp_lt_u32 s73, s60
    s_cbranch_scc1 pfg_23
    s_cmp_ge_u32 s55, 2
    s_cbranch_scc1 pfx_24
    s_mov_b32 s73, s61
    s_mov_b32 s60, 7340032
    s_add_u32 s55, s55, 1
    s_cmp_eq_u32 s55, 2
    s_cbranch_scc1 pfw2_25
    s_mov_b32 s44, s56
    s_and_b32 s45, s57, 0xffff
    s_mov_b32 s46, 7340032
    s_mov_b32 s47, 0x20000
    s_branch pfg_23
pfw2_25:
    s_mov_b32 s44, s58
    s_and_b32 s45, s59, 0xffff
    s_mov_b32 s46, 7340032
    s_mov_b32 s47, 0x20000
pfg_23:
    s_buffer_load_dword s74, s[44:47], s73 offset:0
    s_buffer_load_dword s74, s[44:47], s73 offset:64
    s_buffer_load_dword s74, s[44:47], s73 offset:128
    s_buffer_load_dword s74, s[44:47], s73 offset:192
    s_add_u32 s73, s73, 262144
pfx_24:
    s_waitcnt vmcnt(20)
    s_barrier
    s_add_u32 s99, s67, 5111808
    s_add_u32 m0, s69, 57344
    s_add_u32 s31, s99, 0
    buffer_load_dwordx4 v236, s[12:15], s31 offen offset:0  lds
    buffer_load_dwordx4 v237, s[12:15], s31 offen offset:1024  lds
    buffer_load_dwordx4 v238, s[12:15], s31 offen offset:2048  lds
    buffer_load_dwordx4 v239, s[12:15], s31 offen offset:3072  lds
    s_add_u32 m0, s69, 81920
    s_add_u32 s31, s99, 2048
    buffer_load_dwordx4 v236, s[12:15], s31 offen offset:0  lds
    buffer_load_dwordx4 v237, s[12:15], s31 offen offset:1024  lds
    buffer_load_dwordx4 v238, s[12:15], s31 offen offset:2048  lds
    buffer_load_dwordx4 v239, s[12:15], s31 offen offset:3072  lds
    s_add_u32 m0, s69, 106496
    s_add_u32 s31, s99, 4096
    buffer_load_dwordx4 v236, s[12:15], s31 offen offset:0  lds
    buffer_load_dwordx4 v237, s[12:15], s31 offen offset:1024  lds
    buffer_load_dwordx4 v238, s[12:15], s31 offen offset:2048  lds
    buffer_load_dwordx4 v239, s[12:15], s31 offen offset:3072  lds
    s_add_u32 s98, s66, 1664
    s_add_u32 m0, s68, 16384
    s_add_u32 s31, s98, 0
    buffer_load_dwordx4 v232, s[4:7], s31 offen offset:0 lds
    buffer_load_dwordx4 v233, s[4:7], s31 offen offset:1024 lds
    buffer_load_dwordx4 v234, s[4:7], s31 offen offset:2048 lds
    buffer_load_dwordx4 v235, s[4:7], s31 offen offset:3072 lds
    s_add_u32 m0, s68, 20480
    s_add_u32 s31, s98, 65536
    buffer_load_dwordx4 v232, s[4:7], s31 offen offset:0 lds
    buffer_load_dwordx4 v233, s[4:7], s31 offen offset:1024 lds
    buffer_load_dwordx4 v234, s[4:7], s31 offen offset:2048 lds
    buffer_load_dwordx4 v235, s[4:7], s31 offen offset:3072 lds
    s_cmp_lt_u32 s73, s60
    s_cbranch_scc1 pfg_26
    s_cmp_ge_u32 s55, 2
    s_cbranch_scc1 pfx_27
    s_mov_b32 s73, s61
    s_mov_b32 s60, 7340032
    s_add_u32 s55, s55, 1
    s_cmp_eq_u32 s55, 2
    s_cbranch_scc1 pfw2_28
    s_mov_b32 s44, s56
    s_and_b32 s45, s57, 0xffff
    s_mov_b32 s46, 7340032
    s_mov_b32 s47, 0x20000
    s_branch pfg_26
pfw2_28:
    s_mov_b32 s44, s58
    s_and_b32 s45, s59, 0xffff
    s_mov_b32 s46, 7340032
    s_mov_b32 s47, 0x20000
pfg_26:
    s_buffer_load_dword s74, s[44:47], s73 offset:0
    s_buffer_load_dword s74, s[44:47], s73 offset:64
    s_buffer_load_dword s74, s[44:47], s73 offset:128
    s_buffer_load_dword s74, s[44:47], s73 offset:192
    s_add_u32 s73, s73, 262144
pfx_27:
    s_waitcnt vmcnt(20)
    s_barrier
    s_add_u32 s99, s67, 5505024
    s_add_u32 m0, s69, 65536
    s_add_u32 s31, s99, 0
    buffer_load_dwordx4 v236, s[12:15], s31 offen offset:0  lds
    buffer_load_dwordx4 v237, s[12:15], s31 offen offset:1024  lds
    buffer_load_dwordx4 v238, s[12:15], s31 offen offset:2048  lds
    buffer_load_dwordx4 v239, s[12:15], s31 offen offset:3072  lds
    s_add_u32 m0, s69, 90112
    s_add_u32 s31, s99, 2048
    buffer_load_dwordx4 v236, s[12:15], s31 offen offset:0  lds
    buffer_load_dwordx4 v237, s[12:15], s31 offen offset:1024  lds
    buffer_load_dwordx4 v238, s[12:15], s31 offen offset:2048  lds
    buffer_load_dwordx4 v239, s[12:15], s31 offen offset:3072  lds
    s_add_u32 m0, s69, 114688
    s_add_u32 s31, s99, 4096
    buffer_load_dwordx4 v236, s[12:15], s31 offen offset:0  lds
    buffer_load_dwordx4 v237, s[12:15], s31 offen offset:1024  lds
    buffer_load_dwordx4 v238, s[12:15], s31 offen offset:2048  lds
    buffer_load_dwordx4 v239, s[12:15], s31 offen offset:3072  lds
    s_add_u32 s98, s66, 1792
    s_add_u32 m0, s68, 32768
    s_add_u32 s31, s98, 0
    buffer_load_dwordx4 v232, s[4:7], s31 offen offset:0 lds
    buffer_load_dwordx4 v233, s[4:7], s31 offen offset:1024 lds
    buffer_load_dwordx4 v234, s[4:7], s31 offen offset:2048 lds
    buffer_load_dwordx4 v235, s[4:7], s31 offen offset:3072 lds
    s_add_u32 m0, s68, 36864
    s_add_u32 s31, s98, 65536
    buffer_load_dwordx4 v232, s[4:7], s31 offen offset:0 lds
    buffer_load_dwordx4 v233, s[4:7], s31 offen offset:1024 lds
    buffer_load_dwordx4 v234, s[4:7], s31 offen offset:2048 lds
    buffer_load_dwordx4 v235, s[4:7], s31 offen offset:3072 lds
    s_cmp_lt_u32 s73, s60
    s_cbranch_scc1 pfg_29
    s_cmp_ge_u32 s55, 2
    s_cbranch_scc1 pfx_30
    s_mov_b32 s73, s61
    s_mov_b32 s60, 7340032
    s_add_u32 s55, s55, 1
    s_cmp_eq_u32 s55, 2
    s_cbranch_scc1 pfw2_31
    s_mov_b32 s44, s56
    s_and_b32 s45, s57, 0xffff
    s_mov_b32 s46, 7340032
    s_mov_b32 s47, 0x20000
    s_branch pfg_29
pfw2_31:
    s_mov_b32 s44, s58
    s_and_b32 s45, s59, 0xffff
    s_mov_b32 s46, 7340032
    s_mov_b32 s47, 0x20000
pfg_29:
    s_buffer_load_dword s74, s[44:47], s73 offset:0
    s_buffer_load_dword s74, s[44:47], s73 offset:64
    s_buffer_load_dword s74, s[44:47], s73 offset:128
    s_buffer_load_dword s74, s[44:47], s73 offset:192
    s_add_u32 s73, s73, 262144
pfx_30:
    s_waitcnt vmcnt(20)
    s_barrier
    s_add_u32 s99, s67, 5898240
    s_add_u32 m0, s69, 49152
    s_add_u32 s31, s99, 0
    buffer_load_dwordx4 v236, s[12:15], s31 offen offset:0  lds
    buffer_load_dwordx4 v237, s[12:15], s31 offen offset:1024  lds
    buffer_load_dwordx4 v238, s[12:15], s31 offen offset:2048  lds
    buffer_load_dwordx4 v239, s[12:15], s31 offen offset:3072  lds
    s_add_u32 m0, s69, 73728
    s_add_u32 s31, s99, 2048
    buffer_load_dwordx4 v236, s[12:15], s31 offen offset:0  lds
    buffer_load_dwordx4 v237, s[12:15], s31 offen offset:1024  lds
    buffer_load_dwordx4 v238, s[12:15], s31 offen offset:2048  lds
    buffer_load_dwordx4 v239, s[12:15], s31 offen offset:3072  lds
    s_add_u32 m0, s69, 98304
    s_add_u32 s31, s99, 4096
    buffer_load_dwordx4 v236, s[12:15], s31 offen offset:0  lds
    buffer_load_dwordx4 v237, s[12:15], s31 offen offset:1024  lds
    buffer_load_dwordx4 v238, s[12:15], s31 offen offset:2048  lds
    buffer_load_dwordx4 v239, s[12:15], s31 offen offset:3072  lds
    s_add_u32 s98, s66, 1920
    s_add_u32 m0, s68, 0
    s_add_u32 s31, s98, 0
    buffer_load_dwordx4 v232, s[4:7], s31 offen offset:0 lds
    buffer_load_dwordx4 v233, s[4:7], s31 offen offset:1024 lds
    buffer_load_dwordx4 v234, s[4:7], s31 offen offset:2048 lds
    buffer_load_dwordx4 v235, s[4:7], s31 offen offset:3072 lds
    s_add_u32 m0, s68, 4096
    s_add_u32 s31, s98, 65536
    buffer_load_dwordx4 v232, s[4:7], s31 offen offset:0 lds
    buffer_load_dwordx4 v233, s[4:7], s31 offen offset:1024 lds
    buffer_load_dwordx4 v234, s[4:7], s31 offen offset:2048 lds
    buffer_load_dwordx4 v235, s[4:7], s31 offen offset:3072 lds
    s_cmp_lt_u32 s73, s60
    s_cbranch_scc1 pfg_32
    s_cmp_ge_u32 s55, 2
    s_cbranch_scc1 pfx_33
    s_mov_b32 s73, s61
    s_mov_b32 s60, 7340032
    s_add_u32 s55, s55, 1
    s_cmp_eq_u32 s55, 2
    s_cbranch_scc1 pfw2_34
    s_mov_b32 s44, s56
    s_and_b32 s45, s57, 0xffff
    s_mov_b32 s46, 7340032
    s_mov_b32 s47, 0x20000
    s_branch pfg_32
pfw2_34:
    s_mov_b32 s44, s58
    s_and_b32 s45, s59, 0xffff
    s_mov_b32 s46, 7340032
    s_mov_b32 s47, 0x20000
pfg_32:
    s_buffer_load_dword s74, s[44:47], s73 offset:0
    s_buffer_load_dword s74, s[44:47], s73 offset:64
    s_buffer_load_dword s74, s[44:47], s73 offset:128
    s_buffer_load_dword s74, s[44:47], s73 offset:192
    s_add_u32 s73, s73, 262144
pfx_33:
    s_waitcnt vmcnt(20)
    s_barrier
    s_waitcnt vmcnt(0)
    s_barrier
    s_barrier
    s_waitcnt lgkmcnt(0)
    s_branch L_att
L_h0:
    s_lshl_b32 s35, s24, 4
    s_add_u32 s35, s35, s25
    s_lshl_b32 s34, s35, 14
    v_lshrrev_b32 v6, 3, v1
    v_lshlrev_b32 v5, 11, v6
    v_and_b32 v7, 7, v1
    v_lshl_add_u32 v5, v7, 4, v5
    s_getreg_b32 s39, hwreg(HW_REG_XCC_ID)
    v_mov_b32 v84, 0x3f803f80
    v_mov_b64 v[80:81], 0
    v_mov_b64 v[82:83], 0
    buffer_load_dwordx4 v[16:19], v5, s[4:7], s34 offen offset:0
    buffer_load_dwordx4 v[20:23], v5, s[4:7], s34 offen offset:128
    buffer_load_dwordx4 v[24:27], v5, s[4:7], s34 offen offset:256
    buffer_load_dwordx4 v[28:31], v5, s[4:7], s34 offen offset:384
    buffer_load_dwordx4 v[32:35], v5, s[4:7], s34 offen offset:512
    buffer_load_dwordx4 v[36:39], v5, s[4:7], s34 offen offset:640
    s_barrier
    s_getpc_b64 s[42:43]
pc_40:
    s_sub_u32 s42, s42, pc_40-sequential_preLN__sliding_block__dense_activation_silu__prompt_kernel
    s_subb_u32 s43, s43, 0
    s_lshl_b32 s75, s23, 2
    s_add_u32 s75, s75, s21
    s_lshl_b32 s75, s75, 6
    s_load_dword s74, s[42:43], s75 offset:0
    s_load_dword s74, s[42:43], s75 offset:8192
    s_load_dword s74, s[42:43], s75 offset:16384
    s_load_dword s74, s[42:43], s75 offset:24576
    s_load_dword s74, s[42:43], s75 offset:32768
    s_load_dword s74, s[42:43], s75 offset:40960
    s_load_dword s74, s[42:43], s75 offset:49152
    s_load_dword s74, s[42:43], s75 offset:57344
    s_load_dword s74, s[42:43], s75 offset:65536
    s_load_dword s74, s[42:43], s75 offset:73728
    s_load_dword s74, s[42:43], s75 offset:81920
    buffer_load_dwordx4 v[40:43], v5, s[4:7], s34 offen offset:768
    buffer_load_dwordx4 v[44:47], v5, s[4:7], s34 offen offset:896
    buffer_load_dwordx4 v[48:51], v5, s[4:7], s34 offen offset:1024
    buffer_load_dwordx4 v[52:55], v5, s[4:7], s34 offen offset:1152
    v_lshlrev_b32 v2, 2, v1
    v_mov_b32 v8, 0
    s_lshl_b32 s32, s25, 4
    s_add_u32 s32, s32, s24
    s_mul_i32 s32, s32, 4
    s_lshl_b32 s32, s32, 2
    s_add_u32 s32, s32, 43909120
    s_mov_b64 exec, 15
    buffer_store_dword v8, v2, s[8:11], s32 offen sc1
    s_lshl_b32 s32, s24, 4
    s_add_u32 s32, s32, s25
    s_mul_i32 s32, s32, 32
    s_lshl_b32 s32, s32, 2
    s_add_u32 s32, s32, 44302336
    s_mov_b32 exec_lo, 0xff
    s_mov_b32 exec_hi, 0x0
    buffer_store_dword v8, v2, s[8:11], s32 offen sc1
    s_and_b32 s36, s22, 3
    s_lshl_b32 s36, s36, 2
    s_bfe_u32 s30, s23, 0x20001
    s_add_u32 s36, s36, s30
    s_lshr_b32 s37, s22, 2
    s_lshl_b32 s37, s37, 2
    s_lshr_b32 s30, s23, 3
    s_add_u32 s37, s37, s30
    s_lshl_b32 s37, s37, 1
    s_and_b32 s30, s23, 1
    s_add_u32 s37, s37, s30
    s_lshl_b32 s32, s36, 4
    s_add_u32 s32, s32, s37
    s_mul_i32 s32, s32, 32
    s_lshl_b32 s32, s32, 2
    s_add_u32 s32, s32, 44335104
    s_mov_b64 exec, 15
    buffer_store_dword v8, v2, s[8:11], s32 offen sc1
    s_and_b32 s36, s22, 1
    s_lshl_b32 s36, s36, 3
    s_and_b32 s30, s23, 6
    s_add_u32 s36, s36, s30
    s_and_b32 s37, s23, 1
    s_lshl_b32 s37, s37, 2
    s_lshr_b32 s30, s23, 3
    s_add_u32 s37, s37, s30
    s_lshr_b32 s38, s22, 1
    s_lshl_b32 s32, s36, 3
    s_add_u32 s32, s32, s37
    s_lshl_b32 s32, s32, 5
    s_add_u32 s32, s32, s38
    s_lshl_b32 s32, s32, 4
    s_add_u32 s32, s32, 44040192
    s_mov_b64 exec, 15
    v_lshlrev_b32 v9, 7, v1
    buffer_store_dword v8, v9, s[8:11], s32 offen sc1
    s_and_b32 s36, s22, 1
    s_lshl_b32 s36, s36, 3
    s_and_b32 s30, s23, 7
    s_add_u32 s36, s36, s30
    s_lshr_b32 s37, s22, 1
    s_lshl_b32 s37, s37, 2
    s_lshr_b32 s30, s23, 3
    s_add_u32 s37, s37, s30
    s_lshl_b32 s32, s36, 2
    s_lshr_b32 s30, s37, 2
    s_add_u32 s32, s32, s30
    s_lshl_b32 s32, s32, 3
    s_and_b32 s30, s37, 3
    s_add_u32 s32, s32, s30
    s_lshl_b32 s32, s32, 2
    s_lshl_b32 s32, s32, 2
    s_add_u32 s32, s32, 44171264
    s_mov_b64 exec, 15
    buffer_store_dword v8, v2, s[8:11], s32 offen sc1
    s_mov_b64 exec, -1
    v_mov_b32 v8, -1
    v_mov_b32 v9, -1
    v_mov_b32 v10, -1
    v_mov_b32 v11, -1
    v_lshlrev_b32 v7, 4, v1
    s_lshl_b32 s32, s35, 5
    s_add_u32 s32, s32, 43778048
    s_mov_b32 exec_lo, 0xff
    s_mov_b32 exec_hi, 0x0
    buffer_store_dword v8, v2, s[8:11], s32 offen sc1
    s_add_u32 s32, s32, 8192
    s_mov_b32 exec_lo, 0xff
    s_mov_b32 exec_hi, 0x0
    buffer_store_dword v8, v2, s[8:11], s32 offen sc1
    s_mul_i32 s32, s35, 768
    s_add_u32 s32, s32, 42991616
    s_mov_b32 exec_lo, 0xffffffff
    s_mov_b32 exec_hi, 0xffff
    buffer_store_dwordx4 v[8:11], v7, s[8:11], s32 offen sc1
    s_mul_i32 s32, s36, 28672
    s_mul_i32 s33, s37, 896
    s_add_u32 s32, s32, s33
    s_add_u32 s32, s32, 43253760
    s_mov_b32 exec_lo, 0xffffffff
    s_mov_b32 exec_hi, 0xffffff
    buffer_store_dwordx4 v[8:11], v7, s[8:11], s32 offen sc1
    s_add_u32 s32, s32, 14336
    s_mov_b32 exec_lo, 0xffffffff
    s_mov_b32 exec_hi, 0xffffff
    s_barrier
    buffer_store_dwordx4 v[8:11], v7, s[8:11], s32 offen sc1
    s_lshl_b32 s32, s36, 4
    s_add_u32 s32, s32, s37
    s_lshl_b32 s32, s32, 6
    s_add_u32 s32, s32, 44433408
    s_mov_b64 exec, 15
    buffer_store_dwordx4 v[8:11], v7, s[8:11], s32 offen sc1
    s_lshl_b32 s32, s37, 4
    s_add_u32 s32, s32, s36
    s_lshl_b32 s32, s32, 6
    s_add_u32 s32, s32, 44466176
    s_mov_b64 exec, 15
    buffer_store_dwordx4 v[8:11], v7, s[8:11], s32 offen sc1
    s_mov_b64 exec, -1
    s_waitcnt vmcnt(16)
    v_dot2_f32_bf16 v80, v16, v84, v80
    v_dot2_f32_bf16 v82, v16, v16, v82
    v_dot2_f32_bf16 v81, v17, v84, v81
    v_dot2_f32_bf16 v83, v17, v17, v83
    v_dot2_f32_bf16 v80, v18, v84, v80
    v_dot2_f32_bf16 v82, v18, v18, v82
    v_dot2_f32_bf16 v81, v19, v84, v81
    v_dot2_f32_bf16 v83, v19, v19, v83
    v_dot2_f32_bf16 v80, v20, v84, v80
    v_dot2_f32_bf16 v82, v20, v20, v82
    v_dot2_f32_bf16 v81, v21, v84, v81
    v_dot2_f32_bf16 v83, v21, v21, v83
    v_dot2_f32_bf16 v80, v22, v84, v80
    v_dot2_f32_bf16 v82, v22, v22, v82
    v_dot2_f32_bf16 v81, v23, v84, v81
    v_dot2_f32_bf16 v83, v23, v23, v83
    v_dot2_f32_bf16 v80, v24, v84, v80
    v_dot2_f32_bf16 v82, v24, v24, v82
    v_dot2_f32_bf16 v81, v25, v84, v81
    v_dot2_f32_bf16 v83, v25, v25, v83
    v_dot2_f32_bf16 v80, v26, v84, v80
    v_dot2_f32_bf16 v82, v26, v26, v82
    v_dot2_f32_bf16 v81, v27, v84, v81
    v_dot2_f32_bf16 v83, v27, v27, v83
    v_dot2_f32_bf16 v80, v28, v84, v80
    v_dot2_f32_bf16 v82, v28, v28, v82
    v_dot2_f32_bf16 v81, v29, v84, v81
    v_dot2_f32_bf16 v83, v29, v29, v83
    v_dot2_f32_bf16 v80, v30, v84, v80
    v_dot2_f32_bf16 v82, v30, v30, v82
    v_dot2_f32_bf16 v81, v31, v84, v81
    v_dot2_f32_bf16 v83, v31, v31, v83
    v_dot2_f32_bf16 v80, v32, v84, v80
    v_dot2_f32_bf16 v82, v32, v32, v82
    v_dot2_f32_bf16 v81, v33, v84, v81
    v_dot2_f32_bf16 v83, v33, v33, v83
    v_dot2_f32_bf16 v80, v34, v84, v80
    v_dot2_f32_bf16 v82, v34, v34, v82
    v_dot2_f32_bf16 v81, v35, v84, v81
    v_dot2_f32_bf16 v83, v35, v35, v83
    v_dot2_f32_bf16 v80, v36, v84, v80
    v_dot2_f32_bf16 v82, v36, v36, v82
    v_dot2_f32_bf16 v81, v37, v84, v81
    v_dot2_f32_bf16 v83, v37, v37, v83
    v_dot2_f32_bf16 v80, v38, v84, v80
    v_dot2_f32_bf16 v82, v38, v38, v82
    v_dot2_f32_bf16 v81, v39, v84, v81
    v_dot2_f32_bf16 v83, v39, v39, v83
    buffer_load_dwordx4 v[56:59], v5, s[4:7], s34 offen offset:1280
    buffer_load_dwordx4 v[60:63], v5, s[4:7], s34 offen offset:1408
    buffer_load_dwordx4 v[64:67], v5, s[4:7], s34 offen offset:1536
    buffer_load_dwordx4 v[68:71], v5, s[4:7], s34 offen offset:1664
    s_waitcnt vmcnt(16)
    v_dot2_f32_bf16 v80, v40, v84, v80
    v_dot2_f32_bf16 v82, v40, v40, v82
    v_dot2_f32_bf16 v81, v41, v84, v81
    v_dot2_f32_bf16 v83, v41, v41, v83
    v_dot2_f32_bf16 v80, v42, v84, v80
    v_dot2_f32_bf16 v82, v42, v42, v82
    v_dot2_f32_bf16 v81, v43, v84, v81
    v_dot2_f32_bf16 v83, v43, v43, v83
    v_dot2_f32_bf16 v80, v44, v84, v80
    v_dot2_f32_bf16 v82, v44, v44, v82
    v_dot2_f32_bf16 v81, v45, v84, v81
    v_dot2_f32_bf16 v83, v45, v45, v83
    v_dot2_f32_bf16 v80, v46, v84, v80
    v_dot2_f32_bf16 v82, v46, v46, v82
    v_dot2_f32_bf16 v81, v47, v84, v81
    v_dot2_f32_bf16 v83, v47, v47, v83
    v_dot2_f32_bf16 v80, v48, v84, v80
    v_dot2_f32_bf16 v82, v48, v48, v82
    v_dot2_f32_bf16 v81, v49, v84, v81
    v_dot2_f32_bf16 v83, v49, v49, v83
    v_dot2_f32_bf16 v80, v50, v84, v80
    v_dot2_f32_bf16 v82, v50, v50, v82
    v_dot2_f32_bf16 v81, v51, v84, v81
    v_dot2_f32_bf16 v83, v51, v51, v83
    v_dot2_f32_bf16 v80, v52, v84, v80
    v_dot2_f32_bf16 v82, v52, v52, v82
    v_dot2_f32_bf16 v81, v53, v84, v81
    v_dot2_f32_bf16 v83, v53, v53, v83
    v_dot2_f32_bf16 v80, v54, v84, v80
    v_dot2_f32_bf16 v82, v54, v54, v82
    s_barrier
    v_dot2_f32_bf16 v81, v55, v84, v81
    v_dot2_f32_bf16 v83, v55, v55, v83
    buffer_load_dwordx4 v[72:75], v5, s[4:7], s34 offen offset:1792
    buffer_load_dwordx4 v[76:79], v5, s[4:7], s34 offen offset:1920
    s_waitcnt vmcnt(2)
    v_dot2_f32_bf16 v80, v56, v84, v80
    v_dot2_f32_bf16 v82, v56, v56, v82
    v_dot2_f32_bf16 v81, v57, v84, v81
    v_dot2_f32_bf16 v83, v57, v57, v83
    v_dot2_f32_bf16 v80, v58, v84, v80
    v_dot2_f32_bf16 v82, v58, v58, v82
    v_dot2_f32_bf16 v81, v59, v84, v81
    v_dot2_f32_bf16 v83, v59, v59, v83
    v_dot2_f32_bf16 v80, v60, v84, v80
    v_dot2_f32_bf16 v82, v60, v60, v82
    v_dot2_f32_bf16 v81, v61, v84, v81
    v_dot2_f32_bf16 v83, v61, v61, v83
    v_dot2_f32_bf16 v80, v62, v84, v80
    v_dot2_f32_bf16 v82, v62, v62, v82
    v_dot2_f32_bf16 v81, v63, v84, v81
    v_dot2_f32_bf16 v83, v63, v63, v83
    v_dot2_f32_bf16 v80, v64, v84, v80
    v_dot2_f32_bf16 v82, v64, v64, v82
    v_dot2_f32_bf16 v81, v65, v84, v81
    v_dot2_f32_bf16 v83, v65, v65, v83
    v_dot2_f32_bf16 v80, v66, v84, v80
    v_dot2_f32_bf16 v82, v66, v66, v82
    v_dot2_f32_bf16 v81, v67, v84, v81
    v_dot2_f32_bf16 v83, v67, v67, v83
    v_dot2_f32_bf16 v80, v68, v84, v80
    v_dot2_f32_bf16 v82, v68, v68, v82
    v_dot2_f32_bf16 v81, v69, v84, v81
    v_dot2_f32_bf16 v83, v69, v69, v83
    v_dot2_f32_bf16 v80, v70, v84, v80
    v_dot2_f32_bf16 v82, v70, v70, v82
    v_dot2_f32_bf16 v81, v71, v84, v81
    v_dot2_f32_bf16 v83, v71, v71, v83
    s_barrier
    s_cmp_lt_u32 s73, s60
    s_cbranch_scc1 pfg_41
    s_cmp_ge_u32 s55, 2
    s_cbranch_scc1 pfx_42
    s_mov_b32 s73, s61
    s_mov_b32 s60, 7340032
    s_add_u32 s55, s55, 1
    s_cmp_eq_u32 s55, 2
    s_cbranch_scc1 pfw2_43
    s_mov_b32 s44, s56
    s_and_b32 s45, s57, 0xffff
    s_mov_b32 s46, 7340032
    s_mov_b32 s47, 0x20000
    s_branch pfg_41
pfw2_43:
    s_mov_b32 s44, s58
    s_and_b32 s45, s59, 0xffff
    s_mov_b32 s46, 7340032
    s_mov_b32 s47, 0x20000
pfg_41:
    s_buffer_load_dword s74, s[44:47], s73 offset:0
    s_buffer_load_dword s74, s[44:47], s73 offset:64
    s_buffer_load_dword s74, s[44:47], s73 offset:128
    s_buffer_load_dword s74, s[44:47], s73 offset:192
    s_add_u32 s73, s73, 262144
pfx_42:
    s_waitcnt vmcnt(0)
    v_dot2_f32_bf16 v80, v72, v84, v80
    v_dot2_f32_bf16 v82, v72, v72, v82
    v_dot2_f32_bf16 v81, v73, v84, v81
    v_dot2_f32_bf16 v83, v73, v73, v83
    v_dot2_f32_bf16 v80, v74, v84, v80
    v_dot2_f32_bf16 v82, v74, v74, v82
    v_dot2_f32_bf16 v81, v75, v84, v81
    v_dot2_f32_bf16 v83, v75, v75, v83
    v_dot2_f32_bf16 v80, v76, v84, v80
    v_dot2_f32_bf16 v82, v76, v76, v82
    v_dot2_f32_bf16 v81, v77, v84, v81
    v_dot2_f32_bf16 v83, v77, v77, v83
    v_dot2_f32_bf16 v80, v78, v84, v80
    v_dot2_f32_bf16 v82, v78, v78, v82
    v_dot2_f32_bf16 v81, v79, v84, v81
    v_dot2_f32_bf16 v83, v79, v79, v83
    s_and_b32 s39, s39, 15
    s_or_b32 s39, s39, 0x80
    s_lshl_b32 s30, s22, 5
    s_add_u32 s30, s30, s23
    v_mov_b32 v8, s39
    v_mov_b32 v2, s30
    s_mov_b64 exec, 1
    buffer_store_byte v8, v2, s[16:19], 0 offen sc1
    s_mov_b64 exec, -1
    v_add_f32 v10, v80, v81
    v_add_f32 v11, v82, v83
    s_nop 0
    v_add_f32_dpp v10, v10, v10 quad_perm:[1,0,3,2] row_mask:0xf bank_mask:0xf
    s_nop 1
    v_add_f32_dpp v10, v10, v10 quad_perm:[2,3,0,1] row_mask:0xf bank_mask:0xf
    s_nop 1
    v_add_f32_dpp v10, v10, v10 row_half_mirror row_mask:0xf bank_mask:0xf
    v_add_f32_dpp v11, v11, v11 quad_perm:[1,0,3,2] row_mask:0xf bank_mask:0xf
    s_nop 1
    v_add_f32_dpp v11, v11, v11 quad_perm:[2,3,0,1] row_mask:0xf bank_mask:0xf
    s_nop 1
    v_add_f32_dpp v11, v11, v11 row_half_mirror row_mask:0xf bank_mask:0xf
    v_mul_f32 v12, 0xba800000, v10
    v_fma_f32 v11, v12, v10, v11
    v_max_f32 v11, 0, v11
    v_mul_f32 v10, 0x3a800000, v10
    v_cvt_pk_bf16_f32 v10, v10, v10
    v_and_b32 v10, 0xffff0000, v10
    v_mul_f32 v11, 0x3a800000, v11
    v_cvt_pk_bf16_f32 v11, v11, v11
    v_and_b32 v11, 0xffff0000, v11
    v_add_f32 v11, 0x3727c5ac, v11
    v_cvt_pk_bf16_f32 v11, v11, v11
    v_and_b32 v11, 0xffff0000, v11
    v_sqrt_f32 v11, v11
    s_nop 0
    v_cvt_pk_bf16_f32 v11, v11, v11
    v_and_b32 v11, 0xffff0000, v11
    v_rcp_f32 v11, v11
    s_nop 0
    v_mul_f32 v10, v10, v11
    v_sub_f32 v10, 0, v10
    v_lshrrev_b32 v7, 3, v1
    v_lshlrev_b32 v7, 2, v7
    s_lshl_b32 s32, s35, 5
    s_add_u32 s32, s32, 43778048
    s_add_u32 s33, s32, 8192
    s_mov_b32 exec_lo, 0x1010101
    s_mov_b32 exec_hi, 0x1010101
    buffer_store_dword v11, v7, s[8:11], s32 offen sc1
    buffer_store_dword v10, v7, s[8:11], s33 offen sc1
    s_mov_b64 exec, -1
    s_barrier
    s_cmp_lt_u32 s73, s60
    s_cbranch_scc1 pfg_44
    s_cmp_ge_u32 s55, 2
    s_cbranch_scc1 pfx_45
    s_mov_b32 s73, s61
    s_mov_b32 s60, 7340032
    s_add_u32 s55, s55, 1
    s_cmp_eq_u32 s55, 2
    s_cbranch_scc1 pfw2_46
    s_mov_b32 s44, s56
    s_and_b32 s45, s57, 0xffff
    s_mov_b32 s46, 7340032
    s_mov_b32 s47, 0x20000
    s_branch pfg_44
pfw2_46:
    s_mov_b32 s44, s58
    s_and_b32 s45, s59, 0xffff
    s_mov_b32 s46, 7340032
    s_mov_b32 s47, 0x20000
pfg_44:
    s_buffer_load_dword s74, s[44:47], s73 offset:0
    s_buffer_load_dword s74, s[44:47], s73 offset:64
    s_buffer_load_dword s74, s[44:47], s73 offset:128
    s_buffer_load_dword s74, s[44:47], s73 offset:192
    s_add_u32 s73, s73, 262144
pfx_45:
    s_barrier
    s_cmp_lt_u32 s73, s60
    s_cbranch_scc1 pfg_47
    s_cmp_ge_u32 s55, 2
    s_cbranch_scc1 pfx_48
    s_mov_b32 s73, s61
    s_mov_b32 s60, 7340032
    s_add_u32 s55, s55, 1
    s_cmp_eq_u32 s55, 2
    s_cbranch_scc1 pfw2_49
    s_mov_b32 s44, s56
    s_and_b32 s45, s57, 0xffff
    s_mov_b32 s46, 7340032
    s_mov_b32 s47, 0x20000
    s_branch pfg_47
pfw2_49:
    s_mov_b32 s44, s58
    s_and_b32 s45, s59, 0xffff
    s_mov_b32 s46, 7340032
    s_mov_b32 s47, 0x20000
pfg_47:
    s_buffer_load_dword s74, s[44:47], s73 offset:0
    s_buffer_load_dword s74, s[44:47], s73 offset:64
    s_buffer_load_dword s74, s[44:47], s73 offset:128
    s_buffer_load_dword s74, s[44:47], s73 offset:192
    s_add_u32 s73, s73, 262144
pfx_48:
    s_barrier
    s_cmp_lt_u32 s73, s60
    s_cbranch_scc1 pfg_50
    s_cmp_ge_u32 s55, 2
    s_cbranch_scc1 pfx_51
    s_mov_b32 s73, s61
    s_mov_b32 s60, 7340032
    s_add_u32 s55, s55, 1
    s_cmp_eq_u32 s55, 2
    s_cbranch_scc1 pfw2_52
    s_mov_b32 s44, s56
    s_and_b32 s45, s57, 0xffff
    s_mov_b32 s46, 7340032
    s_mov_b32 s47, 0x20000
    s_branch pfg_50
pfw2_52:
    s_mov_b32 s44, s58
    s_and_b32 s45, s59, 0xffff
    s_mov_b32 s46, 7340032
    s_mov_b32 s47, 0x20000
pfg_50:
    s_buffer_load_dword s74, s[44:47], s73 offset:0
    s_buffer_load_dword s74, s[44:47], s73 offset:64
    s_buffer_load_dword s74, s[44:47], s73 offset:128
    s_buffer_load_dword s74, s[44:47], s73 offset:192
    s_add_u32 s73, s73, 262144
pfx_51:
    s_barrier
    s_cmp_lt_u32 s73, s60
    s_cbranch_scc1 pfg_53
    s_cmp_ge_u32 s55, 2
    s_cbranch_scc1 pfx_54
    s_mov_b32 s73, s61
    s_mov_b32 s60, 7340032
    s_add_u32 s55, s55, 1
    s_cmp_eq_u32 s55, 2
    s_cbranch_scc1 pfw2_55
    s_mov_b32 s44, s56
    s_and_b32 s45, s57, 0xffff
    s_mov_b32 s46, 7340032
    s_mov_b32 s47, 0x20000
    s_branch pfg_53
pfw2_55:
    s_mov_b32 s44, s58
    s_and_b32 s45, s59, 0xffff
    s_mov_b32 s46, 7340032
    s_mov_b32 s47, 0x20000
pfg_53:
    s_buffer_load_dword s74, s[44:47], s73 offset:0
    s_buffer_load_dword s74, s[44:47], s73 offset:64
    s_buffer_load_dword s74, s[44:47], s73 offset:128
    s_buffer_load_dword s74, s[44:47], s73 offset:192
    s_add_u32 s73, s73, 262144
pfx_54:
    s_barrier
    s_cmp_lt_u32 s73, s60
    s_cbranch_scc1 pfg_56
    s_cmp_ge_u32 s55, 2
    s_cbranch_scc1 pfx_57
    s_mov_b32 s73, s61
    s_mov_b32 s60, 7340032
    s_add_u32 s55, s55, 1
    s_cmp_eq_u32 s55, 2
    s_cbranch_scc1 pfw2_58
    s_mov_b32 s44, s56
    s_and_b32 s45, s57, 0xffff
    s_mov_b32 s46, 7340032
    s_mov_b32 s47, 0x20000
    s_branch pfg_56
pfw2_58:
    s_mov_b32 s44, s58
    s_and_b32 s45, s59, 0xffff
    s_mov_b32 s46, 7340032
    s_mov_b32 s47, 0x20000
pfg_56:
    s_buffer_load_dword s74, s[44:47], s73 offset:0
    s_buffer_load_dword s74, s[44:47], s73 offset:64
    s_buffer_load_dword s74, s[44:47], s73 offset:128
    s_buffer_load_dword s74, s[44:47], s73 offset:192
    s_add_u32 s73, s73, 262144
pfx_57:
    s_barrier
    s_cmp_lt_u32 s73, s60
    s_cbranch_scc1 pfg_59
    s_cmp_ge_u32 s55, 2
    s_cbranch_scc1 pfx_60
    s_mov_b32 s73, s61
    s_mov_b32 s60, 7340032
    s_add_u32 s55, s55, 1
    s_cmp_eq_u32 s55, 2
    s_cbranch_scc1 pfw2_61
    s_mov_b32 s44, s56
    s_and_b32 s45, s57, 0xffff
    s_mov_b32 s46, 7340032
    s_mov_b32 s47, 0x20000
    s_branch pfg_59
pfw2_61:
    s_mov_b32 s44, s58
    s_and_b32 s45, s59, 0xffff
    s_mov_b32 s46, 7340032
    s_mov_b32 s47, 0x20000
pfg_59:
    s_buffer_load_dword s74, s[44:47], s73 offset:0
    s_buffer_load_dword s74, s[44:47], s73 offset:64
    s_buffer_load_dword s74, s[44:47], s73 offset:128
    s_buffer_load_dword s74, s[44:47], s73 offset:192
    s_add_u32 s73, s73, 262144
pfx_60:
    s_barrier
    s_cmp_lt_u32 s73, s60
    s_cbranch_scc1 pfg_62
    s_cmp_ge_u32 s55, 2
    s_cbranch_scc1 pfx_63
    s_mov_b32 s73, s61
    s_mov_b32 s60, 7340032
    s_add_u32 s55, s55, 1
    s_cmp_eq_u32 s55, 2
    s_cbranch_scc1 pfw2_64
    s_mov_b32 s44, s56
    s_and_b32 s45, s57, 0xffff
    s_mov_b32 s46, 7340032
    s_mov_b32 s47, 0x20000
    s_branch pfg_62
pfw2_64:
    s_mov_b32 s44, s58
    s_and_b32 s45, s59, 0xffff
    s_mov_b32 s46, 7340032
    s_mov_b32 s47, 0x20000
pfg_62:
    s_buffer_load_dword s74, s[44:47], s73 offset:0
    s_buffer_load_dword s74, s[44:47], s73 offset:64
    s_buffer_load_dword s74, s[44:47], s73 offset:128
    s_buffer_load_dword s74, s[44:47], s73 offset:192
    s_add_u32 s73, s73, 262144
pfx_63:
    v_lshlrev_b32 v12, 2, v1
    buffer_load_dword v13, v12, s[16:19], 0 offen sc1
    s_barrier
    s_cmp_lt_u32 s73, s60
    s_cbranch_scc1 pfg_65
    s_cmp_ge_u32 s55, 2
    s_cbranch_scc1 pfx_66
    s_mov_b32 s73, s61
    s_mov_b32 s60, 7340032
    s_add_u32 s55, s55, 1
    s_cmp_eq_u32 s55, 2
    s_cbranch_scc1 pfw2_67
    s_mov_b32 s44, s56
    s_and_b32 s45, s57, 0xffff
    s_mov_b32 s46, 7340032
    s_mov_b32 s47, 0x20000
    s_branch pfg_65
pfw2_67:
    s_mov_b32 s44, s58
    s_and_b32 s45, s59, 0xffff
    s_mov_b32 s46, 7340032
    s_mov_b32 s47, 0x20000
pfg_65:
    s_buffer_load_dword s74, s[44:47], s73 offset:0
    s_buffer_load_dword s74, s[44:47], s73 offset:64
    s_buffer_load_dword s74, s[44:47], s73 offset:128
    s_buffer_load_dword s74, s[44:47], s73 offset:192
    s_add_u32 s73, s73, 262144
pfx_66:
    s_barrier
    s_cmp_lt_u32 s73, s60
    s_cbranch_scc1 pfg_68
    s_cmp_ge_u32 s55, 2
    s_cbranch_scc1 pfx_69
    s_mov_b32 s73, s61
    s_mov_b32 s60, 7340032
    s_add_u32 s55, s55, 1
    s_cmp_eq_u32 s55, 2
    s_cbranch_scc1 pfw2_70
    s_mov_b32 s44, s56
    s_and_b32 s45, s57, 0xffff
    s_mov_b32 s46, 7340032
    s_mov_b32 s47, 0x20000
    s_branch pfg_68
pfw2_70:
    s_mov_b32 s44, s58
    s_and_b32 s45, s59, 0xffff
    s_mov_b32 s46, 7340032
    s_mov_b32 s47, 0x20000
pfg_68:
    s_buffer_load_dword s74, s[44:47], s73 offset:0
    s_buffer_load_dword s74, s[44:47], s73 offset:64
    s_buffer_load_dword s74, s[44:47], s73 offset:128
    s_buffer_load_dword s74, s[44:47], s73 offset:192
    s_add_u32 s73, s73, 262144
pfx_69:
    s_waitcnt vmcnt(0)
    v_and_b32 v8, 0x80808080, v13
    v_cmp_ne_u32 vcc, 0x80808080, v8
    s_cbranch_vccz hsx_35
    v_lshlrev_b32 v10, 2, v1
    s_mov_b32 s72, 0
poll_36:
    buffer_load_dword v8, v10, s[16:19], 0 offen sc1
    s_add_u32 s72, s72, 1
    s_cmp_gt_u32 s72, 524288
    s_waitcnt vmcnt(0)
    s_cbranch_scc1 pollx_37
    v_and_b32 v8, 0x80808080, v8
    v_cmp_ne_u32 vcc, 0x80808080, v8
    s_cbranch_vccz pollx_37
    s_sleep 16
    s_branch poll_36
pollx_37:
    s_mov_b64 exec, -1
    buffer_load_dword v13, v12, s[16:19], 0 offen sc1
    s_waitcnt vmcnt(0)
hsx_35:
    s_mul_i32 s31, s39, 0x01010101
    v_cmp_ne_u32 vcc, s31, v13
    s_lshl_b32 s30, s22, 3
    s_lshr_b64 s[32:33], vcc, s30
    s_and_b32 s30, s32, 0xff
    v_mov_b32 v8, s30
    v_mov_b32 v7, 161792
    s_mov_b64 exec, 1
    ds_write_b32 v7, v8
    s_mov_b64 exec, -1
    s_barrier
    s_cmp_lt_u32 s73, s60
    s_cbranch_scc1 pfg_71
    s_cmp_ge_u32 s55, 2
    s_cbranch_scc1 pfx_72
    s_mov_b32 s73, s61
    s_mov_b32 s60, 7340032
    s_add_u32 s55, s55, 1
    s_cmp_eq_u32 s55, 2
    s_cbranch_scc1 pfw2_73
    s_mov_b32 s44, s56
    s_and_b32 s45, s57, 0xffff
    s_mov_b32 s46, 7340032
    s_mov_b32 s47, 0x20000
    s_branch pfg_71
pfw2_73:
    s_mov_b32 s44, s58
    s_and_b32 s45, s59, 0xffff
    s_mov_b32 s46, 7340032
    s_mov_b32 s47, 0x20000
pfg_71:
    s_buffer_load_dword s74, s[44:47], s73 offset:0
    s_buffer_load_dword s74, s[44:47], s73 offset:64
    s_buffer_load_dword s74, s[44:47], s73 offset:128
    s_buffer_load_dword s74, s[44:47], s73 offset:192
    s_add_u32 s73, s73, 262144
pfx_72:
    v_and_b32 v6, 31, v1
    v_lshlrev_b32 v6, 4, v6
    v_lshrrev_b32 v7, 5, v1
    v_lshl_add_u32 v6, v7, 13, v6
    s_lshl_b32 s34, s24, 9
    s_add_u32 s34, s34, 43778048
    buffer_load_dwordx4 v[16:19], v6, s[8:11], s34 offen sc1
    s_barrier
    s_barrier
    s_mov_b64 exec, -1
    s_mov_b32 s72, 0
rt_38:
    s_waitcnt vmcnt(0)
    v_max_u32 v8, v16, v17
    v_max3_u32 v8, v18, v19, v8
    v_cmp_eq_u32 vcc, -1, v8
    s_cbranch_vccz rtx_39
    s_add_u32 s72, s72, 1
    s_cmp_gt_u32 s72, 524288
    s_cbranch_scc1 rtx_39
    s_sleep 8
    buffer_load_dwordx4 v[16:19], v6, s[8:11], s34 offen sc1
    s_branch rt_38
rtx_39:
    v_lshlrev_b32 v6, 4, v1
    v_add_u32 v6, 157696, v6
    ds_write_b128 v6, v[16:19]
    s_waitcnt lgkmcnt(0)
    s_barrier
    s_waitcnt lgkmcnt(0)
    s_branch L_att
L_h1:
    s_lshl_b32 s35, s24, 4
    s_add_u32 s35, s35, s25
    v_bfe_u32 v6, v1, 3, 2
    v_lshrrev_b32 v7, 5, v1
    v_lshl_add_u32 v6, v7, 6, v6
    v_and_b32 v7, 7, v1
    v_mul_u32_u24 v6, 6144, v6
    v_lshl_add_u32 v6, v7, 4, v6
    s_mul_i32 s32, s24, 24576
    s_lshl_b32 s33, s25, 7
    s_add_u32 s32, s32, s33
    v_mov_b32 v10, 0x00003f80
    v_mov_b32 v11, 0x3f800000
    v_mov_b64 v[200:201], 0
    v_mov_b64 v[202:203], 0
    v_mov_b64 v[204:205], 0
    v_mov_b64 v[206:207], 0
    v_mov_b64 v[208:209], 0
    v_mov_b64 v[210:211], 0
    v_mov_b64 v[212:213], 0
    v_mov_b64 v[214:215], 0
    v_mov_b64 v[216:217], 0
    v_mov_b64 v[218:219], 0
    v_mov_b64 v[220:221], 0
    v_mov_b64 v[222:223], 0
    s_add_u32 s31, s32, 0
    buffer_load_dwordx4 v[80:83], v6, s[12:15], s31 offen
    s_add_u32 s31, s32, 2048
    buffer_load_dwordx4 v[112:115], v6, s[12:15], s31 offen
    s_add_u32 s31, s32, 4096
    buffer_load_dwordx4 v[144:147], v6, s[12:15], s31 offen
    s_add_u32 s31, s32, 786432
    buffer_load_dwordx4 v[84:87], v6, s[12:15], s31 offen
    s_add_u32 s31, s32, 788480
    buffer_load_dwordx4 v[116:119], v6, s[12:15], s31 offen
    s_add_u32 s31, s32, 790528
    buffer_load_dwordx4 v[148:151], v6, s[12:15], s31 offen
    s_add_u32 s31, s32, 1572864
    buffer_load_dwordx4 v[88:91], v6, s[12:15], s31 offen
    s_add_u32 s31, s32, 1574912
    buffer_load_dwordx4 v[120:123], v6, s[12:15], s31 offen
    s_add_u32 s31, s32, 1576960
    buffer_load_dwordx4 v[152:155], v6, s[12:15], s31 offen
    s_barrier
    s_getpc_b64 s[42:43]
pc_76:
    s_sub_u32 s42, s42, pc_76-sequential_preLN__sliding_block__dense_activation_silu__prompt_kernel
    s_subb_u32 s43, s43, 0
    s_lshl_b32 s75, s23, 2
    s_add_u32 s75, s75, s21
    s_lshl_b32 s75, s75, 6
    s_load_dword s74, s[42:43], s75 offset:0
    s_load_dword s74, s[42:43], s75 offset:8192
    s_load_dword s74, s[42:43], s75 offset:16384
    s_load_dword s74, s[42:43], s75 offset:24576
    s_load_dword s74, s[42:43], s75 offset:32768
    s_load_dword s74, s[42:43], s75 offset:40960
    s_load_dword s74, s[42:43], s75 offset:49152
    s_load_dword s74, s[42:43], s75 offset:57344
    s_load_dword s74, s[42:43], s75 offset:65536
    s_load_dword s74, s[42:43], s75 offset:73728
    s_load_dword s74, s[42:43], s75 offset:81920
    s_add_u32 s31, s32, 2359296
    buffer_load_dwordx4 v[92:95], v6, s[12:15], s31 offen
    s_add_u32 s31, s32, 2361344
    buffer_load_dwordx4 v[124:127], v6, s[12:15], s31 offen
    s_add_u32 s31, s32, 2363392
    buffer_load_dwordx4 v[156:159], v6, s[12:15], s31 offen
    s_add_u32 s31, s32, 3145728
    buffer_load_dwordx4 v[96:99], v6, s[12:15], s31 offen
    s_add_u32 s31, s32, 3147776
    buffer_load_dwordx4 v[128:131], v6, s[12:15], s31 offen
    s_add_u32 s31, s32, 3149824
    buffer_load_dwordx4 v[160:163], v6, s[12:15], s31 offen
    s_waitcnt vmcnt(6)
    v_dot2_f32_bf16 v200, v80, v10, v200
    v_dot2_f32_bf16 v201, v80, v11, v201
    v_dot2_f32_bf16 v202, v81, v10, v202
    v_dot2_f32_bf16 v203, v81, v11, v203
    v_dot2_f32_bf16 v204, v82, v10, v204
    v_dot2_f32_bf16 v205, v82, v11, v205
    v_dot2_f32_bf16 v206, v83, v10, v206
    v_dot2_f32_bf16 v207, v83, v11, v207
    v_dot2_f32_bf16 v208, v112, v10, v208
    v_dot2_f32_bf16 v209, v112, v11, v209
    v_dot2_f32_bf16 v210, v113, v10, v210
    v_dot2_f32_bf16 v211, v113, v11, v211
    v_dot2_f32_bf16 v212, v114, v10, v212
    v_dot2_f32_bf16 v213, v114, v11, v213
    v_dot2_f32_bf16 v214, v115, v10, v214
    v_dot2_f32_bf16 v215, v115, v11, v215
    v_dot2_f32_bf16 v216, v144, v10, v216
    v_dot2_f32_bf16 v217, v144, v11, v217
    v_dot2_f32_bf16 v218, v145, v10, v218
    v_dot2_f32_bf16 v219, v145, v11, v219
    v_dot2_f32_bf16 v220, v146, v10, v220
    v_dot2_f32_bf16 v221, v146, v11, v221
    v_dot2_f32_bf16 v222, v147, v10, v222
    v_dot2_f32_bf16 v223, v147, v11, v223
    v_dot2_f32_bf16 v200, v84, v10, v200
    v_dot2_f32_bf16 v201, v84, v11, v201
    v_dot2_f32_bf16 v202, v85, v10, v202
    v_dot2_f32_bf16 v203, v85, v11, v203
    v_dot2_f32_bf16 v204, v86, v10, v204
    v_dot2_f32_bf16 v205, v86, v11, v205
    v_dot2_f32_bf16 v206, v87, v10, v206
    v_dot2_f32_bf16 v207, v87, v11, v207
    v_dot2_f32_bf16 v208, v116, v10, v208
    v_dot2_f32_bf16 v209, v116, v11, v209
    v_dot2_f32_bf16 v210, v117, v10, v210
    v_dot2_f32_bf16 v211, v117, v11, v211
    v_dot2_f32_bf16 v212, v118, v10, v212
    v_dot2_f32_bf16 v213, v118, v11, v213
    v_dot2_f32_bf16 v214, v119, v10, v214
    v_dot2_f32_bf16 v215, v119, v11, v215
    v_dot2_f32_bf16 v216, v148, v10, v216
    v_dot2_f32_bf16 v217, v148, v11, v217
    v_dot2_f32_bf16 v218, v149, v10, v218
    v_dot2_f32_bf16 v219, v149, v11, v219
    v_dot2_f32_bf16 v220, v150, v10, v220
    v_dot2_f32_bf16 v221, v150, v11, v221
    v_dot2_f32_bf16 v222, v151, v10, v222
    v_dot2_f32_bf16 v223, v151, v11, v223
    v_dot2_f32_bf16 v200, v88, v10, v200
    v_dot2_f32_bf16 v201, v88, v11, v201
    v_dot2_f32_bf16 v202, v89, v10, v202
    v_dot2_f32_bf16 v203, v89, v11, v203
    v_dot2_f32_bf16 v204, v90, v10, v204
    v_dot2_f32_bf16 v205, v90, v11, v205
    v_dot2_f32_bf16 v206, v91, v10, v206
    v_dot2_f32_bf16 v207, v91, v11, v207
    v_dot2_f32_bf16 v208, v120, v10, v208
    v_dot2_f32_bf16 v209, v120, v11, v209
    v_dot2_f32_bf16 v210, v121, v10, v210
    v_dot2_f32_bf16 v211, v121, v11, v211
    v_dot2_f32_bf16 v212, v122, v10, v212
    v_dot2_f32_bf16 v213, v122, v11, v213
    v_dot2_f32_bf16 v214, v123, v10, v214
    v_dot2_f32_bf16 v215, v123, v11, v215
    v_dot2_f32_bf16 v216, v152, v10, v216
    v_dot2_f32_bf16 v217, v152, v11, v217
    v_dot2_f32_bf16 v218, v153, v10, v218
    v_dot2_f32_bf16 v219, v153, v11, v219
    v_dot2_f32_bf16 v220, v154, v10, v220
    v_dot2_f32_bf16 v221, v154, v11, v221
    v_dot2_f32_bf16 v222, v155, v10, v222
    v_dot2_f32_bf16 v223, v155, v11, v223
    s_barrier
    s_add_u32 s31, s32, 3932160
    buffer_load_dwordx4 v[100:103], v6, s[12:15], s31 offen
    s_add_u32 s31, s32, 3934208
    buffer_load_dwordx4 v[132:135], v6, s[12:15], s31 offen
    s_add_u32 s31, s32, 3936256
    buffer_load_dwordx4 v[164:167], v6, s[12:15], s31 offen
    s_add_u32 s31, s32, 4718592
    buffer_load_dwordx4 v[104:107], v6, s[12:15], s31 offen
    s_add_u32 s31, s32, 4720640
    buffer_load_dwordx4 v[136:139], v6, s[12:15], s31 offen
    s_add_u32 s31, s32, 4722688
    buffer_load_dwordx4 v[168:171], v6, s[12:15], s31 offen
    s_waitcnt vmcnt(6)
    v_dot2_f32_bf16 v200, v92, v10, v200
    v_dot2_f32_bf16 v201, v92, v11, v201
    v_dot2_f32_bf16 v202, v93, v10, v202
    v_dot2_f32_bf16 v203, v93, v11, v203
    v_dot2_f32_bf16 v204, v94, v10, v204
    v_dot2_f32_bf16 v205, v94, v11, v205
    v_dot2_f32_bf16 v206, v95, v10, v206
    v_dot2_f32_bf16 v207, v95, v11, v207
    v_dot2_f32_bf16 v208, v124, v10, v208
    v_dot2_f32_bf16 v209, v124, v11, v209
    v_dot2_f32_bf16 v210, v125, v10, v210
    v_dot2_f32_bf16 v211, v125, v11, v211
    v_dot2_f32_bf16 v212, v126, v10, v212
    v_dot2_f32_bf16 v213, v126, v11, v213
    v_dot2_f32_bf16 v214, v127, v10, v214
    v_dot2_f32_bf16 v215, v127, v11, v215
    v_dot2_f32_bf16 v216, v156, v10, v216
    v_dot2_f32_bf16 v217, v156, v11, v217
    v_dot2_f32_bf16 v218, v157, v10, v218
    v_dot2_f32_bf16 v219, v157, v11, v219
    v_dot2_f32_bf16 v220, v158, v10, v220
    v_dot2_f32_bf16 v221, v158, v11, v221
    v_dot2_f32_bf16 v222, v159, v10, v222
    v_dot2_f32_bf16 v223, v159, v11, v223
    v_dot2_f32_bf16 v200, v96, v10, v200
    v_dot2_f32_bf16 v201, v96, v11, v201
    v_dot2_f32_bf16 v202, v97, v10, v202
    v_dot2_f32_bf16 v203, v97, v11, v203
    v_dot2_f32_bf16 v204, v98, v10, v204
    v_dot2_f32_bf16 v205, v98, v11, v205
    v_dot2_f32_bf16 v206, v99, v10, v206
    v_dot2_f32_bf16 v207, v99, v11, v207
    v_dot2_f32_bf16 v208, v128, v10, v208
    v_dot2_f32_bf16 v209, v128, v11, v209
    v_dot2_f32_bf16 v210, v129, v10, v210
    v_dot2_f32_bf16 v211, v129, v11, v211
    v_dot2_f32_bf16 v212, v130, v10, v212
    v_dot2_f32_bf16 v213, v130, v11, v213
    v_dot2_f32_bf16 v214, v131, v10, v214
    v_dot2_f32_bf16 v215, v131, v11, v215
    v_dot2_f32_bf16 v216, v160, v10, v216
    v_dot2_f32_bf16 v217, v160, v11, v217
    v_dot2_f32_bf16 v218, v161, v10, v218
    v_dot2_f32_bf16 v219, v161, v11, v219
    v_dot2_f32_bf16 v220, v162, v10, v220
    v_dot2_f32_bf16 v221, v162, v11, v221
    v_dot2_f32_bf16 v222, v163, v10, v222
    v_dot2_f32_bf16 v223, v163, v11, v223
    s_barrier
    s_add_u32 s31, s32, 5505024
    buffer_load_dwordx4 v[108:111], v6, s[12:15], s31 offen
    s_add_u32 s31, s32, 5507072
    buffer_load_dwordx4 v[140:143], v6, s[12:15], s31 offen
    s_add_u32 s31, s32, 5509120
    buffer_load_dwordx4 v[172:175], v6, s[12:15], s31 offen
    s_waitcnt vmcnt(3)
    v_dot2_f32_bf16 v200, v100, v10, v200
    v_dot2_f32_bf16 v201, v100, v11, v201
    v_dot2_f32_bf16 v202, v101, v10, v202
    v_dot2_f32_bf16 v203, v101, v11, v203
    v_dot2_f32_bf16 v204, v102, v10, v204
    v_dot2_f32_bf16 v205, v102, v11, v205
    v_dot2_f32_bf16 v206, v103, v10, v206
    v_dot2_f32_bf16 v207, v103, v11, v207
    v_dot2_f32_bf16 v208, v132, v10, v208
    v_dot2_f32_bf16 v209, v132, v11, v209
    v_dot2_f32_bf16 v210, v133, v10, v210
    v_dot2_f32_bf16 v211, v133, v11, v211
    v_dot2_f32_bf16 v212, v134, v10, v212
    v_dot2_f32_bf16 v213, v134, v11, v213
    v_dot2_f32_bf16 v214, v135, v10, v214
    v_dot2_f32_bf16 v215, v135, v11, v215
    v_dot2_f32_bf16 v216, v164, v10, v216
    v_dot2_f32_bf16 v217, v164, v11, v217
    v_dot2_f32_bf16 v218, v165, v10, v218
    v_dot2_f32_bf16 v219, v165, v11, v219
    v_dot2_f32_bf16 v220, v166, v10, v220
    v_dot2_f32_bf16 v221, v166, v11, v221
    v_dot2_f32_bf16 v222, v167, v10, v222
    v_dot2_f32_bf16 v223, v167, v11, v223
    v_dot2_f32_bf16 v200, v104, v10, v200
    v_dot2_f32_bf16 v201, v104, v11, v201
    v_dot2_f32_bf16 v202, v105, v10, v202
    v_dot2_f32_bf16 v203, v105, v11, v203
    v_dot2_f32_bf16 v204, v106, v10, v204
    v_dot2_f32_bf16 v205, v106, v11, v205
    v_dot2_f32_bf16 v206, v107, v10, v206
    v_dot2_f32_bf16 v207, v107, v11, v207
    v_dot2_f32_bf16 v208, v136, v10, v208
    v_dot2_f32_bf16 v209, v136, v11, v209
    v_dot2_f32_bf16 v210, v137, v10, v210
    v_dot2_f32_bf16 v211, v137, v11, v211
    v_dot2_f32_bf16 v212, v138, v10, v212
    v_dot2_f32_bf16 v213, v138, v11, v213
    v_dot2_f32_bf16 v214, v139, v10, v214
    v_dot2_f32_bf16 v215, v139, v11, v215
    v_dot2_f32_bf16 v216, v168, v10, v216
    v_dot2_f32_bf16 v217, v168, v11, v217
    v_dot2_f32_bf16 v218, v169, v10, v218
    v_dot2_f32_bf16 v219, v169, v11, v219
    v_dot2_f32_bf16 v220, v170, v10, v220
    v_dot2_f32_bf16 v221, v170, v11, v221
    v_dot2_f32_bf16 v222, v171, v10, v222
    v_dot2_f32_bf16 v223, v171, v11, v223
    s_barrier
    s_cmp_lt_u32 s73, s60
    s_cbranch_scc1 pfg_77
    s_cmp_ge_u32 s55, 2
    s_cbranch_scc1 pfx_78
    s_mov_b32 s73, s61
    s_mov_b32 s60, 7340032
    s_add_u32 s55, s55, 1
    s_cmp_eq_u32 s55, 2
    s_cbranch_scc1 pfw2_79
    s_mov_b32 s44, s56
    s_and_b32 s45, s57, 0xffff
    s_mov_b32 s46, 7340032
    s_mov_b32 s47, 0x20000
    s_branch pfg_77
pfw2_79:
    s_mov_b32 s44, s58
    s_and_b32 s45, s59, 0xffff
    s_mov_b32 s46, 7340032
    s_mov_b32 s47, 0x20000
pfg_77:
    s_buffer_load_dword s74, s[44:47], s73 offset:0
    s_buffer_load_dword s74, s[44:47], s73 offset:64
    s_buffer_load_dword s74, s[44:47], s73 offset:128
    s_buffer_load_dword s74, s[44:47], s73 offset:192
    s_add_u32 s73, s73, 262144
pfx_78:
    s_waitcnt vmcnt(0)
    v_dot2_f32_bf16 v200, v108, v10, v200
    v_dot2_f32_bf16 v201, v108, v11, v201
    v_dot2_f32_bf16 v202, v109, v10, v202
    v_dot2_f32_bf16 v203, v109, v11, v203
    v_dot2_f32_bf16 v204, v110, v10, v204
    v_dot2_f32_bf16 v205, v110, v11, v205
    v_dot2_f32_bf16 v206, v111, v10, v206
    v_dot2_f32_bf16 v207, v111, v11, v207
    v_dot2_f32_bf16 v208, v140, v10, v208
    v_dot2_f32_bf16 v209, v140, v11, v209
    v_dot2_f32_bf16 v210, v141, v10, v210
    v_dot2_f32_bf16 v211, v141, v11, v211
    v_dot2_f32_bf16 v212, v142, v10, v212
    v_dot2_f32_bf16 v213, v142, v11, v213
    v_dot2_f32_bf16 v214, v143, v10, v214
    v_dot2_f32_bf16 v215, v143, v11, v215
    v_dot2_f32_bf16 v216, v172, v10, v216
    v_dot2_f32_bf16 v217, v172, v11, v217
    v_dot2_f32_bf16 v218, v173, v10, v218
    v_dot2_f32_bf16 v219, v173, v11, v219
    v_dot2_f32_bf16 v220, v174, v10, v220
    v_dot2_f32_bf16 v221, v174, v11, v221
    v_dot2_f32_bf16 v222, v175, v10, v222
    v_dot2_f32_bf16 v223, v175, v11, v223
    s_mul_i32 s33, s35, 768
    s_add_u32 s33, s33, 42991616
    v_mov_b32 v10, 0x00003f80
    v_mov_b32 v11, 0x3f800000
    v_permlane32_swap_b32 v200, v204
    v_permlane32_swap_b32 v201, v205
    v_permlane32_swap_b32 v202, v206
    v_permlane32_swap_b32 v203, v207
    v_pk_add_f32 v[200:201], v[200:201], v[204:205]
    v_pk_add_f32 v[202:203], v[202:203], v[206:207]
    s_nop 1
    v_permlane16_swap_b32 v200, v202
    v_permlane16_swap_b32 v201, v203
    v_pk_add_f32 v[200:201], v[200:201], v[202:203]
    s_nop 1
    v_add_f32_dpp v200, v200, v200 row_ror:8 row_mask:0xf bank_mask:0xf
    v_add_f32_dpp v201, v201, v201 row_ror:8 row_mask:0xf bank_mask:0xf
    v_mov_b32 v10, 0x00003f80
    v_mov_b32 v11, 0x3f800000
    v_permlane32_swap_b32 v208, v212
    v_permlane32_swap_b32 v209, v213
    v_permlane32_swap_b32 v210, v214
    v_permlane32_swap_b32 v211, v215
    v_pk_add_f32 v[208:209], v[208:209], v[212:213]
    v_pk_add_f32 v[210:211], v[210:211], v[214:215]
    s_nop 1
    v_permlane16_swap_b32 v208, v210
    v_permlane16_swap_b32 v209, v211
    v_pk_add_f32 v[208:209], v[208:209], v[210:211]
    s_nop 1
    v_add_f32_dpp v208, v208, v208 row_ror:8 row_mask:0xf bank_mask:0xf
    v_add_f32_dpp v209, v209, v209 row_ror:8 row_mask:0xf bank_mask:0xf
    v_mov_b32 v10, 0x00003f80
    v_mov_b32 v11, 0x3f800000
    v_permlane32_swap_b32 v216, v220
    v_permlane32_swap_b32 v217, v221
    v_permlane32_swap_b32 v218, v222
    v_permlane32_swap_b32 v219, v223
    v_pk_add_f32 v[216:217], v[216:217], v[220:221]
    v_pk_add_f32 v[218:219], v[218:219], v[222:223]
    s_nop 1
    v_permlane16_swap_b32 v216, v218
    v_permlane16_swap_b32 v217, v219
    v_pk_add_f32 v[216:217], v[216:217], v[218:219]
    s_nop 1
    v_add_f32_dpp v216, v216, v216 row_ror:8 row_mask:0xf bank_mask:0xf
    v_add_f32_dpp v217, v217, v217 row_ror:8 row_mask:0xf bank_mask:0xf
    s_barrier
    s_cmp_lt_u32 s73, s60
    s_cbranch_scc1 pfg_80
    s_cmp_ge_u32 s55, 2
    s_cbranch_scc1 pfx_81
    s_mov_b32 s73, s61
    s_mov_b32 s60, 7340032
    s_add_u32 s55, s55, 1
    s_cmp_eq_u32 s55, 2
    s_cbranch_scc1 pfw2_82
    s_mov_b32 s44, s56
    s_and_b32 s45, s57, 0xffff
    s_mov_b32 s46, 7340032
    s_mov_b32 s47, 0x20000
    s_branch pfg_80
pfw2_82:
    s_mov_b32 s44, s58
    s_and_b32 s45, s59, 0xffff
    s_mov_b32 s46, 7340032
    s_mov_b32 s47, 0x20000
pfg_80:
    s_buffer_load_dword s74, s[44:47], s73 offset:0
    s_buffer_load_dword s74, s[44:47], s73 offset:64
    s_buffer_load_dword s74, s[44:47], s73 offset:128
    s_buffer_load_dword s74, s[44:47], s73 offset:192
    s_add_u32 s73, s73, 262144
pfx_81:
    s_barrier
    s_cmp_lt_u32 s73, s60
    s_cbranch_scc1 pfg_83
    s_cmp_ge_u32 s55, 2
    s_cbranch_scc1 pfx_84
    s_mov_b32 s73, s61
    s_mov_b32 s60, 7340032
    s_add_u32 s55, s55, 1
    s_cmp_eq_u32 s55, 2
    s_cbranch_scc1 pfw2_85
    s_mov_b32 s44, s56
    s_and_b32 s45, s57, 0xffff
    s_mov_b32 s46, 7340032
    s_mov_b32 s47, 0x20000
    s_branch pfg_83
pfw2_85:
    s_mov_b32 s44, s58
    s_and_b32 s45, s59, 0xffff
    s_mov_b32 s46, 7340032
    s_mov_b32 s47, 0x20000
pfg_83:
    s_buffer_load_dword s74, s[44:47], s73 offset:0
    s_buffer_load_dword s74, s[44:47], s73 offset:64
    s_buffer_load_dword s74, s[44:47], s73 offset:128
    s_buffer_load_dword s74, s[44:47], s73 offset:192
    s_add_u32 s73, s73, 262144
pfx_84:
    s_barrier
    s_cmp_lt_u32 s73, s60
    s_cbranch_scc1 pfg_86
    s_cmp_ge_u32 s55, 2
    s_cbranch_scc1 pfx_87
    s_mov_b32 s73, s61
    s_mov_b32 s60, 7340032
    s_add_u32 s55, s55, 1
    s_cmp_eq_u32 s55, 2
    s_cbranch_scc1 pfw2_88
    s_mov_b32 s44, s56
    s_and_b32 s45, s57, 0xffff
    s_mov_b32 s46, 7340032
    s_mov_b32 s47, 0x20000
    s_branch pfg_86
pfw2_88:
    s_mov_b32 s44, s58
    s_and_b32 s45, s59, 0xffff
    s_mov_b32 s46, 7340032
    s_mov_b32 s47, 0x20000
pfg_86:
    s_buffer_load_dword s74, s[44:47], s73 offset:0
    s_buffer_load_dword s74, s[44:47], s73 offset:64
    s_buffer_load_dword s74, s[44:47], s73 offset:128
    s_buffer_load_dword s74, s[44:47], s73 offset:192
    s_add_u32 s73, s73, 262144
pfx_87:
    v_lshlrev_b32 v6, 5, v4
    v_lshl_add_u32 v6, v3, 3, v6
    s_mov_b32 exec_lo, 0xff00ff
    s_mov_b32 exec_hi, 0xff00ff
    buffer_store_dwordx2 v[200:201], v6, s[8:11], s33 offen offset:0 sc1
    s_mov_b64 exec, -1
    v_lshlrev_b32 v6, 5, v4
    v_lshl_add_u32 v6, v3, 3, v6
    s_mov_b32 exec_lo, 0xff00ff
    s_mov_b32 exec_hi, 0xff00ff
    buffer_store_dwordx2 v[208:209], v6, s[8:11], s33 offen offset:256 sc1
    s_mov_b64 exec, -1
    v_lshlrev_b32 v6, 5, v4
    v_lshl_add_u32 v6, v3, 3, v6
    s_mov_b32 exec_lo, 0xff00ff
    s_mov_b32 exec_hi, 0xff00ff
    buffer_store_dwordx2 v[216:217], v6, s[8:11], s33 offen offset:512 sc1
    s_mov_b64 exec, -1
    s_barrier
    s_cmp_lt_u32 s73, s60
    s_cbranch_scc1 pfg_89
    s_cmp_ge_u32 s55, 2
    s_cbranch_scc1 pfx_90
    s_mov_b32 s73, s61
    s_mov_b32 s60, 7340032
    s_add_u32 s55, s55, 1
    s_cmp_eq_u32 s55, 2
    s_cbranch_scc1 pfw2_91
    s_mov_b32 s44, s56
    s_and_b32 s45, s57, 0xffff
    s_mov_b32 s46, 7340032
    s_mov_b32 s47, 0x20000
    s_branch pfg_89
pfw2_91:
    s_mov_b32 s44, s58
    s_and_b32 s45, s59, 0xffff
    s_mov_b32 s46, 7340032
    s_mov_b32 s47, 0x20000
pfg_89:
    s_buffer_load_dword s74, s[44:47], s73 offset:0
    s_buffer_load_dword s74, s[44:47], s73 offset:64
    s_buffer_load_dword s74, s[44:47], s73 offset:128
    s_buffer_load_dword s74, s[44:47], s73 offset:192
    s_add_u32 s73, s73, 262144
pfx_90:
    s_barrier
    s_cmp_lt_u32 s73, s60
    s_cbranch_scc1 pfg_92
    s_cmp_ge_u32 s55, 2
    s_cbranch_scc1 pfx_93
    s_mov_b32 s73, s61
    s_mov_b32 s60, 7340032
    s_add_u32 s55, s55, 1
    s_cmp_eq_u32 s55, 2
    s_cbranch_scc1 pfw2_94
    s_mov_b32 s44, s56
    s_and_b32 s45, s57, 0xffff
    s_mov_b32 s46, 7340032
    s_mov_b32 s47, 0x20000
    s_branch pfg_92
pfw2_94:
    s_mov_b32 s44, s58
    s_and_b32 s45, s59, 0xffff
    s_mov_b32 s46, 7340032
    s_mov_b32 s47, 0x20000
pfg_92:
    s_buffer_load_dword s74, s[44:47], s73 offset:0
    s_buffer_load_dword s74, s[44:47], s73 offset:64
    s_buffer_load_dword s74, s[44:47], s73 offset:128
    s_buffer_load_dword s74, s[44:47], s73 offset:192
    s_add_u32 s73, s73, 262144
pfx_93:
    s_barrier
    s_cmp_lt_u32 s73, s60
    s_cbranch_scc1 pfg_95
    s_cmp_ge_u32 s55, 2
    s_cbranch_scc1 pfx_96
    s_mov_b32 s73, s61
    s_mov_b32 s60, 7340032
    s_add_u32 s55, s55, 1
    s_cmp_eq_u32 s55, 2
    s_cbranch_scc1 pfw2_97
    s_mov_b32 s44, s56
    s_and_b32 s45, s57, 0xffff
    s_mov_b32 s46, 7340032
    s_mov_b32 s47, 0x20000
    s_branch pfg_95
pfw2_97:
    s_mov_b32 s44, s58
    s_and_b32 s45, s59, 0xffff
    s_mov_b32 s46, 7340032
    s_mov_b32 s47, 0x20000
pfg_95:
    s_buffer_load_dword s74, s[44:47], s73 offset:0
    s_buffer_load_dword s74, s[44:47], s73 offset:64
    s_buffer_load_dword s74, s[44:47], s73 offset:128
    s_buffer_load_dword s74, s[44:47], s73 offset:192
    s_add_u32 s73, s73, 262144
pfx_96:
    s_barrier
    s_cmp_lt_u32 s73, s60
    s_cbranch_scc1 pfg_98
    s_cmp_ge_u32 s55, 2
    s_cbranch_scc1 pfx_99
    s_mov_b32 s73, s61
    s_mov_b32 s60, 7340032
    s_add_u32 s55, s55, 1
    s_cmp_eq_u32 s55, 2
    s_cbranch_scc1 pfw2_100
    s_mov_b32 s44, s56
    s_and_b32 s45, s57, 0xffff
    s_mov_b32 s46, 7340032
    s_mov_b32 s47, 0x20000
    s_branch pfg_98
pfw2_100:
    s_mov_b32 s44, s58
    s_and_b32 s45, s59, 0xffff
    s_mov_b32 s46, 7340032
    s_mov_b32 s47, 0x20000
pfg_98:
    s_buffer_load_dword s74, s[44:47], s73 offset:0
    s_buffer_load_dword s74, s[44:47], s73 offset:64
    s_buffer_load_dword s74, s[44:47], s73 offset:128
    s_buffer_load_dword s74, s[44:47], s73 offset:192
    s_add_u32 s73, s73, 262144
pfx_99:
    s_barrier
    s_cmp_lt_u32 s73, s60
    s_cbranch_scc1 pfg_101
    s_cmp_ge_u32 s55, 2
    s_cbranch_scc1 pfx_102
    s_mov_b32 s73, s61
    s_mov_b32 s60, 7340032
    s_add_u32 s55, s55, 1
    s_cmp_eq_u32 s55, 2
    s_cbranch_scc1 pfw2_103
    s_mov_b32 s44, s56
    s_and_b32 s45, s57, 0xffff
    s_mov_b32 s46, 7340032
    s_mov_b32 s47, 0x20000
    s_branch pfg_101
pfw2_103:
    s_mov_b32 s44, s58
    s_and_b32 s45, s59, 0xffff
    s_mov_b32 s46, 7340032
    s_mov_b32 s47, 0x20000
pfg_101:
    s_buffer_load_dword s74, s[44:47], s73 offset:0
    s_buffer_load_dword s74, s[44:47], s73 offset:64
    s_buffer_load_dword s74, s[44:47], s73 offset:128
    s_buffer_load_dword s74, s[44:47], s73 offset:192
    s_add_u32 s73, s73, 262144
pfx_102:
    s_barrier
    s_cmp_lt_u32 s73, s60
    s_cbranch_scc1 pfg_104
    s_cmp_ge_u32 s55, 2
    s_cbranch_scc1 pfx_105
    s_mov_b32 s73, s61
    s_mov_b32 s60, 7340032
    s_add_u32 s55, s55, 1
    s_cmp_eq_u32 s55, 2
    s_cbranch_scc1 pfw2_106
    s_mov_b32 s44, s56
    s_and_b32 s45, s57, 0xffff
    s_mov_b32 s46, 7340032
    s_mov_b32 s47, 0x20000
    s_branch pfg_104
pfw2_106:
    s_mov_b32 s44, s58
    s_and_b32 s45, s59, 0xffff
    s_mov_b32 s46, 7340032
    s_mov_b32 s47, 0x20000
pfg_104:
    s_buffer_load_dword s74, s[44:47], s73 offset:0
    s_buffer_load_dword s74, s[44:47], s73 offset:64
    s_buffer_load_dword s74, s[44:47], s73 offset:128
    s_buffer_load_dword s74, s[44:47], s73 offset:192
    s_add_u32 s73, s73, 262144
pfx_105:
    s_barrier
    s_cmp_lt_u32 s73, s60
    s_cbranch_scc1 pfg_107
    s_cmp_ge_u32 s55, 2
    s_cbranch_scc1 pfx_108
    s_mov_b32 s73, s61
    s_mov_b32 s60, 7340032
    s_add_u32 s55, s55, 1
    s_cmp_eq_u32 s55, 2
    s_cbranch_scc1 pfw2_109
    s_mov_b32 s44, s56
    s_and_b32 s45, s57, 0xffff
    s_mov_b32 s46, 7340032
    s_mov_b32 s47, 0x20000
    s_branch pfg_107
pfw2_109:
    s_mov_b32 s44, s58
    s_and_b32 s45, s59, 0xffff
    s_mov_b32 s46, 7340032
    s_mov_b32 s47, 0x20000
pfg_107:
    s_buffer_load_dword s74, s[44:47], s73 offset:0
    s_buffer_load_dword s74, s[44:47], s73 offset:64
    s_buffer_load_dword s74, s[44:47], s73 offset:128
    s_buffer_load_dword s74, s[44:47], s73 offset:192
    s_add_u32 s73, s73, 262144
pfx_108:
    s_mul_i32 s33, s25, 768
    s_add_u32 s33, s33, 42991616
    v_lshlrev_b32 v6, 4, v1
    s_mov_b32 exec_lo, 0xffffffff
    s_mov_b32 exec_hi, 0xffff
    s_add_u32 s31, s33, 0
    buffer_load_dwordx4 v[16:19], v6, s[8:11], s31 offen sc1
    s_add_u32 s31, s33, 12288
    buffer_load_dwordx4 v[20:23], v6, s[8:11], s31 offen sc1
    s_add_u32 s31, s33, 24576
    buffer_load_dwordx4 v[24:27], v6, s[8:11], s31 offen sc1
    s_add_u32 s31, s33, 36864
    buffer_load_dwordx4 v[28:31], v6, s[8:11], s31 offen sc1
    s_add_u32 s31, s33, 49152
    buffer_load_dwordx4 v[32:35], v6, s[8:11], s31 offen sc1
    s_add_u32 s31, s33, 61440
    buffer_load_dwordx4 v[36:39], v6, s[8:11], s31 offen sc1
    s_add_u32 s31, s33, 73728
    buffer_load_dwordx4 v[40:43], v6, s[8:11], s31 offen sc1
    s_add_u32 s31, s33, 86016
    buffer_load_dwordx4 v[44:47], v6, s[8:11], s31 offen sc1
    s_add_u32 s31, s33, 98304
    buffer_load_dwordx4 v[48:51], v6, s[8:11], s31 offen sc1
    s_add_u32 s31, s33, 110592
    buffer_load_dwordx4 v[52:55], v6, s[8:11], s31 offen sc1
    s_add_u32 s31, s33, 122880
    buffer_load_dwordx4 v[56:59], v6, s[8:11], s31 offen sc1
    s_add_u32 s31, s33, 135168
    buffer_load_dwordx4 v[60:63], v6, s[8:11], s31 offen sc1
    s_add_u32 s31, s33, 147456
    buffer_load_dwordx4 v[64:67], v6, s[8:11], s31 offen sc1
    s_add_u32 s31, s33, 159744
    buffer_load_dwordx4 v[68:71], v6, s[8:11], s31 offen sc1
    s_add_u32 s31, s33, 172032
    buffer_load_dwordx4 v[72:75], v6, s[8:11], s31 offen sc1
    s_add_u32 s31, s33, 184320
    buffer_load_dwordx4 v[76:79], v6, s[8:11], s31 offen sc1
    s_mov_b64 exec, -1
    s_barrier
    s_barrier
    s_mov_b32 exec_lo, 0xffffffff
    s_mov_b32 exec_hi, 0xffff
    s_mov_b32 s72, 0
rt_74:
    s_waitcnt vmcnt(0)
    v_max_u32 v8, v16, v17
    v_max3_u32 v8, v18, v19, v8
    v_max3_u32 v8, v20, v21, v8
    v_max3_u32 v8, v22, v23, v8
    v_max3_u32 v8, v24, v25, v8
    v_max3_u32 v8, v26, v27, v8
    v_max3_u32 v8, v28, v29, v8
    v_max3_u32 v8, v30, v31, v8
    v_max3_u32 v8, v32, v33, v8
    v_max3_u32 v8, v34, v35, v8
    v_max3_u32 v8, v36, v37, v8
    v_max3_u32 v8, v38, v39, v8
    v_max3_u32 v8, v40, v41, v8
    v_max3_u32 v8, v42, v43, v8
    v_max3_u32 v8, v44, v45, v8
    v_max3_u32 v8, v46, v47, v8
    v_max3_u32 v8, v48, v49, v8
    v_max3_u32 v8, v50, v51, v8
    v_max3_u32 v8, v52, v53, v8
    v_max3_u32 v8, v54, v55, v8
    v_max3_u32 v8, v56, v57, v8
    v_max3_u32 v8, v58, v59, v8
    v_max3_u32 v8, v60, v61, v8
    v_max3_u32 v8, v62, v63, v8
    v_max3_u32 v8, v64, v65, v8
    v_max3_u32 v8, v66, v67, v8
    v_max3_u32 v8, v68, v69, v8
    v_max3_u32 v8, v70, v71, v8
    v_max3_u32 v8, v72, v73, v8
    v_max3_u32 v8, v74, v75, v8
    v_max3_u32 v8, v76, v77, v8
    v_max3_u32 v8, v78, v79, v8
    v_cmp_eq_u32 vcc, -1, v8
    s_cbranch_vccz rtx_75
    s_add_u32 s72, s72, 1
    s_cmp_gt_u32 s72, 524288
    s_cbranch_scc1 rtx_75
    s_sleep 8
    s_add_u32 s31, s33, 0
    buffer_load_dwordx4 v[16:19], v6, s[8:11], s31 offen sc1
    s_add_u32 s31, s33, 12288
    buffer_load_dwordx4 v[20:23], v6, s[8:11], s31 offen sc1
    s_add_u32 s31, s33, 24576
    buffer_load_dwordx4 v[24:27], v6, s[8:11], s31 offen sc1
    s_add_u32 s31, s33, 36864
    buffer_load_dwordx4 v[28:31], v6, s[8:11], s31 offen sc1
    s_add_u32 s31, s33, 49152
    buffer_load_dwordx4 v[32:35], v6, s[8:11], s31 offen sc1
    s_add_u32 s31, s33, 61440
    buffer_load_dwordx4 v[36:39], v6, s[8:11], s31 offen sc1
    s_add_u32 s31, s33, 73728
    buffer_load_dwordx4 v[40:43], v6, s[8:11], s31 offen sc1
    s_add_u32 s31, s33, 86016
    buffer_load_dwordx4 v[44:47], v6, s[8:11], s31 offen sc1
    s_add_u32 s31, s33, 98304
    buffer_load_dwordx4 v[48:51], v6, s[8:11], s31 offen sc1
    s_add_u32 s31, s33, 110592
    buffer_load_dwordx4 v[52:55], v6, s[8:11], s31 offen sc1
    s_add_u32 s31, s33, 122880
    buffer_load_dwordx4 v[56:59], v6, s[8:11], s31 offen sc1
    s_add_u32 s31, s33, 135168
    buffer_load_dwordx4 v[60:63], v6, s[8:11], s31 offen sc1
    s_add_u32 s31, s33, 147456
    buffer_load_dwordx4 v[64:67], v6, s[8:11], s31 offen sc1
    s_add_u32 s31, s33, 159744
    buffer_load_dwordx4 v[68:71], v6, s[8:11], s31 offen sc1
    s_add_u32 s31, s33, 172032
    buffer_load_dwordx4 v[72:75], v6, s[8:11], s31 offen sc1
    s_add_u32 s31, s33, 184320
    buffer_load_dwordx4 v[76:79], v6, s[8:11], s31 offen sc1
    s_branch rt_74
rtx_75:
    v_pk_add_f32 v[16:17], v[16:17], v[20:21]
    v_pk_add_f32 v[18:19], v[18:19], v[22:23]
    v_pk_add_f32 v[16:17], v[16:17], v[24:25]
    v_pk_add_f32 v[18:19], v[18:19], v[26:27]
    v_pk_add_f32 v[16:17], v[16:17], v[28:29]
    v_pk_add_f32 v[18:19], v[18:19], v[30:31]
    v_pk_add_f32 v[16:17], v[16:17], v[32:33]
    v_pk_add_f32 v[18:19], v[18:19], v[34:35]
    v_pk_add_f32 v[16:17], v[16:17], v[36:37]
    v_pk_add_f32 v[18:19], v[18:19], v[38:39]
    v_pk_add_f32 v[16:17], v[16:17], v[40:41]
    v_pk_add_f32 v[18:19], v[18:19], v[42:43]
    v_pk_add_f32 v[16:17], v[16:17], v[44:45]
    v_pk_add_f32 v[18:19], v[18:19], v[46:47]
    v_pk_add_f32 v[16:17], v[16:17], v[48:49]
    v_pk_add_f32 v[18:19], v[18:19], v[50:51]
    v_pk_add_f32 v[16:17], v[16:17], v[52:53]
    v_pk_add_f32 v[18:19], v[18:19], v[54:55]
    v_pk_add_f32 v[16:17], v[16:17], v[56:57]
    v_pk_add_f32 v[18:19], v[18:19], v[58:59]
    v_pk_add_f32 v[16:17], v[16:17], v[60:61]
    v_pk_add_f32 v[18:19], v[18:19], v[62:63]
    v_pk_add_f32 v[16:17], v[16:17], v[64:65]
    v_pk_add_f32 v[18:19], v[18:19], v[66:67]
    v_pk_add_f32 v[16:17], v[16:17], v[68:69]
    v_pk_add_f32 v[18:19], v[18:19], v[70:71]
    v_pk_add_f32 v[16:17], v[16:17], v[72:73]
    v_pk_add_f32 v[18:19], v[18:19], v[74:75]
    v_pk_add_f32 v[16:17], v[16:17], v[76:77]
    v_pk_add_f32 v[18:19], v[18:19], v[78:79]
    v_add_u32 v6, 158720, v6
    ds_write_b128 v6, v[16:19]
    s_mov_b64 exec, -1
    s_waitcnt lgkmcnt(0)
    s_barrier
    s_waitcnt lgkmcnt(0)
L_att:
    s_setprio 0
    s_lshl_b32 s38, s28, 1
    s_add_u32 s38, s38, 1
    v_lshlrev_b32 v5, 2, v3
    v_mov_b32 v6, 0xf149f2ca
    v_add_u32 v7, 0, v5
    v_cmp_gt_u32 vcc, v7, v4
    s_nop 1
    v_cndmask_b32_e64 v56, v6, 0, vcc
    v_cndmask_b32 v60, 0, v6, vcc
    v_add_u32 v7, 1, v5
    v_cmp_gt_u32 vcc, v7, v4
    s_nop 1
    v_cndmask_b32_e64 v57, v6, 0, vcc
    v_cndmask_b32 v61, 0, v6, vcc
    v_add_u32 v7, 2, v5
    v_cmp_gt_u32 vcc, v7, v4
    s_nop 1
    v_cndmask_b32_e64 v58, v6, 0, vcc
    v_cndmask_b32 v62, 0, v6, vcc
    v_add_u32 v7, 3, v5
    v_cmp_gt_u32 vcc, v7, v4
    s_nop 1
    v_cndmask_b32_e64 v59, v6, 0, vcc
    v_cndmask_b32 v63, 0, v6, vcc

    s_lshl_b32 s36, s24, 2
    s_add_u32 s36, s36, s38
    s_sub_i32 s36, 8, s36
    s_max_i32 s36, s36, 0
    s_mul_i32 s37, s29, 24
    s_lshl_b32 s39, s38, 1
    s_add_u32 s37, s37, s39
    s_lshl_b32 s37, s37, 10
    v_lshl_add_u32 v5, v1, 4, s37
    v_add_u32 v7, 49152, v5

    s_add_u32 s34, s100, 32768
    s_lshl_b32 s35, s38, 12
    s_add_u32 s34, s34, s35
    s_lshl_b32 s35, s29, 10
    s_add_u32 s34, s34, s35
    s_add_u32 s35, s34, 2048
    s_lshl_b32 s33, s24, 4
    s_add_u32 s33, s33, s25
    s_mul_i32 s33, s33, 32
    s_add_u32 s33, s33, s20
    s_lshl_b32 s33, s33, 2
    s_add_u32 s33, s33, 44302336
    s_add_u32 s42, s100, 0

    s_add_u32 s40, s24, s28
    s_sub_u32 s41, s40, 2
    s_lshl_b32 s31, s28, 16
    s_add_u32 s42, s42, s31
    s_sub_u32 s42, s42, 131072
    s_lshl_b32 s31, s29, 13
    s_add_u32 s42, s42, s31
    s_mul_i32 s43, s29, 24
    s_lshl_b32 s31, s28, 3
    s_add_u32 s43, s43, s31
    s_lshl_b32 s43, s43, 10
    v_lshlrev_b32 v2, 4, v1
    s_cmp_lt_u32 s40, 2
    s_cselect_b32 s42, 268435456, s42
    s_cbranch_scc1 nonb_110

    s_lshl_b32 s32, s25, 4
    s_add_u32 s32, s32, s41
    s_mul_i32 s32, s32, 4
    s_lshl_b32 s32, s32, 2
    s_add_u32 s32, s32, 43909120
    v_lshlrev_b32 v10, 2, v1
    s_mov_b64 exec, 15
    s_mov_b32 s72, 0
poll_111:
    buffer_load_dword v8, v10, s[8:11], s32 offen sc1
    s_add_u32 s72, s72, 1
    s_cmp_gt_u32 s72, 524288
    s_waitcnt vmcnt(0)
    s_cbranch_scc1 pollx_112
    v_and_b32 v8, 1, v8
    v_cmp_ne_u32 vcc, 1, v8
    s_cbranch_vccz pollx_112
    s_sleep 1
    s_branch poll_111
pollx_112:
    s_mov_b64 exec, -1
nonb_110:
    s_add_u32 m0, s43, 0
    s_add_u32 s31, s42, 0
    buffer_load_dwordx4 v2, s[8:11], s31 offen offset:0 sc1 lds
    buffer_load_dwordx4 v2, s[8:11], s31 offen offset:1024 sc1 lds
    buffer_load_dwordx4 v2, s[8:11], s31 offen offset:2048 sc1 lds
    buffer_load_dwordx4 v2, s[8:11], s31 offen offset:3072 sc1 lds
    s_add_u32 m0, s43, 4096
    s_add_u32 s31, s42, 4096
    buffer_load_dwordx4 v2, s[8:11], s31 offen offset:0 sc1 lds
    buffer_load_dwordx4 v2, s[8:11], s31 offen offset:1024 sc1 lds
    buffer_load_dwordx4 v2, s[8:11], s31 offen offset:2048 sc1 lds
    buffer_load_dwordx4 v2, s[8:11], s31 offen offset:3072 sc1 lds
    s_waitcnt vmcnt(0)
    s_waitcnt lgkmcnt(0)
    s_barrier
    s_lshl_b32 s30, s21, 11
    s_add_u32 s30, s30, 98304
    v_lshl_add_u32 v2, v1, 4, s30
    ds_read_b128 v[8:11], v2
    ds_read_b128 v[12:15], v2 offset:1024
    s_cmp_lt_u32 s40, 2
    s_cbranch_scc1 nonv_113
    v_lshlrev_b32 v22, 2, v1
    s_mov_b64 exec, 15
    s_mov_b32 s72, 0
poll_114:
    buffer_load_dword v20, v22, s[8:11], s32 offen sc1
    s_add_u32 s72, s72, 1
    s_cmp_gt_u32 s72, 524288
    s_waitcnt vmcnt(0)
    s_cbranch_scc1 pollx_115
    v_and_b32 v20, 2, v20
    v_cmp_ne_u32 vcc, 2, v20
    s_cbranch_vccz pollx_115
    s_sleep 1
    s_branch poll_114
pollx_115:
    s_mov_b64 exec, -1
nonv_113:
    v_lshlrev_b32 v2, 4, v1
    s_add_u32 m0, s43, 49152
    s_add_u32 s31, s42, 16384
    buffer_load_dwordx4 v2, s[8:11], s31 offen offset:0 sc1 lds
    buffer_load_dwordx4 v2, s[8:11], s31 offen offset:1024 sc1 lds
    buffer_load_dwordx4 v2, s[8:11], s31 offen offset:2048 sc1 lds
    buffer_load_dwordx4 v2, s[8:11], s31 offen offset:3072 sc1 lds
    s_add_u32 m0, s43, 53248
    s_add_u32 s31, s42, 20480
    buffer_load_dwordx4 v2, s[8:11], s31 offen offset:0 sc1 lds
    buffer_load_dwordx4 v2, s[8:11], s31 offen offset:1024 sc1 lds
    buffer_load_dwordx4 v2, s[8:11], s31 offen offset:2048 sc1 lds
    buffer_load_dwordx4 v2, s[8:11], s31 offen offset:3072 sc1 lds
    s_mov_b32 s12, s56
    s_and_b32 s13, s57, 0xffff
    s_mov_b32 s14, 7340032
    s_mov_b32 s15, 0x20000
    s_xor_b32 s30, s2, 0
    s_lshl_b32 s30, s30, 2
    s_add_u32 s30, s30, s21
    s_lshl_b32 s30, s30, 13
    v_lshlrev_b32 v251, 7, v1
    buffer_load_dword v248, v251, s[12:15], s30 offen
    ds_read_b128 v[24:27], v5 offset:0
    ds_read_b128 v[28:31], v5 offset:1024
    ds_read_b128 v[32:35], v5 offset:2048
    ds_read_b128 v[36:39], v5 offset:3072
    ds_read_b128 v[40:43], v5 offset:4096
    ds_read_b128 v[44:47], v5 offset:5120
    ds_read_b128 v[48:51], v5 offset:6144
    ds_read_b128 v[52:55], v5 offset:7168
    v_mov_b32 v16, 0x3f803f80
    v_mov_b32 v17, 0x3f803f80
    v_mov_b32 v18, 0x3f803f80
    v_mov_b32 v19, 0x3f803f80
    v_mov_b32 v232, v6
    v_mov_b32 v233, v6
    v_mov_b32 v234, v6
    v_mov_b32 v235, v6
    v_mov_b64 v[208:209], 0
    v_mov_b64 v[210:211], 0
    v_mov_b64 v[212:213], 0
    v_mov_b64 v[214:215], 0
    v_mov_b64 v[216:217], 0
    v_mov_b64 v[218:219], 0
    v_mov_b64 v[220:221], 0
    v_mov_b64 v[222:223], 0
    v_mov_b64 v[224:225], 0
    v_mov_b64 v[226:227], 0
    v_mov_b64 v[228:229], 0
    v_mov_b64 v[230:231], 0
    s_cmp_lg_u32 s36, 0
    s_cbranch_scc1 sgen_116
    s_waitcnt lgkmcnt(7)
    v_mfma_f32_16x16x32_bf16 v[64:67], v[24:27], v[8:11], v[56:59]
    ds_read_b128 v[24:27], v5 offset:8192
    s_waitcnt lgkmcnt(7)
    v_mfma_f32_16x16x32_bf16 v[68:71], v[28:31], v[8:11], 0
    v_mfma_f32_16x16x32_bf16 v[140:143], v[28:31], v[12:15], v[56:59]
    ds_read_b128 v[28:31], v5 offset:9216
    s_waitcnt lgkmcnt(7)
    v_mfma_f32_16x16x32_bf16 v[72:75], v[32:35], v[8:11], 0
    v_mfma_f32_16x16x32_bf16 v[144:147], v[32:35], v[12:15], 0
    v_max3_f32 v232, v64, v65, v232
    v_max3_f32 v233, v66, v67, v233
    ds_read_b128 v[32:35], v5 offset:10240
    s_waitcnt lgkmcnt(7)
    v_mfma_f32_16x16x32_bf16 v[76:79], v[36:39], v[8:11], 0
    v_max3_f32 v232, v68, v69, v232
    v_max3_f32 v233, v70, v71, v233
    v_mfma_f32_16x16x32_bf16 v[148:151], v[36:39], v[12:15], 0
    v_max3_f32 v234, v140, v141, v234
    v_max3_f32 v235, v142, v143, v235
    ds_read_b128 v[36:39], v5 offset:11264
    s_waitcnt lgkmcnt(7)
    v_mfma_f32_16x16x32_bf16 v[80:83], v[40:43], v[8:11], 0
    v_max3_f32 v232, v72, v73, v232
    v_max3_f32 v233, v74, v75, v233
    v_mfma_f32_16x16x32_bf16 v[152:155], v[40:43], v[12:15], 0
    v_max3_f32 v234, v144, v145, v234
    v_max3_f32 v235, v146, v147, v235
    ds_read_b128 v[40:43], v5 offset:12288
    s_waitcnt lgkmcnt(7)
    v_mfma_f32_16x16x32_bf16 v[84:87], v[44:47], v[8:11], 0
    v_max3_f32 v232, v76, v77, v232
    v_max3_f32 v233, v78, v79, v233
    v_mfma_f32_16x16x32_bf16 v[156:159], v[44:47], v[12:15], 0
    v_max3_f32 v234, v148, v149, v234
    v_max3_f32 v235, v150, v151, v235
    ds_read_b128 v[44:47], v5 offset:13312
    s_waitcnt lgkmcnt(7)
    v_mfma_f32_16x16x32_bf16 v[88:91], v[48:51], v[8:11], 0
    v_max3_f32 v232, v80, v81, v232
    v_max3_f32 v233, v82, v83, v233
    v_mfma_f32_16x16x32_bf16 v[160:163], v[48:51], v[12:15], 0
    v_max3_f32 v234, v152, v153, v234
    v_max3_f32 v235, v154, v155, v235
    ds_read_b128 v[48:51], v5 offset:14336
    s_waitcnt lgkmcnt(7)
    v_mfma_f32_16x16x32_bf16 v[92:95], v[52:55], v[8:11], 0
    v_max3_f32 v232, v84, v85, v232
    v_max3_f32 v233, v86, v87, v233
    v_mfma_f32_16x16x32_bf16 v[164:167], v[52:55], v[12:15], 0
    v_max3_f32 v234, v156, v157, v234
    v_max3_f32 v235, v158, v159, v235
    ds_read_b128 v[52:55], v5 offset:15360
    s_waitcnt lgkmcnt(7)
    v_mfma_f32_16x16x32_bf16 v[96:99], v[24:27], v[8:11], 0
    v_max3_f32 v232, v88, v89, v232
    v_max3_f32 v233, v90, v91, v233
    v_mfma_f32_16x16x32_bf16 v[168:171], v[24:27], v[12:15], 0
    v_max3_f32 v234, v160, v161, v234
    v_max3_f32 v235, v162, v163, v235
    ds_read_b128 v[24:27], v5 offset:16384
    s_waitcnt lgkmcnt(7)
    v_mfma_f32_16x16x32_bf16 v[100:103], v[28:31], v[8:11], 0
    v_max3_f32 v232, v92, v93, v232
    v_max3_f32 v233, v94, v95, v233
    v_mfma_f32_16x16x32_bf16 v[172:175], v[28:31], v[12:15], 0
    v_max3_f32 v234, v164, v165, v234
    v_max3_f32 v235, v166, v167, v235
    ds_read_b128 v[28:31], v5 offset:17408
    s_waitcnt lgkmcnt(7)
    v_mfma_f32_16x16x32_bf16 v[104:107], v[32:35], v[8:11], 0
    v_max3_f32 v232, v96, v97, v232
    v_max3_f32 v233, v98, v99, v233
    v_mfma_f32_16x16x32_bf16 v[176:179], v[32:35], v[12:15], 0
    v_max3_f32 v234, v168, v169, v234
    v_max3_f32 v235, v170, v171, v235
    s_waitcnt lgkmcnt(6)
    v_mfma_f32_16x16x32_bf16 v[108:111], v[36:39], v[8:11], 0
    v_max3_f32 v232, v100, v101, v232
    v_max3_f32 v233, v102, v103, v233
    v_mfma_f32_16x16x32_bf16 v[180:183], v[36:39], v[12:15], 0
    v_max3_f32 v234, v172, v173, v234
    v_max3_f32 v235, v174, v175, v235
    s_waitcnt lgkmcnt(5)
    v_mfma_f32_16x16x32_bf16 v[112:115], v[40:43], v[8:11], 0
    v_max3_f32 v232, v104, v105, v232
    v_max3_f32 v233, v106, v107, v233
    v_mfma_f32_16x16x32_bf16 v[184:187], v[40:43], v[12:15], 0
    v_max3_f32 v234, v176, v177, v234
    v_max3_f32 v235, v178, v179, v235
    s_waitcnt lgkmcnt(4)
    v_mfma_f32_16x16x32_bf16 v[116:119], v[44:47], v[8:11], 0
    v_max3_f32 v232, v108, v109, v232
    v_max3_f32 v233, v110, v111, v233
    v_mfma_f32_16x16x32_bf16 v[188:191], v[44:47], v[12:15], 0
    v_max3_f32 v234, v180, v181, v234
    v_max3_f32 v235, v182, v183, v235
    s_waitcnt lgkmcnt(3)
    v_mfma_f32_16x16x32_bf16 v[120:123], v[48:51], v[8:11], 0
    v_max3_f32 v232, v112, v113, v232
    v_max3_f32 v233, v114, v115, v233
    v_mfma_f32_16x16x32_bf16 v[192:195], v[48:51], v[12:15], 0
    v_max3_f32 v234, v184, v185, v234
    v_max3_f32 v235, v186, v187, v235
    s_waitcnt lgkmcnt(2)
    v_mfma_f32_16x16x32_bf16 v[124:127], v[52:55], v[8:11], 0
    v_max3_f32 v232, v116, v117, v232
    v_max3_f32 v233, v118, v119, v233
    v_mfma_f32_16x16x32_bf16 v[196:199], v[52:55], v[12:15], 0
    v_max3_f32 v234, v188, v189, v234
    v_max3_f32 v235, v190, v191, v235
    s_waitcnt lgkmcnt(1)
    v_mfma_f32_16x16x32_bf16 v[128:131], v[24:27], v[8:11], v[60:63]
    v_max3_f32 v232, v120, v121, v232
    v_max3_f32 v233, v122, v123, v233
    v_mfma_f32_16x16x32_bf16 v[200:203], v[24:27], v[12:15], 0
    v_max3_f32 v234, v192, v193, v234
    v_max3_f32 v235, v194, v195, v235
    s_waitcnt lgkmcnt(0)
    v_mfma_f32_16x16x32_bf16 v[204:207], v[28:31], v[12:15], v[60:63]
    v_max3_f32 v232, v124, v125, v232
    v_max3_f32 v233, v126, v127, v233
    v_max3_f32 v234, v196, v197, v234
    v_max3_f32 v235, v198, v199, v235
    v_max3_f32 v232, v128, v129, v232
    v_max3_f32 v233, v130, v131, v233
    v_max3_f32 v234, v200, v201, v234
    v_max3_f32 v235, v202, v203, v235
    v_max3_f32 v234, v204, v205, v234
    v_max3_f32 v235, v206, v207, v235
    s_branch sx_117
sgen_116:
    s_waitcnt lgkmcnt(7)
    s_cmp_gt_u32 s36, 0
    s_cselect_b32 s30, 0xf149f2ca, 0
    v_mov_b32 v20, s30
    v_mov_b32 v21, s30
    v_mov_b32 v22, s30
    v_mov_b32 v23, s30
    s_nop 1
    v_mfma_f32_16x16x32_bf16 v[64:67], v[24:27], v[8:11], v[20:23]
    ds_read_b128 v[24:27], v5 offset:8192
    s_waitcnt lgkmcnt(7)
    v_mfma_f32_16x16x32_bf16 v[68:71], v[28:31], v[8:11], v[20:23]
    v_mfma_f32_16x16x32_bf16 v[140:143], v[28:31], v[12:15], v[20:23]
    ds_read_b128 v[28:31], v5 offset:9216
    s_waitcnt lgkmcnt(7)
    s_cmp_gt_u32 s36, 1
    s_cselect_b32 s30, 0xf149f2ca, 0
    v_mov_b32 v20, s30
    v_mov_b32 v21, s30
    v_mov_b32 v22, s30
    v_mov_b32 v23, s30
    s_nop 1
    v_mfma_f32_16x16x32_bf16 v[72:75], v[32:35], v[8:11], v[20:23]
    v_mfma_f32_16x16x32_bf16 v[144:147], v[32:35], v[12:15], v[20:23]
    v_max3_f32 v232, v64, v65, v232
    v_max3_f32 v233, v66, v67, v233
    ds_read_b128 v[32:35], v5 offset:10240
    s_waitcnt lgkmcnt(7)
    v_mfma_f32_16x16x32_bf16 v[76:79], v[36:39], v[8:11], v[20:23]
    v_max3_f32 v232, v68, v69, v232
    v_max3_f32 v233, v70, v71, v233
    v_mfma_f32_16x16x32_bf16 v[148:151], v[36:39], v[12:15], v[20:23]
    v_max3_f32 v234, v140, v141, v234
    v_max3_f32 v235, v142, v143, v235
    ds_read_b128 v[36:39], v5 offset:11264
    s_waitcnt lgkmcnt(7)
    s_cmp_gt_u32 s36, 2
    s_cselect_b32 s30, 0xf149f2ca, 0
    v_mov_b32 v20, s30
    v_mov_b32 v21, s30
    v_mov_b32 v22, s30
    v_mov_b32 v23, s30
    s_nop 1
    v_mfma_f32_16x16x32_bf16 v[80:83], v[40:43], v[8:11], v[20:23]
    v_max3_f32 v232, v72, v73, v232
    v_max3_f32 v233, v74, v75, v233
    v_mfma_f32_16x16x32_bf16 v[152:155], v[40:43], v[12:15], v[20:23]
    v_max3_f32 v234, v144, v145, v234
    v_max3_f32 v235, v146, v147, v235
    ds_read_b128 v[40:43], v5 offset:12288
    s_waitcnt lgkmcnt(7)
    v_mfma_f32_16x16x32_bf16 v[84:87], v[44:47], v[8:11], v[20:23]
    v_max3_f32 v232, v76, v77, v232
    v_max3_f32 v233, v78, v79, v233
    v_mfma_f32_16x16x32_bf16 v[156:159], v[44:47], v[12:15], v[20:23]
    v_max3_f32 v234, v148, v149, v234
    v_max3_f32 v235, v150, v151, v235
    ds_read_b128 v[44:47], v5 offset:13312
    s_waitcnt lgkmcnt(7)
    s_cmp_gt_u32 s36, 3
    s_cselect_b32 s30, 0xf149f2ca, 0
    v_mov_b32 v20, s30
    v_mov_b32 v21, s30
    v_mov_b32 v22, s30
    v_mov_b32 v23, s30
    s_nop 1
    v_mfma_f32_16x16x32_bf16 v[88:91], v[48:51], v[8:11], v[20:23]
    v_max3_f32 v232, v80, v81, v232
    v_max3_f32 v233, v82, v83, v233
    v_mfma_f32_16x16x32_bf16 v[160:163], v[48:51], v[12:15], v[20:23]
    v_max3_f32 v234, v152, v153, v234
    v_max3_f32 v235, v154, v155, v235
    ds_read_b128 v[48:51], v5 offset:14336
    s_waitcnt lgkmcnt(7)
    v_mfma_f32_16x16x32_bf16 v[92:95], v[52:55], v[8:11], v[20:23]
    v_max3_f32 v232, v84, v85, v232
    v_max3_f32 v233, v86, v87, v233
    v_mfma_f32_16x16x32_bf16 v[164:167], v[52:55], v[12:15], v[20:23]
    v_max3_f32 v234, v156, v157, v234
    v_max3_f32 v235, v158, v159, v235
    ds_read_b128 v[52:55], v5 offset:15360
    s_waitcnt lgkmcnt(7)
    s_cmp_gt_u32 s36, 4
    s_cselect_b32 s30, 0xf149f2ca, 0
    v_mov_b32 v20, s30
    v_mov_b32 v21, s30
    v_mov_b32 v22, s30
    v_mov_b32 v23, s30
    s_nop 1
    v_mfma_f32_16x16x32_bf16 v[96:99], v[24:27], v[8:11], v[20:23]
    v_max3_f32 v232, v88, v89, v232
    v_max3_f32 v233, v90, v91, v233
    v_mfma_f32_16x16x32_bf16 v[168:171], v[24:27], v[12:15], v[20:23]
    v_max3_f32 v234, v160, v161, v234
    v_max3_f32 v235, v162, v163, v235
    ds_read_b128 v[24:27], v5 offset:16384
    s_waitcnt lgkmcnt(7)
    v_mfma_f32_16x16x32_bf16 v[100:103], v[28:31], v[8:11], v[20:23]
    v_max3_f32 v232, v92, v93, v232
    v_max3_f32 v233, v94, v95, v233
    v_mfma_f32_16x16x32_bf16 v[172:175], v[28:31], v[12:15], v[20:23]
    v_max3_f32 v234, v164, v165, v234
    v_max3_f32 v235, v166, v167, v235
    ds_read_b128 v[28:31], v5 offset:17408
    s_waitcnt lgkmcnt(7)
    s_cmp_gt_u32 s36, 5
    s_cselect_b32 s30, 0xf149f2ca, 0
    v_mov_b32 v20, s30
    v_mov_b32 v21, s30
    v_mov_b32 v22, s30
    v_mov_b32 v23, s30
    s_nop 1
    v_mfma_f32_16x16x32_bf16 v[104:107], v[32:35], v[8:11], v[20:23]
    v_max3_f32 v232, v96, v97, v232
    v_max3_f32 v233, v98, v99, v233
    v_mfma_f32_16x16x32_bf16 v[176:179], v[32:35], v[12:15], v[20:23]
    v_max3_f32 v234, v168, v169, v234
    v_max3_f32 v235, v170, v171, v235
    s_waitcnt lgkmcnt(6)
    v_mfma_f32_16x16x32_bf16 v[108:111], v[36:39], v[8:11], v[20:23]
    v_max3_f32 v232, v100, v101, v232
    v_max3_f32 v233, v102, v103, v233
    v_mfma_f32_16x16x32_bf16 v[180:183], v[36:39], v[12:15], v[20:23]
    v_max3_f32 v234, v172, v173, v234
    v_max3_f32 v235, v174, v175, v235
    s_waitcnt lgkmcnt(5)
    s_cmp_gt_u32 s36, 6
    s_cselect_b32 s30, 0xf149f2ca, 0
    v_mov_b32 v20, s30
    v_mov_b32 v21, s30
    v_mov_b32 v22, s30
    v_mov_b32 v23, s30
    s_nop 1
    v_mfma_f32_16x16x32_bf16 v[112:115], v[40:43], v[8:11], v[20:23]
    v_max3_f32 v232, v104, v105, v232
    v_max3_f32 v233, v106, v107, v233
    v_mfma_f32_16x16x32_bf16 v[184:187], v[40:43], v[12:15], v[20:23]
    v_max3_f32 v234, v176, v177, v234
    v_max3_f32 v235, v178, v179, v235
    s_waitcnt lgkmcnt(4)
    v_mfma_f32_16x16x32_bf16 v[116:119], v[44:47], v[8:11], v[20:23]
    v_max3_f32 v232, v108, v109, v232
    v_max3_f32 v233, v110, v111, v233
    v_mfma_f32_16x16x32_bf16 v[188:191], v[44:47], v[12:15], v[20:23]
    v_max3_f32 v234, v180, v181, v234
    v_max3_f32 v235, v182, v183, v235
    s_waitcnt lgkmcnt(3)
    s_cmp_gt_u32 s36, 7
    s_cselect_b32 s30, 0xf149f2ca, 0
    v_mov_b32 v20, s30
    v_mov_b32 v21, s30
    v_mov_b32 v22, s30
    v_mov_b32 v23, s30
    s_nop 1
    v_mfma_f32_16x16x32_bf16 v[120:123], v[48:51], v[8:11], v[20:23]
    v_max3_f32 v232, v112, v113, v232
    v_max3_f32 v233, v114, v115, v233
    v_mfma_f32_16x16x32_bf16 v[192:195], v[48:51], v[12:15], v[20:23]
    v_max3_f32 v234, v184, v185, v234
    v_max3_f32 v235, v186, v187, v235
    s_waitcnt lgkmcnt(2)
    v_mfma_f32_16x16x32_bf16 v[124:127], v[52:55], v[8:11], v[20:23]
    v_max3_f32 v232, v116, v117, v232
    v_max3_f32 v233, v118, v119, v233
    v_mfma_f32_16x16x32_bf16 v[196:199], v[52:55], v[12:15], v[20:23]
    v_max3_f32 v234, v188, v189, v234
    v_max3_f32 v235, v190, v191, v235
    s_waitcnt lgkmcnt(1)
    v_mfma_f32_16x16x32_bf16 v[128:131], v[24:27], v[8:11], v[60:63]
    v_max3_f32 v232, v120, v121, v232
    v_max3_f32 v233, v122, v123, v233
    v_mfma_f32_16x16x32_bf16 v[200:203], v[24:27], v[12:15], 0
    v_max3_f32 v234, v192, v193, v234
    v_max3_f32 v235, v194, v195, v235
    s_waitcnt lgkmcnt(0)
    v_mfma_f32_16x16x32_bf16 v[204:207], v[28:31], v[12:15], v[60:63]
    v_max3_f32 v232, v124, v125, v232
    v_max3_f32 v233, v126, v127, v233
    v_max3_f32 v234, v196, v197, v234
    v_max3_f32 v235, v198, v199, v235
    v_max3_f32 v232, v128, v129, v232
    v_max3_f32 v233, v130, v131, v233
    v_max3_f32 v234, v200, v201, v234
    v_max3_f32 v235, v202, v203, v235
    v_max3_f32 v234, v204, v205, v234
    v_max3_f32 v235, v206, v207, v235
sx_117:
    s_mov_b32 s74, 0x3e8293ee
    s_mov_b32 s75, 0x3e8293ee
    v_max_f32 v232, v232, v233
    v_max_f32 v234, v234, v235
    v_mov_b32 v233, v232
    v_mov_b32 v235, v234
    s_nop 0
    v_permlane16_swap_b32 v232, v233
    v_permlane16_swap_b32 v234, v235
    v_max_f32 v232, v232, v233
    v_max_f32 v234, v234, v235
    v_mov_b32 v233, v232
    v_mov_b32 v235, v234
    s_nop 0
    v_permlane32_swap_b32 v232, v233
    v_permlane32_swap_b32 v234, v235
    v_max_f32 v232, v232, v233
    v_max_f32 v234, v234, v235
    v_mul_f32 v232, 0xbe8293ee, v232
    v_mul_f32 v234, 0xbe8293ee, v234
    v_pk_fma_f32 v[64:65], v[64:65], s[74:75], v[232:233] op_sel_hi:[1,1,0]
    v_pk_fma_f32 v[66:67], v[66:67], s[74:75], v[232:233] op_sel_hi:[1,1,0]
    v_pk_fma_f32 v[68:69], v[68:69], s[74:75], v[232:233] op_sel_hi:[1,1,0]
    v_pk_fma_f32 v[70:71], v[70:71], s[74:75], v[232:233] op_sel_hi:[1,1,0]
    v_pk_fma_f32 v[140:141], v[140:141], s[74:75], v[234:235] op_sel_hi:[1,1,0]
    v_pk_fma_f32 v[142:143], v[142:143], s[74:75], v[234:235] op_sel_hi:[1,1,0]
    v_exp_f32 v64, v64
    v_exp_f32 v65, v65
    v_exp_f32 v66, v66
    v_exp_f32 v67, v67
    v_exp_f32 v68, v68
    v_exp_f32 v69, v69
    v_exp_f32 v70, v70
    v_exp_f32 v71, v71
    v_exp_f32 v140, v140
    v_exp_f32 v141, v141
    v_exp_f32 v142, v142
    v_exp_f32 v143, v143
    v_cvt_pk_bf16_f32 v64, v64, v65
    v_cvt_pk_bf16_f32 v65, v66, v67
    v_cvt_pk_bf16_f32 v66, v68, v69
    v_cvt_pk_bf16_f32 v67, v70, v71
    v_cvt_pk_bf16_f32 v138, v140, v141
    v_cvt_pk_bf16_f32 v139, v142, v143
    v_mov_b64 v[136:137], 0
    s_waitcnt vmcnt(1)
    s_barrier
    ds_read_b128 v[24:27], v7 offset:0
    ds_read_b128 v[28:31], v7 offset:1024
    ds_read_b128 v[32:35], v7 offset:2048
    ds_read_b128 v[36:39], v7 offset:3072
    ds_read_b128 v[40:43], v7 offset:4096
    ds_read_b128 v[44:47], v7 offset:5120
    ds_read_b128 v[48:51], v7 offset:6144
    ds_read_b128 v[52:55], v7 offset:7168
    v_pk_fma_f32 v[72:73], v[72:73], s[74:75], v[232:233] op_sel_hi:[1,1,0]
    v_pk_fma_f32 v[74:75], v[74:75], s[74:75], v[232:233] op_sel_hi:[1,1,0]
    v_pk_fma_f32 v[76:77], v[76:77], s[74:75], v[232:233] op_sel_hi:[1,1,0]
    v_pk_fma_f32 v[78:79], v[78:79], s[74:75], v[232:233] op_sel_hi:[1,1,0]
    v_pk_fma_f32 v[144:145], v[144:145], s[74:75], v[234:235] op_sel_hi:[1,1,0]
    v_pk_fma_f32 v[146:147], v[146:147], s[74:75], v[234:235] op_sel_hi:[1,1,0]
    v_pk_fma_f32 v[148:149], v[148:149], s[74:75], v[234:235] op_sel_hi:[1,1,0]
    v_pk_fma_f32 v[150:151], v[150:151], s[74:75], v[234:235] op_sel_hi:[1,1,0]
    v_exp_f32 v72, v72
    v_exp_f32 v73, v73
    v_exp_f32 v74, v74
    v_exp_f32 v75, v75
    v_exp_f32 v76, v76
    v_exp_f32 v77, v77
    v_exp_f32 v78, v78
    v_exp_f32 v79, v79
    v_exp_f32 v144, v144
    v_exp_f32 v145, v145
    v_exp_f32 v146, v146
    v_exp_f32 v147, v147
    v_exp_f32 v148, v148
    v_exp_f32 v149, v149
    v_exp_f32 v150, v150
    v_exp_f32 v151, v151
    v_cvt_pk_bf16_f32 v72, v72, v73
    v_cvt_pk_bf16_f32 v73, v74, v75
    v_cvt_pk_bf16_f32 v74, v76, v77
    v_cvt_pk_bf16_f32 v75, v78, v79
    v_cvt_pk_bf16_f32 v144, v144, v145
    v_cvt_pk_bf16_f32 v145, v146, v147
    v_cvt_pk_bf16_f32 v146, v148, v149
    v_cvt_pk_bf16_f32 v147, v150, v151
    s_waitcnt lgkmcnt(4)
    v_pk_fma_f32 v[80:81], v[80:81], s[74:75], v[232:233] op_sel_hi:[1,1,0]
    v_pk_fma_f32 v[82:83], v[82:83], s[74:75], v[232:233] op_sel_hi:[1,1,0]
    v_mfma_f32_16x16x32_bf16 v[208:211], v[24:27], v[64:67], v[208:211]
    v_pk_fma_f32 v[84:85], v[84:85], s[74:75], v[232:233] op_sel_hi:[1,1,0]
    v_pk_fma_f32 v[86:87], v[86:87], s[74:75], v[232:233] op_sel_hi:[1,1,0]
    v_mfma_f32_16x16x32_bf16 v[212:215], v[28:31], v[64:67], v[212:215]
    v_pk_fma_f32 v[152:153], v[152:153], s[74:75], v[234:235] op_sel_hi:[1,1,0]
    v_pk_fma_f32 v[154:155], v[154:155], s[74:75], v[234:235] op_sel_hi:[1,1,0]
    v_mfma_f32_16x16x32_bf16 v[216:219], v[16:19], v[64:67], v[216:219]
    v_pk_fma_f32 v[156:157], v[156:157], s[74:75], v[234:235] op_sel_hi:[1,1,0]
    v_pk_fma_f32 v[158:159], v[158:159], s[74:75], v[234:235] op_sel_hi:[1,1,0]
    v_mfma_f32_16x16x32_bf16 v[220:223], v[24:27], v[136:139], v[220:223]
    v_exp_f32 v80, v80
    v_exp_f32 v81, v81
    v_mfma_f32_16x16x32_bf16 v[224:227], v[28:31], v[136:139], v[224:227]
    v_exp_f32 v82, v82
    v_exp_f32 v83, v83
    v_mfma_f32_16x16x32_bf16 v[228:231], v[16:19], v[136:139], v[228:231]
    v_exp_f32 v84, v84
    v_exp_f32 v85, v85
    v_mfma_f32_16x16x32_bf16 v[208:211], v[32:35], v[72:75], v[208:211]
    v_exp_f32 v86, v86
    v_exp_f32 v87, v87
    v_mfma_f32_16x16x32_bf16 v[212:215], v[36:39], v[72:75], v[212:215]
    v_exp_f32 v152, v152
    v_exp_f32 v153, v153
    v_mfma_f32_16x16x32_bf16 v[216:219], v[16:19], v[72:75], v[216:219]
    v_exp_f32 v154, v154
    v_exp_f32 v155, v155
    v_mfma_f32_16x16x32_bf16 v[220:223], v[32:35], v[144:147], v[220:223]
    v_exp_f32 v156, v156
    v_exp_f32 v157, v157
    v_mfma_f32_16x16x32_bf16 v[224:227], v[36:39], v[144:147], v[224:227]
    v_exp_f32 v158, v158
    v_exp_f32 v159, v159
    v_mfma_f32_16x16x32_bf16 v[228:231], v[16:19], v[144:147], v[228:231]
    v_cvt_pk_bf16_f32 v80, v80, v81
    v_cvt_pk_bf16_f32 v81, v82, v83
    v_cvt_pk_bf16_f32 v82, v84, v85
    v_cvt_pk_bf16_f32 v83, v86, v87
    v_cvt_pk_bf16_f32 v152, v152, v153
    v_cvt_pk_bf16_f32 v153, v154, v155
    v_cvt_pk_bf16_f32 v154, v156, v157
    v_cvt_pk_bf16_f32 v155, v158, v159
    ds_read_b128 v[24:27], v7 offset:8192
    ds_read_b128 v[28:31], v7 offset:9216
    ds_read_b128 v[32:35], v7 offset:10240
    ds_read_b128 v[36:39], v7 offset:11264
    s_waitcnt lgkmcnt(6)
    v_pk_fma_f32 v[88:89], v[88:89], s[74:75], v[232:233] op_sel_hi:[1,1,0]
    v_pk_fma_f32 v[90:91], v[90:91], s[74:75], v[232:233] op_sel_hi:[1,1,0]
    v_mfma_f32_16x16x32_bf16 v[208:211], v[40:43], v[80:83], v[208:211]
    v_pk_fma_f32 v[92:93], v[92:93], s[74:75], v[232:233] op_sel_hi:[1,1,0]
    v_pk_fma_f32 v[94:95], v[94:95], s[74:75], v[232:233] op_sel_hi:[1,1,0]
    v_pk_fma_f32 v[160:161], v[160:161], s[74:75], v[234:235] op_sel_hi:[1,1,0]
    v_pk_fma_f32 v[162:163], v[162:163], s[74:75], v[234:235] op_sel_hi:[1,1,0]
    v_mfma_f32_16x16x32_bf16 v[212:215], v[44:47], v[80:83], v[212:215]
    v_pk_fma_f32 v[164:165], v[164:165], s[74:75], v[234:235] op_sel_hi:[1,1,0]
    v_pk_fma_f32 v[166:167], v[166:167], s[74:75], v[234:235] op_sel_hi:[1,1,0]
    v_exp_f32 v88, v88
    v_exp_f32 v89, v89
    v_mfma_f32_16x16x32_bf16 v[216:219], v[16:19], v[80:83], v[216:219]
    v_exp_f32 v90, v90
    v_exp_f32 v91, v91
    v_exp_f32 v92, v92
    v_exp_f32 v93, v93
    v_mfma_f32_16x16x32_bf16 v[220:223], v[40:43], v[152:155], v[220:223]
    v_exp_f32 v94, v94
    v_exp_f32 v95, v95
    v_exp_f32 v160, v160
    v_exp_f32 v161, v161
    v_mfma_f32_16x16x32_bf16 v[224:227], v[44:47], v[152:155], v[224:227]
    v_exp_f32 v162, v162
    v_exp_f32 v163, v163
    v_exp_f32 v164, v164
    v_exp_f32 v165, v165
    v_mfma_f32_16x16x32_bf16 v[228:231], v[16:19], v[152:155], v[228:231]
    v_exp_f32 v166, v166
    v_exp_f32 v167, v167
    v_cvt_pk_bf16_f32 v88, v88, v89
    v_cvt_pk_bf16_f32 v89, v90, v91
    v_cvt_pk_bf16_f32 v90, v92, v93
    v_cvt_pk_bf16_f32 v91, v94, v95
    v_cvt_pk_bf16_f32 v160, v160, v161
    v_cvt_pk_bf16_f32 v161, v162, v163
    v_cvt_pk_bf16_f32 v162, v164, v165
    v_cvt_pk_bf16_f32 v163, v166, v167
    ds_read_b128 v[40:43], v7 offset:12288
    ds_read_b128 v[44:47], v7 offset:13312
    s_waitcnt lgkmcnt(6)
    v_pk_fma_f32 v[96:97], v[96:97], s[74:75], v[232:233] op_sel_hi:[1,1,0]
    v_pk_fma_f32 v[98:99], v[98:99], s[74:75], v[232:233] op_sel_hi:[1,1,0]
    v_mfma_f32_16x16x32_bf16 v[208:211], v[48:51], v[88:91], v[208:211]
    v_pk_fma_f32 v[100:101], v[100:101], s[74:75], v[232:233] op_sel_hi:[1,1,0]
    v_pk_fma_f32 v[102:103], v[102:103], s[74:75], v[232:233] op_sel_hi:[1,1,0]
    v_pk_fma_f32 v[168:169], v[168:169], s[74:75], v[234:235] op_sel_hi:[1,1,0]
    v_pk_fma_f32 v[170:171], v[170:171], s[74:75], v[234:235] op_sel_hi:[1,1,0]
    v_mfma_f32_16x16x32_bf16 v[212:215], v[52:55], v[88:91], v[212:215]
    v_pk_fma_f32 v[172:173], v[172:173], s[74:75], v[234:235] op_sel_hi:[1,1,0]
    v_pk_fma_f32 v[174:175], v[174:175], s[74:75], v[234:235] op_sel_hi:[1,1,0]
    v_exp_f32 v96, v96
    v_exp_f32 v97, v97
    v_mfma_f32_16x16x32_bf16 v[216:219], v[16:19], v[88:91], v[216:219]
    v_exp_f32 v98, v98
    v_exp_f32 v99, v99
    v_exp_f32 v100, v100
    v_exp_f32 v101, v101
    v_mfma_f32_16x16x32_bf16 v[220:223], v[48:51], v[160:163], v[220:223]
    v_exp_f32 v102, v102
    v_exp_f32 v103, v103
    v_exp_f32 v168, v168
    v_exp_f32 v169, v169
    v_mfma_f32_16x16x32_bf16 v[224:227], v[52:55], v[160:163], v[224:227]
    v_exp_f32 v170, v170
    v_exp_f32 v171, v171
    v_exp_f32 v172, v172
    v_exp_f32 v173, v173
    v_mfma_f32_16x16x32_bf16 v[228:231], v[16:19], v[160:163], v[228:231]
    v_exp_f32 v174, v174
    v_exp_f32 v175, v175
    v_cvt_pk_bf16_f32 v96, v96, v97
    v_cvt_pk_bf16_f32 v97, v98, v99
    v_cvt_pk_bf16_f32 v98, v100, v101
    v_cvt_pk_bf16_f32 v99, v102, v103
    v_cvt_pk_bf16_f32 v168, v168, v169
    v_cvt_pk_bf16_f32 v169, v170, v171
    v_cvt_pk_bf16_f32 v170, v172, v173
    v_cvt_pk_bf16_f32 v171, v174, v175
    ds_read_b128 v[48:51], v7 offset:14336
    ds_read_b128 v[52:55], v7 offset:15360
    s_waitcnt lgkmcnt(6)
    v_pk_fma_f32 v[104:105], v[104:105], s[74:75], v[232:233] op_sel_hi:[1,1,0]
    v_pk_fma_f32 v[106:107], v[106:107], s[74:75], v[232:233] op_sel_hi:[1,1,0]
    v_mfma_f32_16x16x32_bf16 v[208:211], v[24:27], v[96:99], v[208:211]
    v_pk_fma_f32 v[108:109], v[108:109], s[74:75], v[232:233] op_sel_hi:[1,1,0]
    v_pk_fma_f32 v[110:111], v[110:111], s[74:75], v[232:233] op_sel_hi:[1,1,0]
    v_pk_fma_f32 v[176:177], v[176:177], s[74:75], v[234:235] op_sel_hi:[1,1,0]
    v_pk_fma_f32 v[178:179], v[178:179], s[74:75], v[234:235] op_sel_hi:[1,1,0]
    v_mfma_f32_16x16x32_bf16 v[212:215], v[28:31], v[96:99], v[212:215]
    v_pk_fma_f32 v[180:181], v[180:181], s[74:75], v[234:235] op_sel_hi:[1,1,0]
    v_pk_fma_f32 v[182:183], v[182:183], s[74:75], v[234:235] op_sel_hi:[1,1,0]
    v_exp_f32 v104, v104
    v_exp_f32 v105, v105
    v_mfma_f32_16x16x32_bf16 v[216:219], v[16:19], v[96:99], v[216:219]
    v_exp_f32 v106, v106
    v_exp_f32 v107, v107
    v_exp_f32 v108, v108
    v_exp_f32 v109, v109
    v_mfma_f32_16x16x32_bf16 v[220:223], v[24:27], v[168:171], v[220:223]
    v_exp_f32 v110, v110
    v_exp_f32 v111, v111
    v_exp_f32 v176, v176
    v_exp_f32 v177, v177
    v_mfma_f32_16x16x32_bf16 v[224:227], v[28:31], v[168:171], v[224:227]
    v_exp_f32 v178, v178
    v_exp_f32 v179, v179
    v_exp_f32 v180, v180
    v_exp_f32 v181, v181
    v_mfma_f32_16x16x32_bf16 v[228:231], v[16:19], v[168:171], v[228:231]
    v_exp_f32 v182, v182
    v_exp_f32 v183, v183
    v_cvt_pk_bf16_f32 v104, v104, v105
    v_cvt_pk_bf16_f32 v105, v106, v107
    v_cvt_pk_bf16_f32 v106, v108, v109
    v_cvt_pk_bf16_f32 v107, v110, v111
    v_cvt_pk_bf16_f32 v176, v176, v177
    v_cvt_pk_bf16_f32 v177, v178, v179
    v_cvt_pk_bf16_f32 v178, v180, v181
    v_cvt_pk_bf16_f32 v179, v182, v183
    ds_read_b128 v[24:27], v7 offset:16384
    ds_read_b128 v[28:31], v7 offset:17408
    s_waitcnt lgkmcnt(6)
    v_pk_fma_f32 v[112:113], v[112:113], s[74:75], v[232:233] op_sel_hi:[1,1,0]
    v_pk_fma_f32 v[114:115], v[114:115], s[74:75], v[232:233] op_sel_hi:[1,1,0]
    v_mfma_f32_16x16x32_bf16 v[208:211], v[32:35], v[104:107], v[208:211]
    v_pk_fma_f32 v[116:117], v[116:117], s[74:75], v[232:233] op_sel_hi:[1,1,0]
    v_pk_fma_f32 v[118:119], v[118:119], s[74:75], v[232:233] op_sel_hi:[1,1,0]
    v_pk_fma_f32 v[184:185], v[184:185], s[74:75], v[234:235] op_sel_hi:[1,1,0]
    v_pk_fma_f32 v[186:187], v[186:187], s[74:75], v[234:235] op_sel_hi:[1,1,0]
    v_mfma_f32_16x16x32_bf16 v[212:215], v[36:39], v[104:107], v[212:215]
    v_pk_fma_f32 v[188:189], v[188:189], s[74:75], v[234:235] op_sel_hi:[1,1,0]
    v_pk_fma_f32 v[190:191], v[190:191], s[74:75], v[234:235] op_sel_hi:[1,1,0]
    v_exp_f32 v112, v112
    v_exp_f32 v113, v113
    v_mfma_f32_16x16x32_bf16 v[216:219], v[16:19], v[104:107], v[216:219]
    v_exp_f32 v114, v114
    v_exp_f32 v115, v115
    v_exp_f32 v116, v116
    v_exp_f32 v117, v117
    v_mfma_f32_16x16x32_bf16 v[220:223], v[32:35], v[176:179], v[220:223]
    v_exp_f32 v118, v118
    v_exp_f32 v119, v119
    v_exp_f32 v184, v184
    v_exp_f32 v185, v185
    v_mfma_f32_16x16x32_bf16 v[224:227], v[36:39], v[176:179], v[224:227]
    v_exp_f32 v186, v186
    v_exp_f32 v187, v187
    v_exp_f32 v188, v188
    v_exp_f32 v189, v189
    v_mfma_f32_16x16x32_bf16 v[228:231], v[16:19], v[176:179], v[228:231]
    v_exp_f32 v190, v190
    v_exp_f32 v191, v191
    v_cvt_pk_bf16_f32 v112, v112, v113
    v_cvt_pk_bf16_f32 v113, v114, v115
    v_cvt_pk_bf16_f32 v114, v116, v117
    v_cvt_pk_bf16_f32 v115, v118, v119
    v_cvt_pk_bf16_f32 v184, v184, v185
    v_cvt_pk_bf16_f32 v185, v186, v187
    v_cvt_pk_bf16_f32 v186, v188, v189
    v_cvt_pk_bf16_f32 v187, v190, v191
    s_waitcnt lgkmcnt(4)
    v_pk_fma_f32 v[120:121], v[120:121], s[74:75], v[232:233] op_sel_hi:[1,1,0]
    v_pk_fma_f32 v[122:123], v[122:123], s[74:75], v[232:233] op_sel_hi:[1,1,0]
    v_mfma_f32_16x16x32_bf16 v[208:211], v[40:43], v[112:115], v[208:211]
    v_pk_fma_f32 v[124:125], v[124:125], s[74:75], v[232:233] op_sel_hi:[1,1,0]
    v_pk_fma_f32 v[126:127], v[126:127], s[74:75], v[232:233] op_sel_hi:[1,1,0]
    v_pk_fma_f32 v[192:193], v[192:193], s[74:75], v[234:235] op_sel_hi:[1,1,0]
    v_pk_fma_f32 v[194:195], v[194:195], s[74:75], v[234:235] op_sel_hi:[1,1,0]
    v_mfma_f32_16x16x32_bf16 v[212:215], v[44:47], v[112:115], v[212:215]
    v_pk_fma_f32 v[196:197], v[196:197], s[74:75], v[234:235] op_sel_hi:[1,1,0]
    v_pk_fma_f32 v[198:199], v[198:199], s[74:75], v[234:235] op_sel_hi:[1,1,0]
    v_exp_f32 v120, v120
    v_exp_f32 v121, v121
    v_mfma_f32_16x16x32_bf16 v[216:219], v[16:19], v[112:115], v[216:219]
    v_exp_f32 v122, v122
    v_exp_f32 v123, v123
    v_exp_f32 v124, v124
    v_exp_f32 v125, v125
    v_mfma_f32_16x16x32_bf16 v[220:223], v[40:43], v[184:187], v[220:223]
    v_exp_f32 v126, v126
    v_exp_f32 v127, v127
    v_exp_f32 v192, v192
    v_exp_f32 v193, v193
    v_mfma_f32_16x16x32_bf16 v[224:227], v[44:47], v[184:187], v[224:227]
    v_exp_f32 v194, v194
    v_exp_f32 v195, v195
    v_exp_f32 v196, v196
    v_exp_f32 v197, v197
    v_mfma_f32_16x16x32_bf16 v[228:231], v[16:19], v[184:187], v[228:231]
    v_exp_f32 v198, v198
    v_exp_f32 v199, v199
    v_cvt_pk_bf16_f32 v120, v120, v121
    v_cvt_pk_bf16_f32 v121, v122, v123
    v_cvt_pk_bf16_f32 v122, v124, v125
    v_cvt_pk_bf16_f32 v123, v126, v127
    v_cvt_pk_bf16_f32 v192, v192, v193
    v_cvt_pk_bf16_f32 v193, v194, v195
    v_cvt_pk_bf16_f32 v194, v196, v197
    v_cvt_pk_bf16_f32 v195, v198, v199
    s_waitcnt lgkmcnt(2)
    v_pk_fma_f32 v[128:129], v[128:129], s[74:75], v[232:233] op_sel_hi:[1,1,0]
    v_pk_fma_f32 v[130:131], v[130:131], s[74:75], v[232:233] op_sel_hi:[1,1,0]
    v_mfma_f32_16x16x32_bf16 v[208:211], v[48:51], v[120:123], v[208:211]
    v_pk_fma_f32 v[200:201], v[200:201], s[74:75], v[234:235] op_sel_hi:[1,1,0]
    v_pk_fma_f32 v[202:203], v[202:203], s[74:75], v[234:235] op_sel_hi:[1,1,0]
    v_pk_fma_f32 v[204:205], v[204:205], s[74:75], v[234:235] op_sel_hi:[1,1,0]
    v_mfma_f32_16x16x32_bf16 v[212:215], v[52:55], v[120:123], v[212:215]
    v_pk_fma_f32 v[206:207], v[206:207], s[74:75], v[234:235] op_sel_hi:[1,1,0]
    v_exp_f32 v128, v128
    v_exp_f32 v129, v129
    v_mfma_f32_16x16x32_bf16 v[216:219], v[16:19], v[120:123], v[216:219]
    v_exp_f32 v130, v130
    v_exp_f32 v131, v131
    v_exp_f32 v200, v200
    v_mfma_f32_16x16x32_bf16 v[220:223], v[48:51], v[192:195], v[220:223]
    v_exp_f32 v201, v201
    v_exp_f32 v202, v202
    v_exp_f32 v203, v203
    v_mfma_f32_16x16x32_bf16 v[224:227], v[52:55], v[192:195], v[224:227]
    v_exp_f32 v204, v204
    v_exp_f32 v205, v205
    v_exp_f32 v206, v206
    v_mfma_f32_16x16x32_bf16 v[228:231], v[16:19], v[192:195], v[228:231]
    v_exp_f32 v207, v207
    v_cvt_pk_bf16_f32 v128, v128, v129
    v_cvt_pk_bf16_f32 v129, v130, v131
    v_cvt_pk_bf16_f32 v200, v200, v201
    v_cvt_pk_bf16_f32 v201, v202, v203
    v_cvt_pk_bf16_f32 v202, v204, v205
    v_cvt_pk_bf16_f32 v203, v206, v207
    v_mov_b64 v[130:131], 0
    s_waitcnt lgkmcnt(0)
    s_nop 0
    v_mfma_f32_16x16x32_bf16 v[208:211], v[24:27], v[128:131], v[208:211]
    v_mfma_f32_16x16x32_bf16 v[212:215], v[28:31], v[128:131], v[212:215]
    v_mfma_f32_16x16x32_bf16 v[216:219], v[16:19], v[128:131], v[216:219]
    v_mfma_f32_16x16x32_bf16 v[220:223], v[24:27], v[200:203], v[220:223]
    v_mfma_f32_16x16x32_bf16 v[224:227], v[28:31], v[200:203], v[224:227]
    v_mfma_f32_16x16x32_bf16 v[228:231], v[16:19], v[200:203], v[228:231]
    v_lshlrev_b32 v2, 4, v1
    s_nop 3
    v_rcp_f32 v216, v216
    s_nop 0
    v_pk_mul_f32 v[208:209], v[208:209], v[216:217] op_sel_hi:[1,0]
    v_pk_mul_f32 v[210:211], v[210:211], v[216:217] op_sel_hi:[1,0]
    v_pk_mul_f32 v[212:213], v[212:213], v[216:217] op_sel_hi:[1,0]
    v_pk_mul_f32 v[214:215], v[214:215], v[216:217] op_sel_hi:[1,0]
    v_cvt_pk_bf16_f32 v24, v208, v209
    v_cvt_pk_bf16_f32 v25, v210, v211
    v_cvt_pk_bf16_f32 v26, v212, v213
    v_cvt_pk_bf16_f32 v27, v214, v215
    buffer_store_dwordx4 v[24:27], v2, s[8:11], s34 offen sc1
    v_rcp_f32 v228, v228
    s_nop 0
    v_pk_mul_f32 v[220:221], v[220:221], v[228:229] op_sel_hi:[1,0]
    v_pk_mul_f32 v[222:223], v[222:223], v[228:229] op_sel_hi:[1,0]
    v_pk_mul_f32 v[224:225], v[224:225], v[228:229] op_sel_hi:[1,0]
    v_pk_mul_f32 v[226:227], v[226:227], v[228:229] op_sel_hi:[1,0]
    v_cvt_pk_bf16_f32 v28, v220, v221
    v_cvt_pk_bf16_f32 v29, v222, v223
    v_cvt_pk_bf16_f32 v30, v224, v225
    v_cvt_pk_bf16_f32 v31, v226, v227
    buffer_store_dwordx4 v[28:31], v2, s[8:11], s35 offen sc1
    s_and_b32 s24, s22, 3
    s_lshl_b32 s24, s24, 2
    s_bfe_u32 s30, s23, 0x20001
    s_add_u32 s24, s24, s30
    s_lshr_b32 s25, s22, 2
    s_lshl_b32 s25, s25, 2
    s_lshr_b32 s30, s23, 3
    s_add_u32 s25, s25, s30
    s_lshl_b32 s25, s25, 1
    s_and_b32 s30, s23, 1
    s_add_u32 s25, s25, s30
    s_mov_b32 s12, s52
    s_and_b32 s13, s53, 0xffff
    s_mov_b32 s14, 2097152
    s_mov_b32 s15, 0x20000
    s_lshl_b32 s26, s25, 7
    s_mov_b32 s67, 0
    s_lshl_b32 s101, s25, 1
    s_and_b32 s101, s101, 0
    ds_read_b32 v8, v253 offset:2048
    s_lshl_b32 s68, s21, 13
    v_lshl_add_u32 v232, v1, 4, s68
    v_mov_b32 v233, v232
    s_lshl_b32 s66, s24, 16
    s_add_u32 s66, s66, 32768

    s_lshl_b32 s69, s29, 12
    s_lshl_b32 s70, s29, 11
    v_lshrrev_b32 v246, 3, v1
    s_lshl_b32 s30, s29, 5
    v_add_u32 v246, s30, v246
    v_mul_u32_u24 v246, 2048, v246
    v_and_b32 v247, 1, v1
    v_lshl_add_u32 v246, v247, 4, v246
    v_add_u32 v246, s26, v246
    v_bfe_u32 v247, v1, 1, 2

    v_xor_b32 v245, v247, v3
    v_lshl_add_u32 v236, v245, 5, v246
    v_add_u32 v237, 15360, v236
    v_add_u32 v238, 30720, v236
    v_add_u32 v239, 30720, v237
    s_waitcnt lgkmcnt(0)
    v_readfirstlane_b32 s54, v8
    s_waitcnt vmcnt(0)
    v_mov_b32 v5, 0
    v_mov_b32 v6, 1
    s_mov_b64 exec, 1
    buffer_store_dword v6, v5, s[8:11], s33 offen sc1
    s_mov_b64 exec, -1
    s_barrier
    s_cmp_ge_u32 s21, 2
    s_cbranch_scc1 L_hrest
    s_lshl_b32 s32, s24, 11
    s_add_u32 s32, s32, 44302336
    v_lshrrev_b32 v10, 2, v1
    v_lshlrev_b32 v10, 7, v10
    v_and_b32 v11, 3, v1
    v_lshl_add_u32 v10, v11, 3, v10
    s_mov_b64 s[40:41], -1
    s_mov_b32 s72, 0
    s_waitcnt vmcnt(0)
    s_and_b32 s30, s40, 0xff
    s_cbranch_scc0 nfx_119
nf_118:
    s_mov_b32 exec_lo, 0xf0fff
    s_mov_b32 exec_hi, 0x0
    buffer_load_dwordx2 v[8:9], v10, s[8:11], s32 offen sc1
    s_waitcnt vmcnt(0)
    v_and_b32 v8, v8, v9
    v_and_b32 v8, 1, v8
    v_cmp_ne_u32 s[40:41], 1, v8
    s_orn2_b64 s[40:41], s[40:41], exec
    s_mov_b64 exec, -1
    s_add_u32 s72, s72, 1
    s_cmp_gt_u32 s72, 524288
    s_cbranch_scc1 nfx_119
    s_and_b32 s30, s40, 0xff
    s_cbranch_scc1 nf_118
nfx_119:
    s_add_u32 s98, s66, 0
    s_add_u32 m0, s68, 0
    s_add_u32 s31, s98, 0
    buffer_load_dwordx4 v232, s[8:11], s31 offen offset:0 sc1 lds
    buffer_load_dwordx4 v232, s[8:11], s31 offen offset:1024 sc1 lds
    buffer_load_dwordx4 v233, s[8:11], s31 offen offset:2048 sc1 lds
    buffer_load_dwordx4 v233, s[8:11], s31 offen offset:3072 sc1 lds
    s_add_u32 m0, s68, 4096
    s_add_u32 s31, s98, 4096
    buffer_load_dwordx4 v232, s[8:11], s31 offen offset:0 sc1 lds
    buffer_load_dwordx4 v232, s[8:11], s31 offen offset:1024 sc1 lds
    buffer_load_dwordx4 v233, s[8:11], s31 offen offset:2048 sc1 lds
    buffer_load_dwordx4 v233, s[8:11], s31 offen offset:3072 sc1 lds
    s_add_u32 s98, s66, 1048576
    s_add_u32 m0, s68, 16384
    s_add_u32 s31, s98, 0
    buffer_load_dwordx4 v232, s[8:11], s31 offen offset:0 sc1 lds
    buffer_load_dwordx4 v232, s[8:11], s31 offen offset:1024 sc1 lds
    buffer_load_dwordx4 v233, s[8:11], s31 offen offset:2048 sc1 lds
    buffer_load_dwordx4 v233, s[8:11], s31 offen offset:3072 sc1 lds
    s_add_u32 m0, s68, 20480
    s_add_u32 s31, s98, 4096
    buffer_load_dwordx4 v232, s[8:11], s31 offen offset:0 sc1 lds
    buffer_load_dwordx4 v232, s[8:11], s31 offen offset:1024 sc1 lds
    buffer_load_dwordx4 v233, s[8:11], s31 offen offset:2048 sc1 lds
    buffer_load_dwordx4 v233, s[8:11], s31 offen offset:3072 sc1 lds
    s_waitcnt vmcnt(8)
    s_barrier
    s_and_b32 s30, s40, 0xf00
    s_cbranch_scc0 nfx_121
nf_120:
    s_mov_b32 exec_lo, 0xffffff00
    s_mov_b32 exec_hi, 0xffffffff
    buffer_load_dwordx2 v[8:9], v10, s[8:11], s32 offen sc1
    s_waitcnt vmcnt(0)
    v_and_b32 v8, v8, v9
    v_and_b32 v8, 1, v8
    v_cmp_ne_u32 s[40:41], 1, v8
    s_orn2_b64 s[40:41], s[40:41], exec
    s_mov_b64 exec, -1
    s_add_u32 s72, s72, 1
    s_cmp_gt_u32 s72, 524288
    s_cbranch_scc1 nfx_121
    s_and_b32 s30, s40, 0xf00
    s_cbranch_scc1 nf_120
nfx_121:
    s_add_u32 s98, s66, 2097152
    s_add_u32 m0, s68, 32768
    s_add_u32 s31, s98, 0
    buffer_load_dwordx4 v232, s[8:11], s31 offen offset:0 sc1 lds
    buffer_load_dwordx4 v232, s[8:11], s31 offen offset:1024 sc1 lds
    buffer_load_dwordx4 v233, s[8:11], s31 offen offset:2048 sc1 lds
    buffer_load_dwordx4 v233, s[8:11], s31 offen offset:3072 sc1 lds
    s_add_u32 m0, s68, 36864
    s_add_u32 s31, s98, 4096
    buffer_load_dwordx4 v232, s[8:11], s31 offen offset:0 sc1 lds
    buffer_load_dwordx4 v232, s[8:11], s31 offen offset:1024 sc1 lds
    buffer_load_dwordx4 v233, s[8:11], s31 offen offset:2048 sc1 lds
    buffer_load_dwordx4 v233, s[8:11], s31 offen offset:3072 sc1 lds
    s_and_b32 s30, s40, 0xf0000
    s_cbranch_scc0 nfx_123
nf_122:
    s_mov_b32 exec_lo, 0xfffff000
    s_mov_b32 exec_hi, 0xffffffff
    buffer_load_dwordx2 v[8:9], v10, s[8:11], s32 offen sc1
    s_waitcnt vmcnt(0)
    v_and_b32 v8, v8, v9
    v_and_b32 v8, 1, v8
    v_cmp_ne_u32 s[40:41], 1, v8
    s_orn2_b64 s[40:41], s[40:41], exec
    s_mov_b64 exec, -1
    s_add_u32 s72, s72, 1
    s_cmp_gt_u32 s72, 524288
    s_cbranch_scc1 nfx_123
    s_and_b32 s30, s40, 0xf0000
    s_cbranch_scc1 nf_122
nfx_123:
    s_add_u32 s98, s66, 4194304
    s_add_u32 m0, s68, 49152
    s_add_u32 s31, s98, 0
    buffer_load_dwordx4 v232, s[8:11], s31 offen offset:0 sc1 lds
    buffer_load_dwordx4 v232, s[8:11], s31 offen offset:1024 sc1 lds
    buffer_load_dwordx4 v233, s[8:11], s31 offen offset:2048 sc1 lds
    buffer_load_dwordx4 v233, s[8:11], s31 offen offset:3072 sc1 lds
    s_add_u32 m0, s68, 53248
    s_add_u32 s31, s98, 4096
    buffer_load_dwordx4 v232, s[8:11], s31 offen offset:0 sc1 lds
    buffer_load_dwordx4 v232, s[8:11], s31 offen offset:1024 sc1 lds
    buffer_load_dwordx4 v233, s[8:11], s31 offen offset:2048 sc1 lds
    buffer_load_dwordx4 v233, s[8:11], s31 offen offset:3072 sc1 lds
    s_waitcnt vmcnt(16)
    s_barrier
    s_add_u32 s99, s67, 1703936
    s_add_u32 m0, s69, 106496
    s_add_u32 s31, s99, 0
    buffer_load_dwordx4 v236, s[12:15], s31 offen offset:0  lds
    buffer_load_dwordx4 v237, s[12:15], s31 offen offset:1024  lds
    buffer_load_dwordx4 v238, s[12:15], s31 offen offset:2048  lds
    buffer_load_dwordx4 v239, s[12:15], s31 offen offset:3072  lds
    s_and_b32 s30, s40, 0xf00000
    s_cbranch_scc0 nfx_125
nf_124:
    s_mov_b32 exec_lo, 0xfff0f000
    s_mov_b32 exec_hi, 0xffffffff
    buffer_load_dwordx2 v[8:9], v10, s[8:11], s32 offen sc1
    s_waitcnt vmcnt(0)
    v_and_b32 v8, v8, v9
    v_and_b32 v8, 1, v8
    v_cmp_ne_u32 s[40:41], 1, v8
    s_orn2_b64 s[40:41], s[40:41], exec
    s_mov_b64 exec, -1
    s_add_u32 s72, s72, 1
    s_cmp_gt_u32 s72, 524288
    s_cbranch_scc1 nfx_125
    s_and_b32 s30, s40, 0xf00000
    s_cbranch_scc1 nf_124
nfx_125:
    s_add_u32 s98, s66, 5242880
    s_add_u32 m0, s68, 0
    s_add_u32 s31, s98, 0
    buffer_load_dwordx4 v232, s[8:11], s31 offen offset:0 sc1 lds
    buffer_load_dwordx4 v232, s[8:11], s31 offen offset:1024 sc1 lds
    buffer_load_dwordx4 v233, s[8:11], s31 offen offset:2048 sc1 lds
    buffer_load_dwordx4 v233, s[8:11], s31 offen offset:3072 sc1 lds
    s_add_u32 m0, s68, 4096
    s_add_u32 s31, s98, 4096
    buffer_load_dwordx4 v232, s[8:11], s31 offen offset:0 sc1 lds
    buffer_load_dwordx4 v232, s[8:11], s31 offen offset:1024 sc1 lds
    buffer_load_dwordx4 v233, s[8:11], s31 offen offset:2048 sc1 lds
    buffer_load_dwordx4 v233, s[8:11], s31 offen offset:3072 sc1 lds
    s_waitcnt vmcnt(20)
    s_barrier
    s_add_u32 s99, s67, 1835008
    s_add_u32 m0, s69, 114688
    s_add_u32 s31, s99, 0
    buffer_load_dwordx4 v236, s[12:15], s31 offen offset:0  lds
    buffer_load_dwordx4 v237, s[12:15], s31 offen offset:1024  lds
    buffer_load_dwordx4 v238, s[12:15], s31 offen offset:2048  lds
    buffer_load_dwordx4 v239, s[12:15], s31 offen offset:3072  lds
    s_and_b32 s30, s40, 0xf000000
    s_cbranch_scc0 nfx_127
nf_126:
    s_mov_b32 exec_lo, 0xff00f000
    s_mov_b32 exec_hi, 0xffffffff
    buffer_load_dwordx2 v[8:9], v10, s[8:11], s32 offen sc1
    s_waitcnt vmcnt(0)
    v_and_b32 v8, v8, v9
    v_and_b32 v8, 1, v8
    v_cmp_ne_u32 s[40:41], 1, v8
    s_orn2_b64 s[40:41], s[40:41], exec
    s_mov_b64 exec, -1
    s_add_u32 s72, s72, 1
    s_cmp_gt_u32 s72, 524288
    s_cbranch_scc1 nfx_127
    s_and_b32 s30, s40, 0xf000000
    s_cbranch_scc1 nf_126
nfx_127:
    s_add_u32 s98, s66, 6291456
    s_add_u32 m0, s68, 16384
    s_add_u32 s31, s98, 0
    buffer_load_dwordx4 v232, s[8:11], s31 offen offset:0 sc1 lds
    buffer_load_dwordx4 v232, s[8:11], s31 offen offset:1024 sc1 lds
    buffer_load_dwordx4 v233, s[8:11], s31 offen offset:2048 sc1 lds
    buffer_load_dwordx4 v233, s[8:11], s31 offen offset:3072 sc1 lds
    s_add_u32 m0, s68, 20480
    s_add_u32 s31, s98, 4096
    buffer_load_dwordx4 v232, s[8:11], s31 offen offset:0 sc1 lds
    buffer_load_dwordx4 v232, s[8:11], s31 offen offset:1024 sc1 lds
    buffer_load_dwordx4 v233, s[8:11], s31 offen offset:2048 sc1 lds
    buffer_load_dwordx4 v233, s[8:11], s31 offen offset:3072 sc1 lds
    s_waitcnt vmcnt(24)
    s_barrier
    s_add_u32 s99, s67, 1966080
    s_add_u32 m0, s69, 122880
    s_add_u32 s31, s99, 0
    buffer_load_dwordx4 v236, s[12:15], s31 offen offset:0  lds
    buffer_load_dwordx4 v237, s[12:15], s31 offen offset:1024  lds
    buffer_load_dwordx4 v238, s[12:15], s31 offen offset:2048  lds
    buffer_load_dwordx4 v239, s[12:15], s31 offen offset:3072  lds
    s_and_b32 s30, s40, 0xf0000000
    s_cbranch_scc0 nfx_129
nf_128:
    s_mov_b32 exec_lo, 0xf000f000
    s_mov_b32 exec_hi, 0xffffffff
    buffer_load_dwordx2 v[8:9], v10, s[8:11], s32 offen sc1
    s_waitcnt vmcnt(0)
    v_and_b32 v8, v8, v9
    v_and_b32 v8, 1, v8
    v_cmp_ne_u32 s[40:41], 1, v8
    s_orn2_b64 s[40:41], s[40:41], exec
    s_mov_b64 exec, -1
    s_add_u32 s72, s72, 1
    s_cmp_gt_u32 s72, 524288
    s_cbranch_scc1 nfx_129
    s_and_b32 s30, s40, 0xf0000000
    s_cbranch_scc1 nf_128
nfx_129:
    s_add_u32 s98, s66, 7340032
    s_add_u32 m0, s68, 32768
    s_add_u32 s31, s98, 0
    buffer_load_dwordx4 v232, s[8:11], s31 offen offset:0 sc1 lds
    buffer_load_dwordx4 v232, s[8:11], s31 offen offset:1024 sc1 lds
    buffer_load_dwordx4 v233, s[8:11], s31 offen offset:2048 sc1 lds
    buffer_load_dwordx4 v233, s[8:11], s31 offen offset:3072 sc1 lds
    s_add_u32 m0, s68, 36864
    s_add_u32 s31, s98, 4096
    buffer_load_dwordx4 v232, s[8:11], s31 offen offset:0 sc1 lds
    buffer_load_dwordx4 v232, s[8:11], s31 offen offset:1024 sc1 lds
    buffer_load_dwordx4 v233, s[8:11], s31 offen offset:2048 sc1 lds
    buffer_load_dwordx4 v233, s[8:11], s31 offen offset:3072 sc1 lds
    s_cmp_lt_u32 s73, s60
    s_cbranch_scc1 pfg_130
    s_cmp_ge_u32 s55, 2
    s_cbranch_scc1 pfx_131
    s_mov_b32 s73, s61
    s_mov_b32 s60, 7340032
    s_add_u32 s55, s55, 1
    s_cmp_eq_u32 s55, 2
    s_cbranch_scc1 pfw2_132
    s_mov_b32 s44, s56
    s_and_b32 s45, s57, 0xffff
    s_mov_b32 s46, 7340032
    s_mov_b32 s47, 0x20000
    s_branch pfg_130
pfw2_132:
    s_mov_b32 s44, s58
    s_and_b32 s45, s59, 0xffff
    s_mov_b32 s46, 7340032
    s_mov_b32 s47, 0x20000
pfg_130:
    s_buffer_load_dword s74, s[44:47], s73 offset:0
    s_buffer_load_dword s74, s[44:47], s73 offset:64
    s_buffer_load_dword s74, s[44:47], s73 offset:128
    s_buffer_load_dword s74, s[44:47], s73 offset:192
    s_add_u32 s73, s73, 262144
pfx_131:
    s_waitcnt vmcnt(24)
    s_barrier
    s_add_u32 s99, s67, 393216
    s_add_u32 m0, s69, 131072
    s_add_u32 s31, s99, 0
    buffer_load_dwordx4 v236, s[12:15], s31 offen offset:0  lds
    buffer_load_dwordx4 v237, s[12:15], s31 offen offset:1024  lds
    buffer_load_dwordx4 v238, s[12:15], s31 offen offset:2048  lds
    buffer_load_dwordx4 v239, s[12:15], s31 offen offset:3072  lds
    s_and_b32 s30, s41, 0xf
    s_cbranch_scc0 nfx_134
nf_133:
    s_mov_b32 exec_lo, 0xf000
    s_mov_b32 exec_hi, 0xffffffff
    buffer_load_dwordx2 v[8:9], v10, s[8:11], s32 offen sc1
    s_waitcnt vmcnt(0)
    v_and_b32 v8, v8, v9
    v_and_b32 v8, 1, v8
    v_cmp_ne_u32 s[40:41], 1, v8
    s_orn2_b64 s[40:41], s[40:41], exec
    s_mov_b64 exec, -1
    s_add_u32 s72, s72, 1
    s_cmp_gt_u32 s72, 524288
    s_cbranch_scc1 nfx_134
    s_and_b32 s30, s41, 0xf
    s_cbranch_scc1 nf_133
nfx_134:
    s_add_u32 s98, s66, 8388608
    s_add_u32 m0, s68, 49152
    s_add_u32 s31, s98, 0
    buffer_load_dwordx4 v232, s[8:11], s31 offen offset:0 sc1 lds
    buffer_load_dwordx4 v232, s[8:11], s31 offen offset:1024 sc1 lds
    buffer_load_dwordx4 v233, s[8:11], s31 offen offset:2048 sc1 lds
    buffer_load_dwordx4 v233, s[8:11], s31 offen offset:3072 sc1 lds
    s_add_u32 m0, s68, 53248
    s_add_u32 s31, s98, 4096
    buffer_load_dwordx4 v232, s[8:11], s31 offen offset:0 sc1 lds
    buffer_load_dwordx4 v232, s[8:11], s31 offen offset:1024 sc1 lds
    buffer_load_dwordx4 v233, s[8:11], s31 offen offset:2048 sc1 lds
    buffer_load_dwordx4 v233, s[8:11], s31 offen offset:3072 sc1 lds
    s_waitcnt vmcnt(24)
    s_barrier
    s_add_u32 s99, s67, 1441792
    s_add_u32 m0, s69, 139264
    s_add_u32 s31, s99, 0
    buffer_load_dwordx4 v236, s[12:15], s31 offen offset:0  lds
    buffer_load_dwordx4 v237, s[12:15], s31 offen offset:1024  lds
    buffer_load_dwordx4 v238, s[12:15], s31 offen offset:2048  lds
    buffer_load_dwordx4 v239, s[12:15], s31 offen offset:3072  lds
    s_and_b32 s30, s41, 0xf0
    s_cbranch_scc0 nfx_136
nf_135:
    s_mov_b32 exec_lo, 0xf000
    s_mov_b32 exec_hi, 0xfffffff0
    buffer_load_dwordx2 v[8:9], v10, s[8:11], s32 offen sc1
    s_waitcnt vmcnt(0)
    v_and_b32 v8, v8, v9
    v_and_b32 v8, 1, v8
    v_cmp_ne_u32 s[40:41], 1, v8
    s_orn2_b64 s[40:41], s[40:41], exec
    s_mov_b64 exec, -1
    s_add_u32 s72, s72, 1
    s_cmp_gt_u32 s72, 524288
    s_cbranch_scc1 nfx_136
    s_and_b32 s30, s41, 0xf0
    s_cbranch_scc1 nf_135
nfx_136:
    s_add_u32 s98, s66, 9437184
    s_add_u32 m0, s68, 0
    s_add_u32 s31, s98, 0
    buffer_load_dwordx4 v232, s[8:11], s31 offen offset:0 sc1 lds
    buffer_load_dwordx4 v232, s[8:11], s31 offen offset:1024 sc1 lds
    buffer_load_dwordx4 v233, s[8:11], s31 offen offset:2048 sc1 lds
    buffer_load_dwordx4 v233, s[8:11], s31 offen offset:3072 sc1 lds
    s_add_u32 m0, s68, 4096
    s_add_u32 s31, s98, 4096
    buffer_load_dwordx4 v232, s[8:11], s31 offen offset:0 sc1 lds
    buffer_load_dwordx4 v232, s[8:11], s31 offen offset:1024 sc1 lds
    buffer_load_dwordx4 v233, s[8:11], s31 offen offset:2048 sc1 lds
    buffer_load_dwordx4 v233, s[8:11], s31 offen offset:3072 sc1 lds
    s_waitcnt vmcnt(24)
    s_barrier
    s_and_b32 s30, s41, 0xf00
    s_cbranch_scc0 nfx_138
nf_137:
    s_mov_b32 exec_lo, 0xf000
    s_mov_b32 exec_hi, 0xffffff00
    buffer_load_dwordx2 v[8:9], v10, s[8:11], s32 offen sc1
    s_waitcnt vmcnt(0)
    v_and_b32 v8, v8, v9
    v_and_b32 v8, 1, v8
    v_cmp_ne_u32 s[40:41], 1, v8
    s_orn2_b64 s[40:41], s[40:41], exec
    s_mov_b64 exec, -1
    s_add_u32 s72, s72, 1
    s_cmp_gt_u32 s72, 524288
    s_cbranch_scc1 nfx_138
    s_and_b32 s30, s41, 0xf00
    s_cbranch_scc1 nf_137
nfx_138:
    s_add_u32 s98, s66, 10485760
    s_add_u32 m0, s68, 16384
    s_add_u32 s31, s98, 0
    buffer_load_dwordx4 v232, s[8:11], s31 offen offset:0 sc1 lds
    buffer_load_dwordx4 v232, s[8:11], s31 offen offset:1024 sc1 lds
    buffer_load_dwordx4 v233, s[8:11], s31 offen offset:2048 sc1 lds
    buffer_load_dwordx4 v233, s[8:11], s31 offen offset:3072 sc1 lds
    s_add_u32 m0, s68, 20480
    s_add_u32 s31, s98, 4096
    buffer_load_dwordx4 v232, s[8:11], s31 offen offset:0 sc1 lds
    buffer_load_dwordx4 v232, s[8:11], s31 offen offset:1024 sc1 lds
    buffer_load_dwordx4 v233, s[8:11], s31 offen offset:2048 sc1 lds
    buffer_load_dwordx4 v233, s[8:11], s31 offen offset:3072 sc1 lds
    s_cmp_lt_u32 s73, s60
    s_cbranch_scc1 pfg_139
    s_cmp_ge_u32 s55, 2
    s_cbranch_scc1 pfx_140
    s_mov_b32 s73, s61
    s_mov_b32 s60, 7340032
    s_add_u32 s55, s55, 1
    s_cmp_eq_u32 s55, 2
    s_cbranch_scc1 pfw2_141
    s_mov_b32 s44, s56
    s_and_b32 s45, s57, 0xffff
    s_mov_b32 s46, 7340032
    s_mov_b32 s47, 0x20000
    s_branch pfg_139
pfw2_141:
    s_mov_b32 s44, s58
    s_and_b32 s45, s59, 0xffff
    s_mov_b32 s46, 7340032
    s_mov_b32 s47, 0x20000
pfg_139:
    s_buffer_load_dword s74, s[44:47], s73 offset:0
    s_buffer_load_dword s74, s[44:47], s73 offset:64
    s_buffer_load_dword s74, s[44:47], s73 offset:128
    s_buffer_load_dword s74, s[44:47], s73 offset:192
    s_add_u32 s73, s73, 262144
pfx_140:
    s_waitcnt vmcnt(20)
    s_barrier
    s_and_b32 s30, s41, 0xf0000
    s_cbranch_scc0 nfx_143
nf_142:
    s_mov_b32 exec_lo, 0xf000
    s_mov_b32 exec_hi, 0xfffff000
    buffer_load_dwordx2 v[8:9], v10, s[8:11], s32 offen sc1
    s_waitcnt vmcnt(0)
    v_and_b32 v8, v8, v9
    v_and_b32 v8, 1, v8
    v_cmp_ne_u32 s[40:41], 1, v8
    s_orn2_b64 s[40:41], s[40:41], exec
    s_mov_b64 exec, -1
    s_add_u32 s72, s72, 1
    s_cmp_gt_u32 s72, 524288
    s_cbranch_scc1 nfx_143
    s_and_b32 s30, s41, 0xf0000
    s_cbranch_scc1 nf_142
nfx_143:
    s_add_u32 s98, s66, 12582912
    s_add_u32 m0, s68, 32768
    s_add_u32 s31, s98, 0
    buffer_load_dwordx4 v232, s[8:11], s31 offen offset:0 sc1 lds
    buffer_load_dwordx4 v232, s[8:11], s31 offen offset:1024 sc1 lds
    buffer_load_dwordx4 v233, s[8:11], s31 offen offset:2048 sc1 lds
    buffer_load_dwordx4 v233, s[8:11], s31 offen offset:3072 sc1 lds
    s_add_u32 m0, s68, 36864
    s_add_u32 s31, s98, 4096
    buffer_load_dwordx4 v232, s[8:11], s31 offen offset:0 sc1 lds
    buffer_load_dwordx4 v232, s[8:11], s31 offen offset:1024 sc1 lds
    buffer_load_dwordx4 v233, s[8:11], s31 offen offset:2048 sc1 lds
    buffer_load_dwordx4 v233, s[8:11], s31 offen offset:3072 sc1 lds
    s_waitcnt vmcnt(16)
    s_barrier
    s_and_b32 s30, s41, 0xf00000
    s_cbranch_scc0 nfx_145
nf_144:
    s_mov_b32 exec_lo, 0xf000
    s_mov_b32 exec_hi, 0xfff0f000
    buffer_load_dwordx2 v[8:9], v10, s[8:11], s32 offen sc1
    s_waitcnt vmcnt(0)
    v_and_b32 v8, v8, v9
    v_and_b32 v8, 1, v8
    v_cmp_ne_u32 s[40:41], 1, v8
    s_orn2_b64 s[40:41], s[40:41], exec
    s_mov_b64 exec, -1
    s_add_u32 s72, s72, 1
    s_cmp_gt_u32 s72, 524288
    s_cbranch_scc1 nfx_145
    s_and_b32 s30, s41, 0xf00000
    s_cbranch_scc1 nf_144
nfx_145:
    s_add_u32 s98, s66, 13631488
    s_add_u32 m0, s68, 49152
    s_add_u32 s31, s98, 0
    buffer_load_dwordx4 v232, s[8:11], s31 offen offset:0 sc1 lds
    buffer_load_dwordx4 v232, s[8:11], s31 offen offset:1024 sc1 lds
    buffer_load_dwordx4 v233, s[8:11], s31 offen offset:2048 sc1 lds
    buffer_load_dwordx4 v233, s[8:11], s31 offen offset:3072 sc1 lds
    s_add_u32 m0, s68, 53248
    s_add_u32 s31, s98, 4096
    buffer_load_dwordx4 v232, s[8:11], s31 offen offset:0 sc1 lds
    buffer_load_dwordx4 v232, s[8:11], s31 offen offset:1024 sc1 lds
    buffer_load_dwordx4 v233, s[8:11], s31 offen offset:2048 sc1 lds
    buffer_load_dwordx4 v233, s[8:11], s31 offen offset:3072 sc1 lds
    s_waitcnt vmcnt(16)
    s_barrier
    s_and_b32 s30, s41, 0xf000000
    s_cbranch_scc0 nfx_147
nf_146:
    s_mov_b32 exec_lo, 0xf000
    s_mov_b32 exec_hi, 0xff00f000
    buffer_load_dwordx2 v[8:9], v10, s[8:11], s32 offen sc1
    s_waitcnt vmcnt(0)
    v_and_b32 v8, v8, v9
    v_and_b32 v8, 1, v8
    v_cmp_ne_u32 s[40:41], 1, v8
    s_orn2_b64 s[40:41], s[40:41], exec
    s_mov_b64 exec, -1
    s_add_u32 s72, s72, 1
    s_cmp_gt_u32 s72, 524288
    s_cbranch_scc1 nfx_147
    s_and_b32 s30, s41, 0xf000000
    s_cbranch_scc1 nf_146
nfx_147:
    s_add_u32 s98, s66, 14680064
    s_add_u32 m0, s68, 0
    s_add_u32 s31, s98, 0
    buffer_load_dwordx4 v232, s[8:11], s31 offen offset:0 sc1 lds
    buffer_load_dwordx4 v232, s[8:11], s31 offen offset:1024 sc1 lds
    buffer_load_dwordx4 v233, s[8:11], s31 offen offset:2048 sc1 lds
    buffer_load_dwordx4 v233, s[8:11], s31 offen offset:3072 sc1 lds
    s_add_u32 m0, s68, 4096
    s_add_u32 s31, s98, 4096
    buffer_load_dwordx4 v232, s[8:11], s31 offen offset:0 sc1 lds
    buffer_load_dwordx4 v232, s[8:11], s31 offen offset:1024 sc1 lds
    buffer_load_dwordx4 v233, s[8:11], s31 offen offset:2048 sc1 lds
    buffer_load_dwordx4 v233, s[8:11], s31 offen offset:3072 sc1 lds
    s_cmp_lt_u32 s73, s60
    s_cbranch_scc1 pfg_148
    s_cmp_ge_u32 s55, 2
    s_cbranch_scc1 pfx_149
    s_mov_b32 s73, s61
    s_mov_b32 s60, 7340032
    s_add_u32 s55, s55, 1
    s_cmp_eq_u32 s55, 2
    s_cbranch_scc1 pfw2_150
    s_mov_b32 s44, s56
    s_and_b32 s45, s57, 0xffff
    s_mov_b32 s46, 7340032
    s_mov_b32 s47, 0x20000
    s_branch pfg_148
pfw2_150:
    s_mov_b32 s44, s58
    s_and_b32 s45, s59, 0xffff
    s_mov_b32 s46, 7340032
    s_mov_b32 s47, 0x20000
pfg_148:
    s_buffer_load_dword s74, s[44:47], s73 offset:0
    s_buffer_load_dword s74, s[44:47], s73 offset:64
    s_buffer_load_dword s74, s[44:47], s73 offset:128
    s_buffer_load_dword s74, s[44:47], s73 offset:192
    s_add_u32 s73, s73, 262144
pfx_149:
    s_waitcnt vmcnt(16)
    s_barrier
    s_and_b32 s30, s41, 0xf0000000
    s_cbranch_scc0 nfx_152
nf_151:
    s_mov_b32 exec_lo, 0xf000
    s_mov_b32 exec_hi, 0xf000f000
    buffer_load_dwordx2 v[8:9], v10, s[8:11], s32 offen sc1
    s_waitcnt vmcnt(0)
    v_and_b32 v8, v8, v9
    v_and_b32 v8, 1, v8
    v_cmp_ne_u32 s[40:41], 1, v8
    s_orn2_b64 s[40:41], s[40:41], exec
    s_mov_b64 exec, -1
    s_add_u32 s72, s72, 1
    s_cmp_gt_u32 s72, 524288
    s_cbranch_scc1 nfx_152
    s_and_b32 s30, s41, 0xf0000000
    s_cbranch_scc1 nf_151
nfx_152:
    s_add_u32 s98, s66, 15728640
    s_add_u32 m0, s68, 16384
    s_add_u32 s31, s98, 0
    buffer_load_dwordx4 v232, s[8:11], s31 offen offset:0 sc1 lds
    buffer_load_dwordx4 v232, s[8:11], s31 offen offset:1024 sc1 lds
    buffer_load_dwordx4 v233, s[8:11], s31 offen offset:2048 sc1 lds
    buffer_load_dwordx4 v233, s[8:11], s31 offen offset:3072 sc1 lds
    s_add_u32 m0, s68, 20480
    s_add_u32 s31, s98, 4096
    buffer_load_dwordx4 v232, s[8:11], s31 offen offset:0 sc1 lds
    buffer_load_dwordx4 v232, s[8:11], s31 offen offset:1024 sc1 lds
    buffer_load_dwordx4 v233, s[8:11], s31 offen offset:2048 sc1 lds
    buffer_load_dwordx4 v233, s[8:11], s31 offen offset:3072 sc1 lds
    s_waitcnt vmcnt(16)
    s_barrier
    s_and_b32 s30, s40, 0xf000
    s_cbranch_scc0 nfx_154
nf_153:
    s_mov_b32 exec_lo, 0xf000
    s_mov_b32 exec_hi, 0xf000
    buffer_load_dwordx2 v[8:9], v10, s[8:11], s32 offen sc1
    s_waitcnt vmcnt(0)
    v_and_b32 v8, v8, v9
    v_and_b32 v8, 1, v8
    v_cmp_ne_u32 s[40:41], 1, v8
    s_orn2_b64 s[40:41], s[40:41], exec
    s_mov_b64 exec, -1
    s_add_u32 s72, s72, 1
    s_cmp_gt_u32 s72, 524288
    s_cbranch_scc1 nfx_154
    s_and_b32 s30, s40, 0xf000
    s_cbranch_scc1 nf_153
nfx_154:
    s_add_u32 s98, s66, 3145728
    s_add_u32 m0, s68, 32768
    s_add_u32 s31, s98, 0
    buffer_load_dwordx4 v232, s[8:11], s31 offen offset:0 sc1 lds
    buffer_load_dwordx4 v232, s[8:11], s31 offen offset:1024 sc1 lds
    buffer_load_dwordx4 v233, s[8:11], s31 offen offset:2048 sc1 lds
    buffer_load_dwordx4 v233, s[8:11], s31 offen offset:3072 sc1 lds
    s_add_u32 m0, s68, 36864
    s_add_u32 s31, s98, 4096
    buffer_load_dwordx4 v232, s[8:11], s31 offen offset:0 sc1 lds
    buffer_load_dwordx4 v232, s[8:11], s31 offen offset:1024 sc1 lds
    buffer_load_dwordx4 v233, s[8:11], s31 offen offset:2048 sc1 lds
    buffer_load_dwordx4 v233, s[8:11], s31 offen offset:3072 sc1 lds
    s_waitcnt vmcnt(16)
    s_barrier
    s_and_b32 s30, s41, 0xf000
    s_cbranch_scc0 nfx_156
nf_155:
    s_mov_b32 exec_lo, 0x0
    s_mov_b32 exec_hi, 0xf000
    buffer_load_dwordx2 v[8:9], v10, s[8:11], s32 offen sc1
    s_waitcnt vmcnt(0)
    v_and_b32 v8, v8, v9
    v_and_b32 v8, 1, v8
    v_cmp_ne_u32 s[40:41], 1, v8
    s_orn2_b64 s[40:41], s[40:41], exec
    s_mov_b64 exec, -1
    s_add_u32 s72, s72, 1
    s_cmp_gt_u32 s72, 524288
    s_cbranch_scc1 nfx_156
    s_and_b32 s30, s41, 0xf000
    s_cbranch_scc1 nf_155
nfx_156:
    s_add_u32 s98, s66, 11534336
    s_add_u32 m0, s68, 49152
    s_add_u32 s31, s98, 0
    buffer_load_dwordx4 v232, s[8:11], s31 offen offset:0 sc1 lds
    buffer_load_dwordx4 v232, s[8:11], s31 offen offset:1024 sc1 lds
    buffer_load_dwordx4 v233, s[8:11], s31 offen offset:2048 sc1 lds
    buffer_load_dwordx4 v233, s[8:11], s31 offen offset:3072 sc1 lds
    s_add_u32 m0, s68, 53248
    s_add_u32 s31, s98, 4096
    buffer_load_dwordx4 v232, s[8:11], s31 offen offset:0 sc1 lds
    buffer_load_dwordx4 v232, s[8:11], s31 offen offset:1024 sc1 lds
    buffer_load_dwordx4 v233, s[8:11], s31 offen offset:2048 sc1 lds
    buffer_load_dwordx4 v233, s[8:11], s31 offen offset:3072 sc1 lds
    s_cmp_lt_u32 s73, s60
    s_cbranch_scc1 pfg_157
    s_cmp_ge_u32 s55, 2
    s_cbranch_scc1 pfx_158
    s_mov_b32 s73, s61
    s_mov_b32 s60, 7340032
    s_add_u32 s55, s55, 1
    s_cmp_eq_u32 s55, 2
    s_cbranch_scc1 pfw2_159
    s_mov_b32 s44, s56
    s_and_b32 s45, s57, 0xffff
    s_mov_b32 s46, 7340032
    s_mov_b32 s47, 0x20000
    s_branch pfg_157
pfw2_159:
    s_mov_b32 s44, s58
    s_and_b32 s45, s59, 0xffff
    s_mov_b32 s46, 7340032
    s_mov_b32 s47, 0x20000
pfg_157:
    s_buffer_load_dword s74, s[44:47], s73 offset:0
    s_buffer_load_dword s74, s[44:47], s73 offset:64
    s_buffer_load_dword s74, s[44:47], s73 offset:128
    s_buffer_load_dword s74, s[44:47], s73 offset:192
    s_add_u32 s73, s73, 262144
pfx_158:
    s_waitcnt vmcnt(16)
    s_barrier
    s_waitcnt vmcnt(8)
    s_barrier
    s_waitcnt vmcnt(0)
    s_barrier
    s_barrier
    s_and_b32 s24, s22, 1
    s_lshl_b32 s24, s24, 3
    s_and_b32 s30, s23, 7
    s_add_u32 s24, s24, s30
    s_lshr_b32 s25, s22, 1
    s_lshl_b32 s25, s25, 2
    s_lshr_b32 s30, s23, 3
    s_add_u32 s25, s25, s30
    s_mov_b32 s12, s56
    s_and_b32 s13, s57, 0xffff
    s_mov_b32 s14, 7340032
    s_mov_b32 s15, 0x20000

    s_mul_i32 s27, s25, 448
    s_and_b32 s30, s25, 1
    s_lshl_b32 s26, s30, 6
    s_add_u32 s26, s26, s27
    s_xor_b32 s30, s30, 1
    s_mul_i32 s30, s30, 384
    s_add_u32 s27, s27, s30
    s_mov_b32 s67, 0
    s_and_b32 s101, s25, 12

    s_lshl_b32 s66, s24, 18
    s_add_u32 s66, s66, 20971520

    s_lshl_b32 s69, s21, 12
    s_lshl_b32 s70, s21, 11
    v_lshrrev_b32 v246, 3, v1
    s_lshl_b32 s30, s21, 5
    v_add_u32 v246, s30, v246
    v_mul_u32_u24 v246, 7168, v246
    v_and_b32 v247, 1, v1
    v_lshl_add_u32 v246, v247, 4, v246
    v_add_u32 v246, s26, v246
    v_bfe_u32 v247, v1, 1, 2

    v_xor_b32 v245, v247, v3
    v_lshl_add_u32 v236, v245, 5, v246
    v_add_u32 v237, 56320, v236
    v_add_u32 v238, 112640, v236
    v_add_u32 v239, 112640, v237

    v_lshrrev_b32 v246, 2, v1
    v_add_u32 v246, s30, v246
    v_mul_u32_u24 v246, 7168, v246
    v_and_b32 v247, 1, v1
    v_lshl_add_u32 v246, v247, 4, v246
    v_add_u32 v246, s27, v246
    v_bfe_u32 v247, v1, 1, 1
    v_and_b32 v245, 1, v3
    v_xor_b32 v245, v247, v245
    v_lshl_add_u32 v240, v245, 5, v246
    v_add_u32 v241, 113664, v240

    s_mul_i32 s68, s21, 8192
    s_mul_i32 s30, s21, 131072
    v_lshl_add_u32 v232, v1, 4, s30
    v_add_u32 v233, 30720, v232
    s_lshl_b32 s32, s24, 11
    s_add_u32 s32, s32, 44335104
lw_160:
    ds_read_b32 v255, v253 offset:3072
    s_waitcnt lgkmcnt(0)
    v_cmp_gt_u32 vcc, 2, v255
    s_cbranch_vccz lwx_161
    s_sleep 1
    s_add_u32 s3, s3, 1
    s_cmp_lt_u32 s3, 4194304
    s_cbranch_scc1 lw_160
lwx_161:
    s_add_u32 s99, s67, 0
    s_add_u32 m0, s69, 49152
    s_add_u32 s31, s99, 0
    buffer_load_dwordx4 v236, s[12:15], s31 offen offset:0  lds
    buffer_load_dwordx4 v237, s[12:15], s31 offen offset:1024  lds
    buffer_load_dwordx4 v238, s[12:15], s31 offen offset:2048  lds
    buffer_load_dwordx4 v239, s[12:15], s31 offen offset:3072  lds
    s_add_u32 m0, s69, 73728
    s_add_u32 s31, s99, 128
    buffer_load_dwordx4 v236, s[12:15], s31 offen offset:0  lds
    buffer_load_dwordx4 v237, s[12:15], s31 offen offset:1024  lds
    buffer_load_dwordx4 v238, s[12:15], s31 offen offset:2048  lds
    buffer_load_dwordx4 v239, s[12:15], s31 offen offset:3072  lds
    s_add_u32 m0, s69, 98304
    s_add_u32 s31, s99, 256
    buffer_load_dwordx4 v236, s[12:15], s31 offen offset:0  lds
    buffer_load_dwordx4 v237, s[12:15], s31 offen offset:1024  lds
    buffer_load_dwordx4 v238, s[12:15], s31 offen offset:2048  lds
    buffer_load_dwordx4 v239, s[12:15], s31 offen offset:3072  lds
    s_add_u32 m0, s70, 122880
    s_add_u32 s31, s99, 0
    buffer_load_dwordx4 v240, s[12:15], s31 offen offset:0  lds
    buffer_load_dwordx4 v241, s[12:15], s31 offen offset:1024  lds
    v_lshrrev_b32 v10, 2, v1
    v_lshlrev_b32 v10, 7, v10
    v_and_b32 v11, 3, v1
    v_lshl_add_u32 v10, v11, 2, v10
    s_mov_b64 s[40:41], -1
    s_mov_b32 s72, 0
    s_waitcnt vmcnt(0)
    s_and_b32 s30, s40, 0xf0f
    s_cbranch_scc0 nfx_163
nf_162:
    s_mov_b32 exec_lo, 0xf0f0f0f
    s_mov_b32 exec_hi, 0x0
    buffer_load_dword v8, v10, s[8:11], s32 offen sc1
    s_waitcnt vmcnt(0)
    v_and_b32 v8, 1, v8
    v_cmp_ne_u32 s[40:41], 1, v8
    s_orn2_b64 s[40:41], s[40:41], exec
    s_mov_b64 exec, -1
    s_add_u32 s72, s72, 1
    s_cmp_gt_u32 s72, 524288
    s_cbranch_scc1 nfx_163
    s_and_b32 s30, s40, 0xf0f
    s_cbranch_scc1 nf_162
nfx_163:
    s_add_u32 s98, s66, 0
    s_add_u32 m0, s68, 0
    s_add_u32 s31, s98, 0
    buffer_load_dwordx4 v232, s[8:11], s31 offen offset:0 sc1 lds
    buffer_load_dwordx4 v232, s[8:11], s31 offen offset:1024 sc1 lds
    buffer_load_dwordx4 v233, s[8:11], s31 offen offset:2048 sc1 lds
    buffer_load_dwordx4 v233, s[8:11], s31 offen offset:3072 sc1 lds
    s_add_u32 m0, s68, 4096
    s_add_u32 s31, s98, 65536
    buffer_load_dwordx4 v232, s[8:11], s31 offen offset:0 sc1 lds
    buffer_load_dwordx4 v232, s[8:11], s31 offen offset:1024 sc1 lds
    buffer_load_dwordx4 v233, s[8:11], s31 offen offset:2048 sc1 lds
    buffer_load_dwordx4 v233, s[8:11], s31 offen offset:3072 sc1 lds
    s_add_u32 s98, s66, 4096
    s_add_u32 m0, s68, 16384
    s_add_u32 s31, s98, 0
    buffer_load_dwordx4 v232, s[8:11], s31 offen offset:0 sc1 lds
    buffer_load_dwordx4 v232, s[8:11], s31 offen offset:1024 sc1 lds
    buffer_load_dwordx4 v233, s[8:11], s31 offen offset:2048 sc1 lds
    buffer_load_dwordx4 v233, s[8:11], s31 offen offset:3072 sc1 lds
    s_add_u32 m0, s68, 20480
    s_add_u32 s31, s98, 65536
    buffer_load_dwordx4 v232, s[8:11], s31 offen offset:0 sc1 lds
    buffer_load_dwordx4 v232, s[8:11], s31 offen offset:1024 sc1 lds
    buffer_load_dwordx4 v233, s[8:11], s31 offen offset:2048 sc1 lds
    buffer_load_dwordx4 v233, s[8:11], s31 offen offset:3072 sc1 lds
    s_waitcnt vmcnt(8)
    s_barrier
    s_and_b32 s30, s40, 0xf0000
    s_cbranch_scc0 nfx_165
nf_164:
    s_mov_b32 exec_lo, 0xfffff0f0
    s_mov_b32 exec_hi, 0xffffffff
    buffer_load_dword v8, v10, s[8:11], s32 offen sc1
    s_waitcnt vmcnt(0)
    v_and_b32 v8, 1, v8
    v_cmp_ne_u32 s[40:41], 1, v8
    s_orn2_b64 s[40:41], s[40:41], exec
    s_mov_b64 exec, -1
    s_add_u32 s72, s72, 1
    s_cmp_gt_u32 s72, 524288
    s_cbranch_scc1 nfx_165
    s_and_b32 s30, s40, 0xf0000
    s_cbranch_scc1 nf_164
nfx_165:
    s_add_u32 s98, s66, 8192
    s_add_u32 m0, s68, 32768
    s_add_u32 s31, s98, 0
    buffer_load_dwordx4 v232, s[8:11], s31 offen offset:0 sc1 lds
    buffer_load_dwordx4 v232, s[8:11], s31 offen offset:1024 sc1 lds
    buffer_load_dwordx4 v233, s[8:11], s31 offen offset:2048 sc1 lds
    buffer_load_dwordx4 v233, s[8:11], s31 offen offset:3072 sc1 lds
    s_add_u32 m0, s68, 36864
    s_add_u32 s31, s98, 65536
    buffer_load_dwordx4 v232, s[8:11], s31 offen offset:0 sc1 lds
    buffer_load_dwordx4 v232, s[8:11], s31 offen offset:1024 sc1 lds
    buffer_load_dwordx4 v233, s[8:11], s31 offen offset:2048 sc1 lds
    buffer_load_dwordx4 v233, s[8:11], s31 offen offset:3072 sc1 lds
    s_waitcnt vmcnt(8)
    s_barrier
    s_add_u32 s99, s67, 2752512
    s_add_u32 m0, s69, 49152
    s_add_u32 s31, s99, 0
    buffer_load_dwordx4 v236, s[12:15], s31 offen offset:0  lds
    buffer_load_dwordx4 v237, s[12:15], s31 offen offset:1024  lds
    buffer_load_dwordx4 v238, s[12:15], s31 offen offset:2048  lds
    buffer_load_dwordx4 v239, s[12:15], s31 offen offset:3072  lds
    s_add_u32 m0, s69, 73728
    s_add_u32 s31, s99, 128
    buffer_load_dwordx4 v236, s[12:15], s31 offen offset:0  lds
    buffer_load_dwordx4 v237, s[12:15], s31 offen offset:1024  lds
    buffer_load_dwordx4 v238, s[12:15], s31 offen offset:2048  lds
    buffer_load_dwordx4 v239, s[12:15], s31 offen offset:3072  lds
    s_add_u32 m0, s69, 98304
    s_add_u32 s31, s99, 256
    buffer_load_dwordx4 v236, s[12:15], s31 offen offset:0  lds
    buffer_load_dwordx4 v237, s[12:15], s31 offen offset:1024  lds
    buffer_load_dwordx4 v238, s[12:15], s31 offen offset:2048  lds
    buffer_load_dwordx4 v239, s[12:15], s31 offen offset:3072  lds
    s_add_u32 m0, s70, 122880
    s_add_u32 s31, s99, 0
    buffer_load_dwordx4 v240, s[12:15], s31 offen offset:0  lds
    buffer_load_dwordx4 v241, s[12:15], s31 offen offset:1024  lds
    s_and_b32 s30, s40, 0xf000000
    s_cbranch_scc0 nfx_167
nf_166:
    s_mov_b32 exec_lo, 0xfff0f0f0
    s_mov_b32 exec_hi, 0xffffffff
    buffer_load_dword v8, v10, s[8:11], s32 offen sc1
    s_waitcnt vmcnt(0)
    v_and_b32 v8, 1, v8
    v_cmp_ne_u32 s[40:41], 1, v8
    s_orn2_b64 s[40:41], s[40:41], exec
    s_mov_b64 exec, -1
    s_add_u32 s72, s72, 1
    s_cmp_gt_u32 s72, 524288
    s_cbranch_scc1 nfx_167
    s_and_b32 s30, s40, 0xf000000
    s_cbranch_scc1 nf_166
nfx_167:
    s_add_u32 s98, s66, 12288
    s_add_u32 m0, s68, 0
    s_add_u32 s31, s98, 0
    buffer_load_dwordx4 v232, s[8:11], s31 offen offset:0 sc1 lds
    buffer_load_dwordx4 v232, s[8:11], s31 offen offset:1024 sc1 lds
    buffer_load_dwordx4 v233, s[8:11], s31 offen offset:2048 sc1 lds
    buffer_load_dwordx4 v233, s[8:11], s31 offen offset:3072 sc1 lds
    s_add_u32 m0, s68, 4096
    s_add_u32 s31, s98, 65536
    buffer_load_dwordx4 v232, s[8:11], s31 offen offset:0 sc1 lds
    buffer_load_dwordx4 v232, s[8:11], s31 offen offset:1024 sc1 lds
    buffer_load_dwordx4 v233, s[8:11], s31 offen offset:2048 sc1 lds
    buffer_load_dwordx4 v233, s[8:11], s31 offen offset:3072 sc1 lds
    s_cmp_lt_u32 s73, s60
    s_cbranch_scc1 pfg_168
    s_cmp_ge_u32 s55, 2
    s_cbranch_scc1 pfx_169
    s_mov_b32 s73, s61
    s_mov_b32 s60, 7340032
    s_add_u32 s55, s55, 1
    s_cmp_eq_u32 s55, 2
    s_cbranch_scc1 pfw2_170
    s_mov_b32 s44, s56
    s_and_b32 s45, s57, 0xffff
    s_mov_b32 s46, 7340032
    s_mov_b32 s47, 0x20000
    s_branch pfg_168
pfw2_170:
    s_mov_b32 s44, s58
    s_and_b32 s45, s59, 0xffff
    s_mov_b32 s46, 7340032
    s_mov_b32 s47, 0x20000
pfg_168:
    s_buffer_load_dword s74, s[44:47], s73 offset:0
    s_buffer_load_dword s74, s[44:47], s73 offset:64
    s_buffer_load_dword s74, s[44:47], s73 offset:128
    s_buffer_load_dword s74, s[44:47], s73 offset:192
    s_add_u32 s73, s73, 262144
    s_buffer_load_dword s74, s[44:47], s73 offset:0
    s_buffer_load_dword s74, s[44:47], s73 offset:64
    s_buffer_load_dword s74, s[44:47], s73 offset:128
    s_buffer_load_dword s74, s[44:47], s73 offset:192
    s_add_u32 s73, s73, 262144
pfx_169:
    s_waitcnt vmcnt(22)
    s_barrier
    s_add_u32 s99, s67, 3670016
    s_add_u32 m0, s69, 57344
    s_add_u32 s31, s99, 0
    buffer_load_dwordx4 v236, s[12:15], s31 offen offset:0  lds
    buffer_load_dwordx4 v237, s[12:15], s31 offen offset:1024  lds
    buffer_load_dwordx4 v238, s[12:15], s31 offen offset:2048  lds
    buffer_load_dwordx4 v239, s[12:15], s31 offen offset:3072  lds
    s_add_u32 m0, s69, 81920
    s_add_u32 s31, s99, 128
    buffer_load_dwordx4 v236, s[12:15], s31 offen offset:0  lds
    buffer_load_dwordx4 v237, s[12:15], s31 offen offset:1024  lds
    buffer_load_dwordx4 v238, s[12:15], s31 offen offset:2048  lds
    buffer_load_dwordx4 v239, s[12:15], s31 offen offset:3072  lds
    s_add_u32 m0, s69, 106496
    s_add_u32 s31, s99, 256
    buffer_load_dwordx4 v236, s[12:15], s31 offen offset:0  lds
    buffer_load_dwordx4 v237, s[12:15], s31 offen offset:1024  lds
    buffer_load_dwordx4 v238, s[12:15], s31 offen offset:2048  lds
    buffer_load_dwordx4 v239, s[12:15], s31 offen offset:3072  lds
    s_add_u32 m0, s70, 126976
    s_add_u32 s31, s99, 0
    buffer_load_dwordx4 v240, s[12:15], s31 offen offset:0  lds
    buffer_load_dwordx4 v241, s[12:15], s31 offen offset:1024  lds
    s_and_b32 s30, s41, 0xf
    s_cbranch_scc0 nfx_172
nf_171:
    s_mov_b32 exec_lo, 0xf0f0f0f0
    s_mov_b32 exec_hi, 0xffffffff
    buffer_load_dword v8, v10, s[8:11], s32 offen sc1
    s_waitcnt vmcnt(0)
    v_and_b32 v8, 1, v8
    v_cmp_ne_u32 s[40:41], 1, v8
    s_orn2_b64 s[40:41], s[40:41], exec
    s_mov_b64 exec, -1
    s_add_u32 s72, s72, 1
    s_cmp_gt_u32 s72, 524288
    s_cbranch_scc1 nfx_172
    s_and_b32 s30, s41, 0xf
    s_cbranch_scc1 nf_171
nfx_172:
    s_add_u32 s98, s66, 16384
    s_add_u32 m0, s68, 16384
    s_add_u32 s31, s98, 0
    buffer_load_dwordx4 v232, s[8:11], s31 offen offset:0 sc1 lds
    buffer_load_dwordx4 v232, s[8:11], s31 offen offset:1024 sc1 lds
    buffer_load_dwordx4 v233, s[8:11], s31 offen offset:2048 sc1 lds
    buffer_load_dwordx4 v233, s[8:11], s31 offen offset:3072 sc1 lds
    s_add_u32 m0, s68, 20480
    s_add_u32 s31, s98, 65536
    buffer_load_dwordx4 v232, s[8:11], s31 offen offset:0 sc1 lds
    buffer_load_dwordx4 v232, s[8:11], s31 offen offset:1024 sc1 lds
    buffer_load_dwordx4 v233, s[8:11], s31 offen offset:2048 sc1 lds
    buffer_load_dwordx4 v233, s[8:11], s31 offen offset:3072 sc1 lds
    s_cmp_lt_u32 s73, s60
    s_cbranch_scc1 pfg_173
    s_cmp_ge_u32 s55, 2
    s_cbranch_scc1 pfx_174
    s_mov_b32 s73, s61
    s_mov_b32 s60, 7340032
    s_add_u32 s55, s55, 1
    s_cmp_eq_u32 s55, 2
    s_cbranch_scc1 pfw2_175
    s_mov_b32 s44, s56
    s_and_b32 s45, s57, 0xffff
    s_mov_b32 s46, 7340032
    s_mov_b32 s47, 0x20000
    s_branch pfg_173
pfw2_175:
    s_mov_b32 s44, s58
    s_and_b32 s45, s59, 0xffff
    s_mov_b32 s46, 7340032
    s_mov_b32 s47, 0x20000
pfg_173:
    s_buffer_load_dword s74, s[44:47], s73 offset:0
    s_buffer_load_dword s74, s[44:47], s73 offset:64
    s_buffer_load_dword s74, s[44:47], s73 offset:128
    s_buffer_load_dword s74, s[44:47], s73 offset:192
    s_add_u32 s73, s73, 262144
    s_buffer_load_dword s74, s[44:47], s73 offset:0
    s_buffer_load_dword s74, s[44:47], s73 offset:64
    s_buffer_load_dword s74, s[44:47], s73 offset:128
    s_buffer_load_dword s74, s[44:47], s73 offset:192
    s_add_u32 s73, s73, 262144
pfx_174:
    s_waitcnt vmcnt(22)
    s_barrier
    s_add_u32 s99, s67, 4587520
    s_add_u32 m0, s69, 65536
    s_add_u32 s31, s99, 0
    buffer_load_dwordx4 v236, s[12:15], s31 offen offset:0  lds
    buffer_load_dwordx4 v237, s[12:15], s31 offen offset:1024  lds
    buffer_load_dwordx4 v238, s[12:15], s31 offen offset:2048  lds
    buffer_load_dwordx4 v239, s[12:15], s31 offen offset:3072  lds
    s_add_u32 m0, s69, 90112
    s_add_u32 s31, s99, 128
    buffer_load_dwordx4 v236, s[12:15], s31 offen offset:0  lds
    buffer_load_dwordx4 v237, s[12:15], s31 offen offset:1024  lds
    buffer_load_dwordx4 v238, s[12:15], s31 offen offset:2048  lds
    buffer_load_dwordx4 v239, s[12:15], s31 offen offset:3072  lds
    s_add_u32 m0, s69, 114688
    s_add_u32 s31, s99, 256
    buffer_load_dwordx4 v236, s[12:15], s31 offen offset:0  lds
    buffer_load_dwordx4 v237, s[12:15], s31 offen offset:1024  lds
    buffer_load_dwordx4 v238, s[12:15], s31 offen offset:2048  lds
    buffer_load_dwordx4 v239, s[12:15], s31 offen offset:3072  lds
    s_add_u32 m0, s70, 131072
    s_add_u32 s31, s99, 0
    buffer_load_dwordx4 v240, s[12:15], s31 offen offset:0  lds
    buffer_load_dwordx4 v241, s[12:15], s31 offen offset:1024  lds
    s_and_b32 s30, s41, 0xf00
    s_cbranch_scc0 nfx_177
nf_176:
    s_mov_b32 exec_lo, 0xf0f0f0f0
    s_mov_b32 exec_hi, 0xfffffff0
    buffer_load_dword v8, v10, s[8:11], s32 offen sc1
    s_waitcnt vmcnt(0)
    v_and_b32 v8, 1, v8
    v_cmp_ne_u32 s[40:41], 1, v8
    s_orn2_b64 s[40:41], s[40:41], exec
    s_mov_b64 exec, -1
    s_add_u32 s72, s72, 1
    s_cmp_gt_u32 s72, 524288
    s_cbranch_scc1 nfx_177
    s_and_b32 s30, s41, 0xf00
    s_cbranch_scc1 nf_176
nfx_177:
    s_add_u32 s98, s66, 20480
    s_add_u32 m0, s68, 32768
    s_add_u32 s31, s98, 0
    buffer_load_dwordx4 v232, s[8:11], s31 offen offset:0 sc1 lds
    buffer_load_dwordx4 v232, s[8:11], s31 offen offset:1024 sc1 lds
    buffer_load_dwordx4 v233, s[8:11], s31 offen offset:2048 sc1 lds
    buffer_load_dwordx4 v233, s[8:11], s31 offen offset:3072 sc1 lds
    s_add_u32 m0, s68, 36864
    s_add_u32 s31, s98, 65536
    buffer_load_dwordx4 v232, s[8:11], s31 offen offset:0 sc1 lds
    buffer_load_dwordx4 v232, s[8:11], s31 offen offset:1024 sc1 lds
    buffer_load_dwordx4 v233, s[8:11], s31 offen offset:2048 sc1 lds
    buffer_load_dwordx4 v233, s[8:11], s31 offen offset:3072 sc1 lds
    s_cmp_lt_u32 s73, s60
    s_cbranch_scc1 pfg_178
    s_cmp_ge_u32 s55, 2
    s_cbranch_scc1 pfx_179
    s_mov_b32 s73, s61
    s_mov_b32 s60, 7340032
    s_add_u32 s55, s55, 1
    s_cmp_eq_u32 s55, 2
    s_cbranch_scc1 pfw2_180
    s_mov_b32 s44, s56
    s_and_b32 s45, s57, 0xffff
    s_mov_b32 s46, 7340032
    s_mov_b32 s47, 0x20000
    s_branch pfg_178
pfw2_180:
    s_mov_b32 s44, s58
    s_and_b32 s45, s59, 0xffff
    s_mov_b32 s46, 7340032
    s_mov_b32 s47, 0x20000
pfg_178:
    s_buffer_load_dword s74, s[44:47], s73 offset:0
    s_buffer_load_dword s74, s[44:47], s73 offset:64
    s_buffer_load_dword s74, s[44:47], s73 offset:128
    s_buffer_load_dword s74, s[44:47], s73 offset:192
    s_add_u32 s73, s73, 262144
pfx_179:
    s_waitcnt vmcnt(22)
    s_barrier
    s_add_u32 s99, s67, 5505024
    s_add_u32 m0, s69, 49152
    s_add_u32 s31, s99, 0
    buffer_load_dwordx4 v236, s[12:15], s31 offen offset:0  lds
    buffer_load_dwordx4 v237, s[12:15], s31 offen offset:1024  lds
    buffer_load_dwordx4 v238, s[12:15], s31 offen offset:2048  lds
    buffer_load_dwordx4 v239, s[12:15], s31 offen offset:3072  lds
    s_add_u32 m0, s69, 73728
    s_add_u32 s31, s99, 128
    buffer_load_dwordx4 v236, s[12:15], s31 offen offset:0  lds
    buffer_load_dwordx4 v237, s[12:15], s31 offen offset:1024  lds
    buffer_load_dwordx4 v238, s[12:15], s31 offen offset:2048  lds
    buffer_load_dwordx4 v239, s[12:15], s31 offen offset:3072  lds
    s_add_u32 m0, s69, 98304
    s_add_u32 s31, s99, 256
    buffer_load_dwordx4 v236, s[12:15], s31 offen offset:0  lds
    buffer_load_dwordx4 v237, s[12:15], s31 offen offset:1024  lds
    buffer_load_dwordx4 v238, s[12:15], s31 offen offset:2048  lds
    buffer_load_dwordx4 v239, s[12:15], s31 offen offset:3072  lds
    s_add_u32 m0, s70, 122880
    s_add_u32 s31, s99, 0
    buffer_load_dwordx4 v240, s[12:15], s31 offen offset:0  lds
    buffer_load_dwordx4 v241, s[12:15], s31 offen offset:1024  lds
    s_and_b32 s30, s41, 0xf0000
    s_cbranch_scc0 nfx_182
nf_181:
    s_mov_b32 exec_lo, 0xf0f0f0f0
    s_mov_b32 exec_hi, 0xfffff0f0
    buffer_load_dword v8, v10, s[8:11], s32 offen sc1
    s_waitcnt vmcnt(0)
    v_and_b32 v8, 1, v8
    v_cmp_ne_u32 s[40:41], 1, v8
    s_orn2_b64 s[40:41], s[40:41], exec
    s_mov_b64 exec, -1
    s_add_u32 s72, s72, 1
    s_cmp_gt_u32 s72, 524288
    s_cbranch_scc1 nfx_182
    s_and_b32 s30, s41, 0xf0000
    s_cbranch_scc1 nf_181
nfx_182:
    s_add_u32 s98, s66, 24576
    s_add_u32 m0, s68, 0
    s_add_u32 s31, s98, 0
    buffer_load_dwordx4 v232, s[8:11], s31 offen offset:0 sc1 lds
    buffer_load_dwordx4 v232, s[8:11], s31 offen offset:1024 sc1 lds
    buffer_load_dwordx4 v233, s[8:11], s31 offen offset:2048 sc1 lds
    buffer_load_dwordx4 v233, s[8:11], s31 offen offset:3072 sc1 lds
    s_add_u32 m0, s68, 4096
    s_add_u32 s31, s98, 65536
    buffer_load_dwordx4 v232, s[8:11], s31 offen offset:0 sc1 lds
    buffer_load_dwordx4 v232, s[8:11], s31 offen offset:1024 sc1 lds
    buffer_load_dwordx4 v233, s[8:11], s31 offen offset:2048 sc1 lds
    buffer_load_dwordx4 v233, s[8:11], s31 offen offset:3072 sc1 lds
    s_cmp_lt_u32 s73, s60
    s_cbranch_scc1 pfg_183
    s_cmp_ge_u32 s55, 2
    s_cbranch_scc1 pfx_184
    s_mov_b32 s73, s61
    s_mov_b32 s60, 7340032
    s_add_u32 s55, s55, 1
    s_cmp_eq_u32 s55, 2
    s_cbranch_scc1 pfw2_185
    s_mov_b32 s44, s56
    s_and_b32 s45, s57, 0xffff
    s_mov_b32 s46, 7340032
    s_mov_b32 s47, 0x20000
    s_branch pfg_183
pfw2_185:
    s_mov_b32 s44, s58
    s_and_b32 s45, s59, 0xffff
    s_mov_b32 s46, 7340032
    s_mov_b32 s47, 0x20000
pfg_183:
    s_buffer_load_dword s74, s[44:47], s73 offset:0
    s_buffer_load_dword s74, s[44:47], s73 offset:64
    s_buffer_load_dword s74, s[44:47], s73 offset:128
    s_buffer_load_dword s74, s[44:47], s73 offset:192
    s_add_u32 s73, s73, 262144
    s_buffer_load_dword s74, s[44:47], s73 offset:0
    s_buffer_load_dword s74, s[44:47], s73 offset:64
    s_buffer_load_dword s74, s[44:47], s73 offset:128
    s_buffer_load_dword s74, s[44:47], s73 offset:192
    s_add_u32 s73, s73, 262144
pfx_184:
    s_waitcnt vmcnt(22)
    s_barrier
    s_add_u32 s99, s67, 6422528
    s_add_u32 m0, s69, 57344
    s_add_u32 s31, s99, 0
    buffer_load_dwordx4 v236, s[12:15], s31 offen offset:0  lds
    buffer_load_dwordx4 v237, s[12:15], s31 offen offset:1024  lds
    buffer_load_dwordx4 v238, s[12:15], s31 offen offset:2048  lds
    buffer_load_dwordx4 v239, s[12:15], s31 offen offset:3072  lds
    s_add_u32 m0, s69, 81920
    s_add_u32 s31, s99, 128
    buffer_load_dwordx4 v236, s[12:15], s31 offen offset:0  lds
    buffer_load_dwordx4 v237, s[12:15], s31 offen offset:1024  lds
    buffer_load_dwordx4 v238, s[12:15], s31 offen offset:2048  lds
    buffer_load_dwordx4 v239, s[12:15], s31 offen offset:3072  lds
    s_add_u32 m0, s69, 106496
    s_add_u32 s31, s99, 256
    buffer_load_dwordx4 v236, s[12:15], s31 offen offset:0  lds
    buffer_load_dwordx4 v237, s[12:15], s31 offen offset:1024  lds
    buffer_load_dwordx4 v238, s[12:15], s31 offen offset:2048  lds
    buffer_load_dwordx4 v239, s[12:15], s31 offen offset:3072  lds
    s_add_u32 m0, s70, 126976
    s_add_u32 s31, s99, 0
    buffer_load_dwordx4 v240, s[12:15], s31 offen offset:0  lds
    buffer_load_dwordx4 v241, s[12:15], s31 offen offset:1024  lds
    s_and_b32 s30, s41, 0xf000000
    s_cbranch_scc0 nfx_187
nf_186:
    s_mov_b32 exec_lo, 0xf0f0f0f0
    s_mov_b32 exec_hi, 0xfff0f0f0
    buffer_load_dword v8, v10, s[8:11], s32 offen sc1
    s_waitcnt vmcnt(0)
    v_and_b32 v8, 1, v8
    v_cmp_ne_u32 s[40:41], 1, v8
    s_orn2_b64 s[40:41], s[40:41], exec
    s_mov_b64 exec, -1
    s_add_u32 s72, s72, 1
    s_cmp_gt_u32 s72, 524288
    s_cbranch_scc1 nfx_187
    s_and_b32 s30, s41, 0xf000000
    s_cbranch_scc1 nf_186
nfx_187:
    s_add_u32 s98, s66, 28672
    s_add_u32 m0, s68, 16384
    s_add_u32 s31, s98, 0
    buffer_load_dwordx4 v232, s[8:11], s31 offen offset:0 sc1 lds
    buffer_load_dwordx4 v232, s[8:11], s31 offen offset:1024 sc1 lds
    buffer_load_dwordx4 v233, s[8:11], s31 offen offset:2048 sc1 lds
    buffer_load_dwordx4 v233, s[8:11], s31 offen offset:3072 sc1 lds
    s_add_u32 m0, s68, 20480
    s_add_u32 s31, s98, 65536
    buffer_load_dwordx4 v232, s[8:11], s31 offen offset:0 sc1 lds
    buffer_load_dwordx4 v232, s[8:11], s31 offen offset:1024 sc1 lds
    buffer_load_dwordx4 v233, s[8:11], s31 offen offset:2048 sc1 lds
    buffer_load_dwordx4 v233, s[8:11], s31 offen offset:3072 sc1 lds
    s_cmp_lt_u32 s73, s60
    s_cbranch_scc1 pfg_188
    s_cmp_ge_u32 s55, 2
    s_cbranch_scc1 pfx_189
    s_mov_b32 s73, s61
    s_mov_b32 s60, 7340032
    s_add_u32 s55, s55, 1
    s_cmp_eq_u32 s55, 2
    s_cbranch_scc1 pfw2_190
    s_mov_b32 s44, s56
    s_and_b32 s45, s57, 0xffff
    s_mov_b32 s46, 7340032
    s_mov_b32 s47, 0x20000
    s_branch pfg_188
pfw2_190:
    s_mov_b32 s44, s58
    s_and_b32 s45, s59, 0xffff
    s_mov_b32 s46, 7340032
    s_mov_b32 s47, 0x20000
pfg_188:
    s_buffer_load_dword s74, s[44:47], s73 offset:0
    s_buffer_load_dword s74, s[44:47], s73 offset:64
    s_buffer_load_dword s74, s[44:47], s73 offset:128
    s_buffer_load_dword s74, s[44:47], s73 offset:192
    s_add_u32 s73, s73, 262144
    s_buffer_load_dword s74, s[44:47], s73 offset:0
    s_buffer_load_dword s74, s[44:47], s73 offset:64
    s_buffer_load_dword s74, s[44:47], s73 offset:128
    s_buffer_load_dword s74, s[44:47], s73 offset:192
    s_add_u32 s73, s73, 262144
pfx_189:
    s_waitcnt vmcnt(22)
    s_barrier
    s_add_u32 s99, s67, 458752
    s_add_u32 m0, s69, 65536
    s_add_u32 s31, s99, 0
    buffer_load_dwordx4 v236, s[12:15], s31 offen offset:0  lds
    buffer_load_dwordx4 v237, s[12:15], s31 offen offset:1024  lds
    buffer_load_dwordx4 v238, s[12:15], s31 offen offset:2048  lds
    buffer_load_dwordx4 v239, s[12:15], s31 offen offset:3072  lds
    s_add_u32 m0, s69, 90112
    s_add_u32 s31, s99, 128
    buffer_load_dwordx4 v236, s[12:15], s31 offen offset:0  lds
    buffer_load_dwordx4 v237, s[12:15], s31 offen offset:1024  lds
    buffer_load_dwordx4 v238, s[12:15], s31 offen offset:2048  lds
    buffer_load_dwordx4 v239, s[12:15], s31 offen offset:3072  lds
    s_add_u32 m0, s69, 114688
    s_add_u32 s31, s99, 256
    buffer_load_dwordx4 v236, s[12:15], s31 offen offset:0  lds
    buffer_load_dwordx4 v237, s[12:15], s31 offen offset:1024  lds
    buffer_load_dwordx4 v238, s[12:15], s31 offen offset:2048  lds
    buffer_load_dwordx4 v239, s[12:15], s31 offen offset:3072  lds
    s_add_u32 m0, s70, 131072
    s_add_u32 s31, s99, 0
    buffer_load_dwordx4 v240, s[12:15], s31 offen offset:0  lds
    buffer_load_dwordx4 v241, s[12:15], s31 offen offset:1024  lds
    s_and_b32 s30, s40, 0xf0
    s_cbranch_scc0 nfx_192
nf_191:
    s_mov_b32 exec_lo, 0xf0f0f0f0
    s_mov_b32 exec_hi, 0xf0f0f0f0
    buffer_load_dword v8, v10, s[8:11], s32 offen sc1
    s_waitcnt vmcnt(0)
    v_and_b32 v8, 1, v8
    v_cmp_ne_u32 s[40:41], 1, v8
    s_orn2_b64 s[40:41], s[40:41], exec
    s_mov_b64 exec, -1
    s_add_u32 s72, s72, 1
    s_cmp_gt_u32 s72, 524288
    s_cbranch_scc1 nfx_192
    s_and_b32 s30, s40, 0xf0
    s_cbranch_scc1 nf_191
nfx_192:
    s_add_u32 s98, s66, 2048
    s_add_u32 m0, s68, 32768
    s_add_u32 s31, s98, 0
    buffer_load_dwordx4 v232, s[8:11], s31 offen offset:0 sc1 lds
    buffer_load_dwordx4 v232, s[8:11], s31 offen offset:1024 sc1 lds
    buffer_load_dwordx4 v233, s[8:11], s31 offen offset:2048 sc1 lds
    buffer_load_dwordx4 v233, s[8:11], s31 offen offset:3072 sc1 lds
    s_add_u32 m0, s68, 36864
    s_add_u32 s31, s98, 65536
    buffer_load_dwordx4 v232, s[8:11], s31 offen offset:0 sc1 lds
    buffer_load_dwordx4 v232, s[8:11], s31 offen offset:1024 sc1 lds
    buffer_load_dwordx4 v233, s[8:11], s31 offen offset:2048 sc1 lds
    buffer_load_dwordx4 v233, s[8:11], s31 offen offset:3072 sc1 lds
    s_cmp_lt_u32 s73, s60
    s_cbranch_scc1 pfg_193
    s_cmp_ge_u32 s55, 2
    s_cbranch_scc1 pfx_194
    s_mov_b32 s73, s61
    s_mov_b32 s60, 7340032
    s_add_u32 s55, s55, 1
    s_cmp_eq_u32 s55, 2
    s_cbranch_scc1 pfw2_195
    s_mov_b32 s44, s56
    s_and_b32 s45, s57, 0xffff
    s_mov_b32 s46, 7340032
    s_mov_b32 s47, 0x20000
    s_branch pfg_193
pfw2_195:
    s_mov_b32 s44, s58
    s_and_b32 s45, s59, 0xffff
    s_mov_b32 s46, 7340032
    s_mov_b32 s47, 0x20000
pfg_193:
    s_buffer_load_dword s74, s[44:47], s73 offset:0
    s_buffer_load_dword s74, s[44:47], s73 offset:64
    s_buffer_load_dword s74, s[44:47], s73 offset:128
    s_buffer_load_dword s74, s[44:47], s73 offset:192
    s_add_u32 s73, s73, 262144
pfx_194:
    s_waitcnt vmcnt(22)
    s_barrier
    s_add_u32 s99, s67, 1376256
    s_add_u32 m0, s69, 49152
    s_add_u32 s31, s99, 0
    buffer_load_dwordx4 v236, s[12:15], s31 offen offset:0  lds
    buffer_load_dwordx4 v237, s[12:15], s31 offen offset:1024  lds
    buffer_load_dwordx4 v238, s[12:15], s31 offen offset:2048  lds
    buffer_load_dwordx4 v239, s[12:15], s31 offen offset:3072  lds
    s_add_u32 m0, s69, 73728
    s_add_u32 s31, s99, 128
    buffer_load_dwordx4 v236, s[12:15], s31 offen offset:0  lds
    buffer_load_dwordx4 v237, s[12:15], s31 offen offset:1024  lds
    buffer_load_dwordx4 v238, s[12:15], s31 offen offset:2048  lds
    buffer_load_dwordx4 v239, s[12:15], s31 offen offset:3072  lds
    s_add_u32 m0, s69, 98304
    s_add_u32 s31, s99, 256
    buffer_load_dwordx4 v236, s[12:15], s31 offen offset:0  lds
    buffer_load_dwordx4 v237, s[12:15], s31 offen offset:1024  lds
    buffer_load_dwordx4 v238, s[12:15], s31 offen offset:2048  lds
    buffer_load_dwordx4 v239, s[12:15], s31 offen offset:3072  lds
    s_add_u32 m0, s70, 122880
    s_add_u32 s31, s99, 0
    buffer_load_dwordx4 v240, s[12:15], s31 offen offset:0  lds
    buffer_load_dwordx4 v241, s[12:15], s31 offen offset:1024  lds
    s_and_b32 s30, s40, 0xf000
    s_cbranch_scc0 nfx_197
nf_196:
    s_mov_b32 exec_lo, 0xf0f0f000
    s_mov_b32 exec_hi, 0xf0f0f0f0
    buffer_load_dword v8, v10, s[8:11], s32 offen sc1
    s_waitcnt vmcnt(0)
    v_and_b32 v8, 1, v8
    v_cmp_ne_u32 s[40:41], 1, v8
    s_orn2_b64 s[40:41], s[40:41], exec
    s_mov_b64 exec, -1
    s_add_u32 s72, s72, 1
    s_cmp_gt_u32 s72, 524288
    s_cbranch_scc1 nfx_197
    s_and_b32 s30, s40, 0xf000
    s_cbranch_scc1 nf_196
nfx_197:
    s_add_u32 s98, s66, 6144
    s_add_u32 m0, s68, 0
    s_add_u32 s31, s98, 0
    buffer_load_dwordx4 v232, s[8:11], s31 offen offset:0 sc1 lds
    buffer_load_dwordx4 v232, s[8:11], s31 offen offset:1024 sc1 lds
    buffer_load_dwordx4 v233, s[8:11], s31 offen offset:2048 sc1 lds
    buffer_load_dwordx4 v233, s[8:11], s31 offen offset:3072 sc1 lds
    s_add_u32 m0, s68, 4096
    s_add_u32 s31, s98, 65536
    buffer_load_dwordx4 v232, s[8:11], s31 offen offset:0 sc1 lds
    buffer_load_dwordx4 v232, s[8:11], s31 offen offset:1024 sc1 lds
    buffer_load_dwordx4 v233, s[8:11], s31 offen offset:2048 sc1 lds
    buffer_load_dwordx4 v233, s[8:11], s31 offen offset:3072 sc1 lds
    s_cmp_lt_u32 s73, s60
    s_cbranch_scc1 pfg_198
    s_cmp_ge_u32 s55, 2
    s_cbranch_scc1 pfx_199
    s_mov_b32 s73, s61
    s_mov_b32 s60, 7340032
    s_add_u32 s55, s55, 1
    s_cmp_eq_u32 s55, 2
    s_cbranch_scc1 pfw2_200
    s_mov_b32 s44, s56
    s_and_b32 s45, s57, 0xffff
    s_mov_b32 s46, 7340032
    s_mov_b32 s47, 0x20000
    s_branch pfg_198
pfw2_200:
    s_mov_b32 s44, s58
    s_and_b32 s45, s59, 0xffff
    s_mov_b32 s46, 7340032
    s_mov_b32 s47, 0x20000
pfg_198:
    s_buffer_load_dword s74, s[44:47], s73 offset:0
    s_buffer_load_dword s74, s[44:47], s73 offset:64
    s_buffer_load_dword s74, s[44:47], s73 offset:128
    s_buffer_load_dword s74, s[44:47], s73 offset:192
    s_add_u32 s73, s73, 262144
    s_buffer_load_dword s74, s[44:47], s73 offset:0
    s_buffer_load_dword s74, s[44:47], s73 offset:64
    s_buffer_load_dword s74, s[44:47], s73 offset:128
    s_buffer_load_dword s74, s[44:47], s73 offset:192
    s_add_u32 s73, s73, 262144
pfx_199:
    s_waitcnt vmcnt(22)
    s_barrier
    s_add_u32 s99, s67, 2293760
    s_add_u32 m0, s69, 57344
    s_add_u32 s31, s99, 0
    buffer_load_dwordx4 v236, s[12:15], s31 offen offset:0  lds
    buffer_load_dwordx4 v237, s[12:15], s31 offen offset:1024  lds
    buffer_load_dwordx4 v238, s[12:15], s31 offen offset:2048  lds
    buffer_load_dwordx4 v239, s[12:15], s31 offen offset:3072  lds
    s_add_u32 m0, s69, 81920
    s_add_u32 s31, s99, 128
    buffer_load_dwordx4 v236, s[12:15], s31 offen offset:0  lds
    buffer_load_dwordx4 v237, s[12:15], s31 offen offset:1024  lds
    buffer_load_dwordx4 v238, s[12:15], s31 offen offset:2048  lds
    buffer_load_dwordx4 v239, s[12:15], s31 offen offset:3072  lds
    s_add_u32 m0, s69, 106496
    s_add_u32 s31, s99, 256
    buffer_load_dwordx4 v236, s[12:15], s31 offen offset:0  lds
    buffer_load_dwordx4 v237, s[12:15], s31 offen offset:1024  lds
    buffer_load_dwordx4 v238, s[12:15], s31 offen offset:2048  lds
    buffer_load_dwordx4 v239, s[12:15], s31 offen offset:3072  lds
    s_add_u32 m0, s70, 126976
    s_add_u32 s31, s99, 0
    buffer_load_dwordx4 v240, s[12:15], s31 offen offset:0  lds
    buffer_load_dwordx4 v241, s[12:15], s31 offen offset:1024  lds
    s_and_b32 s30, s40, 0xf00000
    s_cbranch_scc0 nfx_202
nf_201:
    s_mov_b32 exec_lo, 0xf0f00000
    s_mov_b32 exec_hi, 0xf0f0f0f0
    buffer_load_dword v8, v10, s[8:11], s32 offen sc1
    s_waitcnt vmcnt(0)
    v_and_b32 v8, 1, v8
    v_cmp_ne_u32 s[40:41], 1, v8
    s_orn2_b64 s[40:41], s[40:41], exec
    s_mov_b64 exec, -1
    s_add_u32 s72, s72, 1
    s_cmp_gt_u32 s72, 524288
    s_cbranch_scc1 nfx_202
    s_and_b32 s30, s40, 0xf00000
    s_cbranch_scc1 nf_201
nfx_202:
    s_add_u32 s98, s66, 10240
    s_add_u32 m0, s68, 16384
    s_add_u32 s31, s98, 0
    buffer_load_dwordx4 v232, s[8:11], s31 offen offset:0 sc1 lds
    buffer_load_dwordx4 v232, s[8:11], s31 offen offset:1024 sc1 lds
    buffer_load_dwordx4 v233, s[8:11], s31 offen offset:2048 sc1 lds
    buffer_load_dwordx4 v233, s[8:11], s31 offen offset:3072 sc1 lds
    s_add_u32 m0, s68, 20480
    s_add_u32 s31, s98, 65536
    buffer_load_dwordx4 v232, s[8:11], s31 offen offset:0 sc1 lds
    buffer_load_dwordx4 v232, s[8:11], s31 offen offset:1024 sc1 lds
    buffer_load_dwordx4 v233, s[8:11], s31 offen offset:2048 sc1 lds
    buffer_load_dwordx4 v233, s[8:11], s31 offen offset:3072 sc1 lds
    s_cmp_lt_u32 s73, s60
    s_cbranch_scc1 pfg_203
    s_cmp_ge_u32 s55, 2
    s_cbranch_scc1 pfx_204
    s_mov_b32 s73, s61
    s_mov_b32 s60, 7340032
    s_add_u32 s55, s55, 1
    s_cmp_eq_u32 s55, 2
    s_cbranch_scc1 pfw2_205
    s_mov_b32 s44, s56
    s_and_b32 s45, s57, 0xffff
    s_mov_b32 s46, 7340032
    s_mov_b32 s47, 0x20000
    s_branch pfg_203
pfw2_205:
    s_mov_b32 s44, s58
    s_and_b32 s45, s59, 0xffff
    s_mov_b32 s46, 7340032
    s_mov_b32 s47, 0x20000
pfg_203:
    s_buffer_load_dword s74, s[44:47], s73 offset:0
    s_buffer_load_dword s74, s[44:47], s73 offset:64
    s_buffer_load_dword s74, s[44:47], s73 offset:128
    s_buffer_load_dword s74, s[44:47], s73 offset:192
    s_add_u32 s73, s73, 262144
    s_buffer_load_dword s74, s[44:47], s73 offset:0
    s_buffer_load_dword s74, s[44:47], s73 offset:64
    s_buffer_load_dword s74, s[44:47], s73 offset:128
    s_buffer_load_dword s74, s[44:47], s73 offset:192
    s_add_u32 s73, s73, 262144
pfx_204:
    s_waitcnt vmcnt(22)
    s_barrier
    s_add_u32 s99, s67, 3211264
    s_add_u32 m0, s69, 65536
    s_add_u32 s31, s99, 0
    buffer_load_dwordx4 v236, s[12:15], s31 offen offset:0  lds
    buffer_load_dwordx4 v237, s[12:15], s31 offen offset:1024  lds
    buffer_load_dwordx4 v238, s[12:15], s31 offen offset:2048  lds
    buffer_load_dwordx4 v239, s[12:15], s31 offen offset:3072  lds
    s_add_u32 m0, s69, 90112
    s_add_u32 s31, s99, 128
    buffer_load_dwordx4 v236, s[12:15], s31 offen offset:0  lds
    buffer_load_dwordx4 v237, s[12:15], s31 offen offset:1024  lds
    buffer_load_dwordx4 v238, s[12:15], s31 offen offset:2048  lds
    buffer_load_dwordx4 v239, s[12:15], s31 offen offset:3072  lds
    s_add_u32 m0, s69, 114688
    s_add_u32 s31, s99, 256
    buffer_load_dwordx4 v236, s[12:15], s31 offen offset:0  lds
    buffer_load_dwordx4 v237, s[12:15], s31 offen offset:1024  lds
    buffer_load_dwordx4 v238, s[12:15], s31 offen offset:2048  lds
    buffer_load_dwordx4 v239, s[12:15], s31 offen offset:3072  lds
    s_add_u32 m0, s70, 131072
    s_add_u32 s31, s99, 0
    buffer_load_dwordx4 v240, s[12:15], s31 offen offset:0  lds
    buffer_load_dwordx4 v241, s[12:15], s31 offen offset:1024  lds
    s_and_b32 s30, s40, 0xf0000000
    s_cbranch_scc0 nfx_207
nf_206:
    s_mov_b32 exec_lo, 0xf0000000
    s_mov_b32 exec_hi, 0xf0f0f0f0
    buffer_load_dword v8, v10, s[8:11], s32 offen sc1
    s_waitcnt vmcnt(0)
    v_and_b32 v8, 1, v8
    v_cmp_ne_u32 s[40:41], 1, v8
    s_orn2_b64 s[40:41], s[40:41], exec
    s_mov_b64 exec, -1
    s_add_u32 s72, s72, 1
    s_cmp_gt_u32 s72, 524288
    s_cbranch_scc1 nfx_207
    s_and_b32 s30, s40, 0xf0000000
    s_cbranch_scc1 nf_206
nfx_207:
    s_add_u32 s98, s66, 14336
    s_add_u32 m0, s68, 32768
    s_add_u32 s31, s98, 0
    buffer_load_dwordx4 v232, s[8:11], s31 offen offset:0 sc1 lds
    buffer_load_dwordx4 v232, s[8:11], s31 offen offset:1024 sc1 lds
    buffer_load_dwordx4 v233, s[8:11], s31 offen offset:2048 sc1 lds
    buffer_load_dwordx4 v233, s[8:11], s31 offen offset:3072 sc1 lds
    s_add_u32 m0, s68, 36864
    s_add_u32 s31, s98, 65536
    buffer_load_dwordx4 v232, s[8:11], s31 offen offset:0 sc1 lds
    buffer_load_dwordx4 v232, s[8:11], s31 offen offset:1024 sc1 lds
    buffer_load_dwordx4 v233, s[8:11], s31 offen offset:2048 sc1 lds
    buffer_load_dwordx4 v233, s[8:11], s31 offen offset:3072 sc1 lds
    s_cmp_lt_u32 s73, s60
    s_cbranch_scc1 pfg_208
    s_cmp_ge_u32 s55, 2
    s_cbranch_scc1 pfx_209
    s_mov_b32 s73, s61
    s_mov_b32 s60, 7340032
    s_add_u32 s55, s55, 1
    s_cmp_eq_u32 s55, 2
    s_cbranch_scc1 pfw2_210
    s_mov_b32 s44, s56
    s_and_b32 s45, s57, 0xffff
    s_mov_b32 s46, 7340032
    s_mov_b32 s47, 0x20000
    s_branch pfg_208
pfw2_210:
    s_mov_b32 s44, s58
    s_and_b32 s45, s59, 0xffff
    s_mov_b32 s46, 7340032
    s_mov_b32 s47, 0x20000
pfg_208:
    s_buffer_load_dword s74, s[44:47], s73 offset:0
    s_buffer_load_dword s74, s[44:47], s73 offset:64
    s_buffer_load_dword s74, s[44:47], s73 offset:128
    s_buffer_load_dword s74, s[44:47], s73 offset:192
    s_add_u32 s73, s73, 262144
pfx_209:
    s_waitcnt vmcnt(22)
    s_barrier
    s_add_u32 s99, s67, 4128768
    s_add_u32 m0, s69, 49152
    s_add_u32 s31, s99, 0
    buffer_load_dwordx4 v236, s[12:15], s31 offen offset:0  lds
    buffer_load_dwordx4 v237, s[12:15], s31 offen offset:1024  lds
    buffer_load_dwordx4 v238, s[12:15], s31 offen offset:2048  lds
    buffer_load_dwordx4 v239, s[12:15], s31 offen offset:3072  lds
    s_add_u32 m0, s69, 73728
    s_add_u32 s31, s99, 128
    buffer_load_dwordx4 v236, s[12:15], s31 offen offset:0  lds
    buffer_load_dwordx4 v237, s[12:15], s31 offen offset:1024  lds
    buffer_load_dwordx4 v238, s[12:15], s31 offen offset:2048  lds
    buffer_load_dwordx4 v239, s[12:15], s31 offen offset:3072  lds
    s_add_u32 m0, s69, 98304
    s_add_u32 s31, s99, 256
    buffer_load_dwordx4 v236, s[12:15], s31 offen offset:0  lds
    buffer_load_dwordx4 v237, s[12:15], s31 offen offset:1024  lds
    buffer_load_dwordx4 v238, s[12:15], s31 offen offset:2048  lds
    buffer_load_dwordx4 v239, s[12:15], s31 offen offset:3072  lds
    s_add_u32 m0, s70, 122880
    s_add_u32 s31, s99, 0
    buffer_load_dwordx4 v240, s[12:15], s31 offen offset:0  lds
    buffer_load_dwordx4 v241, s[12:15], s31 offen offset:1024  lds
    s_and_b32 s30, s41, 0xf0
    s_cbranch_scc0 nfx_212
nf_211:
    s_mov_b32 exec_lo, 0x0
    s_mov_b32 exec_hi, 0xf0f0f0f0
    buffer_load_dword v8, v10, s[8:11], s32 offen sc1
    s_waitcnt vmcnt(0)
    v_and_b32 v8, 1, v8
    v_cmp_ne_u32 s[40:41], 1, v8
    s_orn2_b64 s[40:41], s[40:41], exec
    s_mov_b64 exec, -1
    s_add_u32 s72, s72, 1
    s_cmp_gt_u32 s72, 524288
    s_cbranch_scc1 nfx_212
    s_and_b32 s30, s41, 0xf0
    s_cbranch_scc1 nf_211
nfx_212:
    s_add_u32 s98, s66, 18432
    s_add_u32 m0, s68, 0
    s_add_u32 s31, s98, 0
    buffer_load_dwordx4 v232, s[8:11], s31 offen offset:0 sc1 lds
    buffer_load_dwordx4 v232, s[8:11], s31 offen offset:1024 sc1 lds
    buffer_load_dwordx4 v233, s[8:11], s31 offen offset:2048 sc1 lds
    buffer_load_dwordx4 v233, s[8:11], s31 offen offset:3072 sc1 lds
    s_add_u32 m0, s68, 4096
    s_add_u32 s31, s98, 65536
    buffer_load_dwordx4 v232, s[8:11], s31 offen offset:0 sc1 lds
    buffer_load_dwordx4 v232, s[8:11], s31 offen offset:1024 sc1 lds
    buffer_load_dwordx4 v233, s[8:11], s31 offen offset:2048 sc1 lds
    buffer_load_dwordx4 v233, s[8:11], s31 offen offset:3072 sc1 lds
    s_cmp_lt_u32 s73, s60
    s_cbranch_scc1 pfg_213
    s_cmp_ge_u32 s55, 2
    s_cbranch_scc1 pfx_214
    s_mov_b32 s73, s61
    s_mov_b32 s60, 7340032
    s_add_u32 s55, s55, 1
    s_cmp_eq_u32 s55, 2
    s_cbranch_scc1 pfw2_215
    s_mov_b32 s44, s56
    s_and_b32 s45, s57, 0xffff
    s_mov_b32 s46, 7340032
    s_mov_b32 s47, 0x20000
    s_branch pfg_213
pfw2_215:
    s_mov_b32 s44, s58
    s_and_b32 s45, s59, 0xffff
    s_mov_b32 s46, 7340032
    s_mov_b32 s47, 0x20000
pfg_213:
    s_buffer_load_dword s74, s[44:47], s73 offset:0
    s_buffer_load_dword s74, s[44:47], s73 offset:64
    s_buffer_load_dword s74, s[44:47], s73 offset:128
    s_buffer_load_dword s74, s[44:47], s73 offset:192
    s_add_u32 s73, s73, 262144
    s_buffer_load_dword s74, s[44:47], s73 offset:0
    s_buffer_load_dword s74, s[44:47], s73 offset:64
    s_buffer_load_dword s74, s[44:47], s73 offset:128
    s_buffer_load_dword s74, s[44:47], s73 offset:192
    s_add_u32 s73, s73, 262144
pfx_214:
    s_waitcnt vmcnt(22)
    s_barrier
    s_add_u32 s99, s67, 5046272
    s_add_u32 m0, s69, 57344
    s_add_u32 s31, s99, 0
    buffer_load_dwordx4 v236, s[12:15], s31 offen offset:0  lds
    buffer_load_dwordx4 v237, s[12:15], s31 offen offset:1024  lds
    buffer_load_dwordx4 v238, s[12:15], s31 offen offset:2048  lds
    buffer_load_dwordx4 v239, s[12:15], s31 offen offset:3072  lds
    s_add_u32 m0, s69, 81920
    s_add_u32 s31, s99, 128
    buffer_load_dwordx4 v236, s[12:15], s31 offen offset:0  lds
    buffer_load_dwordx4 v237, s[12:15], s31 offen offset:1024  lds
    buffer_load_dwordx4 v238, s[12:15], s31 offen offset:2048  lds
    buffer_load_dwordx4 v239, s[12:15], s31 offen offset:3072  lds
    s_add_u32 m0, s69, 106496
    s_add_u32 s31, s99, 256
    buffer_load_dwordx4 v236, s[12:15], s31 offen offset:0  lds
    buffer_load_dwordx4 v237, s[12:15], s31 offen offset:1024  lds
    buffer_load_dwordx4 v238, s[12:15], s31 offen offset:2048  lds
    buffer_load_dwordx4 v239, s[12:15], s31 offen offset:3072  lds
    s_add_u32 m0, s70, 126976
    s_add_u32 s31, s99, 0
    buffer_load_dwordx4 v240, s[12:15], s31 offen offset:0  lds
    buffer_load_dwordx4 v241, s[12:15], s31 offen offset:1024  lds
    s_and_b32 s30, s41, 0xf000
    s_cbranch_scc0 nfx_217
nf_216:
    s_mov_b32 exec_lo, 0x0
    s_mov_b32 exec_hi, 0xf0f0f000
    buffer_load_dword v8, v10, s[8:11], s32 offen sc1
    s_waitcnt vmcnt(0)
    v_and_b32 v8, 1, v8
    v_cmp_ne_u32 s[40:41], 1, v8
    s_orn2_b64 s[40:41], s[40:41], exec
    s_mov_b64 exec, -1
    s_add_u32 s72, s72, 1
    s_cmp_gt_u32 s72, 524288
    s_cbranch_scc1 nfx_217
    s_and_b32 s30, s41, 0xf000
    s_cbranch_scc1 nf_216
nfx_217:
    s_add_u32 s98, s66, 22528
    s_add_u32 m0, s68, 16384
    s_add_u32 s31, s98, 0
    buffer_load_dwordx4 v232, s[8:11], s31 offen offset:0 sc1 lds
    buffer_load_dwordx4 v232, s[8:11], s31 offen offset:1024 sc1 lds
    buffer_load_dwordx4 v233, s[8:11], s31 offen offset:2048 sc1 lds
    buffer_load_dwordx4 v233, s[8:11], s31 offen offset:3072 sc1 lds
    s_add_u32 m0, s68, 20480
    s_add_u32 s31, s98, 65536
    buffer_load_dwordx4 v232, s[8:11], s31 offen offset:0 sc1 lds
    buffer_load_dwordx4 v232, s[8:11], s31 offen offset:1024 sc1 lds
    buffer_load_dwordx4 v233, s[8:11], s31 offen offset:2048 sc1 lds
    buffer_load_dwordx4 v233, s[8:11], s31 offen offset:3072 sc1 lds
    s_cmp_lt_u32 s73, s60
    s_cbranch_scc1 pfg_218
    s_cmp_ge_u32 s55, 2
    s_cbranch_scc1 pfx_219
    s_mov_b32 s73, s61
    s_mov_b32 s60, 7340032
    s_add_u32 s55, s55, 1
    s_cmp_eq_u32 s55, 2
    s_cbranch_scc1 pfw2_220
    s_mov_b32 s44, s56
    s_and_b32 s45, s57, 0xffff
    s_mov_b32 s46, 7340032
    s_mov_b32 s47, 0x20000
    s_branch pfg_218
pfw2_220:
    s_mov_b32 s44, s58
    s_and_b32 s45, s59, 0xffff
    s_mov_b32 s46, 7340032
    s_mov_b32 s47, 0x20000
pfg_218:
    s_buffer_load_dword s74, s[44:47], s73 offset:0
    s_buffer_load_dword s74, s[44:47], s73 offset:64
    s_buffer_load_dword s74, s[44:47], s73 offset:128
    s_buffer_load_dword s74, s[44:47], s73 offset:192
    s_add_u32 s73, s73, 262144
    s_buffer_load_dword s74, s[44:47], s73 offset:0
    s_buffer_load_dword s74, s[44:47], s73 offset:64
    s_buffer_load_dword s74, s[44:47], s73 offset:128
    s_buffer_load_dword s74, s[44:47], s73 offset:192
    s_add_u32 s73, s73, 262144
pfx_219:
    s_waitcnt vmcnt(22)
    s_barrier
    s_add_u32 s99, s67, 5963776
    s_add_u32 m0, s69, 65536
    s_add_u32 s31, s99, 0
    buffer_load_dwordx4 v236, s[12:15], s31 offen offset:0  lds
    buffer_load_dwordx4 v237, s[12:15], s31 offen offset:1024  lds
    buffer_load_dwordx4 v238, s[12:15], s31 offen offset:2048  lds
    buffer_load_dwordx4 v239, s[12:15], s31 offen offset:3072  lds
    s_add_u32 m0, s69, 90112
    s_add_u32 s31, s99, 128
    buffer_load_dwordx4 v236, s[12:15], s31 offen offset:0  lds
    buffer_load_dwordx4 v237, s[12:15], s31 offen offset:1024  lds
    buffer_load_dwordx4 v238, s[12:15], s31 offen offset:2048  lds
    buffer_load_dwordx4 v239, s[12:15], s31 offen offset:3072  lds
    s_add_u32 m0, s69, 114688
    s_add_u32 s31, s99, 256
    buffer_load_dwordx4 v236, s[12:15], s31 offen offset:0  lds
    buffer_load_dwordx4 v237, s[12:15], s31 offen offset:1024  lds
    buffer_load_dwordx4 v238, s[12:15], s31 offen offset:2048  lds
    buffer_load_dwordx4 v239, s[12:15], s31 offen offset:3072  lds
    s_add_u32 m0, s70, 131072
    s_add_u32 s31, s99, 0
    buffer_load_dwordx4 v240, s[12:15], s31 offen offset:0  lds
    buffer_load_dwordx4 v241, s[12:15], s31 offen offset:1024  lds
    s_and_b32 s30, s41, 0xf00000
    s_cbranch_scc0 nfx_222
nf_221:
    s_mov_b32 exec_lo, 0x0
    s_mov_b32 exec_hi, 0xf0f00000
    buffer_load_dword v8, v10, s[8:11], s32 offen sc1
    s_waitcnt vmcnt(0)
    v_and_b32 v8, 1, v8
    v_cmp_ne_u32 s[40:41], 1, v8
    s_orn2_b64 s[40:41], s[40:41], exec
    s_mov_b64 exec, -1
    s_add_u32 s72, s72, 1
    s_cmp_gt_u32 s72, 524288
    s_cbranch_scc1 nfx_222
    s_and_b32 s30, s41, 0xf00000
    s_cbranch_scc1 nf_221
nfx_222:
    s_add_u32 s98, s66, 26624
    s_add_u32 m0, s68, 32768
    s_add_u32 s31, s98, 0
    buffer_load_dwordx4 v232, s[8:11], s31 offen offset:0 sc1 lds
    buffer_load_dwordx4 v232, s[8:11], s31 offen offset:1024 sc1 lds
    buffer_load_dwordx4 v233, s[8:11], s31 offen offset:2048 sc1 lds
    buffer_load_dwordx4 v233, s[8:11], s31 offen offset:3072 sc1 lds
    s_add_u32 m0, s68, 36864
    s_add_u32 s31, s98, 65536
    buffer_load_dwordx4 v232, s[8:11], s31 offen offset:0 sc1 lds
    buffer_load_dwordx4 v232, s[8:11], s31 offen offset:1024 sc1 lds
    buffer_load_dwordx4 v233, s[8:11], s31 offen offset:2048 sc1 lds
    buffer_load_dwordx4 v233, s[8:11], s31 offen offset:3072 sc1 lds
    s_cmp_lt_u32 s73, s60
    s_cbranch_scc1 pfg_223
    s_cmp_ge_u32 s55, 2
    s_cbranch_scc1 pfx_224
    s_mov_b32 s73, s61
    s_mov_b32 s60, 7340032
    s_add_u32 s55, s55, 1
    s_cmp_eq_u32 s55, 2
    s_cbranch_scc1 pfw2_225
    s_mov_b32 s44, s56
    s_and_b32 s45, s57, 0xffff
    s_mov_b32 s46, 7340032
    s_mov_b32 s47, 0x20000
    s_branch pfg_223
pfw2_225:
    s_mov_b32 s44, s58
    s_and_b32 s45, s59, 0xffff
    s_mov_b32 s46, 7340032
    s_mov_b32 s47, 0x20000
pfg_223:
    s_buffer_load_dword s74, s[44:47], s73 offset:0
    s_buffer_load_dword s74, s[44:47], s73 offset:64
    s_buffer_load_dword s74, s[44:47], s73 offset:128
    s_buffer_load_dword s74, s[44:47], s73 offset:192
    s_add_u32 s73, s73, 262144
pfx_224:
    s_waitcnt vmcnt(22)
    s_barrier
    s_add_u32 s99, s67, 6881280
    s_add_u32 m0, s69, 49152
    s_add_u32 s31, s99, 0
    buffer_load_dwordx4 v236, s[12:15], s31 offen offset:0  lds
    buffer_load_dwordx4 v237, s[12:15], s31 offen offset:1024  lds
    buffer_load_dwordx4 v238, s[12:15], s31 offen offset:2048  lds
    buffer_load_dwordx4 v239, s[12:15], s31 offen offset:3072  lds
    s_add_u32 m0, s69, 73728
    s_add_u32 s31, s99, 128
    buffer_load_dwordx4 v236, s[12:15], s31 offen offset:0  lds
    buffer_load_dwordx4 v237, s[12:15], s31 offen offset:1024  lds
    buffer_load_dwordx4 v238, s[12:15], s31 offen offset:2048  lds
    buffer_load_dwordx4 v239, s[12:15], s31 offen offset:3072  lds
    s_add_u32 m0, s69, 98304
    s_add_u32 s31, s99, 256
    buffer_load_dwordx4 v236, s[12:15], s31 offen offset:0  lds
    buffer_load_dwordx4 v237, s[12:15], s31 offen offset:1024  lds
    buffer_load_dwordx4 v238, s[12:15], s31 offen offset:2048  lds
    buffer_load_dwordx4 v239, s[12:15], s31 offen offset:3072  lds
    s_add_u32 m0, s70, 122880
    s_add_u32 s31, s99, 0
    buffer_load_dwordx4 v240, s[12:15], s31 offen offset:0  lds
    buffer_load_dwordx4 v241, s[12:15], s31 offen offset:1024  lds
    s_and_b32 s30, s41, 0xf0000000
    s_cbranch_scc0 nfx_227
nf_226:
    s_mov_b32 exec_lo, 0x0
    s_mov_b32 exec_hi, 0xf0000000
    buffer_load_dword v8, v10, s[8:11], s32 offen sc1
    s_waitcnt vmcnt(0)
    v_and_b32 v8, 1, v8
    v_cmp_ne_u32 s[40:41], 1, v8
    s_orn2_b64 s[40:41], s[40:41], exec
    s_mov_b64 exec, -1
    s_add_u32 s72, s72, 1
    s_cmp_gt_u32 s72, 524288
    s_cbranch_scc1 nfx_227
    s_and_b32 s30, s41, 0xf0000000
    s_cbranch_scc1 nf_226
nfx_227:
    s_add_u32 s98, s66, 30720
    s_add_u32 m0, s68, 0
    s_add_u32 s31, s98, 0
    buffer_load_dwordx4 v232, s[8:11], s31 offen offset:0 sc1 lds
    buffer_load_dwordx4 v232, s[8:11], s31 offen offset:1024 sc1 lds
    buffer_load_dwordx4 v233, s[8:11], s31 offen offset:2048 sc1 lds
    buffer_load_dwordx4 v233, s[8:11], s31 offen offset:3072 sc1 lds
    s_add_u32 m0, s68, 4096
    s_add_u32 s31, s98, 65536
    buffer_load_dwordx4 v232, s[8:11], s31 offen offset:0 sc1 lds
    buffer_load_dwordx4 v232, s[8:11], s31 offen offset:1024 sc1 lds
    buffer_load_dwordx4 v233, s[8:11], s31 offen offset:2048 sc1 lds
    buffer_load_dwordx4 v233, s[8:11], s31 offen offset:3072 sc1 lds
    s_cmp_lt_u32 s73, s60
    s_cbranch_scc1 pfg_228
    s_cmp_ge_u32 s55, 2
    s_cbranch_scc1 pfx_229
    s_mov_b32 s73, s61
    s_mov_b32 s60, 7340032
    s_add_u32 s55, s55, 1
    s_cmp_eq_u32 s55, 2
    s_cbranch_scc1 pfw2_230
    s_mov_b32 s44, s56
    s_and_b32 s45, s57, 0xffff
    s_mov_b32 s46, 7340032
    s_mov_b32 s47, 0x20000
    s_branch pfg_228
pfw2_230:
    s_mov_b32 s44, s58
    s_and_b32 s45, s59, 0xffff
    s_mov_b32 s46, 7340032
    s_mov_b32 s47, 0x20000
pfg_228:
    s_buffer_load_dword s74, s[44:47], s73 offset:0
    s_buffer_load_dword s74, s[44:47], s73 offset:64
    s_buffer_load_dword s74, s[44:47], s73 offset:128
    s_buffer_load_dword s74, s[44:47], s73 offset:192
    s_add_u32 s73, s73, 262144
    s_buffer_load_dword s74, s[44:47], s73 offset:0
    s_buffer_load_dword s74, s[44:47], s73 offset:64
    s_buffer_load_dword s74, s[44:47], s73 offset:128
    s_buffer_load_dword s74, s[44:47], s73 offset:192
    s_add_u32 s73, s73, 262144
pfx_229:
    s_waitcnt vmcnt(22)
    s_barrier
    s_waitcnt vmcnt(0)
    s_barrier
    s_barrier
pfin_231:
    s_cmp_lt_u32 s73, s60
    s_cbranch_scc1 pfg_232
    s_cmp_ge_u32 s55, 2
    s_cbranch_scc1 pfx_233
    s_mov_b32 s73, s61
    s_mov_b32 s60, 7340032
    s_add_u32 s55, s55, 1
    s_cmp_eq_u32 s55, 2
    s_cbranch_scc1 pfw2_234
    s_mov_b32 s44, s56
    s_and_b32 s45, s57, 0xffff
    s_mov_b32 s46, 7340032
    s_mov_b32 s47, 0x20000
    s_branch pfg_232
pfw2_234:
    s_mov_b32 s44, s58
    s_and_b32 s45, s59, 0xffff
    s_mov_b32 s46, 7340032
    s_mov_b32 s47, 0x20000
pfg_232:
    s_buffer_load_dword s74, s[44:47], s73 offset:0
    s_buffer_load_dword s74, s[44:47], s73 offset:64
    s_buffer_load_dword s74, s[44:47], s73 offset:128
    s_buffer_load_dword s74, s[44:47], s73 offset:192
    s_add_u32 s73, s73, 262144
    s_buffer_load_dword s74, s[44:47], s73 offset:0
    s_buffer_load_dword s74, s[44:47], s73 offset:64
    s_buffer_load_dword s74, s[44:47], s73 offset:128
    s_buffer_load_dword s74, s[44:47], s73 offset:192
    s_add_u32 s73, s73, 262144
pfx_233:
    s_waitcnt lgkmcnt(6)
    s_cmp_lt_u32 s55, 2
    s_cbranch_scc1 pfin_231
    s_cmp_lt_u32 s73, s60
    s_cbranch_scc1 pfin_231
    s_and_b32 s24, s22, 1
    s_lshl_b32 s24, s24, 3
    s_and_b32 s30, s23, 6
    s_add_u32 s24, s24, s30
    s_and_b32 s25, s23, 1
    s_lshl_b32 s25, s25, 2
    s_lshr_b32 s30, s23, 3
    s_add_u32 s25, s25, s30
    s_lshr_b32 s71, s22, 1
    s_mov_b32 s12, s58
    s_and_b32 s13, s59, 0xffff
    s_mov_b32 s14, 7340032
    s_mov_b32 s15, 0x20000
    s_lshl_b32 s26, s25, 8
    s_mul_i32 s67, s71, 1835008

    s_lshl_b32 s69, s21, 12
    s_lshl_b32 s70, s21, 11
    v_lshrrev_b32 v246, 3, v1
    s_lshl_b32 s30, s21, 5
    v_add_u32 v246, s30, v246
    v_mul_u32_u24 v246, 2048, v246
    v_and_b32 v247, 1, v1
    v_lshl_add_u32 v246, v247, 4, v246
    v_add_u32 v246, s26, v246
    v_bfe_u32 v247, v1, 1, 2

    v_xor_b32 v245, v247, v3
    v_lshl_add_u32 v236, v245, 5, v246
    v_add_u32 v237, 15360, v236
    v_add_u32 v238, 30720, v236
    v_add_u32 v239, 30720, v237
    s_lshl_b32 s68, s21, 14
    v_lshlrev_b32 v232, 4, v1
    v_mov_b32 v233, v232
    s_cmp_lg_u32 s54, 0
    s_cselect_b32 s66, 25165824, 0
    s_lshl_b32 s30, s22, 5
    s_bfe_u32 s31, s24, 0x20001
    s_add_u32 s30, s30, s31
    s_lshl_b32 s31, s21, 4
    s_add_u32 s30, s30, s31
    s_lshl_b32 s30, s30, 16
    s_add_u32 s66, s66, s30
    s_mul_i32 s99, s29, 196608
    s_add_u32 s99, s99, 0
    s_add_u32 s99, s99, s67
    s_add_u32 m0, s69, 98304
    s_add_u32 s31, s99, 0
    buffer_load_dwordx4 v236, s[12:15], s31 offen offset:0  lds
    buffer_load_dwordx4 v237, s[12:15], s31 offen offset:1024  lds
    buffer_load_dwordx4 v238, s[12:15], s31 offen offset:2048  lds
    buffer_load_dwordx4 v239, s[12:15], s31 offen offset:3072  lds
    s_add_u32 m0, s69, 122880
    s_add_u32 s31, s99, 128
    buffer_load_dwordx4 v236, s[12:15], s31 offen offset:0  lds
    buffer_load_dwordx4 v237, s[12:15], s31 offen offset:1024  lds
    buffer_load_dwordx4 v238, s[12:15], s31 offen offset:2048  lds
    buffer_load_dwordx4 v239, s[12:15], s31 offen offset:3072  lds
    s_mul_i32 s99, s29, 196608
    s_add_u32 s99, s99, 65536
    s_add_u32 s99, s99, s67
    s_add_u32 m0, s69, 106496
    s_add_u32 s31, s99, 0
    buffer_load_dwordx4 v236, s[12:15], s31 offen offset:0  lds
    buffer_load_dwordx4 v237, s[12:15], s31 offen offset:1024  lds
    buffer_load_dwordx4 v238, s[12:15], s31 offen offset:2048  lds
    buffer_load_dwordx4 v239, s[12:15], s31 offen offset:3072  lds
    s_add_u32 m0, s69, 131072
    s_add_u32 s31, s99, 128
    buffer_load_dwordx4 v236, s[12:15], s31 offen offset:0  lds
    buffer_load_dwordx4 v237, s[12:15], s31 offen offset:1024  lds
    buffer_load_dwordx4 v238, s[12:15], s31 offen offset:2048  lds
    buffer_load_dwordx4 v239, s[12:15], s31 offen offset:3072  lds
    s_mul_i32 s99, s29, 196608
    s_add_u32 s99, s99, 524288
    s_add_u32 s99, s99, s67
    s_add_u32 m0, s69, 114688
    s_add_u32 s31, s99, 0
    buffer_load_dwordx4 v236, s[12:15], s31 offen offset:0  lds
    buffer_load_dwordx4 v237, s[12:15], s31 offen offset:1024  lds
    buffer_load_dwordx4 v238, s[12:15], s31 offen offset:2048  lds
    buffer_load_dwordx4 v239, s[12:15], s31 offen offset:3072  lds
    s_add_u32 m0, s69, 139264
    s_add_u32 s31, s99, 128
    buffer_load_dwordx4 v236, s[12:15], s31 offen offset:0  lds
    buffer_load_dwordx4 v237, s[12:15], s31 offen offset:1024  lds
    buffer_load_dwordx4 v238, s[12:15], s31 offen offset:2048  lds
    buffer_load_dwordx4 v239, s[12:15], s31 offen offset:3072  lds
    s_lshl_b32 s32, s24, 9
    s_lshl_b32 s30, s71, 7
    s_add_u32 s32, s32, s30
    s_add_u32 s32, s32, 44171264
    s_lshl_b32 s30, s21, 9
    s_add_u32 s32, s32, s30
    v_lshlrev_b32 v10, 2, v4
    v_and_b32 v11, 1, v3
    s_mov_b64 s[40:41], -1
    s_mov_b32 s72, 0
    s_and_b32 s30, s40, 0xf
    s_cbranch_scc0 nfx_236
nf_235:
    buffer_load_dword v8, v10, s[8:11], s32 offen sc1
    s_waitcnt vmcnt(0)
    v_lshrrev_b32 v8, v11, v8
    v_and_b32 v8, 1, v8
    v_cmp_ne_u32 s[40:41], 1, v8
    s_add_u32 s72, s72, 1
    s_cmp_gt_u32 s72, 524288
    s_cbranch_scc1 nfx_236
    s_and_b32 s30, s40, 0xf
    s_cbranch_scc1 nf_235
nfx_236:
    s_add_u32 m0, s68, 0
    s_add_u32 s31, s66, 0
    buffer_load_dwordx4 v232, s[8:11], s31 offen offset:0 sc1 lds
    buffer_load_dwordx4 v232, s[8:11], s31 offen offset:1024 sc1 lds
    buffer_load_dwordx4 v233, s[8:11], s31 offen offset:2048 sc1 lds
    buffer_load_dwordx4 v233, s[8:11], s31 offen offset:3072 sc1 lds
    s_add_u32 m0, s68, 4096
    s_add_u32 s31, s66, 4096
    buffer_load_dwordx4 v232, s[8:11], s31 offen offset:0 sc1 lds
    buffer_load_dwordx4 v232, s[8:11], s31 offen offset:1024 sc1 lds
    buffer_load_dwordx4 v233, s[8:11], s31 offen offset:2048 sc1 lds
    buffer_load_dwordx4 v233, s[8:11], s31 offen offset:3072 sc1 lds
    s_add_u32 m0, s68, 8192
    s_add_u32 s31, s66, 32768
    buffer_load_dwordx4 v232, s[8:11], s31 offen offset:0 sc1 lds
    buffer_load_dwordx4 v232, s[8:11], s31 offen offset:1024 sc1 lds
    buffer_load_dwordx4 v233, s[8:11], s31 offen offset:2048 sc1 lds
    buffer_load_dwordx4 v233, s[8:11], s31 offen offset:3072 sc1 lds
    s_add_u32 m0, s68, 12288
    s_add_u32 s31, s66, 36864
    buffer_load_dwordx4 v232, s[8:11], s31 offen offset:0 sc1 lds
    buffer_load_dwordx4 v232, s[8:11], s31 offen offset:1024 sc1 lds
    buffer_load_dwordx4 v233, s[8:11], s31 offen offset:2048 sc1 lds
    buffer_load_dwordx4 v233, s[8:11], s31 offen offset:3072 sc1 lds
    s_add_u32 m0, s68, 32768
    s_add_u32 s31, s66, 8192
    buffer_load_dwordx4 v232, s[8:11], s31 offen offset:0 sc1 lds
    buffer_load_dwordx4 v232, s[8:11], s31 offen offset:1024 sc1 lds
    buffer_load_dwordx4 v233, s[8:11], s31 offen offset:2048 sc1 lds
    buffer_load_dwordx4 v233, s[8:11], s31 offen offset:3072 sc1 lds
    s_add_u32 m0, s68, 36864
    s_add_u32 s31, s66, 12288
    buffer_load_dwordx4 v232, s[8:11], s31 offen offset:0 sc1 lds
    buffer_load_dwordx4 v232, s[8:11], s31 offen offset:1024 sc1 lds
    buffer_load_dwordx4 v233, s[8:11], s31 offen offset:2048 sc1 lds
    buffer_load_dwordx4 v233, s[8:11], s31 offen offset:3072 sc1 lds
    s_add_u32 m0, s68, 40960
    s_add_u32 s31, s66, 40960
    buffer_load_dwordx4 v232, s[8:11], s31 offen offset:0 sc1 lds
    buffer_load_dwordx4 v232, s[8:11], s31 offen offset:1024 sc1 lds
    buffer_load_dwordx4 v233, s[8:11], s31 offen offset:2048 sc1 lds
    buffer_load_dwordx4 v233, s[8:11], s31 offen offset:3072 sc1 lds
    s_add_u32 m0, s68, 45056
    s_add_u32 s31, s66, 45056
    buffer_load_dwordx4 v232, s[8:11], s31 offen offset:0 sc1 lds
    buffer_load_dwordx4 v232, s[8:11], s31 offen offset:1024 sc1 lds
    buffer_load_dwordx4 v233, s[8:11], s31 offen offset:2048 sc1 lds
    buffer_load_dwordx4 v233, s[8:11], s31 offen offset:3072 sc1 lds
    s_waitcnt vmcnt(16)
    s_barrier
    s_cmp_eq_u64 s[40:41], 0
    s_cselect_b32 s30, 268435456, s32
    buffer_load_dword v14, v10, s[8:11], s30 offen sc1
    s_and_b32 s30, s40, 0xf0
    s_cbranch_scc0 nfx_238
nf_237:
    buffer_load_dword v8, v10, s[8:11], s32 offen sc1
    s_waitcnt vmcnt(0)
    v_lshrrev_b32 v8, v11, v8
    v_and_b32 v8, 1, v8
    v_cmp_ne_u32 s[40:41], 1, v8
    s_add_u32 s72, s72, 1
    s_cmp_gt_u32 s72, 524288
    s_cbranch_scc1 nfx_238
    s_and_b32 s30, s40, 0xf0
    s_cbranch_scc1 nf_237
nfx_238:
    s_add_u32 m0, s68, 65536
    s_add_u32 s31, s66, 270336
    buffer_load_dwordx4 v232, s[8:11], s31 offen offset:0 sc1 lds
    buffer_load_dwordx4 v232, s[8:11], s31 offen offset:1024 sc1 lds
    buffer_load_dwordx4 v233, s[8:11], s31 offen offset:2048 sc1 lds
    buffer_load_dwordx4 v233, s[8:11], s31 offen offset:3072 sc1 lds
    s_add_u32 m0, s68, 69632
    s_add_u32 s31, s66, 274432
    buffer_load_dwordx4 v232, s[8:11], s31 offen offset:0 sc1 lds
    buffer_load_dwordx4 v232, s[8:11], s31 offen offset:1024 sc1 lds
    buffer_load_dwordx4 v233, s[8:11], s31 offen offset:2048 sc1 lds
    buffer_load_dwordx4 v233, s[8:11], s31 offen offset:3072 sc1 lds
    s_add_u32 m0, s68, 73728
    s_add_u32 s31, s66, 303104
    buffer_load_dwordx4 v232, s[8:11], s31 offen offset:0 sc1 lds
    buffer_load_dwordx4 v232, s[8:11], s31 offen offset:1024 sc1 lds
    buffer_load_dwordx4 v233, s[8:11], s31 offen offset:2048 sc1 lds
    buffer_load_dwordx4 v233, s[8:11], s31 offen offset:3072 sc1 lds
    s_add_u32 m0, s68, 77824
    s_add_u32 s31, s66, 307200
    buffer_load_dwordx4 v232, s[8:11], s31 offen offset:0 sc1 lds
    buffer_load_dwordx4 v232, s[8:11], s31 offen offset:1024 sc1 lds
    buffer_load_dwordx4 v233, s[8:11], s31 offen offset:2048 sc1 lds
    buffer_load_dwordx4 v233, s[8:11], s31 offen offset:3072 sc1 lds
    s_waitcnt vmcnt(17)
    s_barrier
    s_mul_i32 s99, s29, 196608
    s_add_u32 s99, s99, 589824
    s_add_u32 s99, s99, s67
    s_add_u32 m0, s69, 98304
    s_add_u32 s31, s99, 0
    buffer_load_dwordx4 v236, s[12:15], s31 offen offset:0  lds
    buffer_load_dwordx4 v237, s[12:15], s31 offen offset:1024  lds
    buffer_load_dwordx4 v238, s[12:15], s31 offen offset:2048  lds
    buffer_load_dwordx4 v239, s[12:15], s31 offen offset:3072  lds
    s_add_u32 m0, s69, 122880
    s_add_u32 s31, s99, 128
    buffer_load_dwordx4 v236, s[12:15], s31 offen offset:0  lds
    buffer_load_dwordx4 v237, s[12:15], s31 offen offset:1024  lds
    buffer_load_dwordx4 v238, s[12:15], s31 offen offset:2048  lds
    buffer_load_dwordx4 v239, s[12:15], s31 offen offset:3072  lds
    s_add_u32 m0, s68, 0
    s_add_u32 s31, s66, 278528
    buffer_load_dwordx4 v232, s[8:11], s31 offen offset:0 sc1 lds
    buffer_load_dwordx4 v232, s[8:11], s31 offen offset:1024 sc1 lds
    buffer_load_dwordx4 v233, s[8:11], s31 offen offset:2048 sc1 lds
    buffer_load_dwordx4 v233, s[8:11], s31 offen offset:3072 sc1 lds
    s_add_u32 m0, s68, 4096
    s_add_u32 s31, s66, 282624
    buffer_load_dwordx4 v232, s[8:11], s31 offen offset:0 sc1 lds
    buffer_load_dwordx4 v232, s[8:11], s31 offen offset:1024 sc1 lds
    buffer_load_dwordx4 v233, s[8:11], s31 offen offset:2048 sc1 lds
    buffer_load_dwordx4 v233, s[8:11], s31 offen offset:3072 sc1 lds
    s_add_u32 m0, s68, 8192
    s_add_u32 s31, s66, 311296
    buffer_load_dwordx4 v232, s[8:11], s31 offen offset:0 sc1 lds
    buffer_load_dwordx4 v232, s[8:11], s31 offen offset:1024 sc1 lds
    buffer_load_dwordx4 v233, s[8:11], s31 offen offset:2048 sc1 lds
    buffer_load_dwordx4 v233, s[8:11], s31 offen offset:3072 sc1 lds
    s_add_u32 m0, s68, 12288
    s_add_u32 s31, s66, 315392
    buffer_load_dwordx4 v232, s[8:11], s31 offen offset:0 sc1 lds
    buffer_load_dwordx4 v232, s[8:11], s31 offen offset:1024 sc1 lds
    buffer_load_dwordx4 v233, s[8:11], s31 offen offset:2048 sc1 lds
    buffer_load_dwordx4 v233, s[8:11], s31 offen offset:3072 sc1 lds
    s_waitcnt vmcnt(24)
    s_barrier
    v_lshrrev_b32 v14, v11, v14
    v_and_b32 v14, 1, v14
    v_cmp_ne_u32 vcc, 1, v14
    s_and_b64 s[40:41], s[40:41], vcc
    s_cmp_eq_u64 s[40:41], 0
    s_cselect_b32 s30, 268435456, s32
    buffer_load_dword v14, v10, s[8:11], s30 offen sc1
    s_mul_i32 s99, s29, 196608
    s_add_u32 s99, s99, 917504
    s_add_u32 s99, s99, s67
    s_add_u32 m0, s69, 106496
    s_add_u32 s31, s99, 0
    buffer_load_dwordx4 v236, s[12:15], s31 offen offset:0  lds
    buffer_load_dwordx4 v237, s[12:15], s31 offen offset:1024  lds
    buffer_load_dwordx4 v238, s[12:15], s31 offen offset:2048  lds
    buffer_load_dwordx4 v239, s[12:15], s31 offen offset:3072  lds
    s_add_u32 m0, s69, 131072
    s_add_u32 s31, s99, 128
    buffer_load_dwordx4 v236, s[12:15], s31 offen offset:0  lds
    buffer_load_dwordx4 v237, s[12:15], s31 offen offset:1024  lds
    buffer_load_dwordx4 v238, s[12:15], s31 offen offset:2048  lds
    buffer_load_dwordx4 v239, s[12:15], s31 offen offset:3072  lds
    s_and_b32 s30, s40, 0xf00
    s_cbranch_scc0 nfx_240
nf_239:
    buffer_load_dword v8, v10, s[8:11], s32 offen sc1
    s_waitcnt vmcnt(0)
    v_lshrrev_b32 v8, v11, v8
    v_and_b32 v8, 1, v8
    v_cmp_ne_u32 s[40:41], 1, v8
    s_add_u32 s72, s72, 1
    s_cmp_gt_u32 s72, 524288
    s_cbranch_scc1 nfx_240
    s_and_b32 s30, s40, 0xf00
    s_cbranch_scc1 nf_239
nfx_240:
    s_add_u32 m0, s68, 32768
    s_add_u32 s31, s66, 524288
    buffer_load_dwordx4 v232, s[8:11], s31 offen offset:0 sc1 lds
    buffer_load_dwordx4 v232, s[8:11], s31 offen offset:1024 sc1 lds
    buffer_load_dwordx4 v233, s[8:11], s31 offen offset:2048 sc1 lds
    buffer_load_dwordx4 v233, s[8:11], s31 offen offset:3072 sc1 lds
    s_add_u32 m0, s68, 36864
    s_add_u32 s31, s66, 528384
    buffer_load_dwordx4 v232, s[8:11], s31 offen offset:0 sc1 lds
    buffer_load_dwordx4 v232, s[8:11], s31 offen offset:1024 sc1 lds
    buffer_load_dwordx4 v233, s[8:11], s31 offen offset:2048 sc1 lds
    buffer_load_dwordx4 v233, s[8:11], s31 offen offset:3072 sc1 lds
    s_add_u32 m0, s68, 40960
    s_add_u32 s31, s66, 557056
    buffer_load_dwordx4 v232, s[8:11], s31 offen offset:0 sc1 lds
    buffer_load_dwordx4 v232, s[8:11], s31 offen offset:1024 sc1 lds
    buffer_load_dwordx4 v233, s[8:11], s31 offen offset:2048 sc1 lds
    buffer_load_dwordx4 v233, s[8:11], s31 offen offset:3072 sc1 lds
    s_add_u32 m0, s68, 45056
    s_add_u32 s31, s66, 561152
    buffer_load_dwordx4 v232, s[8:11], s31 offen offset:0 sc1 lds
    buffer_load_dwordx4 v232, s[8:11], s31 offen offset:1024 sc1 lds
    buffer_load_dwordx4 v233, s[8:11], s31 offen offset:2048 sc1 lds
    buffer_load_dwordx4 v233, s[8:11], s31 offen offset:3072 sc1 lds
    s_waitcnt vmcnt(25)
    s_barrier
    s_mul_i32 s99, s29, 196608
    s_add_u32 s99, s99, 983040
    s_add_u32 s99, s99, s67
    s_add_u32 m0, s69, 114688
    s_add_u32 s31, s99, 0
    buffer_load_dwordx4 v236, s[12:15], s31 offen offset:0  lds
    buffer_load_dwordx4 v237, s[12:15], s31 offen offset:1024  lds
    buffer_load_dwordx4 v238, s[12:15], s31 offen offset:2048  lds
    buffer_load_dwordx4 v239, s[12:15], s31 offen offset:3072  lds
    s_add_u32 m0, s69, 139264
    s_add_u32 s31, s99, 128
    buffer_load_dwordx4 v236, s[12:15], s31 offen offset:0  lds
    buffer_load_dwordx4 v237, s[12:15], s31 offen offset:1024  lds
    buffer_load_dwordx4 v238, s[12:15], s31 offen offset:2048  lds
    buffer_load_dwordx4 v239, s[12:15], s31 offen offset:3072  lds
    s_add_u32 m0, s68, 65536
    s_add_u32 s31, s66, 532480
    buffer_load_dwordx4 v232, s[8:11], s31 offen offset:0 sc1 lds
    buffer_load_dwordx4 v232, s[8:11], s31 offen offset:1024 sc1 lds
    buffer_load_dwordx4 v233, s[8:11], s31 offen offset:2048 sc1 lds
    buffer_load_dwordx4 v233, s[8:11], s31 offen offset:3072 sc1 lds
    s_add_u32 m0, s68, 69632
    s_add_u32 s31, s66, 536576
    buffer_load_dwordx4 v232, s[8:11], s31 offen offset:0 sc1 lds
    buffer_load_dwordx4 v232, s[8:11], s31 offen offset:1024 sc1 lds
    buffer_load_dwordx4 v233, s[8:11], s31 offen offset:2048 sc1 lds
    buffer_load_dwordx4 v233, s[8:11], s31 offen offset:3072 sc1 lds
    s_add_u32 m0, s68, 73728
    s_add_u32 s31, s66, 565248
    buffer_load_dwordx4 v232, s[8:11], s31 offen offset:0 sc1 lds
    buffer_load_dwordx4 v232, s[8:11], s31 offen offset:1024 sc1 lds
    buffer_load_dwordx4 v233, s[8:11], s31 offen offset:2048 sc1 lds
    buffer_load_dwordx4 v233, s[8:11], s31 offen offset:3072 sc1 lds
    s_add_u32 m0, s68, 77824
    s_add_u32 s31, s66, 569344
    buffer_load_dwordx4 v232, s[8:11], s31 offen offset:0 sc1 lds
    buffer_load_dwordx4 v232, s[8:11], s31 offen offset:1024 sc1 lds
    buffer_load_dwordx4 v233, s[8:11], s31 offen offset:2048 sc1 lds
    buffer_load_dwordx4 v233, s[8:11], s31 offen offset:3072 sc1 lds
    s_waitcnt vmcnt(24)
    s_barrier
    v_lshrrev_b32 v14, v11, v14
    v_and_b32 v14, 1, v14
    v_cmp_ne_u32 vcc, 1, v14
    s_and_b64 s[40:41], s[40:41], vcc
    s_cmp_eq_u64 s[40:41], 0
    s_cselect_b32 s30, 268435456, s32
    buffer_load_dword v14, v10, s[8:11], s30 offen sc1
    s_mul_i32 s99, s29, 196608
    s_add_u32 s99, s99, 1441792
    s_add_u32 s99, s99, s67
    s_add_u32 m0, s69, 98304
    s_add_u32 s31, s99, 0
    buffer_load_dwordx4 v236, s[12:15], s31 offen offset:0  lds
    buffer_load_dwordx4 v237, s[12:15], s31 offen offset:1024  lds
    buffer_load_dwordx4 v238, s[12:15], s31 offen offset:2048  lds
    buffer_load_dwordx4 v239, s[12:15], s31 offen offset:3072  lds
    s_add_u32 m0, s69, 122880
    s_add_u32 s31, s99, 128
    buffer_load_dwordx4 v236, s[12:15], s31 offen offset:0  lds
    buffer_load_dwordx4 v237, s[12:15], s31 offen offset:1024  lds
    buffer_load_dwordx4 v238, s[12:15], s31 offen offset:2048  lds
    buffer_load_dwordx4 v239, s[12:15], s31 offen offset:3072  lds
    s_and_b32 s30, s40, 0xf000
    s_cbranch_scc0 nfx_242
nf_241:
    buffer_load_dword v8, v10, s[8:11], s32 offen sc1
    s_waitcnt vmcnt(0)
    v_lshrrev_b32 v8, v11, v8
    v_and_b32 v8, 1, v8
    v_cmp_ne_u32 s[40:41], 1, v8
    s_add_u32 s72, s72, 1
    s_cmp_gt_u32 s72, 524288
    s_cbranch_scc1 nfx_242
    s_and_b32 s30, s40, 0xf000
    s_cbranch_scc1 nf_241
nfx_242:
    s_add_u32 m0, s68, 0
    s_add_u32 s31, s66, 794624
    buffer_load_dwordx4 v232, s[8:11], s31 offen offset:0 sc1 lds
    buffer_load_dwordx4 v232, s[8:11], s31 offen offset:1024 sc1 lds
    buffer_load_dwordx4 v233, s[8:11], s31 offen offset:2048 sc1 lds
    buffer_load_dwordx4 v233, s[8:11], s31 offen offset:3072 sc1 lds
    s_add_u32 m0, s68, 4096
    s_add_u32 s31, s66, 798720
    buffer_load_dwordx4 v232, s[8:11], s31 offen offset:0 sc1 lds
    buffer_load_dwordx4 v232, s[8:11], s31 offen offset:1024 sc1 lds
    buffer_load_dwordx4 v233, s[8:11], s31 offen offset:2048 sc1 lds
    buffer_load_dwordx4 v233, s[8:11], s31 offen offset:3072 sc1 lds
    s_add_u32 m0, s68, 8192
    s_add_u32 s31, s66, 827392
    buffer_load_dwordx4 v232, s[8:11], s31 offen offset:0 sc1 lds
    buffer_load_dwordx4 v232, s[8:11], s31 offen offset:1024 sc1 lds
    buffer_load_dwordx4 v233, s[8:11], s31 offen offset:2048 sc1 lds
    buffer_load_dwordx4 v233, s[8:11], s31 offen offset:3072 sc1 lds
    s_add_u32 m0, s68, 12288
    s_add_u32 s31, s66, 831488
    buffer_load_dwordx4 v232, s[8:11], s31 offen offset:0 sc1 lds
    buffer_load_dwordx4 v232, s[8:11], s31 offen offset:1024 sc1 lds
    buffer_load_dwordx4 v233, s[8:11], s31 offen offset:2048 sc1 lds
    buffer_load_dwordx4 v233, s[8:11], s31 offen offset:3072 sc1 lds
    s_waitcnt vmcnt(25)
    s_barrier
    s_mul_i32 s99, s29, 196608
    s_add_u32 s99, s99, 1507328
    s_add_u32 s99, s99, s67
    s_add_u32 m0, s69, 106496
    s_add_u32 s31, s99, 0
    buffer_load_dwordx4 v236, s[12:15], s31 offen offset:0  lds
    buffer_load_dwordx4 v237, s[12:15], s31 offen offset:1024  lds
    buffer_load_dwordx4 v238, s[12:15], s31 offen offset:2048  lds
    buffer_load_dwordx4 v239, s[12:15], s31 offen offset:3072  lds
    s_add_u32 m0, s69, 131072
    s_add_u32 s31, s99, 128
    buffer_load_dwordx4 v236, s[12:15], s31 offen offset:0  lds
    buffer_load_dwordx4 v237, s[12:15], s31 offen offset:1024  lds
    buffer_load_dwordx4 v238, s[12:15], s31 offen offset:2048  lds
    buffer_load_dwordx4 v239, s[12:15], s31 offen offset:3072  lds
    s_add_u32 m0, s68, 32768
    s_add_u32 s31, s66, 802816
    buffer_load_dwordx4 v232, s[8:11], s31 offen offset:0 sc1 lds
    buffer_load_dwordx4 v232, s[8:11], s31 offen offset:1024 sc1 lds
    buffer_load_dwordx4 v233, s[8:11], s31 offen offset:2048 sc1 lds
    buffer_load_dwordx4 v233, s[8:11], s31 offen offset:3072 sc1 lds
    s_add_u32 m0, s68, 36864
    s_add_u32 s31, s66, 806912
    buffer_load_dwordx4 v232, s[8:11], s31 offen offset:0 sc1 lds
    buffer_load_dwordx4 v232, s[8:11], s31 offen offset:1024 sc1 lds
    buffer_load_dwordx4 v233, s[8:11], s31 offen offset:2048 sc1 lds
    buffer_load_dwordx4 v233, s[8:11], s31 offen offset:3072 sc1 lds
    s_add_u32 m0, s68, 40960
    s_add_u32 s31, s66, 835584
    buffer_load_dwordx4 v232, s[8:11], s31 offen offset:0 sc1 lds
    buffer_load_dwordx4 v232, s[8:11], s31 offen offset:1024 sc1 lds
    buffer_load_dwordx4 v233, s[8:11], s31 offen offset:2048 sc1 lds
    buffer_load_dwordx4 v233, s[8:11], s31 offen offset:3072 sc1 lds
    s_add_u32 m0, s68, 45056
    s_add_u32 s31, s66, 839680
    buffer_load_dwordx4 v232, s[8:11], s31 offen offset:0 sc1 lds
    buffer_load_dwordx4 v232, s[8:11], s31 offen offset:1024 sc1 lds
    buffer_load_dwordx4 v233, s[8:11], s31 offen offset:2048 sc1 lds
    buffer_load_dwordx4 v233, s[8:11], s31 offen offset:3072 sc1 lds
    s_waitcnt vmcnt(24)
    s_barrier
    v_lshrrev_b32 v14, v11, v14
    v_and_b32 v14, 1, v14
    v_cmp_ne_u32 vcc, 1, v14
    s_and_b64 s[40:41], s[40:41], vcc
    s_cmp_eq_u64 s[40:41], 0
    s_cselect_b32 s30, 268435456, s32
    buffer_load_dword v14, v10, s[8:11], s30 offen sc1
    s_mul_i32 s99, s29, 0
    s_add_u32 s99, s99, 131072
    s_add_u32 s99, s99, s67
    s_add_u32 m0, s69, 114688
    s_add_u32 s31, s99, 0
    buffer_load_dwordx4 v236, s[12:15], s31 offen offset:0  lds
    buffer_load_dwordx4 v237, s[12:15], s31 offen offset:1024  lds
    buffer_load_dwordx4 v238, s[12:15], s31 offen offset:2048  lds
    buffer_load_dwordx4 v239, s[12:15], s31 offen offset:3072  lds
    s_add_u32 m0, s69, 139264
    s_add_u32 s31, s99, 128
    buffer_load_dwordx4 v236, s[12:15], s31 offen offset:0  lds
    buffer_load_dwordx4 v237, s[12:15], s31 offen offset:1024  lds
    buffer_load_dwordx4 v238, s[12:15], s31 offen offset:2048  lds
    buffer_load_dwordx4 v239, s[12:15], s31 offen offset:3072  lds
    s_and_b32 s30, s40, 0xf0000
    s_cbranch_scc0 nfx_244
nf_243:
    buffer_load_dword v8, v10, s[8:11], s32 offen sc1
    s_waitcnt vmcnt(0)
    v_lshrrev_b32 v8, v11, v8
    v_and_b32 v8, 1, v8
    v_cmp_ne_u32 s[40:41], 1, v8
    s_add_u32 s72, s72, 1
    s_cmp_gt_u32 s72, 524288
    s_cbranch_scc1 nfx_244
    s_and_b32 s30, s40, 0xf0000
    s_cbranch_scc1 nf_243
nfx_244:
    s_add_u32 m0, s68, 65536
    s_add_u32 s31, s66, 16384
    buffer_load_dwordx4 v232, s[8:11], s31 offen offset:0 sc1 lds
    buffer_load_dwordx4 v232, s[8:11], s31 offen offset:1024 sc1 lds
    buffer_load_dwordx4 v233, s[8:11], s31 offen offset:2048 sc1 lds
    buffer_load_dwordx4 v233, s[8:11], s31 offen offset:3072 sc1 lds
    s_add_u32 m0, s68, 69632
    s_add_u32 s31, s66, 20480
    buffer_load_dwordx4 v232, s[8:11], s31 offen offset:0 sc1 lds
    buffer_load_dwordx4 v232, s[8:11], s31 offen offset:1024 sc1 lds
    buffer_load_dwordx4 v233, s[8:11], s31 offen offset:2048 sc1 lds
    buffer_load_dwordx4 v233, s[8:11], s31 offen offset:3072 sc1 lds
    s_add_u32 m0, s68, 73728
    s_add_u32 s31, s66, 24576
    buffer_load_dwordx4 v232, s[8:11], s31 offen offset:0 sc1 lds
    buffer_load_dwordx4 v232, s[8:11], s31 offen offset:1024 sc1 lds
    buffer_load_dwordx4 v233, s[8:11], s31 offen offset:2048 sc1 lds
    buffer_load_dwordx4 v233, s[8:11], s31 offen offset:3072 sc1 lds
    s_add_u32 m0, s68, 77824
    s_add_u32 s31, s66, 28672
    buffer_load_dwordx4 v232, s[8:11], s31 offen offset:0 sc1 lds
    buffer_load_dwordx4 v232, s[8:11], s31 offen offset:1024 sc1 lds
    buffer_load_dwordx4 v233, s[8:11], s31 offen offset:2048 sc1 lds
    buffer_load_dwordx4 v233, s[8:11], s31 offen offset:3072 sc1 lds
    s_waitcnt vmcnt(25)
    s_barrier
    s_mul_i32 s99, s29, 0
    s_add_u32 s99, s99, 393216
    s_add_u32 s99, s99, s67
    s_add_u32 m0, s69, 98304
    s_add_u32 s31, s99, 0
    buffer_load_dwordx4 v236, s[12:15], s31 offen offset:0  lds
    buffer_load_dwordx4 v237, s[12:15], s31 offen offset:1024  lds
    buffer_load_dwordx4 v238, s[12:15], s31 offen offset:2048  lds
    buffer_load_dwordx4 v239, s[12:15], s31 offen offset:3072  lds
    s_add_u32 m0, s69, 122880
    s_add_u32 s31, s99, 128
    buffer_load_dwordx4 v236, s[12:15], s31 offen offset:0  lds
    buffer_load_dwordx4 v237, s[12:15], s31 offen offset:1024  lds
    buffer_load_dwordx4 v238, s[12:15], s31 offen offset:2048  lds
    buffer_load_dwordx4 v239, s[12:15], s31 offen offset:3072  lds
    s_and_b32 s30, s40, 0xf00000
    s_cbranch_scc0 nfx_246
nf_245:
    buffer_load_dword v8, v10, s[8:11], s32 offen sc1
    s_waitcnt vmcnt(0)
    v_lshrrev_b32 v8, v11, v8
    v_and_b32 v8, 1, v8
    v_cmp_ne_u32 s[40:41], 1, v8
    s_add_u32 s72, s72, 1
    s_cmp_gt_u32 s72, 524288
    s_cbranch_scc1 nfx_246
    s_and_b32 s30, s40, 0xf00000
    s_cbranch_scc1 nf_245
nfx_246:
    s_add_u32 m0, s68, 0
    s_add_u32 s31, s66, 49152
    buffer_load_dwordx4 v232, s[8:11], s31 offen offset:0 sc1 lds
    buffer_load_dwordx4 v232, s[8:11], s31 offen offset:1024 sc1 lds
    buffer_load_dwordx4 v233, s[8:11], s31 offen offset:2048 sc1 lds
    buffer_load_dwordx4 v233, s[8:11], s31 offen offset:3072 sc1 lds
    s_add_u32 m0, s68, 4096
    s_add_u32 s31, s66, 53248
    buffer_load_dwordx4 v232, s[8:11], s31 offen offset:0 sc1 lds
    buffer_load_dwordx4 v232, s[8:11], s31 offen offset:1024 sc1 lds
    buffer_load_dwordx4 v233, s[8:11], s31 offen offset:2048 sc1 lds
    buffer_load_dwordx4 v233, s[8:11], s31 offen offset:3072 sc1 lds
    s_add_u32 m0, s68, 8192
    s_add_u32 s31, s66, 262144
    buffer_load_dwordx4 v232, s[8:11], s31 offen offset:0 sc1 lds
    buffer_load_dwordx4 v232, s[8:11], s31 offen offset:1024 sc1 lds
    buffer_load_dwordx4 v233, s[8:11], s31 offen offset:2048 sc1 lds
    buffer_load_dwordx4 v233, s[8:11], s31 offen offset:3072 sc1 lds
    s_add_u32 m0, s68, 12288
    s_add_u32 s31, s66, 266240
    buffer_load_dwordx4 v232, s[8:11], s31 offen offset:0 sc1 lds
    buffer_load_dwordx4 v232, s[8:11], s31 offen offset:1024 sc1 lds
    buffer_load_dwordx4 v233, s[8:11], s31 offen offset:2048 sc1 lds
    buffer_load_dwordx4 v233, s[8:11], s31 offen offset:3072 sc1 lds
    s_waitcnt vmcnt(24)
    s_barrier
    v_lshrrev_b32 v14, v11, v14
    v_and_b32 v14, 1, v14
    v_cmp_ne_u32 vcc, 1, v14
    s_and_b64 s[40:41], s[40:41], vcc
    s_cmp_eq_u64 s[40:41], 0
    s_cselect_b32 s30, 268435456, s32
    buffer_load_dword v14, v10, s[8:11], s30 offen sc1
    s_mul_i32 s99, s29, 0
    s_add_u32 s99, s99, 655360
    s_add_u32 s99, s99, s67
    s_add_u32 m0, s69, 106496
    s_add_u32 s31, s99, 0
    buffer_load_dwordx4 v236, s[12:15], s31 offen offset:0  lds
    buffer_load_dwordx4 v237, s[12:15], s31 offen offset:1024  lds
    buffer_load_dwordx4 v238, s[12:15], s31 offen offset:2048  lds
    buffer_load_dwordx4 v239, s[12:15], s31 offen offset:3072  lds
    s_add_u32 m0, s69, 131072
    s_add_u32 s31, s99, 128
    buffer_load_dwordx4 v236, s[12:15], s31 offen offset:0  lds
    buffer_load_dwordx4 v237, s[12:15], s31 offen offset:1024  lds
    buffer_load_dwordx4 v238, s[12:15], s31 offen offset:2048  lds
    buffer_load_dwordx4 v239, s[12:15], s31 offen offset:3072  lds
    s_add_u32 m0, s68, 32768
    s_add_u32 s31, s66, 286720
    buffer_load_dwordx4 v232, s[8:11], s31 offen offset:0 sc1 lds
    buffer_load_dwordx4 v232, s[8:11], s31 offen offset:1024 sc1 lds
    buffer_load_dwordx4 v233, s[8:11], s31 offen offset:2048 sc1 lds
    buffer_load_dwordx4 v233, s[8:11], s31 offen offset:3072 sc1 lds
    s_add_u32 m0, s68, 36864
    s_add_u32 s31, s66, 290816
    buffer_load_dwordx4 v232, s[8:11], s31 offen offset:0 sc1 lds
    buffer_load_dwordx4 v232, s[8:11], s31 offen offset:1024 sc1 lds
    buffer_load_dwordx4 v233, s[8:11], s31 offen offset:2048 sc1 lds
    buffer_load_dwordx4 v233, s[8:11], s31 offen offset:3072 sc1 lds
    s_add_u32 m0, s68, 40960
    s_add_u32 s31, s66, 294912
    buffer_load_dwordx4 v232, s[8:11], s31 offen offset:0 sc1 lds
    buffer_load_dwordx4 v232, s[8:11], s31 offen offset:1024 sc1 lds
    buffer_load_dwordx4 v233, s[8:11], s31 offen offset:2048 sc1 lds
    buffer_load_dwordx4 v233, s[8:11], s31 offen offset:3072 sc1 lds
    s_add_u32 m0, s68, 45056
    s_add_u32 s31, s66, 299008
    buffer_load_dwordx4 v232, s[8:11], s31 offen offset:0 sc1 lds
    buffer_load_dwordx4 v232, s[8:11], s31 offen offset:1024 sc1 lds
    buffer_load_dwordx4 v233, s[8:11], s31 offen offset:2048 sc1 lds
    buffer_load_dwordx4 v233, s[8:11], s31 offen offset:3072 sc1 lds
    s_waitcnt vmcnt(25)
    s_barrier
    s_mul_i32 s99, s29, 0
    s_add_u32 s99, s99, 1048576
    s_add_u32 s99, s99, s67
    s_add_u32 m0, s69, 114688
    s_add_u32 s31, s99, 0
    buffer_load_dwordx4 v236, s[12:15], s31 offen offset:0  lds
    buffer_load_dwordx4 v237, s[12:15], s31 offen offset:1024  lds
    buffer_load_dwordx4 v238, s[12:15], s31 offen offset:2048  lds
    buffer_load_dwordx4 v239, s[12:15], s31 offen offset:3072  lds
    s_add_u32 m0, s69, 139264
    s_add_u32 s31, s99, 128
    buffer_load_dwordx4 v236, s[12:15], s31 offen offset:0  lds
    buffer_load_dwordx4 v237, s[12:15], s31 offen offset:1024  lds
    buffer_load_dwordx4 v238, s[12:15], s31 offen offset:2048  lds
    buffer_load_dwordx4 v239, s[12:15], s31 offen offset:3072  lds
    s_and_b32 s30, s40, 0xf000000
    s_cbranch_scc0 nfx_248
nf_247:
    buffer_load_dword v8, v10, s[8:11], s32 offen sc1
    s_waitcnt vmcnt(0)
    v_lshrrev_b32 v8, v11, v8
    v_and_b32 v8, 1, v8
    v_cmp_ne_u32 s[40:41], 1, v8
    s_add_u32 s72, s72, 1
    s_cmp_gt_u32 s72, 524288
    s_cbranch_scc1 nfx_248
    s_and_b32 s30, s40, 0xf000000
    s_cbranch_scc1 nf_247
nfx_248:
    s_add_u32 m0, s68, 65536
    s_add_u32 s31, s66, 540672
    buffer_load_dwordx4 v232, s[8:11], s31 offen offset:0 sc1 lds
    buffer_load_dwordx4 v232, s[8:11], s31 offen offset:1024 sc1 lds
    buffer_load_dwordx4 v233, s[8:11], s31 offen offset:2048 sc1 lds
    buffer_load_dwordx4 v233, s[8:11], s31 offen offset:3072 sc1 lds
    s_add_u32 m0, s68, 69632
    s_add_u32 s31, s66, 544768
    buffer_load_dwordx4 v232, s[8:11], s31 offen offset:0 sc1 lds
    buffer_load_dwordx4 v232, s[8:11], s31 offen offset:1024 sc1 lds
    buffer_load_dwordx4 v233, s[8:11], s31 offen offset:2048 sc1 lds
    buffer_load_dwordx4 v233, s[8:11], s31 offen offset:3072 sc1 lds
    s_add_u32 m0, s68, 73728
    s_add_u32 s31, s66, 548864
    buffer_load_dwordx4 v232, s[8:11], s31 offen offset:0 sc1 lds
    buffer_load_dwordx4 v232, s[8:11], s31 offen offset:1024 sc1 lds
    buffer_load_dwordx4 v233, s[8:11], s31 offen offset:2048 sc1 lds
    buffer_load_dwordx4 v233, s[8:11], s31 offen offset:3072 sc1 lds
    s_add_u32 m0, s68, 77824
    s_add_u32 s31, s66, 552960
    buffer_load_dwordx4 v232, s[8:11], s31 offen offset:0 sc1 lds
    buffer_load_dwordx4 v232, s[8:11], s31 offen offset:1024 sc1 lds
    buffer_load_dwordx4 v233, s[8:11], s31 offen offset:2048 sc1 lds
    buffer_load_dwordx4 v233, s[8:11], s31 offen offset:3072 sc1 lds
    s_waitcnt vmcnt(24)
    s_barrier
    s_mul_i32 s99, s29, 0
    s_add_u32 s99, s99, 1310720
    s_add_u32 s99, s99, s67
    s_add_u32 m0, s69, 98304
    s_add_u32 s31, s99, 0
    buffer_load_dwordx4 v236, s[12:15], s31 offen offset:0  lds
    buffer_load_dwordx4 v237, s[12:15], s31 offen offset:1024  lds
    buffer_load_dwordx4 v238, s[12:15], s31 offen offset:2048  lds
    buffer_load_dwordx4 v239, s[12:15], s31 offen offset:3072  lds
    s_add_u32 m0, s69, 122880
    s_add_u32 s31, s99, 128
    buffer_load_dwordx4 v236, s[12:15], s31 offen offset:0  lds
    buffer_load_dwordx4 v237, s[12:15], s31 offen offset:1024  lds
    buffer_load_dwordx4 v238, s[12:15], s31 offen offset:2048  lds
    buffer_load_dwordx4 v239, s[12:15], s31 offen offset:3072  lds
    s_and_b32 s30, s40, 0xf0000000
    s_cbranch_scc0 nfx_250
nf_249:
    buffer_load_dword v8, v10, s[8:11], s32 offen sc1
    s_waitcnt vmcnt(0)
    v_lshrrev_b32 v8, v11, v8
    v_and_b32 v8, 1, v8
    v_cmp_ne_u32 s[40:41], 1, v8
    s_add_u32 s72, s72, 1
    s_cmp_gt_u32 s72, 524288
    s_cbranch_scc1 nfx_250
    s_and_b32 s30, s40, 0xf0000000
    s_cbranch_scc1 nf_249
nfx_250:
    s_add_u32 m0, s68, 0
    s_add_u32 s31, s66, 573440
    buffer_load_dwordx4 v232, s[8:11], s31 offen offset:0 sc1 lds
    buffer_load_dwordx4 v232, s[8:11], s31 offen offset:1024 sc1 lds
    buffer_load_dwordx4 v233, s[8:11], s31 offen offset:2048 sc1 lds
    buffer_load_dwordx4 v233, s[8:11], s31 offen offset:3072 sc1 lds
    s_add_u32 m0, s68, 4096
    s_add_u32 s31, s66, 577536
    buffer_load_dwordx4 v232, s[8:11], s31 offen offset:0 sc1 lds
    buffer_load_dwordx4 v232, s[8:11], s31 offen offset:1024 sc1 lds
    buffer_load_dwordx4 v233, s[8:11], s31 offen offset:2048 sc1 lds
    buffer_load_dwordx4 v233, s[8:11], s31 offen offset:3072 sc1 lds
    s_add_u32 m0, s68, 8192
    s_add_u32 s31, s66, 786432
    buffer_load_dwordx4 v232, s[8:11], s31 offen offset:0 sc1 lds
    buffer_load_dwordx4 v232, s[8:11], s31 offen offset:1024 sc1 lds
    buffer_load_dwordx4 v233, s[8:11], s31 offen offset:2048 sc1 lds
    buffer_load_dwordx4 v233, s[8:11], s31 offen offset:3072 sc1 lds
    s_add_u32 m0, s68, 12288
    s_add_u32 s31, s66, 790528
    buffer_load_dwordx4 v232, s[8:11], s31 offen offset:0 sc1 lds
    buffer_load_dwordx4 v232, s[8:11], s31 offen offset:1024 sc1 lds
    buffer_load_dwordx4 v233, s[8:11], s31 offen offset:2048 sc1 lds
    buffer_load_dwordx4 v233, s[8:11], s31 offen offset:3072 sc1 lds
    s_waitcnt vmcnt(24)
    s_barrier
    s_mul_i32 s99, s29, 0
    s_add_u32 s99, s99, 1572864
    s_add_u32 s99, s99, s67
    s_add_u32 m0, s69, 106496
    s_add_u32 s31, s99, 0
    buffer_load_dwordx4 v236, s[12:15], s31 offen offset:0  lds
    buffer_load_dwordx4 v237, s[12:15], s31 offen offset:1024  lds
    buffer_load_dwordx4 v238, s[12:15], s31 offen offset:2048  lds
    buffer_load_dwordx4 v239, s[12:15], s31 offen offset:3072  lds
    s_add_u32 m0, s69, 131072
    s_add_u32 s31, s99, 128
    buffer_load_dwordx4 v236, s[12:15], s31 offen offset:0  lds
    buffer_load_dwordx4 v237, s[12:15], s31 offen offset:1024  lds
    buffer_load_dwordx4 v238, s[12:15], s31 offen offset:2048  lds
    buffer_load_dwordx4 v239, s[12:15], s31 offen offset:3072  lds
    s_add_u32 m0, s68, 32768
    s_add_u32 s31, s66, 811008
    buffer_load_dwordx4 v232, s[8:11], s31 offen offset:0 sc1 lds
    buffer_load_dwordx4 v232, s[8:11], s31 offen offset:1024 sc1 lds
    buffer_load_dwordx4 v233, s[8:11], s31 offen offset:2048 sc1 lds
    buffer_load_dwordx4 v233, s[8:11], s31 offen offset:3072 sc1 lds
    s_add_u32 m0, s68, 36864
    s_add_u32 s31, s66, 815104
    buffer_load_dwordx4 v232, s[8:11], s31 offen offset:0 sc1 lds
    buffer_load_dwordx4 v232, s[8:11], s31 offen offset:1024 sc1 lds
    buffer_load_dwordx4 v233, s[8:11], s31 offen offset:2048 sc1 lds
    buffer_load_dwordx4 v233, s[8:11], s31 offen offset:3072 sc1 lds
    s_add_u32 m0, s68, 40960
    s_add_u32 s31, s66, 819200
    buffer_load_dwordx4 v232, s[8:11], s31 offen offset:0 sc1 lds
    buffer_load_dwordx4 v232, s[8:11], s31 offen offset:1024 sc1 lds
    buffer_load_dwordx4 v233, s[8:11], s31 offen offset:2048 sc1 lds
    buffer_load_dwordx4 v233, s[8:11], s31 offen offset:3072 sc1 lds
    s_add_u32 m0, s68, 45056
    s_add_u32 s31, s66, 823296
    buffer_load_dwordx4 v232, s[8:11], s31 offen offset:0 sc1 lds
    buffer_load_dwordx4 v232, s[8:11], s31 offen offset:1024 sc1 lds
    buffer_load_dwordx4 v233, s[8:11], s31 offen offset:2048 sc1 lds
    buffer_load_dwordx4 v233, s[8:11], s31 offen offset:3072 sc1 lds
    s_waitcnt vmcnt(0)
    s_barrier
    s_endpgm
L_hrest:
    s_setprio 0
    s_add_u32 s99, s67, 917504
    s_add_u32 m0, s69, 65536
    s_add_u32 s31, s99, 0
    buffer_load_dwordx4 v236, s[12:15], s31 offen offset:0  lds
    buffer_load_dwordx4 v237, s[12:15], s31 offen offset:1024  lds
    buffer_load_dwordx4 v238, s[12:15], s31 offen offset:2048  lds
    buffer_load_dwordx4 v239, s[12:15], s31 offen offset:3072  lds
    s_add_u32 s99, s67, 1048576
    s_add_u32 m0, s69, 73728
    s_add_u32 s31, s99, 0
    buffer_load_dwordx4 v236, s[12:15], s31 offen offset:0  lds
    buffer_load_dwordx4 v237, s[12:15], s31 offen offset:1024  lds
    buffer_load_dwordx4 v238, s[12:15], s31 offen offset:2048  lds
    buffer_load_dwordx4 v239, s[12:15], s31 offen offset:3072  lds
    s_add_u32 s99, s67, 1179648
    s_add_u32 m0, s69, 81920
    s_add_u32 s31, s99, 0
    buffer_load_dwordx4 v236, s[12:15], s31 offen offset:0  lds
    buffer_load_dwordx4 v237, s[12:15], s31 offen offset:1024  lds
    buffer_load_dwordx4 v238, s[12:15], s31 offen offset:2048  lds
    buffer_load_dwordx4 v239, s[12:15], s31 offen offset:3072  lds
    s_add_u32 s99, s67, 1310720
    s_add_u32 m0, s69, 90112
    s_add_u32 s31, s99, 0
    buffer_load_dwordx4 v236, s[12:15], s31 offen offset:0  lds
    buffer_load_dwordx4 v237, s[12:15], s31 offen offset:1024  lds
    buffer_load_dwordx4 v238, s[12:15], s31 offen offset:2048  lds
    buffer_load_dwordx4 v239, s[12:15], s31 offen offset:3072  lds
    s_add_u32 s99, s67, 1572864
    s_add_u32 m0, s69, 98304
    s_add_u32 s31, s99, 0
    buffer_load_dwordx4 v236, s[12:15], s31 offen offset:0  lds
    buffer_load_dwordx4 v237, s[12:15], s31 offen offset:1024  lds
    buffer_load_dwordx4 v238, s[12:15], s31 offen offset:2048  lds
    buffer_load_dwordx4 v239, s[12:15], s31 offen offset:3072  lds
    s_barrier
    s_barrier
    s_barrier
    s_cmp_lt_u32 s73, s60
    s_cbranch_scc1 pfg_251
    s_cmp_ge_u32 s55, 2
    s_cbranch_scc1 pfx_252
    s_mov_b32 s73, s61
    s_mov_b32 s60, 7340032
    s_add_u32 s55, s55, 1
    s_cmp_eq_u32 s55, 2
    s_cbranch_scc1 pfw2_253
    s_mov_b32 s44, s56
    s_and_b32 s45, s57, 0xffff
    s_mov_b32 s46, 7340032
    s_mov_b32 s47, 0x20000
    s_branch pfg_251
pfw2_253:
    s_mov_b32 s44, s58
    s_and_b32 s45, s59, 0xffff
    s_mov_b32 s46, 7340032
    s_mov_b32 s47, 0x20000
pfg_251:
    s_buffer_load_dword s74, s[44:47], s73 offset:0
    s_buffer_load_dword s74, s[44:47], s73 offset:64
    s_buffer_load_dword s74, s[44:47], s73 offset:128
    s_buffer_load_dword s74, s[44:47], s73 offset:192
    s_add_u32 s73, s73, 262144
pfx_252:
    s_barrier
    s_barrier
    s_barrier
    s_cmp_lt_u32 s73, s60
    s_cbranch_scc1 pfg_254
    s_cmp_ge_u32 s55, 2
    s_cbranch_scc1 pfx_255
    s_mov_b32 s73, s61
    s_mov_b32 s60, 7340032
    s_add_u32 s55, s55, 1
    s_cmp_eq_u32 s55, 2
    s_cbranch_scc1 pfw2_256
    s_mov_b32 s44, s56
    s_and_b32 s45, s57, 0xffff
    s_mov_b32 s46, 7340032
    s_mov_b32 s47, 0x20000
    s_branch pfg_254
pfw2_256:
    s_mov_b32 s44, s58
    s_and_b32 s45, s59, 0xffff
    s_mov_b32 s46, 7340032
    s_mov_b32 s47, 0x20000
pfg_254:
    s_buffer_load_dword s74, s[44:47], s73 offset:0
    s_buffer_load_dword s74, s[44:47], s73 offset:64
    s_buffer_load_dword s74, s[44:47], s73 offset:128
    s_buffer_load_dword s74, s[44:47], s73 offset:192
    s_add_u32 s73, s73, 262144
pfx_255:
    s_waitcnt vmcnt(0)
    s_and_b32 s24, s22, 1
    s_lshl_b32 s24, s24, 3
    s_and_b32 s30, s23, 7
    s_add_u32 s24, s24, s30
    s_lshr_b32 s25, s22, 1
    s_lshl_b32 s25, s25, 2
    s_lshr_b32 s30, s23, 3
    s_add_u32 s25, s25, s30
    s_mov_b32 s12, s56
    s_and_b32 s13, s57, 0xffff
    s_mov_b32 s14, 7340032
    s_mov_b32 s15, 0x20000
    s_mul_i32 s27, s25, 448
    s_and_b32 s30, s25, 1
    s_lshl_b32 s26, s30, 6
    s_add_u32 s26, s26, s27
    s_xor_b32 s30, s30, 1
    s_mul_i32 s30, s30, 384
    s_add_u32 s27, s27, s30
    s_mov_b32 s67, 0
    s_and_b32 s101, s25, 12
    s_lshl_b32 s69, s29, 12
    s_lshl_b32 s70, s29, 11
    v_lshrrev_b32 v246, 3, v1
    s_lshl_b32 s30, s29, 5
    v_add_u32 v246, s30, v246
    v_mul_u32_u24 v246, 7168, v246
    v_and_b32 v247, 1, v1
    v_lshl_add_u32 v246, v247, 4, v246
    v_add_u32 v246, s26, v246
    v_bfe_u32 v247, v1, 1, 2
    v_xor_b32 v245, v247, v3
    v_lshl_add_u32 v236, v245, 5, v246
    v_add_u32 v237, 56320, v236
    v_add_u32 v238, 112640, v236
    v_add_u32 v239, 112640, v237
    v_lshrrev_b32 v246, 2, v1
    v_add_u32 v246, s30, v246
    v_mul_u32_u24 v246, 7168, v246
    v_and_b32 v247, 1, v1
    v_lshl_add_u32 v246, v247, 4, v246
    v_add_u32 v246, s27, v246
    v_bfe_u32 v247, v1, 1, 1
    v_and_b32 v245, 1, v3
    v_xor_b32 v245, v247, v245
    v_lshl_add_u32 v240, v245, 5, v246
    v_add_u32 v241, 113664, v240
    v_lshrrev_b32 v6, 3, v1
    v_mul_u32_u24 v6, 7168, v6
    v_and_b32 v7, 7, v1
    v_lshl_add_u32 v6, v7, 4, v6
    s_barrier
    v_lshrrev_b32 v5, 2, v1
    v_mul_u32_u24 v5, 7168, v5
    v_and_b32 v7, 3, v1
    v_lshl_add_u32 v5, v7, 4, v5
    s_lshl_b32 s35, s24, 1
    s_add_u32 s35, s35, s29
    s_mul_i32 s32, s35, 229376
    s_mul_i32 s33, s25, 448
    s_add_u32 s32, s32, s33
    s_mul_i32 s33, s35, 14336
    s_mul_i32 s34, s25, 896
    s_add_u32 s33, s33, s34
    s_add_u32 s33, s33, 43253760
    s_barrier
    s_barrier
    s_cmp_lt_u32 s73, s60
    s_cbranch_scc1 pfg_257
    s_cmp_ge_u32 s55, 2
    s_cbranch_scc1 pfx_258
    s_mov_b32 s73, s61
    s_mov_b32 s60, 7340032
    s_add_u32 s55, s55, 1
    s_cmp_eq_u32 s55, 2
    s_cbranch_scc1 pfw2_259
    s_mov_b32 s44, s56
    s_and_b32 s45, s57, 0xffff
    s_mov_b32 s46, 7340032
    s_mov_b32 s47, 0x20000
    s_branch pfg_257
pfw2_259:
    s_mov_b32 s44, s58
    s_and_b32 s45, s59, 0xffff
    s_mov_b32 s46, 7340032
    s_mov_b32 s47, 0x20000
pfg_257:
    s_buffer_load_dword s74, s[44:47], s73 offset:0
    s_buffer_load_dword s74, s[44:47], s73 offset:64
    s_buffer_load_dword s74, s[44:47], s73 offset:128
    s_buffer_load_dword s74, s[44:47], s73 offset:192
    s_add_u32 s73, s73, 262144
pfx_258:
    s_barrier
    s_barrier
    s_barrier
    s_add_u32 s31, s32, 0
    buffer_load_dwordx4 v[16:19], v6, s[12:15], s31 offen offset:0
    s_add_u32 s31, s32, 57344
    buffer_load_dwordx4 v[20:23], v6, s[12:15], s31 offen offset:0
    s_add_u32 s31, s32, 114688
    buffer_load_dwordx4 v[24:27], v6, s[12:15], s31 offen offset:0
    s_add_u32 s31, s32, 172032
    buffer_load_dwordx4 v[28:31], v6, s[12:15], s31 offen offset:0
    s_add_u32 s31, s32, 0
    buffer_load_dwordx4 v[32:35], v6, s[12:15], s31 offen offset:128
    s_add_u32 s31, s32, 57344
    buffer_load_dwordx4 v[36:39], v6, s[12:15], s31 offen offset:128
    s_add_u32 s31, s32, 114688
    buffer_load_dwordx4 v[40:43], v6, s[12:15], s31 offen offset:128
    s_add_u32 s31, s32, 172032
    s_barrier
    buffer_load_dwordx4 v[44:47], v6, s[12:15], s31 offen offset:128
    s_add_u32 s31, s32, 0
    buffer_load_dwordx4 v[48:51], v6, s[12:15], s31 offen offset:256
    s_add_u32 s31, s32, 57344
    buffer_load_dwordx4 v[52:55], v6, s[12:15], s31 offen offset:256
    s_add_u32 s31, s32, 114688
    buffer_load_dwordx4 v[56:59], v6, s[12:15], s31 offen offset:256
    s_add_u32 s31, s32, 172032
    buffer_load_dwordx4 v[60:63], v6, s[12:15], s31 offen offset:256
    s_add_u32 s31, s32, 0
    buffer_load_dwordx4 v[64:67], v5, s[12:15], s31 offen offset:384
    s_add_u32 s31, s32, 114688
    buffer_load_dwordx4 v[68:71], v5, s[12:15], s31 offen offset:384
    s_barrier
    s_barrier
    s_barrier
    s_barrier
    s_waitcnt vmcnt(10)
    v_mov_b32 v10, 0x00003f80
    v_mov_b32 v11, 0x3f800000
    v_lshlrev_b32 v200, 16, v16
    v_and_b32 v201, 0xffff0000, v16
    v_lshlrev_b32 v202, 16, v17
    v_and_b32 v203, 0xffff0000, v17
    v_lshlrev_b32 v204, 16, v18
    v_and_b32 v205, 0xffff0000, v18
    v_lshlrev_b32 v206, 16, v19
    v_and_b32 v207, 0xffff0000, v19
    v_dot2_f32_bf16 v200, v20, v10, v200
    v_dot2_f32_bf16 v201, v20, v11, v201
    v_dot2_f32_bf16 v202, v21, v10, v202
    v_dot2_f32_bf16 v203, v21, v11, v203
    v_dot2_f32_bf16 v204, v22, v10, v204
    v_dot2_f32_bf16 v205, v22, v11, v205
    v_dot2_f32_bf16 v206, v23, v10, v206
    v_dot2_f32_bf16 v207, v23, v11, v207
    v_dot2_f32_bf16 v200, v24, v10, v200
    v_dot2_f32_bf16 v201, v24, v11, v201
    v_dot2_f32_bf16 v202, v25, v10, v202
    v_dot2_f32_bf16 v203, v25, v11, v203
    v_dot2_f32_bf16 v204, v26, v10, v204
    v_dot2_f32_bf16 v205, v26, v11, v205
    v_dot2_f32_bf16 v206, v27, v10, v206
    v_dot2_f32_bf16 v207, v27, v11, v207
    v_dot2_f32_bf16 v200, v28, v10, v200
    v_dot2_f32_bf16 v201, v28, v11, v201
    v_dot2_f32_bf16 v202, v29, v10, v202
    v_dot2_f32_bf16 v203, v29, v11, v203
    v_dot2_f32_bf16 v204, v30, v10, v204
    v_dot2_f32_bf16 v205, v30, v11, v205
    v_dot2_f32_bf16 v206, v31, v10, v206
    v_dot2_f32_bf16 v207, v31, v11, v207
    v_permlane32_swap_b32 v200, v204
    v_permlane32_swap_b32 v201, v205
    v_permlane32_swap_b32 v202, v206
    v_permlane32_swap_b32 v203, v207
    v_pk_add_f32 v[200:201], v[200:201], v[204:205]
    v_pk_add_f32 v[202:203], v[202:203], v[206:207]
    s_nop 1
    v_permlane16_swap_b32 v200, v202
    v_permlane16_swap_b32 v201, v203
    v_pk_add_f32 v[200:201], v[200:201], v[202:203]
    s_nop 1
    v_add_f32_dpp v200, v200, v200 row_ror:8 row_mask:0xf bank_mask:0xf
    v_add_f32_dpp v201, v201, v201 row_ror:8 row_mask:0xf bank_mask:0xf
    s_waitcnt vmcnt(6)
    v_mov_b32 v10, 0x00003f80
    v_mov_b32 v11, 0x3f800000
    v_lshlrev_b32 v208, 16, v32
    v_and_b32 v209, 0xffff0000, v32
    v_lshlrev_b32 v210, 16, v33
    v_and_b32 v211, 0xffff0000, v33
    v_lshlrev_b32 v212, 16, v34
    v_and_b32 v213, 0xffff0000, v34
    v_lshlrev_b32 v214, 16, v35
    v_and_b32 v215, 0xffff0000, v35
    v_dot2_f32_bf16 v208, v36, v10, v208
    v_dot2_f32_bf16 v209, v36, v11, v209
    v_dot2_f32_bf16 v210, v37, v10, v210
    v_dot2_f32_bf16 v211, v37, v11, v211
    v_dot2_f32_bf16 v212, v38, v10, v212
    v_dot2_f32_bf16 v213, v38, v11, v213
    v_dot2_f32_bf16 v214, v39, v10, v214
    v_dot2_f32_bf16 v215, v39, v11, v215
    v_dot2_f32_bf16 v208, v40, v10, v208
    v_dot2_f32_bf16 v209, v40, v11, v209
    v_dot2_f32_bf16 v210, v41, v10, v210
    v_dot2_f32_bf16 v211, v41, v11, v211
    v_dot2_f32_bf16 v212, v42, v10, v212
    v_dot2_f32_bf16 v213, v42, v11, v213
    v_dot2_f32_bf16 v214, v43, v10, v214
    v_dot2_f32_bf16 v215, v43, v11, v215
    v_dot2_f32_bf16 v208, v44, v10, v208
    v_dot2_f32_bf16 v209, v44, v11, v209
    v_dot2_f32_bf16 v210, v45, v10, v210
    v_dot2_f32_bf16 v211, v45, v11, v211
    v_dot2_f32_bf16 v212, v46, v10, v212
    v_dot2_f32_bf16 v213, v46, v11, v213
    v_dot2_f32_bf16 v214, v47, v10, v214
    v_dot2_f32_bf16 v215, v47, v11, v215
    v_permlane32_swap_b32 v208, v212
    v_permlane32_swap_b32 v209, v213
    v_permlane32_swap_b32 v210, v214
    v_permlane32_swap_b32 v211, v215
    v_pk_add_f32 v[208:209], v[208:209], v[212:213]
    v_pk_add_f32 v[210:211], v[210:211], v[214:215]
    s_nop 1
    v_permlane16_swap_b32 v208, v210
    v_permlane16_swap_b32 v209, v211
    v_pk_add_f32 v[208:209], v[208:209], v[210:211]
    s_nop 1
    v_add_f32_dpp v208, v208, v208 row_ror:8 row_mask:0xf bank_mask:0xf
    v_add_f32_dpp v209, v209, v209 row_ror:8 row_mask:0xf bank_mask:0xf
    s_waitcnt vmcnt(2)
    v_mov_b32 v10, 0x00003f80
    v_mov_b32 v11, 0x3f800000
    v_lshlrev_b32 v216, 16, v48
    v_and_b32 v217, 0xffff0000, v48
    v_lshlrev_b32 v218, 16, v49
    v_and_b32 v219, 0xffff0000, v49
    v_lshlrev_b32 v220, 16, v50
    v_and_b32 v221, 0xffff0000, v50
    v_lshlrev_b32 v222, 16, v51
    v_and_b32 v223, 0xffff0000, v51
    v_dot2_f32_bf16 v216, v52, v10, v216
    v_dot2_f32_bf16 v217, v52, v11, v217
    v_dot2_f32_bf16 v218, v53, v10, v218
    v_dot2_f32_bf16 v219, v53, v11, v219
    v_dot2_f32_bf16 v220, v54, v10, v220
    v_dot2_f32_bf16 v221, v54, v11, v221
    v_dot2_f32_bf16 v222, v55, v10, v222
    v_dot2_f32_bf16 v223, v55, v11, v223
    v_dot2_f32_bf16 v216, v56, v10, v216
    v_dot2_f32_bf16 v217, v56, v11, v217
    v_dot2_f32_bf16 v218, v57, v10, v218
    v_dot2_f32_bf16 v219, v57, v11, v219
    v_dot2_f32_bf16 v220, v58, v10, v220
    v_dot2_f32_bf16 v221, v58, v11, v221
    v_dot2_f32_bf16 v222, v59, v10, v222
    v_dot2_f32_bf16 v223, v59, v11, v223
    v_dot2_f32_bf16 v216, v60, v10, v216
    v_dot2_f32_bf16 v217, v60, v11, v217
    v_dot2_f32_bf16 v218, v61, v10, v218
    v_dot2_f32_bf16 v219, v61, v11, v219
    v_dot2_f32_bf16 v220, v62, v10, v220
    v_dot2_f32_bf16 v221, v62, v11, v221
    v_dot2_f32_bf16 v222, v63, v10, v222
    v_dot2_f32_bf16 v223, v63, v11, v223
    v_permlane32_swap_b32 v216, v220
    v_permlane32_swap_b32 v217, v221
    v_permlane32_swap_b32 v218, v222
    v_permlane32_swap_b32 v219, v223
    v_pk_add_f32 v[216:217], v[216:217], v[220:221]
    v_pk_add_f32 v[218:219], v[218:219], v[222:223]
    s_nop 1
    v_permlane16_swap_b32 v216, v218
    v_permlane16_swap_b32 v217, v219
    v_pk_add_f32 v[216:217], v[216:217], v[218:219]
    s_nop 1
    v_add_f32_dpp v216, v216, v216 row_ror:8 row_mask:0xf bank_mask:0xf
    v_add_f32_dpp v217, v217, v217 row_ror:8 row_mask:0xf bank_mask:0xf
    s_waitcnt vmcnt(0)
    v_mov_b32 v10, 0x00003f80
    v_mov_b32 v11, 0x3f800000
    v_lshlrev_b32 v224, 16, v64
    v_and_b32 v225, 0xffff0000, v64
    v_lshlrev_b32 v226, 16, v65
    v_and_b32 v227, 0xffff0000, v65
    v_lshlrev_b32 v228, 16, v66
    v_and_b32 v229, 0xffff0000, v66
    v_lshlrev_b32 v230, 16, v67
    v_and_b32 v231, 0xffff0000, v67
    v_dot2_f32_bf16 v224, v68, v10, v224
    v_dot2_f32_bf16 v225, v68, v11, v225
    v_dot2_f32_bf16 v226, v69, v10, v226
    v_dot2_f32_bf16 v227, v69, v11, v227
    v_dot2_f32_bf16 v228, v70, v10, v228
    v_dot2_f32_bf16 v229, v70, v11, v229
    v_dot2_f32_bf16 v230, v71, v10, v230
    v_dot2_f32_bf16 v231, v71, v11, v231
    v_permlane32_swap_b32 v224, v228
    v_permlane32_swap_b32 v225, v229
    v_permlane32_swap_b32 v226, v230
    v_permlane32_swap_b32 v227, v231
    v_pk_add_f32 v[224:225], v[224:225], v[228:229]
    v_pk_add_f32 v[226:227], v[226:227], v[230:231]
    s_nop 1
    v_permlane16_swap_b32 v224, v226
    v_permlane16_swap_b32 v225, v227
    v_pk_add_f32 v[224:225], v[224:225], v[226:227]
    s_nop 1
    v_add_f32_dpp v224, v224, v224 row_ror:4 row_mask:0xf bank_mask:0xf
    v_add_f32_dpp v225, v225, v225 row_ror:4 row_mask:0xf bank_mask:0xf
    s_nop 0
    v_add_f32_dpp v224, v224, v224 row_ror:8 row_mask:0xf bank_mask:0xf
    v_add_f32_dpp v225, v225, v225 row_ror:8 row_mask:0xf bank_mask:0xf
pu_260:
    ds_read_b32 v255, v253 offset:3072
    s_waitcnt lgkmcnt(0)
    v_cmp_gt_u32 vcc, 2, v255
    s_cbranch_vccz pux_261
    s_sleep 1
    s_add_u32 s3, s3, 1
    s_cmp_lt_u32 s3, 4194304
    s_cbranch_scc1 pu_260
pux_261:
    s_add_u32 s99, s67, 917504
    s_add_u32 m0, s69, 57344
    s_add_u32 s31, s99, 0
    buffer_load_dwordx4 v236, s[12:15], s31 offen offset:0  lds
    buffer_load_dwordx4 v237, s[12:15], s31 offen offset:1024  lds
    buffer_load_dwordx4 v238, s[12:15], s31 offen offset:2048  lds
    buffer_load_dwordx4 v239, s[12:15], s31 offen offset:3072  lds
    s_add_u32 m0, s69, 81920
    s_add_u32 s31, s99, 128
    buffer_load_dwordx4 v236, s[12:15], s31 offen offset:0  lds
    buffer_load_dwordx4 v237, s[12:15], s31 offen offset:1024  lds
    buffer_load_dwordx4 v238, s[12:15], s31 offen offset:2048  lds
    buffer_load_dwordx4 v239, s[12:15], s31 offen offset:3072  lds
    s_add_u32 m0, s69, 106496
    s_add_u32 s31, s99, 256
    buffer_load_dwordx4 v236, s[12:15], s31 offen offset:0  lds
    buffer_load_dwordx4 v237, s[12:15], s31 offen offset:1024  lds
    buffer_load_dwordx4 v238, s[12:15], s31 offen offset:2048  lds
    buffer_load_dwordx4 v239, s[12:15], s31 offen offset:3072  lds
    s_add_u32 m0, s70, 126976
    s_add_u32 s31, s99, 0
    buffer_load_dwordx4 v240, s[12:15], s31 offen offset:0  lds
    buffer_load_dwordx4 v241, s[12:15], s31 offen offset:1024  lds
    s_add_u32 s99, s67, 1835008
    s_add_u32 m0, s69, 65536
    s_add_u32 s31, s99, 0
    buffer_load_dwordx4 v236, s[12:15], s31 offen offset:0  lds
    buffer_load_dwordx4 v237, s[12:15], s31 offen offset:1024  lds
    buffer_load_dwordx4 v238, s[12:15], s31 offen offset:2048  lds
    buffer_load_dwordx4 v239, s[12:15], s31 offen offset:3072  lds
    s_add_u32 m0, s69, 90112
    s_add_u32 s31, s99, 128
    buffer_load_dwordx4 v236, s[12:15], s31 offen offset:0  lds
    buffer_load_dwordx4 v237, s[12:15], s31 offen offset:1024  lds
    buffer_load_dwordx4 v238, s[12:15], s31 offen offset:2048  lds
    buffer_load_dwordx4 v239, s[12:15], s31 offen offset:3072  lds
    s_add_u32 m0, s69, 114688
    s_add_u32 s31, s99, 256
    buffer_load_dwordx4 v236, s[12:15], s31 offen offset:0  lds
    buffer_load_dwordx4 v237, s[12:15], s31 offen offset:1024  lds
    buffer_load_dwordx4 v238, s[12:15], s31 offen offset:2048  lds
    buffer_load_dwordx4 v239, s[12:15], s31 offen offset:3072  lds
    s_add_u32 m0, s70, 131072
    s_add_u32 s31, s99, 0
    buffer_load_dwordx4 v240, s[12:15], s31 offen offset:0  lds
    buffer_load_dwordx4 v241, s[12:15], s31 offen offset:1024  lds
    v_lshlrev_b32 v6, 5, v4
    v_lshl_add_u32 v6, v3, 3, v6
    s_mov_b32 exec_lo, 0xff00ff
    s_mov_b32 exec_hi, 0xff00ff
    buffer_store_dwordx2 v[200:201], v6, s[8:11], s33 offen offset:0 sc1
    s_mov_b64 exec, -1
    v_lshlrev_b32 v6, 5, v4
    v_lshl_add_u32 v6, v3, 3, v6
    s_mov_b32 exec_lo, 0xff00ff
    s_mov_b32 exec_hi, 0xff00ff
    buffer_store_dwordx2 v[208:209], v6, s[8:11], s33 offen offset:256 sc1
    s_mov_b64 exec, -1
    v_lshlrev_b32 v6, 5, v4
    v_lshl_add_u32 v6, v3, 3, v6
    s_mov_b32 exec_lo, 0xff00ff
    s_mov_b32 exec_hi, 0xff00ff
    buffer_store_dwordx2 v[216:217], v6, s[8:11], s33 offen offset:512 sc1
    s_mov_b64 exec, -1
    v_lshlrev_b32 v6, 5, v4
    v_lshl_add_u32 v6, v3, 3, v6
    s_mov_b32 exec_lo, 0xf000f
    s_mov_b32 exec_hi, 0xf000f
    buffer_store_dwordx2 v[224:225], v6, s[8:11], s33 offen offset:768 sc1
    s_mov_b64 exec, -1
    s_cmp_lg_u32 s29, 0
    s_cbranch_scc1 L_h4b
    s_lshl_b32 s36, s24, 11
    s_add_u32 s36, s36, 44335104
    s_lshr_b32 s37, s23, 1
    s_min_u32 s37, s37, 13
    s_lshl_b32 s37, s37, 11
    s_add_u32 s37, s37, 44335104
    s_barrier
    s_cmp_lt_u32 s73, s60
    s_cbranch_scc1 pfg_274
    s_cmp_ge_u32 s55, 2
    s_cbranch_scc1 pfx_275
    s_mov_b32 s73, s61
    s_mov_b32 s60, 7340032
    s_add_u32 s55, s55, 1
    s_cmp_eq_u32 s55, 2
    s_cbranch_scc1 pfw2_276
    s_mov_b32 s44, s56
    s_and_b32 s45, s57, 0xffff
    s_mov_b32 s46, 7340032
    s_mov_b32 s47, 0x20000
    s_branch pfg_274
pfw2_276:
    s_mov_b32 s44, s58
    s_and_b32 s45, s59, 0xffff
    s_mov_b32 s46, 7340032
    s_mov_b32 s47, 0x20000
pfg_274:
    s_buffer_load_dword s74, s[44:47], s73 offset:0
    s_buffer_load_dword s74, s[44:47], s73 offset:64
    s_buffer_load_dword s74, s[44:47], s73 offset:128
    s_buffer_load_dword s74, s[44:47], s73 offset:192
    s_add_u32 s73, s73, 262144
    s_buffer_load_dword s74, s[44:47], s73 offset:0
    s_buffer_load_dword s74, s[44:47], s73 offset:64
    s_buffer_load_dword s74, s[44:47], s73 offset:128
    s_buffer_load_dword s74, s[44:47], s73 offset:192
    s_add_u32 s73, s73, 262144
pfx_275:
    s_waitcnt vmcnt(4)
    v_lshrrev_b32 v240, 2, v1
    v_lshlrev_b32 v240, 7, v240
    v_and_b32 v241, 3, v1
    v_lshl_add_u32 v240, v241, 2, v240
    v_min_u32 v241, 47, v1
    v_lshlrev_b32 v241, 7, v241
    s_lshl_b32 s34, s24, 1
    s_lshr_b32 s30, s25, 3
    s_add_u32 s34, s34, s30
    s_lshl_b32 s34, s34, 14
    s_and_b32 s30, s25, 7
    s_lshl_b32 s30, s30, 6
    s_add_u32 s34, s34, s30
    s_add_u32 s34, s34, 41943040
    s_add_u32 s35, s34, 8192
    v_lshrrev_b32 v11, 2, v1
    v_lshlrev_b32 v11, 9, v11
    v_and_b32 v12, 3, v1
    v_lshlrev_b32 v12, 4, v12
    v_add_u32 v11, v11, v12
    s_barrier
    s_cmp_lt_u32 s73, s60
    s_cbranch_scc1 pfg_277
    s_cmp_ge_u32 s55, 2
    s_cbranch_scc1 pfx_278
    s_mov_b32 s73, s61
    s_mov_b32 s60, 7340032
    s_add_u32 s55, s55, 1
    s_cmp_eq_u32 s55, 2
    s_cbranch_scc1 pfw2_279
    s_mov_b32 s44, s56
    s_and_b32 s45, s57, 0xffff
    s_mov_b32 s46, 7340032
    s_mov_b32 s47, 0x20000
    s_branch pfg_277
pfw2_279:
    s_mov_b32 s44, s58
    s_and_b32 s45, s59, 0xffff
    s_mov_b32 s46, 7340032
    s_mov_b32 s47, 0x20000
pfg_277:
    s_buffer_load_dword s74, s[44:47], s73 offset:0
    s_buffer_load_dword s74, s[44:47], s73 offset:64
    s_buffer_load_dword s74, s[44:47], s73 offset:128
    s_buffer_load_dword s74, s[44:47], s73 offset:192
    s_add_u32 s73, s73, 262144
pfx_278:
    s_barrier
    s_cmp_lt_u32 s73, s60
    s_cbranch_scc1 pfg_280
    s_cmp_ge_u32 s55, 2
    s_cbranch_scc1 pfx_281
    s_mov_b32 s73, s61
    s_mov_b32 s60, 7340032
    s_add_u32 s55, s55, 1
    s_cmp_eq_u32 s55, 2
    s_cbranch_scc1 pfw2_282
    s_mov_b32 s44, s56
    s_and_b32 s45, s57, 0xffff
    s_mov_b32 s46, 7340032
    s_mov_b32 s47, 0x20000
    s_branch pfg_280
pfw2_282:
    s_mov_b32 s44, s58
    s_and_b32 s45, s59, 0xffff
    s_mov_b32 s46, 7340032
    s_mov_b32 s47, 0x20000
pfg_280:
    s_buffer_load_dword s74, s[44:47], s73 offset:0
    s_buffer_load_dword s74, s[44:47], s73 offset:64
    s_buffer_load_dword s74, s[44:47], s73 offset:128
    s_buffer_load_dword s74, s[44:47], s73 offset:192
    s_add_u32 s73, s73, 262144
    s_buffer_load_dword s74, s[44:47], s73 offset:0
    s_buffer_load_dword s74, s[44:47], s73 offset:64
    s_buffer_load_dword s74, s[44:47], s73 offset:128
    s_buffer_load_dword s74, s[44:47], s73 offset:192
    s_add_u32 s73, s73, 262144
pfx_281:
    s_barrier
    s_cmp_lt_u32 s73, s60
    s_cbranch_scc1 pfg_283
    s_cmp_ge_u32 s55, 2
    s_cbranch_scc1 pfx_284
    s_mov_b32 s73, s61
    s_mov_b32 s60, 7340032
    s_add_u32 s55, s55, 1
    s_cmp_eq_u32 s55, 2
    s_cbranch_scc1 pfw2_285
    s_mov_b32 s44, s56
    s_and_b32 s45, s57, 0xffff
    s_mov_b32 s46, 7340032
    s_mov_b32 s47, 0x20000
    s_branch pfg_283
pfw2_285:
    s_mov_b32 s44, s58
    s_and_b32 s45, s59, 0xffff
    s_mov_b32 s46, 7340032
    s_mov_b32 s47, 0x20000
pfg_283:
    s_buffer_load_dword s74, s[44:47], s73 offset:0
    s_buffer_load_dword s74, s[44:47], s73 offset:64
    s_buffer_load_dword s74, s[44:47], s73 offset:128
    s_buffer_load_dword s74, s[44:47], s73 offset:192
    s_add_u32 s73, s73, 262144
    s_buffer_load_dword s74, s[44:47], s73 offset:0
    s_buffer_load_dword s74, s[44:47], s73 offset:64
    s_buffer_load_dword s74, s[44:47], s73 offset:128
    s_buffer_load_dword s74, s[44:47], s73 offset:192
    s_add_u32 s73, s73, 262144
pfx_284:
    buffer_load_dword v232, v240, s[8:11], s36 offen sc1
    s_barrier
    s_cmp_lt_u32 s73, s60
    s_cbranch_scc1 pfg_286
    s_cmp_ge_u32 s55, 2
    s_cbranch_scc1 pfx_287
    s_mov_b32 s73, s61
    s_mov_b32 s60, 7340032
    s_add_u32 s55, s55, 1
    s_cmp_eq_u32 s55, 2
    s_cbranch_scc1 pfw2_288
    s_mov_b32 s44, s56
    s_and_b32 s45, s57, 0xffff
    s_mov_b32 s46, 7340032
    s_mov_b32 s47, 0x20000
    s_branch pfg_286
pfw2_288:
    s_mov_b32 s44, s58
    s_and_b32 s45, s59, 0xffff
    s_mov_b32 s46, 7340032
    s_mov_b32 s47, 0x20000
pfg_286:
    s_buffer_load_dword s74, s[44:47], s73 offset:0
    s_buffer_load_dword s74, s[44:47], s73 offset:64
    s_buffer_load_dword s74, s[44:47], s73 offset:128
    s_buffer_load_dword s74, s[44:47], s73 offset:192
    s_add_u32 s73, s73, 262144
pfx_287:
    s_barrier
    s_cmp_lt_u32 s73, s60
    s_cbranch_scc1 pfg_289
    s_cmp_ge_u32 s55, 2
    s_cbranch_scc1 pfx_290
    s_mov_b32 s73, s61
    s_mov_b32 s60, 7340032
    s_add_u32 s55, s55, 1
    s_cmp_eq_u32 s55, 2
    s_cbranch_scc1 pfw2_291
    s_mov_b32 s44, s56
    s_and_b32 s45, s57, 0xffff
    s_mov_b32 s46, 7340032
    s_mov_b32 s47, 0x20000
    s_branch pfg_289
pfw2_291:
    s_mov_b32 s44, s58
    s_and_b32 s45, s59, 0xffff
    s_mov_b32 s46, 7340032
    s_mov_b32 s47, 0x20000
pfg_289:
    s_buffer_load_dword s74, s[44:47], s73 offset:0
    s_buffer_load_dword s74, s[44:47], s73 offset:64
    s_buffer_load_dword s74, s[44:47], s73 offset:128
    s_buffer_load_dword s74, s[44:47], s73 offset:192
    s_add_u32 s73, s73, 262144
    s_buffer_load_dword s74, s[44:47], s73 offset:0
    s_buffer_load_dword s74, s[44:47], s73 offset:64
    s_buffer_load_dword s74, s[44:47], s73 offset:128
    s_buffer_load_dword s74, s[44:47], s73 offset:192
    s_add_u32 s73, s73, 262144
pfx_290:
    s_waitcnt vmcnt(0)
    v_and_b32 v232, 2, v232
    v_cmp_ne_u32 vcc, 2, v232
    s_cbranch_vccz ckx_262
    s_mov_b32 s72, 0
poll_263:
    buffer_load_dword v8, v240, s[8:11], s36 offen sc1
    s_add_u32 s72, s72, 1
    s_cmp_gt_u32 s72, 524288
    s_waitcnt vmcnt(0)
    s_cbranch_scc1 pollx_264
    v_and_b32 v8, 2, v8
    v_cmp_ne_u32 vcc, 2, v8
    s_cbranch_vccz pollx_264
    s_sleep 8
    s_branch poll_263
pollx_264:
    s_mov_b64 exec, -1
ckx_262:
    buffer_load_dwordx4 v[16:19], v11, s[8:11], s34 offen sc1
    buffer_load_dwordx4 v[20:23], v11, s[8:11], s35 offen sc1
    buffer_load_dwordx4 v[234:237], v241, s[8:11], s37 offen sc1
    s_barrier
    s_cmp_lt_u32 s73, s60
    s_cbranch_scc1 pfg_292
    s_cmp_ge_u32 s55, 2
    s_cbranch_scc1 pfx_293
    s_mov_b32 s73, s61
    s_mov_b32 s60, 7340032
    s_add_u32 s55, s55, 1
    s_cmp_eq_u32 s55, 2
    s_cbranch_scc1 pfw2_294
    s_mov_b32 s44, s56
    s_and_b32 s45, s57, 0xffff
    s_mov_b32 s46, 7340032
    s_mov_b32 s47, 0x20000
    s_branch pfg_292
pfw2_294:
    s_mov_b32 s44, s58
    s_and_b32 s45, s59, 0xffff
    s_mov_b32 s46, 7340032
    s_mov_b32 s47, 0x20000
pfg_292:
    s_buffer_load_dword s74, s[44:47], s73 offset:0
    s_buffer_load_dword s74, s[44:47], s73 offset:64
    s_buffer_load_dword s74, s[44:47], s73 offset:128
    s_buffer_load_dword s74, s[44:47], s73 offset:192
    s_add_u32 s73, s73, 262144
    s_buffer_load_dword s74, s[44:47], s73 offset:0
    s_buffer_load_dword s74, s[44:47], s73 offset:64
    s_buffer_load_dword s74, s[44:47], s73 offset:128
    s_buffer_load_dword s74, s[44:47], s73 offset:192
    s_add_u32 s73, s73, 262144
pfx_293:
    s_barrier
    s_cmp_lt_u32 s73, s60
    s_cbranch_scc1 pfg_295
    s_cmp_ge_u32 s55, 2
    s_cbranch_scc1 pfx_296
    s_mov_b32 s73, s61
    s_mov_b32 s60, 7340032
    s_add_u32 s55, s55, 1
    s_cmp_eq_u32 s55, 2
    s_cbranch_scc1 pfw2_297
    s_mov_b32 s44, s56
    s_and_b32 s45, s57, 0xffff
    s_mov_b32 s46, 7340032
    s_mov_b32 s47, 0x20000
    s_branch pfg_295
pfw2_297:
    s_mov_b32 s44, s58
    s_and_b32 s45, s59, 0xffff
    s_mov_b32 s46, 7340032
    s_mov_b32 s47, 0x20000
pfg_295:
    s_buffer_load_dword s74, s[44:47], s73 offset:0
    s_buffer_load_dword s74, s[44:47], s73 offset:64
    s_buffer_load_dword s74, s[44:47], s73 offset:128
    s_buffer_load_dword s74, s[44:47], s73 offset:192
    s_add_u32 s73, s73, 262144
pfx_296:
    s_waitcnt vmcnt(1)
    v_pk_add_f32 v[24:25], v[16:17], v[20:21]
    v_pk_add_f32 v[26:27], v[18:19], v[22:23]
    s_nop 0
    v_add_f32_dpp v24, v24, v24 row_ror:4 row_mask:0xf bank_mask:0xf
    v_add_f32_dpp v26, v26, v26 row_ror:4 row_mask:0xf bank_mask:0xf
    s_nop 0
    v_add_f32_dpp v24, v24, v24 row_ror:8 row_mask:0xf bank_mask:0xf
    v_add_f32_dpp v26, v26, v26 row_ror:8 row_mask:0xf bank_mask:0xf
    v_mov_b32 v28, v24
    v_mov_b32 v29, v26
    s_nop 0
    v_permlane16_swap_b32 v24, v28
    v_permlane16_swap_b32 v26, v29
    v_add_f32 v24, v24, v28
    v_add_f32 v26, v26, v29
    v_mov_b32 v28, v24
    v_mov_b32 v29, v26
    s_nop 0
    v_permlane32_swap_b32 v24, v28
    v_permlane32_swap_b32 v26, v29
    v_add_f32 v24, v24, v28
    v_add_f32 v26, v26, v29
    v_mul_f32 v30, 0x3d000000, v24
    v_sub_f32 v31, v16, v30
    v_sub_f32 v32, v20, v30
    v_mul_f32 v31, v31, v31
    v_fma_f32 v31, v32, v32, v31
    v_mov_b32 v30, 0x3d000000
    v_fma_f32 v25, v31, v30, v25
    v_mul_f32 v30, 0x3d000000, v26
    v_sub_f32 v31, v18, v30
    v_sub_f32 v32, v22, v30
    v_mul_f32 v31, v31, v31
    v_fma_f32 v31, v32, v32, v31
    v_mov_b32 v30, 0x3d000000
    v_fma_f32 v27, v31, v30, v27
    v_add_f32_dpp v25, v25, v25 row_ror:4 row_mask:0xf bank_mask:0xf
    s_nop 0
    v_add_f32_dpp v27, v27, v27 row_ror:4 row_mask:0xf bank_mask:0xf
    v_add_f32_dpp v25, v25, v25 row_ror:8 row_mask:0xf bank_mask:0xf
    s_nop 0
    v_add_f32_dpp v27, v27, v27 row_ror:8 row_mask:0xf bank_mask:0xf
    v_mov_b32 v28, v25
    v_mov_b32 v29, v27
    s_nop 0
    v_permlane16_swap_b32 v25, v28
    v_permlane16_swap_b32 v27, v29
    v_add_f32 v25, v25, v28
    s_barrier
    s_cmp_lt_u32 s73, s60
    s_cbranch_scc1 pfg_298
    s_cmp_ge_u32 s55, 2
    s_cbranch_scc1 pfx_299
    s_mov_b32 s73, s61
    s_mov_b32 s60, 7340032
    s_add_u32 s55, s55, 1
    s_cmp_eq_u32 s55, 2
    s_cbranch_scc1 pfw2_300
    s_mov_b32 s44, s56
    s_and_b32 s45, s57, 0xffff
    s_mov_b32 s46, 7340032
    s_mov_b32 s47, 0x20000
    s_branch pfg_298
pfw2_300:
    s_mov_b32 s44, s58
    s_and_b32 s45, s59, 0xffff
    s_mov_b32 s46, 7340032
    s_mov_b32 s47, 0x20000
pfg_298:
    s_buffer_load_dword s74, s[44:47], s73 offset:0
    s_buffer_load_dword s74, s[44:47], s73 offset:64
    s_buffer_load_dword s74, s[44:47], s73 offset:128
    s_buffer_load_dword s74, s[44:47], s73 offset:192
    s_add_u32 s73, s73, 262144
    s_buffer_load_dword s74, s[44:47], s73 offset:0
    s_buffer_load_dword s74, s[44:47], s73 offset:64
    s_buffer_load_dword s74, s[44:47], s73 offset:128
    s_buffer_load_dword s74, s[44:47], s73 offset:192
    s_add_u32 s73, s73, 262144
pfx_299:
    v_add_f32 v27, v27, v29
    v_mov_b32 v28, v25
    v_mov_b32 v29, v27
    s_nop 0
    v_permlane32_swap_b32 v25, v28
    v_permlane32_swap_b32 v27, v29
    v_add_f32 v25, v25, v28
    v_add_f32 v27, v27, v29
    v_mul_f32 v24, 0x3a800000, v24
    v_cvt_pk_bf16_f32 v24, v24, v24
    v_and_b32 v24, 0xffff0000, v24
    v_mul_f32 v25, 0x3a800000, v25
    v_cvt_pk_bf16_f32 v25, v25, v25
    v_and_b32 v25, 0xffff0000, v25
    v_add_f32 v25, 0x3727c5ac, v25
    v_cvt_pk_bf16_f32 v25, v25, v25
    v_and_b32 v25, 0xffff0000, v25
    v_sqrt_f32 v25, v25
    s_nop 0
    v_cvt_pk_bf16_f32 v25, v25, v25
    v_and_b32 v25, 0xffff0000, v25
    v_rcp_f32 v25, v25
    s_nop 0
    v_mul_f32 v25, 0xbfb8aa3b, v25
    v_mul_f32 v24, v24, v25
    v_sub_f32 v24, 0, v24
    v_mul_f32 v26, 0x3a800000, v26
    v_cvt_pk_bf16_f32 v26, v26, v26
    v_and_b32 v26, 0xffff0000, v26
    v_mul_f32 v27, 0x3a800000, v27
    v_cvt_pk_bf16_f32 v27, v27, v27
    v_and_b32 v27, 0xffff0000, v27
    v_add_f32 v27, 0x3727c5ac, v27
    v_cvt_pk_bf16_f32 v27, v27, v27
    v_and_b32 v27, 0xffff0000, v27
    v_sqrt_f32 v27, v27
    s_nop 0
    v_cvt_pk_bf16_f32 v27, v27, v27
    v_and_b32 v27, 0xffff0000, v27
    v_rcp_f32 v27, v27
    s_nop 0
    v_mul_f32 v27, 0xbfb8aa3b, v27
    v_mul_f32 v26, v26, v27
    s_barrier
    s_cmp_lt_u32 s73, s60
    s_cbranch_scc1 pfg_301
    s_cmp_ge_u32 s55, 2
    s_cbranch_scc1 pfx_302
    s_mov_b32 s73, s61
    s_mov_b32 s60, 7340032
    s_add_u32 s55, s55, 1
    s_cmp_eq_u32 s55, 2
    s_cbranch_scc1 pfw2_303
    s_mov_b32 s44, s56
    s_and_b32 s45, s57, 0xffff
    s_mov_b32 s46, 7340032
    s_mov_b32 s47, 0x20000
    s_branch pfg_301
pfw2_303:
    s_mov_b32 s44, s58
    s_and_b32 s45, s59, 0xffff
    s_mov_b32 s46, 7340032
    s_mov_b32 s47, 0x20000
pfg_301:
    s_buffer_load_dword s74, s[44:47], s73 offset:0
    s_buffer_load_dword s74, s[44:47], s73 offset:64
    s_buffer_load_dword s74, s[44:47], s73 offset:128
    s_buffer_load_dword s74, s[44:47], s73 offset:192
    s_add_u32 s73, s73, 262144
    s_buffer_load_dword s74, s[44:47], s73 offset:0
    s_buffer_load_dword s74, s[44:47], s73 offset:64
    s_buffer_load_dword s74, s[44:47], s73 offset:128
    s_buffer_load_dword s74, s[44:47], s73 offset:192
    s_add_u32 s73, s73, 262144
pfx_302:
    v_sub_f32 v26, 0, v26
    s_lshl_b32 s34, s24, 10
    s_add_u32 s34, s34, 44433408
    s_lshl_b32 s30, s25, 6
    s_add_u32 s35, s34, s30
    s_mov_b64 exec, 0xf
    buffer_store_dwordx4 v[24:27], v12, s[8:11], s35 offen sc1
    s_mov_b64 exec, -1
    s_waitcnt vmcnt(1)
    v_and_b32 v234, v234, v235
    v_and_b32 v236, v236, v237
    v_and_b32 v234, v234, v236
    v_and_b32 v234, 1, v234
    v_cmp_ne_u32 vcc, 1, v234
    s_cbranch_vccz ckx_265
    s_add_u32 s38, s37, 0
    s_mov_b32 s72, 0
poll_266:
    buffer_load_dword v8, v240, s[8:11], s38 offen sc1
    s_add_u32 s72, s72, 1
    s_cmp_gt_u32 s72, 524288
    s_waitcnt vmcnt(0)
    s_cbranch_scc1 pollx_267
    v_and_b32 v8, 1, v8
    v_cmp_ne_u32 vcc, 1, v8
    s_cbranch_vccz pollx_267
    s_sleep 8
    s_branch poll_266
pollx_267:
    s_mov_b64 exec, -1
    s_add_u32 s38, s37, 2048
    s_mov_b32 s72, 0
poll_268:
    buffer_load_dword v8, v240, s[8:11], s38 offen sc1
    s_add_u32 s72, s72, 1
    s_cmp_gt_u32 s72, 524288
    s_waitcnt vmcnt(0)
    s_cbranch_scc1 pollx_269
    v_and_b32 v8, 1, v8
    v_cmp_ne_u32 vcc, 1, v8
    s_cbranch_vccz pollx_269
    s_sleep 8
    s_branch poll_268
pollx_269:
    s_mov_b64 exec, -1
    s_add_u32 s38, s37, 4096
    s_mov_b32 s72, 0
poll_270:
    buffer_load_dword v8, v240, s[8:11], s38 offen sc1
    s_add_u32 s72, s72, 1
    s_cmp_gt_u32 s72, 524288
    s_waitcnt vmcnt(0)
    s_cbranch_scc1 pollx_271
    v_and_b32 v8, 1, v8
    v_cmp_ne_u32 vcc, 1, v8
    s_cbranch_vccz pollx_271
    s_sleep 8
    s_branch poll_270
pollx_271:
    s_mov_b64 exec, -1
ckx_265:
    v_lshlrev_b32 v6, 4, v1
    s_barrier
    s_cmp_lt_u32 s73, s60
    s_cbranch_scc1 pfg_304
    s_cmp_ge_u32 s55, 2
    s_cbranch_scc1 pfx_305
    s_mov_b32 s73, s61
    s_mov_b32 s60, 7340032
    s_add_u32 s55, s55, 1
    s_cmp_eq_u32 s55, 2
    s_cbranch_scc1 pfw2_306
    s_mov_b32 s44, s56
    s_and_b32 s45, s57, 0xffff
    s_mov_b32 s46, 7340032
    s_mov_b32 s47, 0x20000
    s_branch pfg_304
pfw2_306:
    s_mov_b32 s44, s58
    s_and_b32 s45, s59, 0xffff
    s_mov_b32 s46, 7340032
    s_mov_b32 s47, 0x20000
pfg_304:
    s_buffer_load_dword s74, s[44:47], s73 offset:0
    s_buffer_load_dword s74, s[44:47], s73 offset:64
    s_buffer_load_dword s74, s[44:47], s73 offset:128
    s_buffer_load_dword s74, s[44:47], s73 offset:192
    s_add_u32 s73, s73, 262144
pfx_305:
    s_barrier
    s_cmp_lt_u32 s73, s60
    s_cbranch_scc1 pfg_307
    s_cmp_ge_u32 s55, 2
    s_cbranch_scc1 pfx_308
    s_mov_b32 s73, s61
    s_mov_b32 s60, 7340032
    s_add_u32 s55, s55, 1
    s_cmp_eq_u32 s55, 2
    s_cbranch_scc1 pfw2_309
    s_mov_b32 s44, s56
    s_and_b32 s45, s57, 0xffff
    s_mov_b32 s46, 7340032
    s_mov_b32 s47, 0x20000
    s_branch pfg_307
pfw2_309:
    s_mov_b32 s44, s58
    s_and_b32 s45, s59, 0xffff
    s_mov_b32 s46, 7340032
    s_mov_b32 s47, 0x20000
pfg_307:
    s_buffer_load_dword s74, s[44:47], s73 offset:0
    s_buffer_load_dword s74, s[44:47], s73 offset:64
    s_buffer_load_dword s74, s[44:47], s73 offset:128
    s_buffer_load_dword s74, s[44:47], s73 offset:192
    s_add_u32 s73, s73, 262144
    s_buffer_load_dword s74, s[44:47], s73 offset:0
    s_buffer_load_dword s74, s[44:47], s73 offset:64
    s_buffer_load_dword s74, s[44:47], s73 offset:128
    s_buffer_load_dword s74, s[44:47], s73 offset:192
    s_add_u32 s73, s73, 262144
pfx_308:
    s_barrier
    s_cmp_lt_u32 s73, s60
    s_cbranch_scc1 pfg_310
    s_cmp_ge_u32 s55, 2
    s_cbranch_scc1 pfx_311
    s_mov_b32 s73, s61
    s_mov_b32 s60, 7340032
    s_add_u32 s55, s55, 1
    s_cmp_eq_u32 s55, 2
    s_cbranch_scc1 pfw2_312
    s_mov_b32 s44, s56
    s_and_b32 s45, s57, 0xffff
    s_mov_b32 s46, 7340032
    s_mov_b32 s47, 0x20000
    s_branch pfg_310
pfw2_312:
    s_mov_b32 s44, s58
    s_and_b32 s45, s59, 0xffff
    s_mov_b32 s46, 7340032
    s_mov_b32 s47, 0x20000
pfg_310:
    s_buffer_load_dword s74, s[44:47], s73 offset:0
    s_buffer_load_dword s74, s[44:47], s73 offset:64
    s_buffer_load_dword s74, s[44:47], s73 offset:128
    s_buffer_load_dword s74, s[44:47], s73 offset:192
    s_add_u32 s73, s73, 262144
    s_buffer_load_dword s74, s[44:47], s73 offset:0
    s_buffer_load_dword s74, s[44:47], s73 offset:64
    s_buffer_load_dword s74, s[44:47], s73 offset:128
    s_buffer_load_dword s74, s[44:47], s73 offset:192
    s_add_u32 s73, s73, 262144
pfx_311:
    s_barrier
    s_cmp_lt_u32 s73, s60
    s_cbranch_scc1 pfg_313
    s_cmp_ge_u32 s55, 2
    s_cbranch_scc1 pfx_314
    s_mov_b32 s73, s61
    s_mov_b32 s60, 7340032
    s_add_u32 s55, s55, 1
    s_cmp_eq_u32 s55, 2
    s_cbranch_scc1 pfw2_315
    s_mov_b32 s44, s56
    s_and_b32 s45, s57, 0xffff
    s_mov_b32 s46, 7340032
    s_mov_b32 s47, 0x20000
    s_branch pfg_313
pfw2_315:
    s_mov_b32 s44, s58
    s_and_b32 s45, s59, 0xffff
    s_mov_b32 s46, 7340032
    s_mov_b32 s47, 0x20000
pfg_313:
    s_buffer_load_dword s74, s[44:47], s73 offset:0
    s_buffer_load_dword s74, s[44:47], s73 offset:64
    s_buffer_load_dword s74, s[44:47], s73 offset:128
    s_buffer_load_dword s74, s[44:47], s73 offset:192
    s_add_u32 s73, s73, 262144
pfx_314:
    buffer_load_dwordx4 v[16:19], v6, s[8:11], s34 offen sc1
    s_barrier
    s_barrier
    s_mov_b64 exec, -1
    s_mov_b32 s72, 0
rt_272:
    s_waitcnt vmcnt(0)
    v_max_u32 v8, v16, v17
    v_max3_u32 v8, v18, v19, v8
    v_cmp_eq_u32 vcc, -1, v8
    s_cbranch_vccz rtx_273
    s_add_u32 s72, s72, 1
    s_cmp_gt_u32 s72, 524288
    s_cbranch_scc1 rtx_273
    s_sleep 8
    buffer_load_dwordx4 v[16:19], v6, s[8:11], s34 offen sc1
    s_branch rt_272
rtx_273:
    v_add_u32 v6, 157696, v6
    ds_write_b128 v6, v[16:19]
    s_waitcnt lgkmcnt(0)
    s_barrier
    s_branch L_h4x
L_h4b:
    s_barrier
    s_cmp_lt_u32 s73, s60
    s_cbranch_scc1 pfg_320
    s_cmp_ge_u32 s55, 2
    s_cbranch_scc1 pfx_321
    s_mov_b32 s73, s61
    s_mov_b32 s60, 7340032
    s_add_u32 s55, s55, 1
    s_cmp_eq_u32 s55, 2
    s_cbranch_scc1 pfw2_322
    s_mov_b32 s44, s56
    s_and_b32 s45, s57, 0xffff
    s_mov_b32 s46, 7340032
    s_mov_b32 s47, 0x20000
    s_branch pfg_320
pfw2_322:
    s_mov_b32 s44, s58
    s_and_b32 s45, s59, 0xffff
    s_mov_b32 s46, 7340032
    s_mov_b32 s47, 0x20000
pfg_320:
    s_buffer_load_dword s74, s[44:47], s73 offset:0
    s_buffer_load_dword s74, s[44:47], s73 offset:64
    s_buffer_load_dword s74, s[44:47], s73 offset:128
    s_buffer_load_dword s74, s[44:47], s73 offset:192
    s_add_u32 s73, s73, 262144
    s_buffer_load_dword s74, s[44:47], s73 offset:0
    s_buffer_load_dword s74, s[44:47], s73 offset:64
    s_buffer_load_dword s74, s[44:47], s73 offset:128
    s_buffer_load_dword s74, s[44:47], s73 offset:192
    s_add_u32 s73, s73, 262144
pfx_321:
    s_waitcnt vmcnt(4)
    s_mul_i32 s34, s25, 896
    s_mul_i32 s30, s24, 56
    s_add_u32 s34, s34, s30
    s_add_u32 s34, s34, 43253760
    s_add_u32 s35, s34, 229376
    v_lshrrev_b32 v11, 2, v1
    v_mul_u32_u24 v11, 14336, v11
    v_and_b32 v12, 3, v1
    v_lshlrev_b32 v12, 4, v12
    v_add_u32 v11, v11, v12
    v_and_b32 v13, 3, v1
    v_cmp_eq_u32 s[38:39], 3, v13
    s_barrier
    s_cmp_lt_u32 s73, s60
    s_cbranch_scc1 pfg_323
    s_cmp_ge_u32 s55, 2
    s_cbranch_scc1 pfx_324
    s_mov_b32 s73, s61
    s_mov_b32 s60, 7340032
    s_add_u32 s55, s55, 1
    s_cmp_eq_u32 s55, 2
    s_cbranch_scc1 pfw2_325
    s_mov_b32 s44, s56
    s_and_b32 s45, s57, 0xffff
    s_mov_b32 s46, 7340032
    s_mov_b32 s47, 0x20000
    s_branch pfg_323
pfw2_325:
    s_mov_b32 s44, s58
    s_and_b32 s45, s59, 0xffff
    s_mov_b32 s46, 7340032
    s_mov_b32 s47, 0x20000
pfg_323:
    s_buffer_load_dword s74, s[44:47], s73 offset:0
    s_buffer_load_dword s74, s[44:47], s73 offset:64
    s_buffer_load_dword s74, s[44:47], s73 offset:128
    s_buffer_load_dword s74, s[44:47], s73 offset:192
    s_add_u32 s73, s73, 262144
pfx_324:
    s_barrier
    s_cmp_lt_u32 s73, s60
    s_cbranch_scc1 pfg_326
    s_cmp_ge_u32 s55, 2
    s_cbranch_scc1 pfx_327
    s_mov_b32 s73, s61
    s_mov_b32 s60, 7340032
    s_add_u32 s55, s55, 1
    s_cmp_eq_u32 s55, 2
    s_cbranch_scc1 pfw2_328
    s_mov_b32 s44, s56
    s_and_b32 s45, s57, 0xffff
    s_mov_b32 s46, 7340032
    s_mov_b32 s47, 0x20000
    s_branch pfg_326
pfw2_328:
    s_mov_b32 s44, s58
    s_and_b32 s45, s59, 0xffff
    s_mov_b32 s46, 7340032
    s_mov_b32 s47, 0x20000
pfg_326:
    s_buffer_load_dword s74, s[44:47], s73 offset:0
    s_buffer_load_dword s74, s[44:47], s73 offset:64
    s_buffer_load_dword s74, s[44:47], s73 offset:128
    s_buffer_load_dword s74, s[44:47], s73 offset:192
    s_add_u32 s73, s73, 262144
    s_buffer_load_dword s74, s[44:47], s73 offset:0
    s_buffer_load_dword s74, s[44:47], s73 offset:64
    s_buffer_load_dword s74, s[44:47], s73 offset:128
    s_buffer_load_dword s74, s[44:47], s73 offset:192
    s_add_u32 s73, s73, 262144
pfx_327:
    s_barrier
    s_cmp_lt_u32 s73, s60
    s_cbranch_scc1 pfg_329
    s_cmp_ge_u32 s55, 2
    s_cbranch_scc1 pfx_330
    s_mov_b32 s73, s61
    s_mov_b32 s60, 7340032
    s_add_u32 s55, s55, 1
    s_cmp_eq_u32 s55, 2
    s_cbranch_scc1 pfw2_331
    s_mov_b32 s44, s56
    s_and_b32 s45, s57, 0xffff
    s_mov_b32 s46, 7340032
    s_mov_b32 s47, 0x20000
    s_branch pfg_329
pfw2_331:
    s_mov_b32 s44, s58
    s_and_b32 s45, s59, 0xffff
    s_mov_b32 s46, 7340032
    s_mov_b32 s47, 0x20000
pfg_329:
    s_buffer_load_dword s74, s[44:47], s73 offset:0
    s_buffer_load_dword s74, s[44:47], s73 offset:64
    s_buffer_load_dword s74, s[44:47], s73 offset:128
    s_buffer_load_dword s74, s[44:47], s73 offset:192
    s_add_u32 s73, s73, 262144
    s_buffer_load_dword s74, s[44:47], s73 offset:0
    s_buffer_load_dword s74, s[44:47], s73 offset:64
    s_buffer_load_dword s74, s[44:47], s73 offset:128
    s_buffer_load_dword s74, s[44:47], s73 offset:192
    s_add_u32 s73, s73, 262144
pfx_330:
    s_barrier
    s_cmp_lt_u32 s73, s60
    s_cbranch_scc1 pfg_332
    s_cmp_ge_u32 s55, 2
    s_cbranch_scc1 pfx_333
    s_mov_b32 s73, s61
    s_mov_b32 s60, 7340032
    s_add_u32 s55, s55, 1
    s_cmp_eq_u32 s55, 2
    s_cbranch_scc1 pfw2_334
    s_mov_b32 s44, s56
    s_and_b32 s45, s57, 0xffff
    s_mov_b32 s46, 7340032
    s_mov_b32 s47, 0x20000
    s_branch pfg_332
pfw2_334:
    s_mov_b32 s44, s58
    s_and_b32 s45, s59, 0xffff
    s_mov_b32 s46, 7340032
    s_mov_b32 s47, 0x20000
pfg_332:
    s_buffer_load_dword s74, s[44:47], s73 offset:0
    s_buffer_load_dword s74, s[44:47], s73 offset:64
    s_buffer_load_dword s74, s[44:47], s73 offset:128
    s_buffer_load_dword s74, s[44:47], s73 offset:192
    s_add_u32 s73, s73, 262144
pfx_333:
    buffer_load_dwordx4 v[16:19], v11, s[8:11], s34 offen sc1
    buffer_load_dwordx4 v[20:23], v11, s[8:11], s35 offen sc1
    s_barrier
    s_cmp_lt_u32 s73, s60
    s_cbranch_scc1 pfg_335
    s_cmp_ge_u32 s55, 2
    s_cbranch_scc1 pfx_336
    s_mov_b32 s73, s61
    s_mov_b32 s60, 7340032
    s_add_u32 s55, s55, 1
    s_cmp_eq_u32 s55, 2
    s_cbranch_scc1 pfw2_337
    s_mov_b32 s44, s56
    s_and_b32 s45, s57, 0xffff
    s_mov_b32 s46, 7340032
    s_mov_b32 s47, 0x20000
    s_branch pfg_335
pfw2_337:
    s_mov_b32 s44, s58
    s_and_b32 s45, s59, 0xffff
    s_mov_b32 s46, 7340032
    s_mov_b32 s47, 0x20000
pfg_335:
    s_buffer_load_dword s74, s[44:47], s73 offset:0
    s_buffer_load_dword s74, s[44:47], s73 offset:64
    s_buffer_load_dword s74, s[44:47], s73 offset:128
    s_buffer_load_dword s74, s[44:47], s73 offset:192
    s_add_u32 s73, s73, 262144
    s_buffer_load_dword s74, s[44:47], s73 offset:0
    s_buffer_load_dword s74, s[44:47], s73 offset:64
    s_buffer_load_dword s74, s[44:47], s73 offset:128
    s_buffer_load_dword s74, s[44:47], s73 offset:192
    s_add_u32 s73, s73, 262144
pfx_336:
    s_barrier
    s_cmp_lt_u32 s73, s60
    s_cbranch_scc1 pfg_338
    s_cmp_ge_u32 s55, 2
    s_cbranch_scc1 pfx_339
    s_mov_b32 s73, s61
    s_mov_b32 s60, 7340032
    s_add_u32 s55, s55, 1
    s_cmp_eq_u32 s55, 2
    s_cbranch_scc1 pfw2_340
    s_mov_b32 s44, s56
    s_and_b32 s45, s57, 0xffff
    s_mov_b32 s46, 7340032
    s_mov_b32 s47, 0x20000
    s_branch pfg_338
pfw2_340:
    s_mov_b32 s44, s58
    s_and_b32 s45, s59, 0xffff
    s_mov_b32 s46, 7340032
    s_mov_b32 s47, 0x20000
pfg_338:
    s_buffer_load_dword s74, s[44:47], s73 offset:0
    s_buffer_load_dword s74, s[44:47], s73 offset:64
    s_buffer_load_dword s74, s[44:47], s73 offset:128
    s_buffer_load_dword s74, s[44:47], s73 offset:192
    s_add_u32 s73, s73, 262144
    s_buffer_load_dword s74, s[44:47], s73 offset:0
    s_buffer_load_dword s74, s[44:47], s73 offset:64
    s_buffer_load_dword s74, s[44:47], s73 offset:128
    s_buffer_load_dword s74, s[44:47], s73 offset:192
    s_add_u32 s73, s73, 262144
pfx_339:
    s_mov_b64 exec, -1
    s_mov_b32 s72, 0
rt_316:
    s_waitcnt vmcnt(0)
    v_cndmask_b32_e64 v18, v18, 0, s[38:39]
    v_cndmask_b32_e64 v19, v19, 0, s[38:39]
    v_cndmask_b32_e64 v22, v22, 0, s[38:39]
    v_cndmask_b32_e64 v23, v23, 0, s[38:39]
    v_max_u32 v8, v16, v17
    v_max3_u32 v8, v18, v19, v8
    v_max3_u32 v8, v20, v21, v8
    v_max3_u32 v8, v22, v23, v8
    v_cmp_eq_u32 vcc, -1, v8
    s_cbranch_vccz rtx_317
    s_add_u32 s72, s72, 1
    s_cmp_gt_u32 s72, 524288
    s_cbranch_scc1 rtx_317
    s_sleep 8
    buffer_load_dwordx4 v[16:19], v11, s[8:11], s34 offen sc1
    buffer_load_dwordx4 v[20:23], v11, s[8:11], s35 offen sc1
    s_branch rt_316
rtx_317:
    v_pk_add_f32 v[16:17], v[16:17], v[20:21]
    v_pk_add_f32 v[18:19], v[18:19], v[22:23]
    s_nop 0
    v_add_f32_dpp v16, v16, v16 row_ror:4 row_mask:0xf bank_mask:0xf
    v_add_f32_dpp v17, v17, v17 row_ror:4 row_mask:0xf bank_mask:0xf
    v_add_f32_dpp v18, v18, v18 row_ror:4 row_mask:0xf bank_mask:0xf
    v_add_f32_dpp v19, v19, v19 row_ror:4 row_mask:0xf bank_mask:0xf
    v_add_f32_dpp v16, v16, v16 row_ror:8 row_mask:0xf bank_mask:0xf
    v_add_f32_dpp v17, v17, v17 row_ror:8 row_mask:0xf bank_mask:0xf
    v_add_f32_dpp v18, v18, v18 row_ror:8 row_mask:0xf bank_mask:0xf
    v_add_f32_dpp v19, v19, v19 row_ror:8 row_mask:0xf bank_mask:0xf
    v_mov_b32 v28, v16
    v_mov_b32 v29, v17
    v_mov_b32 v30, v18
    v_mov_b32 v31, v19
    v_permlane16_swap_b32 v16, v28
    v_permlane16_swap_b32 v17, v29
    v_permlane16_swap_b32 v18, v30
    v_permlane16_swap_b32 v19, v31
    v_add_f32 v16, v16, v28
    v_add_f32 v17, v17, v29
    v_add_f32 v18, v18, v30
    v_add_f32 v19, v19, v31
    v_mov_b32 v28, v16
    v_mov_b32 v29, v17
    v_mov_b32 v30, v18
    v_mov_b32 v31, v19
    v_permlane32_swap_b32 v16, v28
    v_permlane32_swap_b32 v17, v29
    s_barrier
    s_cmp_lt_u32 s73, s60
    s_cbranch_scc1 pfg_341
    s_cmp_ge_u32 s55, 2
    s_cbranch_scc1 pfx_342
    s_mov_b32 s73, s61
    s_mov_b32 s60, 7340032
    s_add_u32 s55, s55, 1
    s_cmp_eq_u32 s55, 2
    s_cbranch_scc1 pfw2_343
    s_mov_b32 s44, s56
    s_and_b32 s45, s57, 0xffff
    s_mov_b32 s46, 7340032
    s_mov_b32 s47, 0x20000
    s_branch pfg_341
pfw2_343:
    s_mov_b32 s44, s58
    s_and_b32 s45, s59, 0xffff
    s_mov_b32 s46, 7340032
    s_mov_b32 s47, 0x20000
pfg_341:
    s_buffer_load_dword s74, s[44:47], s73 offset:0
    s_buffer_load_dword s74, s[44:47], s73 offset:64
    s_buffer_load_dword s74, s[44:47], s73 offset:128
    s_buffer_load_dword s74, s[44:47], s73 offset:192
    s_add_u32 s73, s73, 262144
pfx_342:
    v_permlane32_swap_b32 v18, v30
    v_permlane32_swap_b32 v19, v31
    v_add_f32 v16, v16, v28
    v_add_f32 v17, v17, v29
    v_add_f32 v18, v18, v30
    v_add_f32 v19, v19, v31
    s_lshl_b32 s34, s25, 10
    s_add_u32 s34, s34, 44466176
    s_lshl_b32 s30, s24, 6
    s_add_u32 s35, s34, s30
    s_mov_b64 exec, 0xf
    buffer_store_dwordx4 v[16:19], v12, s[8:11], s35 offen sc1
    s_mov_b64 exec, -1
    v_lshlrev_b32 v6, 4, v1
    v_lshrrev_b32 v7, 2, v1
    v_mul_u32_u24 v7, 56, v7
    v_add_u32 v7, v7, v12
    v_add_u32 v7, 158720, v7
    s_barrier
    s_cmp_lt_u32 s73, s60
    s_cbranch_scc1 pfg_344
    s_cmp_ge_u32 s55, 2
    s_cbranch_scc1 pfx_345
    s_mov_b32 s73, s61
    s_mov_b32 s60, 7340032
    s_add_u32 s55, s55, 1
    s_cmp_eq_u32 s55, 2
    s_cbranch_scc1 pfw2_346
    s_mov_b32 s44, s56
    s_and_b32 s45, s57, 0xffff
    s_mov_b32 s46, 7340032
    s_mov_b32 s47, 0x20000
    s_branch pfg_344
pfw2_346:
    s_mov_b32 s44, s58
    s_and_b32 s45, s59, 0xffff
    s_mov_b32 s46, 7340032
    s_mov_b32 s47, 0x20000
pfg_344:
    s_buffer_load_dword s74, s[44:47], s73 offset:0
    s_buffer_load_dword s74, s[44:47], s73 offset:64
    s_buffer_load_dword s74, s[44:47], s73 offset:128
    s_buffer_load_dword s74, s[44:47], s73 offset:192
    s_add_u32 s73, s73, 262144
    s_buffer_load_dword s74, s[44:47], s73 offset:0
    s_buffer_load_dword s74, s[44:47], s73 offset:64
    s_buffer_load_dword s74, s[44:47], s73 offset:128
    s_buffer_load_dword s74, s[44:47], s73 offset:192
    s_add_u32 s73, s73, 262144
pfx_345:
    s_barrier
    s_cmp_lt_u32 s73, s60
    s_cbranch_scc1 pfg_347
    s_cmp_ge_u32 s55, 2
    s_cbranch_scc1 pfx_348
    s_mov_b32 s73, s61
    s_mov_b32 s60, 7340032
    s_add_u32 s55, s55, 1
    s_cmp_eq_u32 s55, 2
    s_cbranch_scc1 pfw2_349
    s_mov_b32 s44, s56
    s_and_b32 s45, s57, 0xffff
    s_mov_b32 s46, 7340032
    s_mov_b32 s47, 0x20000
    s_branch pfg_347
pfw2_349:
    s_mov_b32 s44, s58
    s_and_b32 s45, s59, 0xffff
    s_mov_b32 s46, 7340032
    s_mov_b32 s47, 0x20000
pfg_347:
    s_buffer_load_dword s74, s[44:47], s73 offset:0
    s_buffer_load_dword s74, s[44:47], s73 offset:64
    s_buffer_load_dword s74, s[44:47], s73 offset:128
    s_buffer_load_dword s74, s[44:47], s73 offset:192
    s_add_u32 s73, s73, 262144
    s_buffer_load_dword s74, s[44:47], s73 offset:0
    s_buffer_load_dword s74, s[44:47], s73 offset:64
    s_buffer_load_dword s74, s[44:47], s73 offset:128
    s_buffer_load_dword s74, s[44:47], s73 offset:192
    s_add_u32 s73, s73, 262144
pfx_348:
    s_barrier
    s_cmp_lt_u32 s73, s60
    s_cbranch_scc1 pfg_350
    s_cmp_ge_u32 s55, 2
    s_cbranch_scc1 pfx_351
    s_mov_b32 s73, s61
    s_mov_b32 s60, 7340032
    s_add_u32 s55, s55, 1
    s_cmp_eq_u32 s55, 2
    s_cbranch_scc1 pfw2_352
    s_mov_b32 s44, s56
    s_and_b32 s45, s57, 0xffff
    s_mov_b32 s46, 7340032
    s_mov_b32 s47, 0x20000
    s_branch pfg_350
pfw2_352:
    s_mov_b32 s44, s58
    s_and_b32 s45, s59, 0xffff
    s_mov_b32 s46, 7340032
    s_mov_b32 s47, 0x20000
pfg_350:
    s_buffer_load_dword s74, s[44:47], s73 offset:0
    s_buffer_load_dword s74, s[44:47], s73 offset:64
    s_buffer_load_dword s74, s[44:47], s73 offset:128
    s_buffer_load_dword s74, s[44:47], s73 offset:192
    s_add_u32 s73, s73, 262144
pfx_351:
    s_barrier
    s_cmp_lt_u32 s73, s60
    s_cbranch_scc1 pfg_353
    s_cmp_ge_u32 s55, 2
    s_cbranch_scc1 pfx_354
    s_mov_b32 s73, s61
    s_mov_b32 s60, 7340032
    s_add_u32 s55, s55, 1
    s_cmp_eq_u32 s55, 2
    s_cbranch_scc1 pfw2_355
    s_mov_b32 s44, s56
    s_and_b32 s45, s57, 0xffff
    s_mov_b32 s46, 7340032
    s_mov_b32 s47, 0x20000
    s_branch pfg_353
pfw2_355:
    s_mov_b32 s44, s58
    s_and_b32 s45, s59, 0xffff
    s_mov_b32 s46, 7340032
    s_mov_b32 s47, 0x20000
pfg_353:
    s_buffer_load_dword s74, s[44:47], s73 offset:0
    s_buffer_load_dword s74, s[44:47], s73 offset:64
    s_buffer_load_dword s74, s[44:47], s73 offset:128
    s_buffer_load_dword s74, s[44:47], s73 offset:192
    s_add_u32 s73, s73, 262144
    s_buffer_load_dword s74, s[44:47], s73 offset:0
    s_buffer_load_dword s74, s[44:47], s73 offset:64
    s_buffer_load_dword s74, s[44:47], s73 offset:128
    s_buffer_load_dword s74, s[44:47], s73 offset:192
    s_add_u32 s73, s73, 262144
pfx_354:
    s_barrier
    s_cmp_lt_u32 s73, s60
    s_cbranch_scc1 pfg_356
    s_cmp_ge_u32 s55, 2
    s_cbranch_scc1 pfx_357
    s_mov_b32 s73, s61
    s_mov_b32 s60, 7340032
    s_add_u32 s55, s55, 1
    s_cmp_eq_u32 s55, 2
    s_cbranch_scc1 pfw2_358
    s_mov_b32 s44, s56
    s_and_b32 s45, s57, 0xffff
    s_mov_b32 s46, 7340032
    s_mov_b32 s47, 0x20000
    s_branch pfg_356
pfw2_358:
    s_mov_b32 s44, s58
    s_and_b32 s45, s59, 0xffff
    s_mov_b32 s46, 7340032
    s_mov_b32 s47, 0x20000
pfg_356:
    s_buffer_load_dword s74, s[44:47], s73 offset:0
    s_buffer_load_dword s74, s[44:47], s73 offset:64
    s_buffer_load_dword s74, s[44:47], s73 offset:128
    s_buffer_load_dword s74, s[44:47], s73 offset:192
    s_add_u32 s73, s73, 262144
    s_buffer_load_dword s74, s[44:47], s73 offset:0
    s_buffer_load_dword s74, s[44:47], s73 offset:64
    s_buffer_load_dword s74, s[44:47], s73 offset:128
    s_buffer_load_dword s74, s[44:47], s73 offset:192
    s_add_u32 s73, s73, 262144
pfx_357:
    s_barrier
    s_cmp_lt_u32 s73, s60
    s_cbranch_scc1 pfg_359
    s_cmp_ge_u32 s55, 2
    s_cbranch_scc1 pfx_360
    s_mov_b32 s73, s61
    s_mov_b32 s60, 7340032
    s_add_u32 s55, s55, 1
    s_cmp_eq_u32 s55, 2
    s_cbranch_scc1 pfw2_361
    s_mov_b32 s44, s56
    s_and_b32 s45, s57, 0xffff
    s_mov_b32 s46, 7340032
    s_mov_b32 s47, 0x20000
    s_branch pfg_359
pfw2_361:
    s_mov_b32 s44, s58
    s_and_b32 s45, s59, 0xffff
    s_mov_b32 s46, 7340032
    s_mov_b32 s47, 0x20000
pfg_359:
    s_buffer_load_dword s74, s[44:47], s73 offset:0
    s_buffer_load_dword s74, s[44:47], s73 offset:64
    s_buffer_load_dword s74, s[44:47], s73 offset:128
    s_buffer_load_dword s74, s[44:47], s73 offset:192
    s_add_u32 s73, s73, 262144
pfx_360:
    buffer_load_dwordx4 v[16:19], v6, s[8:11], s34 offen sc1
    s_barrier
    s_barrier
    s_mov_b64 exec, -1
    s_mov_b32 s72, 0
rt_318:
    s_waitcnt vmcnt(0)
    v_max_u32 v8, v16, v17
    v_max3_u32 v8, v18, v19, v8
    v_cmp_eq_u32 vcc, -1, v8
    s_cbranch_vccz rtx_319
    s_add_u32 s72, s72, 1
    s_cmp_gt_u32 s72, 524288
    s_cbranch_scc1 rtx_319
    s_sleep 8
    buffer_load_dwordx4 v[16:19], v6, s[8:11], s34 offen sc1
    s_branch rt_318
rtx_319:
    ds_write_b64 v7, v[16:17]
    s_andn2_b64 exec, exec, s[38:39]
    ds_write_b64 v7, v[18:19] offset:8
    s_mov_b64 exec, -1
    s_waitcnt lgkmcnt(0)
    s_barrier
L_h4x:
pfin_362:
    s_cmp_lt_u32 s73, s60
    s_cbranch_scc1 pfg_363
    s_cmp_ge_u32 s55, 2
    s_cbranch_scc1 pfx_364
    s_mov_b32 s73, s61
    s_mov_b32 s60, 7340032
    s_add_u32 s55, s55, 1
    s_cmp_eq_u32 s55, 2
    s_cbranch_scc1 pfw2_365
    s_mov_b32 s44, s56
    s_and_b32 s45, s57, 0xffff
    s_mov_b32 s46, 7340032
    s_mov_b32 s47, 0x20000
    s_branch pfg_363
pfw2_365:
    s_mov_b32 s44, s58
    s_and_b32 s45, s59, 0xffff
    s_mov_b32 s46, 7340032
    s_mov_b32 s47, 0x20000
pfg_363:
    s_buffer_load_dword s74, s[44:47], s73 offset:0
    s_buffer_load_dword s74, s[44:47], s73 offset:64
    s_buffer_load_dword s74, s[44:47], s73 offset:128
    s_buffer_load_dword s74, s[44:47], s73 offset:192
    s_add_u32 s73, s73, 262144
    s_buffer_load_dword s74, s[44:47], s73 offset:0
    s_buffer_load_dword s74, s[44:47], s73 offset:64
    s_buffer_load_dword s74, s[44:47], s73 offset:128
    s_buffer_load_dword s74, s[44:47], s73 offset:192
    s_add_u32 s73, s73, 262144
pfx_364:
    s_waitcnt lgkmcnt(6)
    s_cmp_lt_u32 s55, 2
    s_cbranch_scc1 pfin_362
    s_cmp_lt_u32 s73, s60
    s_cbranch_scc1 pfin_362
L_end:
    s_endpgm
L_cons:
    s_lshl_b32 s30, s2, 2
    s_add_u32 s30, s30, s21
    s_mul_i32 s31, s30, 6144
    s_lshl_b32 s30, s30, 12
    v_lshlrev_b32 v5, 10, v1
    s_mov_b64 exec, 0x3f
    buffer_load_dword v250, v5, s[12:15], s31 offen offset:384
    s_mov_b64 exec, -1
    v_mov_b32 v254, 0
    ds_write_b32 v252, v254 offset:3072
    ds_write_b32 v252, v254 offset:1024

    s_lshl_b32 s30, s28, 13
    v_lshl_add_u32 v5, v4, 7, s30
    v_lshrrev_b32 v6, 1, v4
    v_xor_b32 v6, v6, v3
    v_lshl_add_u32 v88, v6, 4, v5
    v_xor_b32 v6, 4, v6
    v_lshl_add_u32 v89, v6, 4, v5

    v_bfe_u32 v5, v1, 2, 2
    v_and_b32 v6, 3, v1
    v_lshl_add_u32 v7, v3, 3, v5
    v_lshrrev_b32 v2, 1, v5
    v_and_b32 v8, 1, v3
    v_lshl_or_b32 v2, v8, 1, v2
    v_mov_b32 v9, v7
    v_lshlrev_b32 v7, 7, v7
    v_lshl_add_u32 v7, v6, 3, v7
    s_mul_i32 s30, s29, 2
    s_add_u32 s30, s30, 0
    v_xor_b32 v8, s30, v2
    v_lshl_add_u32 v90, v8, 5, v7
    s_mul_i32 s30, s29, 0
    s_add_u32 s30, s30, 49152
    v_add_u32 v90, s30, v90
    s_mul_i32 s30, s29, 2
    s_add_u32 s30, s30, 1
    v_xor_b32 v8, s30, v2
    v_lshl_add_u32 v91, v8, 5, v7
    s_mul_i32 s30, s29, 0
    s_add_u32 s30, s30, 49152
    v_add_u32 v91, s30, v91
    s_mul_i32 s30, s29, 2
    s_add_u32 s30, s30, 0
    v_xor_b32 v8, s30, v2
    v_lshl_add_u32 v92, v8, 5, v7
    s_mul_i32 s30, s29, 0
    s_add_u32 s30, s30, 73728
    v_add_u32 v92, s30, v92
    s_mul_i32 s30, s29, 2
    s_add_u32 s30, s30, 1
    v_xor_b32 v8, s30, v2
    v_lshl_add_u32 v93, v8, 5, v7
    s_mul_i32 s30, s29, 0
    s_add_u32 s30, s30, 73728
    v_add_u32 v93, s30, v93
    s_mul_i32 s30, s29, 2
    s_add_u32 s30, s30, 0
    v_xor_b32 v8, s30, v2
    v_lshl_add_u32 v94, v8, 5, v7
    s_mul_i32 s30, s29, 0
    s_add_u32 s30, s30, 98304
    v_add_u32 v94, s30, v94
    s_mul_i32 s30, s29, 2
    s_add_u32 s30, s30, 1
    v_xor_b32 v8, s30, v2
    v_lshl_add_u32 v95, v8, 5, v7
    s_mul_i32 s30, s29, 0
    s_add_u32 s30, s30, 98304
    v_add_u32 v95, s30, v95
    v_mov_b64 v[96:97], 0
    v_mov_b64 v[98:99], 0
    v_mov_b64 v[100:101], 0
    v_mov_b64 v[102:103], 0
    v_mov_b64 v[104:105], 0
    v_mov_b64 v[106:107], 0
    v_mov_b64 v[108:109], 0
    v_mov_b64 v[110:111], 0
    v_mov_b64 v[112:113], 0
    v_mov_b64 v[114:115], 0
    v_mov_b64 v[116:117], 0
    v_mov_b64 v[118:119], 0
    v_mov_b64 v[120:121], 0
    v_mov_b64 v[122:123], 0
    v_mov_b64 v[124:125], 0
    v_mov_b64 v[126:127], 0
    v_mov_b64 v[128:129], 0
    v_mov_b64 v[130:131], 0
    v_mov_b64 v[132:133], 0
    v_mov_b64 v[134:135], 0
    v_mov_b64 v[136:137], 0
    v_mov_b64 v[138:139], 0
    v_mov_b64 v[140:141], 0
    v_mov_b64 v[142:143], 0
    v_mov_b64 v[144:145], 0
    v_mov_b64 v[146:147], 0
    v_mov_b64 v[148:149], 0
    v_mov_b64 v[150:151], 0
    v_mov_b64 v[152:153], 0
    v_mov_b64 v[154:155], 0
    v_mov_b64 v[156:157], 0
    v_mov_b64 v[158:159], 0
    v_mov_b64 v[160:161], 0
    v_mov_b64 v[162:163], 0
    v_mov_b64 v[164:165], 0
    v_mov_b64 v[166:167], 0
    v_mov_b64 v[168:169], 0
    v_mov_b64 v[170:171], 0
    v_mov_b64 v[172:173], 0
    v_mov_b64 v[174:175], 0
    v_mov_b64 v[176:177], 0
    v_mov_b64 v[178:179], 0
    v_mov_b64 v[180:181], 0
    v_mov_b64 v[182:183], 0
    v_mov_b64 v[184:185], 0
    v_mov_b64 v[186:187], 0
    v_mov_b64 v[188:189], 0
    v_mov_b64 v[190:191], 0
    s_add_u32 s33, s100, 0

    s_lshl_b32 s30, s29, 13
    s_add_u32 s33, s33, s30
    s_lshl_b32 s30, s28, 12
    s_add_u32 s33, s33, s30
    s_add_u32 s34, s33, 16384
    s_lshl_b32 s31, s28, 2
    s_mul_i32 s35, s29, 24
    s_add_u32 s35, s35, s31
    s_add_u32 s35, s35, 16
    s_lshl_b32 s35, s35, 10
    s_lshl_b32 s36, s21, 11
    s_add_u32 s36, s36, 98304

    s_lshl_b32 s32, s25, 4
    s_add_u32 s32, s32, s24
    s_mul_i32 s32, s32, 4
    s_add_u32 s32, s32, s21
    s_lshl_b32 s32, s32, 2
    s_add_u32 s32, s32, 43909120
    s_barrier
    ds_read_b64_tr_b16 v[24:25], v90 offset:0
    ds_read_b64_tr_b16 v[26:27], v90 offset:512
    ds_read_b128 v[8:11], v88 offset:0
    ds_read_b128 v[12:15], v88 offset:2048
    ds_read_b128 v[16:19], v88 offset:4096
    ds_read_b128 v[20:23], v88 offset:6144
    ds_read_b64_tr_b16 v[28:29], v91 offset:0
    ds_read_b64_tr_b16 v[30:31], v91 offset:512
    ds_read_b64_tr_b16 v[32:33], v92 offset:0
    ds_read_b64_tr_b16 v[34:35], v92 offset:512
    ds_read_b64_tr_b16 v[36:37], v93 offset:0
    ds_read_b64_tr_b16 v[38:39], v93 offset:512
    ds_read_b64_tr_b16 v[40:41], v94 offset:0
    ds_read_b64_tr_b16 v[42:43], v94 offset:512
    ds_read_b64_tr_b16 v[44:45], v95 offset:0
    ds_read_b64_tr_b16 v[46:47], v95 offset:512
    s_mov_b32 s72, 5
qkv_cloop:
    s_waitcnt lgkmcnt(0)
    v_mfma_f32_16x16x32_bf16 v[96:99], v[24:27], v[8:11], v[96:99]
    ds_read_b64_tr_b16 v[64:65], v90 offset:4096
    v_mfma_f32_16x16x32_bf16 v[100:103], v[24:27], v[12:15], v[100:103]
    ds_read_b64_tr_b16 v[66:67], v90 offset:4608
    v_mfma_f32_16x16x32_bf16 v[104:107], v[24:27], v[16:19], v[104:107]
    ds_read_b128 v[48:51], v89 offset:0
    v_mfma_f32_16x16x32_bf16 v[108:111], v[24:27], v[20:23], v[108:111]
    ds_read_b128 v[52:55], v89 offset:2048
    v_mfma_f32_16x16x32_bf16 v[124:127], v[28:31], v[20:23], v[124:127]
    ds_read_b128 v[56:59], v89 offset:4096
    v_mfma_f32_16x16x32_bf16 v[120:123], v[28:31], v[16:19], v[120:123]
    ds_read_b128 v[60:63], v89 offset:6144
    v_mfma_f32_16x16x32_bf16 v[116:119], v[28:31], v[12:15], v[116:119]
    ds_read_b64_tr_b16 v[68:69], v91 offset:4096
    v_mfma_f32_16x16x32_bf16 v[112:115], v[28:31], v[8:11], v[112:115]
    ds_read_b64_tr_b16 v[70:71], v91 offset:4608
    v_mfma_f32_16x16x32_bf16 v[128:131], v[32:35], v[8:11], v[128:131]
    v_mfma_f32_16x16x32_bf16 v[132:135], v[32:35], v[12:15], v[132:135]
    ds_read_b64_tr_b16 v[72:73], v92 offset:4096
    v_mfma_f32_16x16x32_bf16 v[136:139], v[32:35], v[16:19], v[136:139]
    ds_read_b64_tr_b16 v[74:75], v92 offset:4608
    v_mfma_f32_16x16x32_bf16 v[140:143], v[32:35], v[20:23], v[140:143]
    ds_read_b64_tr_b16 v[76:77], v93 offset:4096
    v_mfma_f32_16x16x32_bf16 v[156:159], v[36:39], v[20:23], v[156:159]
    ds_read_b64_tr_b16 v[78:79], v93 offset:4608
    v_mfma_f32_16x16x32_bf16 v[152:155], v[36:39], v[16:19], v[152:155]
    ds_read_b64_tr_b16 v[80:81], v94 offset:4096
    v_mfma_f32_16x16x32_bf16 v[148:151], v[36:39], v[12:15], v[148:151]
    ds_read_b64_tr_b16 v[82:83], v94 offset:4608
    v_mfma_f32_16x16x32_bf16 v[144:147], v[36:39], v[8:11], v[144:147]
    ds_read_b64_tr_b16 v[84:85], v95 offset:4096
    v_mfma_f32_16x16x32_bf16 v[160:163], v[8:11], v[40:43], v[160:163]
    ds_read_b64_tr_b16 v[86:87], v95 offset:4608
    v_mfma_f32_16x16x32_bf16 v[164:167], v[12:15], v[40:43], v[164:167]
    v_mfma_f32_16x16x32_bf16 v[168:171], v[16:19], v[40:43], v[168:171]
    v_mfma_f32_16x16x32_bf16 v[172:175], v[20:23], v[40:43], v[172:175]
    v_mfma_f32_16x16x32_bf16 v[188:191], v[20:23], v[44:47], v[188:191]
    v_mfma_f32_16x16x32_bf16 v[184:187], v[16:19], v[44:47], v[184:187]
    v_mfma_f32_16x16x32_bf16 v[180:183], v[12:15], v[44:47], v[180:183]
    v_mfma_f32_16x16x32_bf16 v[176:179], v[8:11], v[44:47], v[176:179]
    s_waitcnt lgkmcnt(0)
    s_barrier
    v_mfma_f32_16x16x32_bf16 v[96:99], v[64:67], v[48:51], v[96:99]
    ds_read_b64_tr_b16 v[24:25], v90 offset:8192
    v_mfma_f32_16x16x32_bf16 v[100:103], v[64:67], v[52:55], v[100:103]
    ds_read_b64_tr_b16 v[26:27], v90 offset:8704
    v_mfma_f32_16x16x32_bf16 v[104:107], v[64:67], v[56:59], v[104:107]
    ds_read_b128 v[8:11], v88 offset:16384
    v_mfma_f32_16x16x32_bf16 v[108:111], v[64:67], v[60:63], v[108:111]
    ds_read_b128 v[12:15], v88 offset:18432
    v_mfma_f32_16x16x32_bf16 v[124:127], v[68:71], v[60:63], v[124:127]
    ds_read_b128 v[16:19], v88 offset:20480
    v_mfma_f32_16x16x32_bf16 v[120:123], v[68:71], v[56:59], v[120:123]
    ds_read_b128 v[20:23], v88 offset:22528
    v_mfma_f32_16x16x32_bf16 v[116:119], v[68:71], v[52:55], v[116:119]
    ds_read_b64_tr_b16 v[28:29], v91 offset:8192
    v_mfma_f32_16x16x32_bf16 v[112:115], v[68:71], v[48:51], v[112:115]
    ds_read_b64_tr_b16 v[30:31], v91 offset:8704
    v_mfma_f32_16x16x32_bf16 v[128:131], v[72:75], v[48:51], v[128:131]
    v_mfma_f32_16x16x32_bf16 v[132:135], v[72:75], v[52:55], v[132:135]
    ds_read_b64_tr_b16 v[32:33], v92 offset:8192
    v_mfma_f32_16x16x32_bf16 v[136:139], v[72:75], v[56:59], v[136:139]
    ds_read_b64_tr_b16 v[34:35], v92 offset:8704
    v_mfma_f32_16x16x32_bf16 v[140:143], v[72:75], v[60:63], v[140:143]
    ds_read_b64_tr_b16 v[36:37], v93 offset:8192
    v_mfma_f32_16x16x32_bf16 v[156:159], v[76:79], v[60:63], v[156:159]
    ds_read_b64_tr_b16 v[38:39], v93 offset:8704
    v_mfma_f32_16x16x32_bf16 v[152:155], v[76:79], v[56:59], v[152:155]
    ds_read_b64_tr_b16 v[40:41], v94 offset:8192
    v_mfma_f32_16x16x32_bf16 v[148:151], v[76:79], v[52:55], v[148:151]
    ds_read_b64_tr_b16 v[42:43], v94 offset:8704
    v_mfma_f32_16x16x32_bf16 v[144:147], v[76:79], v[48:51], v[144:147]
    ds_read_b64_tr_b16 v[44:45], v95 offset:8192
    v_mfma_f32_16x16x32_bf16 v[160:163], v[48:51], v[80:83], v[160:163]
    ds_read_b64_tr_b16 v[46:47], v95 offset:8704
    v_mfma_f32_16x16x32_bf16 v[164:167], v[52:55], v[80:83], v[164:167]
    v_mfma_f32_16x16x32_bf16 v[168:171], v[56:59], v[80:83], v[168:171]
    v_mfma_f32_16x16x32_bf16 v[172:175], v[60:63], v[80:83], v[172:175]
    v_mfma_f32_16x16x32_bf16 v[188:191], v[60:63], v[84:87], v[188:191]
    v_mfma_f32_16x16x32_bf16 v[184:187], v[56:59], v[84:87], v[184:187]
    v_mfma_f32_16x16x32_bf16 v[180:183], v[52:55], v[84:87], v[180:183]
    v_mfma_f32_16x16x32_bf16 v[176:179], v[48:51], v[84:87], v[176:179]
    s_waitcnt lgkmcnt(0)
    v_mfma_f32_16x16x32_bf16 v[96:99], v[24:27], v[8:11], v[96:99]
    ds_read_b64_tr_b16 v[64:65], v90 offset:12288
    v_mfma_f32_16x16x32_bf16 v[100:103], v[24:27], v[12:15], v[100:103]
    ds_read_b64_tr_b16 v[66:67], v90 offset:12800
    v_mfma_f32_16x16x32_bf16 v[104:107], v[24:27], v[16:19], v[104:107]
    ds_read_b128 v[48:51], v89 offset:16384
    v_mfma_f32_16x16x32_bf16 v[108:111], v[24:27], v[20:23], v[108:111]
    ds_read_b128 v[52:55], v89 offset:18432
    v_mfma_f32_16x16x32_bf16 v[124:127], v[28:31], v[20:23], v[124:127]
    ds_read_b128 v[56:59], v89 offset:20480
    v_mfma_f32_16x16x32_bf16 v[120:123], v[28:31], v[16:19], v[120:123]
    ds_read_b128 v[60:63], v89 offset:22528
    v_mfma_f32_16x16x32_bf16 v[116:119], v[28:31], v[12:15], v[116:119]
    ds_read_b64_tr_b16 v[68:69], v91 offset:12288
    v_mfma_f32_16x16x32_bf16 v[112:115], v[28:31], v[8:11], v[112:115]
    ds_read_b64_tr_b16 v[70:71], v91 offset:12800
    v_mfma_f32_16x16x32_bf16 v[128:131], v[32:35], v[8:11], v[128:131]
    v_mfma_f32_16x16x32_bf16 v[132:135], v[32:35], v[12:15], v[132:135]
    ds_read_b64_tr_b16 v[72:73], v92 offset:12288
    v_mfma_f32_16x16x32_bf16 v[136:139], v[32:35], v[16:19], v[136:139]
    ds_read_b64_tr_b16 v[74:75], v92 offset:12800
    v_mfma_f32_16x16x32_bf16 v[140:143], v[32:35], v[20:23], v[140:143]
    ds_read_b64_tr_b16 v[76:77], v93 offset:12288
    v_mfma_f32_16x16x32_bf16 v[156:159], v[36:39], v[20:23], v[156:159]
    ds_read_b64_tr_b16 v[78:79], v93 offset:12800
    v_mfma_f32_16x16x32_bf16 v[152:155], v[36:39], v[16:19], v[152:155]
    ds_read_b64_tr_b16 v[80:81], v94 offset:12288
    v_mfma_f32_16x16x32_bf16 v[148:151], v[36:39], v[12:15], v[148:151]
    ds_read_b64_tr_b16 v[82:83], v94 offset:12800
    v_mfma_f32_16x16x32_bf16 v[144:147], v[36:39], v[8:11], v[144:147]
    ds_read_b64_tr_b16 v[84:85], v95 offset:12288
    v_mfma_f32_16x16x32_bf16 v[160:163], v[8:11], v[40:43], v[160:163]
    ds_read_b64_tr_b16 v[86:87], v95 offset:12800
    v_mfma_f32_16x16x32_bf16 v[164:167], v[12:15], v[40:43], v[164:167]
    v_mfma_f32_16x16x32_bf16 v[168:171], v[16:19], v[40:43], v[168:171]
    v_mfma_f32_16x16x32_bf16 v[172:175], v[20:23], v[40:43], v[172:175]
    v_mfma_f32_16x16x32_bf16 v[188:191], v[20:23], v[44:47], v[188:191]
    v_mfma_f32_16x16x32_bf16 v[184:187], v[16:19], v[44:47], v[184:187]
    v_mfma_f32_16x16x32_bf16 v[180:183], v[12:15], v[44:47], v[180:183]
    v_mfma_f32_16x16x32_bf16 v[176:179], v[8:11], v[44:47], v[176:179]
    s_waitcnt lgkmcnt(0)
    s_barrier
    v_mfma_f32_16x16x32_bf16 v[96:99], v[64:67], v[48:51], v[96:99]
    ds_read_b64_tr_b16 v[24:25], v90 offset:16384
    v_mfma_f32_16x16x32_bf16 v[100:103], v[64:67], v[52:55], v[100:103]
    ds_read_b64_tr_b16 v[26:27], v90 offset:16896
    v_mfma_f32_16x16x32_bf16 v[104:107], v[64:67], v[56:59], v[104:107]
    ds_read_b128 v[8:11], v88 offset:32768
    v_mfma_f32_16x16x32_bf16 v[108:111], v[64:67], v[60:63], v[108:111]
    ds_read_b128 v[12:15], v88 offset:34816
    v_mfma_f32_16x16x32_bf16 v[124:127], v[68:71], v[60:63], v[124:127]
    ds_read_b128 v[16:19], v88 offset:36864
    v_mfma_f32_16x16x32_bf16 v[120:123], v[68:71], v[56:59], v[120:123]
    ds_read_b128 v[20:23], v88 offset:38912
    v_mfma_f32_16x16x32_bf16 v[116:119], v[68:71], v[52:55], v[116:119]
    ds_read_b64_tr_b16 v[28:29], v91 offset:16384
    v_mfma_f32_16x16x32_bf16 v[112:115], v[68:71], v[48:51], v[112:115]
    ds_read_b64_tr_b16 v[30:31], v91 offset:16896
    v_mfma_f32_16x16x32_bf16 v[128:131], v[72:75], v[48:51], v[128:131]
    v_mfma_f32_16x16x32_bf16 v[132:135], v[72:75], v[52:55], v[132:135]
    ds_read_b64_tr_b16 v[32:33], v92 offset:16384
    v_mfma_f32_16x16x32_bf16 v[136:139], v[72:75], v[56:59], v[136:139]
    ds_read_b64_tr_b16 v[34:35], v92 offset:16896
    v_mfma_f32_16x16x32_bf16 v[140:143], v[72:75], v[60:63], v[140:143]
    ds_read_b64_tr_b16 v[36:37], v93 offset:16384
    v_mfma_f32_16x16x32_bf16 v[156:159], v[76:79], v[60:63], v[156:159]
    ds_read_b64_tr_b16 v[38:39], v93 offset:16896
    v_mfma_f32_16x16x32_bf16 v[152:155], v[76:79], v[56:59], v[152:155]
    ds_read_b64_tr_b16 v[40:41], v94 offset:16384
    v_mfma_f32_16x16x32_bf16 v[148:151], v[76:79], v[52:55], v[148:151]
    ds_read_b64_tr_b16 v[42:43], v94 offset:16896
    v_mfma_f32_16x16x32_bf16 v[144:147], v[76:79], v[48:51], v[144:147]
    ds_read_b64_tr_b16 v[44:45], v95 offset:16384
    v_mfma_f32_16x16x32_bf16 v[160:163], v[48:51], v[80:83], v[160:163]
    ds_read_b64_tr_b16 v[46:47], v95 offset:16896
    v_mfma_f32_16x16x32_bf16 v[164:167], v[52:55], v[80:83], v[164:167]
    v_mfma_f32_16x16x32_bf16 v[168:171], v[56:59], v[80:83], v[168:171]
    v_mfma_f32_16x16x32_bf16 v[172:175], v[60:63], v[80:83], v[172:175]
    v_mfma_f32_16x16x32_bf16 v[188:191], v[60:63], v[84:87], v[188:191]
    v_mfma_f32_16x16x32_bf16 v[184:187], v[56:59], v[84:87], v[184:187]
    v_mfma_f32_16x16x32_bf16 v[180:183], v[52:55], v[84:87], v[180:183]
    v_mfma_f32_16x16x32_bf16 v[176:179], v[48:51], v[84:87], v[176:179]
    s_waitcnt lgkmcnt(0)
    v_mfma_f32_16x16x32_bf16 v[96:99], v[24:27], v[8:11], v[96:99]
    ds_read_b64_tr_b16 v[64:65], v90 offset:20480
    v_mfma_f32_16x16x32_bf16 v[100:103], v[24:27], v[12:15], v[100:103]
    ds_read_b64_tr_b16 v[66:67], v90 offset:20992
    v_mfma_f32_16x16x32_bf16 v[104:107], v[24:27], v[16:19], v[104:107]
    ds_read_b128 v[48:51], v89 offset:32768
    v_mfma_f32_16x16x32_bf16 v[108:111], v[24:27], v[20:23], v[108:111]
    ds_read_b128 v[52:55], v89 offset:34816
    v_mfma_f32_16x16x32_bf16 v[124:127], v[28:31], v[20:23], v[124:127]
    ds_read_b128 v[56:59], v89 offset:36864
    v_mfma_f32_16x16x32_bf16 v[120:123], v[28:31], v[16:19], v[120:123]
    ds_read_b128 v[60:63], v89 offset:38912
    v_mfma_f32_16x16x32_bf16 v[116:119], v[28:31], v[12:15], v[116:119]
    ds_read_b64_tr_b16 v[68:69], v91 offset:20480
    v_mfma_f32_16x16x32_bf16 v[112:115], v[28:31], v[8:11], v[112:115]
    ds_read_b64_tr_b16 v[70:71], v91 offset:20992
    v_mfma_f32_16x16x32_bf16 v[128:131], v[32:35], v[8:11], v[128:131]
    v_mfma_f32_16x16x32_bf16 v[132:135], v[32:35], v[12:15], v[132:135]
    ds_read_b64_tr_b16 v[72:73], v92 offset:20480
    v_mfma_f32_16x16x32_bf16 v[136:139], v[32:35], v[16:19], v[136:139]
    ds_read_b64_tr_b16 v[74:75], v92 offset:20992
    v_mfma_f32_16x16x32_bf16 v[140:143], v[32:35], v[20:23], v[140:143]
    ds_read_b64_tr_b16 v[76:77], v93 offset:20480
    v_mfma_f32_16x16x32_bf16 v[156:159], v[36:39], v[20:23], v[156:159]
    ds_read_b64_tr_b16 v[78:79], v93 offset:20992
    v_mfma_f32_16x16x32_bf16 v[152:155], v[36:39], v[16:19], v[152:155]
    ds_read_b64_tr_b16 v[80:81], v94 offset:20480
    v_mfma_f32_16x16x32_bf16 v[148:151], v[36:39], v[12:15], v[148:151]
    ds_read_b64_tr_b16 v[82:83], v94 offset:20992
    v_mfma_f32_16x16x32_bf16 v[144:147], v[36:39], v[8:11], v[144:147]
    ds_read_b64_tr_b16 v[84:85], v95 offset:20480
    v_mfma_f32_16x16x32_bf16 v[160:163], v[8:11], v[40:43], v[160:163]
    ds_read_b64_tr_b16 v[86:87], v95 offset:20992
    v_mfma_f32_16x16x32_bf16 v[164:167], v[12:15], v[40:43], v[164:167]
    v_mfma_f32_16x16x32_bf16 v[168:171], v[16:19], v[40:43], v[168:171]
    v_mfma_f32_16x16x32_bf16 v[172:175], v[20:23], v[40:43], v[172:175]
    v_mfma_f32_16x16x32_bf16 v[188:191], v[20:23], v[44:47], v[188:191]
    v_mfma_f32_16x16x32_bf16 v[184:187], v[16:19], v[44:47], v[184:187]
    v_mfma_f32_16x16x32_bf16 v[180:183], v[12:15], v[44:47], v[180:183]
    v_mfma_f32_16x16x32_bf16 v[176:179], v[8:11], v[44:47], v[176:179]
    s_waitcnt lgkmcnt(0)
    s_barrier
    v_mfma_f32_16x16x32_bf16 v[96:99], v[64:67], v[48:51], v[96:99]
    ds_read_b64_tr_b16 v[24:25], v90 offset:0
    v_mfma_f32_16x16x32_bf16 v[100:103], v[64:67], v[52:55], v[100:103]
    ds_read_b64_tr_b16 v[26:27], v90 offset:512
    v_mfma_f32_16x16x32_bf16 v[104:107], v[64:67], v[56:59], v[104:107]
    ds_read_b128 v[8:11], v88 offset:0
    v_mfma_f32_16x16x32_bf16 v[108:111], v[64:67], v[60:63], v[108:111]
    ds_read_b128 v[12:15], v88 offset:2048
    v_mfma_f32_16x16x32_bf16 v[124:127], v[68:71], v[60:63], v[124:127]
    ds_read_b128 v[16:19], v88 offset:4096
    v_mfma_f32_16x16x32_bf16 v[120:123], v[68:71], v[56:59], v[120:123]
    ds_read_b128 v[20:23], v88 offset:6144
    v_mfma_f32_16x16x32_bf16 v[116:119], v[68:71], v[52:55], v[116:119]
    ds_read_b64_tr_b16 v[28:29], v91 offset:0
    v_mfma_f32_16x16x32_bf16 v[112:115], v[68:71], v[48:51], v[112:115]
    ds_read_b64_tr_b16 v[30:31], v91 offset:512
    v_mfma_f32_16x16x32_bf16 v[128:131], v[72:75], v[48:51], v[128:131]
    v_mfma_f32_16x16x32_bf16 v[132:135], v[72:75], v[52:55], v[132:135]
    ds_read_b64_tr_b16 v[32:33], v92 offset:0
    v_mfma_f32_16x16x32_bf16 v[136:139], v[72:75], v[56:59], v[136:139]
    ds_read_b64_tr_b16 v[34:35], v92 offset:512
    v_mfma_f32_16x16x32_bf16 v[140:143], v[72:75], v[60:63], v[140:143]
    ds_read_b64_tr_b16 v[36:37], v93 offset:0
    v_mfma_f32_16x16x32_bf16 v[156:159], v[76:79], v[60:63], v[156:159]
    ds_read_b64_tr_b16 v[38:39], v93 offset:512
    v_mfma_f32_16x16x32_bf16 v[152:155], v[76:79], v[56:59], v[152:155]
    ds_read_b64_tr_b16 v[40:41], v94 offset:0
    v_mfma_f32_16x16x32_bf16 v[148:151], v[76:79], v[52:55], v[148:151]
    ds_read_b64_tr_b16 v[42:43], v94 offset:512
    v_mfma_f32_16x16x32_bf16 v[144:147], v[76:79], v[48:51], v[144:147]
    ds_read_b64_tr_b16 v[44:45], v95 offset:0
    v_mfma_f32_16x16x32_bf16 v[160:163], v[48:51], v[80:83], v[160:163]
    ds_read_b64_tr_b16 v[46:47], v95 offset:512
    v_mfma_f32_16x16x32_bf16 v[164:167], v[52:55], v[80:83], v[164:167]
    v_mfma_f32_16x16x32_bf16 v[168:171], v[56:59], v[80:83], v[168:171]
    v_mfma_f32_16x16x32_bf16 v[172:175], v[60:63], v[80:83], v[172:175]
    v_mfma_f32_16x16x32_bf16 v[188:191], v[60:63], v[84:87], v[188:191]
    v_mfma_f32_16x16x32_bf16 v[184:187], v[56:59], v[84:87], v[184:187]
    v_mfma_f32_16x16x32_bf16 v[180:183], v[52:55], v[84:87], v[180:183]
    v_mfma_f32_16x16x32_bf16 v[176:179], v[48:51], v[84:87], v[176:179]
    s_sub_u32 s72, s72, 1
    s_cmp_lg_u32 s72, 0
    s_cbranch_scc1 qkv_cloop
    s_waitcnt lgkmcnt(0)
    v_mfma_f32_16x16x32_bf16 v[96:99], v[24:27], v[8:11], v[96:99]
    ds_read_b64_tr_b16 v[64:65], v90 offset:4096
    s_waitcnt vmcnt(0)
    v_mfma_f32_16x16x32_bf16 v[100:103], v[24:27], v[12:15], v[100:103]
    ds_read_b64_tr_b16 v[66:67], v90 offset:4608
    s_lshl_b32 s30, s28, 8
    v_mfma_f32_16x16x32_bf16 v[104:107], v[24:27], v[16:19], v[104:107]
    ds_read_b128 v[48:51], v89 offset:0
    s_add_u32 s30, s30, 157696
    v_mfma_f32_16x16x32_bf16 v[108:111], v[24:27], v[20:23], v[108:111]
    ds_read_b128 v[52:55], v89 offset:2048
    v_lshl_add_u32 v2, v4, 2, s30
    v_mfma_f32_16x16x32_bf16 v[124:127], v[28:31], v[20:23], v[124:127]
    ds_read_b128 v[56:59], v89 offset:4096
    v_lshl_add_u32 v5, v3, 4, s30
    v_mfma_f32_16x16x32_bf16 v[120:123], v[28:31], v[16:19], v[120:123]
    ds_read_b128 v[60:63], v89 offset:6144
    s_lshl_b32 s30, s29, 7
    v_mfma_f32_16x16x32_bf16 v[116:119], v[28:31], v[12:15], v[116:119]
    ds_read_b64_tr_b16 v[68:69], v91 offset:4096
    s_add_u32 s30, s30, 157696
    v_mfma_f32_16x16x32_bf16 v[112:115], v[28:31], v[8:11], v[112:115]
    ds_read_b64_tr_b16 v[70:71], v91 offset:4608
    v_lshl_add_u32 v6, v3, 4, s30
    v_mfma_f32_16x16x32_bf16 v[128:131], v[32:35], v[8:11], v[128:131]
    v_lshl_add_u32 v7, v4, 2, s30
    v_mfma_f32_16x16x32_bf16 v[132:135], v[32:35], v[12:15], v[132:135]
    ds_read_b64_tr_b16 v[72:73], v92 offset:4096
    v_mfma_f32_16x16x32_bf16 v[136:139], v[32:35], v[16:19], v[136:139]
    ds_read_b64_tr_b16 v[74:75], v92 offset:4608
    v_mfma_f32_16x16x32_bf16 v[140:143], v[32:35], v[20:23], v[140:143]
    ds_read_b64_tr_b16 v[76:77], v93 offset:4096
    v_mfma_f32_16x16x32_bf16 v[156:159], v[36:39], v[20:23], v[156:159]
    ds_read_b64_tr_b16 v[78:79], v93 offset:4608
    v_mfma_f32_16x16x32_bf16 v[152:155], v[36:39], v[16:19], v[152:155]
    ds_read_b64_tr_b16 v[80:81], v94 offset:4096
    v_mfma_f32_16x16x32_bf16 v[148:151], v[36:39], v[12:15], v[148:151]
    ds_read_b64_tr_b16 v[82:83], v94 offset:4608
    v_mfma_f32_16x16x32_bf16 v[144:147], v[36:39], v[8:11], v[144:147]
    ds_read_b64_tr_b16 v[84:85], v95 offset:4096
    v_mfma_f32_16x16x32_bf16 v[160:163], v[8:11], v[40:43], v[160:163]
    ds_read_b64_tr_b16 v[86:87], v95 offset:4608
    v_mfma_f32_16x16x32_bf16 v[164:167], v[12:15], v[40:43], v[164:167]
    v_mfma_f32_16x16x32_bf16 v[168:171], v[16:19], v[40:43], v[168:171]
    v_mfma_f32_16x16x32_bf16 v[172:175], v[20:23], v[40:43], v[172:175]
    v_mfma_f32_16x16x32_bf16 v[188:191], v[20:23], v[44:47], v[188:191]
    v_mfma_f32_16x16x32_bf16 v[184:187], v[16:19], v[44:47], v[184:187]
    v_mfma_f32_16x16x32_bf16 v[180:183], v[12:15], v[44:47], v[180:183]
    v_mfma_f32_16x16x32_bf16 v[176:179], v[8:11], v[44:47], v[176:179]
    s_waitcnt lgkmcnt(0)
    s_barrier
    v_mfma_f32_16x16x32_bf16 v[96:99], v[64:67], v[48:51], v[96:99]
    ds_read_b32 v192, v2 offset:0
    ds_read_b32 v193, v2 offset:512
    v_mfma_f32_16x16x32_bf16 v[100:103], v[64:67], v[52:55], v[100:103]
    ds_read_b32 v194, v2 offset:64
    v_mfma_f32_16x16x32_bf16 v[104:107], v[64:67], v[56:59], v[104:107]
    ds_read_b32 v195, v2 offset:576
    v_mfma_f32_16x16x32_bf16 v[108:111], v[64:67], v[60:63], v[108:111]
    ds_read_b32 v196, v2 offset:128
    ds_read_b32 v197, v2 offset:640
    v_mfma_f32_16x16x32_bf16 v[124:127], v[68:71], v[60:63], v[124:127]
    ds_read_b32 v198, v2 offset:192
    v_mfma_f32_16x16x32_bf16 v[120:123], v[68:71], v[56:59], v[120:123]
    ds_read_b32 v199, v2 offset:704
    v_mfma_f32_16x16x32_bf16 v[116:119], v[68:71], v[52:55], v[116:119]
    ds_read_b128 v[208:211], v6 offset:1280
    v_mfma_f32_16x16x32_bf16 v[112:115], v[68:71], v[48:51], v[112:115]
    ds_read_b128 v[212:215], v6 offset:1344
    ds_read_b128 v[200:203], v6 offset:1024
    v_mfma_f32_16x16x32_bf16 v[128:131], v[72:75], v[48:51], v[128:131]
    ds_read_b128 v[204:207], v6 offset:1088
    v_mfma_f32_16x16x32_bf16 v[132:135], v[72:75], v[52:55], v[132:135]
    ds_read_b128 v[216:219], v5 offset:0
    v_mfma_f32_16x16x32_bf16 v[136:139], v[72:75], v[56:59], v[136:139]
    ds_read_b128 v[232:235], v5 offset:512
    ds_read_b128 v[220:223], v5 offset:64
    v_mfma_f32_16x16x32_bf16 v[140:143], v[72:75], v[60:63], v[140:143]
    ds_read_b128 v[236:239], v5 offset:576
    v_mfma_f32_16x16x32_bf16 v[156:159], v[76:79], v[60:63], v[156:159]
    ds_read_b128 v[224:227], v5 offset:128
    v_mfma_f32_16x16x32_bf16 v[152:155], v[76:79], v[56:59], v[152:155]
    ds_read_b128 v[240:243], v5 offset:640
    v_mfma_f32_16x16x32_bf16 v[148:151], v[76:79], v[52:55], v[148:151]
    ds_read_b128 v[228:231], v5 offset:192
    ds_read_b128 v[244:247], v5 offset:704
    v_mfma_f32_16x16x32_bf16 v[144:147], v[76:79], v[48:51], v[144:147]
    ds_read_b32 v248, v7 offset:1536
    v_mfma_f32_16x16x32_bf16 v[160:163], v[48:51], v[80:83], v[160:163]
    ds_read_b32 v250, v7 offset:1600
    v_mfma_f32_16x16x32_bf16 v[164:167], v[52:55], v[80:83], v[164:167]
    ds_read_b32 v249, v253 offset:2048
    v_mfma_f32_16x16x32_bf16 v[168:171], v[56:59], v[80:83], v[168:171]
    v_mfma_f32_16x16x32_bf16 v[172:175], v[60:63], v[80:83], v[172:175]
    v_mfma_f32_16x16x32_bf16 v[188:191], v[60:63], v[84:87], v[188:191]
    v_mfma_f32_16x16x32_bf16 v[184:187], v[56:59], v[84:87], v[184:187]
    v_mfma_f32_16x16x32_bf16 v[180:183], v[52:55], v[84:87], v[180:183]
    v_mfma_f32_16x16x32_bf16 v[176:179], v[48:51], v[84:87], v[176:179]
    s_waitcnt lgkmcnt(0)
    v_readfirstlane_b32 s54, v249
    v_lshlrev_b32 v2, 4, v1
    v_add_u32 v5, s35, v2
    v_add_u32 v6, s36, v2
    s_lshr_b32 s30, s24, 1
    s_cmp_eq_u32 s30, 99
    s_cselect_b32 s55, 1, s54
    s_cmp_lg_u32 s55, 0
    s_cbranch_scc1 slowst_366
    v_pk_mul_f32 v[128:129], v[128:129], v[192:193] op_sel_hi:[1,0]
    v_pk_mul_f32 v[130:131], v[130:131], v[192:193] op_sel_hi:[1,0]
    v_pk_fma_f32 v[128:129], v[208:209], v[192:193], v[128:129] op_sel:[0,1,0] op_sel_hi:[1,1,1]
    v_pk_fma_f32 v[130:131], v[210:211], v[192:193], v[130:131] op_sel:[0,1,0] op_sel_hi:[1,1,1]
    v_pk_mul_f32 v[144:145], v[144:145], v[192:193] op_sel_hi:[1,0]
    v_pk_mul_f32 v[146:147], v[146:147], v[192:193] op_sel_hi:[1,0]
    v_pk_fma_f32 v[144:145], v[212:213], v[192:193], v[144:145] op_sel:[0,1,0] op_sel_hi:[1,1,1]
    v_pk_fma_f32 v[146:147], v[214:215], v[192:193], v[146:147] op_sel:[0,1,0] op_sel_hi:[1,1,1]
    v_cvt_pk_bf16_f32 v24, v128, v129
    v_cvt_pk_bf16_f32 v25, v130, v131
    v_cvt_pk_bf16_f32 v26, v144, v145
    v_cvt_pk_bf16_f32 v27, v146, v147
    buffer_store_dwordx4 v[24:27], v2, s[8:11], s33 offen offset:0 sc1
    v_pk_mul_f32 v[132:133], v[132:133], v[194:195] op_sel_hi:[1,0]
    v_pk_mul_f32 v[134:135], v[134:135], v[194:195] op_sel_hi:[1,0]
    v_pk_fma_f32 v[132:133], v[208:209], v[194:195], v[132:133] op_sel:[0,1,0] op_sel_hi:[1,1,1]
    v_pk_fma_f32 v[134:135], v[210:211], v[194:195], v[134:135] op_sel:[0,1,0] op_sel_hi:[1,1,1]
    v_pk_mul_f32 v[148:149], v[148:149], v[194:195] op_sel_hi:[1,0]
    v_pk_mul_f32 v[150:151], v[150:151], v[194:195] op_sel_hi:[1,0]
    v_pk_fma_f32 v[148:149], v[212:213], v[194:195], v[148:149] op_sel:[0,1,0] op_sel_hi:[1,1,1]
    v_pk_fma_f32 v[150:151], v[214:215], v[194:195], v[150:151] op_sel:[0,1,0] op_sel_hi:[1,1,1]
    v_cvt_pk_bf16_f32 v28, v132, v133
    v_cvt_pk_bf16_f32 v29, v134, v135
    v_cvt_pk_bf16_f32 v30, v148, v149
    v_cvt_pk_bf16_f32 v31, v150, v151
    buffer_store_dwordx4 v[28:31], v2, s[8:11], s33 offen offset:1024 sc1
    v_pk_mul_f32 v[136:137], v[136:137], v[196:197] op_sel_hi:[1,0]
    v_pk_mul_f32 v[138:139], v[138:139], v[196:197] op_sel_hi:[1,0]
    v_pk_fma_f32 v[136:137], v[208:209], v[196:197], v[136:137] op_sel:[0,1,0] op_sel_hi:[1,1,1]
    v_pk_fma_f32 v[138:139], v[210:211], v[196:197], v[138:139] op_sel:[0,1,0] op_sel_hi:[1,1,1]
    v_pk_mul_f32 v[152:153], v[152:153], v[196:197] op_sel_hi:[1,0]
    v_pk_mul_f32 v[154:155], v[154:155], v[196:197] op_sel_hi:[1,0]
    v_pk_fma_f32 v[152:153], v[212:213], v[196:197], v[152:153] op_sel:[0,1,0] op_sel_hi:[1,1,1]
    v_pk_fma_f32 v[154:155], v[214:215], v[196:197], v[154:155] op_sel:[0,1,0] op_sel_hi:[1,1,1]
    v_cvt_pk_bf16_f32 v32, v136, v137
    v_cvt_pk_bf16_f32 v33, v138, v139
    v_cvt_pk_bf16_f32 v34, v152, v153
    v_cvt_pk_bf16_f32 v35, v154, v155
    buffer_store_dwordx4 v[32:35], v2, s[8:11], s33 offen offset:2048 sc1
    v_pk_mul_f32 v[140:141], v[140:141], v[198:199] op_sel_hi:[1,0]
    v_pk_mul_f32 v[142:143], v[142:143], v[198:199] op_sel_hi:[1,0]
    v_pk_fma_f32 v[140:141], v[208:209], v[198:199], v[140:141] op_sel:[0,1,0] op_sel_hi:[1,1,1]
    v_pk_fma_f32 v[142:143], v[210:211], v[198:199], v[142:143] op_sel:[0,1,0] op_sel_hi:[1,1,1]
    v_pk_mul_f32 v[156:157], v[156:157], v[198:199] op_sel_hi:[1,0]
    v_pk_mul_f32 v[158:159], v[158:159], v[198:199] op_sel_hi:[1,0]
    v_pk_fma_f32 v[156:157], v[212:213], v[198:199], v[156:157] op_sel:[0,1,0] op_sel_hi:[1,1,1]
    v_pk_fma_f32 v[158:159], v[214:215], v[198:199], v[158:159] op_sel:[0,1,0] op_sel_hi:[1,1,1]
    v_cvt_pk_bf16_f32 v36, v140, v141
    v_cvt_pk_bf16_f32 v37, v142, v143
    v_cvt_pk_bf16_f32 v38, v156, v157
    v_cvt_pk_bf16_f32 v39, v158, v159
    buffer_store_dwordx4 v[36:39], v2, s[8:11], s33 offen offset:3072 sc1
    v_pk_mul_f32 v[160:161], v[160:161], v[216:217]
    v_pk_mul_f32 v[162:163], v[162:163], v[218:219]
    v_pk_fma_f32 v[160:161], v[232:233], v[248:249], v[160:161] op_sel_hi:[1,0,1]
    v_pk_fma_f32 v[162:163], v[234:235], v[248:249], v[162:163] op_sel_hi:[1,0,1]
    v_pk_mul_f32 v[164:165], v[164:165], v[220:221]
    v_pk_mul_f32 v[166:167], v[166:167], v[222:223]
    v_pk_fma_f32 v[164:165], v[236:237], v[248:249], v[164:165] op_sel_hi:[1,0,1]
    v_pk_fma_f32 v[166:167], v[238:239], v[248:249], v[166:167] op_sel_hi:[1,0,1]
    v_cvt_pk_bf16_f32 v40, v160, v161
    v_cvt_pk_bf16_f32 v41, v162, v163
    v_cvt_pk_bf16_f32 v42, v164, v165
    v_cvt_pk_bf16_f32 v43, v166, v167
    buffer_store_dwordx4 v[40:43], v2, s[8:11], s34 offen offset:0 sc1
    v_pk_mul_f32 v[176:177], v[176:177], v[216:217]
    v_pk_mul_f32 v[178:179], v[178:179], v[218:219]
    v_pk_fma_f32 v[176:177], v[232:233], v[250:251], v[176:177] op_sel_hi:[1,0,1]
    v_pk_fma_f32 v[178:179], v[234:235], v[250:251], v[178:179] op_sel_hi:[1,0,1]
    v_pk_mul_f32 v[180:181], v[180:181], v[220:221]
    v_pk_mul_f32 v[182:183], v[182:183], v[222:223]
    v_pk_fma_f32 v[180:181], v[236:237], v[250:251], v[180:181] op_sel_hi:[1,0,1]
    v_pk_fma_f32 v[182:183], v[238:239], v[250:251], v[182:183] op_sel_hi:[1,0,1]
    v_cvt_pk_bf16_f32 v44, v176, v177
    v_cvt_pk_bf16_f32 v45, v178, v179
    v_cvt_pk_bf16_f32 v46, v180, v181
    v_cvt_pk_bf16_f32 v47, v182, v183
    buffer_store_dwordx4 v[44:47], v2, s[8:11], s34 offen offset:1024 sc1
    v_pk_mul_f32 v[168:169], v[168:169], v[224:225]
    v_pk_mul_f32 v[170:171], v[170:171], v[226:227]
    v_pk_fma_f32 v[168:169], v[240:241], v[248:249], v[168:169] op_sel_hi:[1,0,1]
    v_pk_fma_f32 v[170:171], v[242:243], v[248:249], v[170:171] op_sel_hi:[1,0,1]
    v_pk_mul_f32 v[172:173], v[172:173], v[228:229]
    v_pk_mul_f32 v[174:175], v[174:175], v[230:231]
    v_pk_fma_f32 v[172:173], v[244:245], v[248:249], v[172:173] op_sel_hi:[1,0,1]
    v_pk_fma_f32 v[174:175], v[246:247], v[248:249], v[174:175] op_sel_hi:[1,0,1]
    v_cvt_pk_bf16_f32 v48, v168, v169
    v_cvt_pk_bf16_f32 v49, v170, v171
    v_cvt_pk_bf16_f32 v50, v172, v173
    v_cvt_pk_bf16_f32 v51, v174, v175
    buffer_store_dwordx4 v[48:51], v2, s[8:11], s34 offen offset:2048 sc1
    v_pk_mul_f32 v[184:185], v[184:185], v[224:225]
    v_pk_mul_f32 v[186:187], v[186:187], v[226:227]
    v_pk_fma_f32 v[184:185], v[240:241], v[250:251], v[184:185] op_sel_hi:[1,0,1]
    v_pk_fma_f32 v[186:187], v[242:243], v[250:251], v[186:187] op_sel_hi:[1,0,1]
    v_pk_mul_f32 v[188:189], v[188:189], v[228:229]
    v_pk_mul_f32 v[190:191], v[190:191], v[230:231]
    v_pk_fma_f32 v[188:189], v[244:245], v[250:251], v[188:189] op_sel_hi:[1,0,1]
    v_pk_fma_f32 v[190:191], v[246:247], v[250:251], v[190:191] op_sel_hi:[1,0,1]
    v_cvt_pk_bf16_f32 v52, v184, v185
    v_cvt_pk_bf16_f32 v53, v186, v187
    v_cvt_pk_bf16_f32 v54, v188, v189
    v_cvt_pk_bf16_f32 v55, v190, v191
    buffer_store_dwordx4 v[52:55], v2, s[8:11], s34 offen offset:3072 sc1
    s_waitcnt vmcnt(4)
    v_mov_b32 v64, 0
    v_mov_b32 v65, 1
    s_mov_b64 exec, 1
    buffer_store_dword v65, v64, s[8:11], s32 offen
    s_mov_b64 exec, -1
    ds_write_b128 v5, v[24:27] offset:0
    ds_write_b128 v5, v[28:31] offset:1024
    ds_write_b128 v5, v[32:35] offset:2048
    ds_write_b128 v5, v[36:39] offset:3072
    ds_write_b128 v5, v[40:43] offset:49152
    ds_write_b128 v5, v[44:47] offset:50176
    ds_write_b128 v5, v[48:51] offset:51200
    ds_write_b128 v5, v[52:55] offset:52224
    v_pk_mul_f32 v[104:105], v[104:105], v[196:197] op_sel_hi:[1,0]
    v_pk_mul_f32 v[106:107], v[106:107], v[196:197] op_sel_hi:[1,0]
    v_pk_fma_f32 v[104:105], v[200:201], v[196:197], v[104:105] op_sel:[0,1,0] op_sel_hi:[1,1,1]
    v_pk_fma_f32 v[106:107], v[202:203], v[196:197], v[106:107] op_sel:[0,1,0] op_sel_hi:[1,1,1]
    v_pk_mul_f32 v[120:121], v[120:121], v[196:197] op_sel_hi:[1,0]
    v_pk_mul_f32 v[122:123], v[122:123], v[196:197] op_sel_hi:[1,0]
    v_pk_fma_f32 v[120:121], v[204:205], v[196:197], v[120:121] op_sel:[0,1,0] op_sel_hi:[1,1,1]
    v_pk_fma_f32 v[122:123], v[206:207], v[196:197], v[122:123] op_sel:[0,1,0] op_sel_hi:[1,1,1]
    v_cvt_pk_bf16_f32 v16, v104, v105
    v_cvt_pk_bf16_f32 v17, v106, v107
    v_cvt_pk_bf16_f32 v18, v120, v121
    v_cvt_pk_bf16_f32 v19, v122, v123
    ds_write_b128 v6, v[16:19] offset:0
    v_pk_mul_f32 v[108:109], v[108:109], v[198:199] op_sel_hi:[1,0]
    v_pk_mul_f32 v[110:111], v[110:111], v[198:199] op_sel_hi:[1,0]
    v_pk_fma_f32 v[108:109], v[200:201], v[198:199], v[108:109] op_sel:[0,1,0] op_sel_hi:[1,1,1]
    v_pk_fma_f32 v[110:111], v[202:203], v[198:199], v[110:111] op_sel:[0,1,0] op_sel_hi:[1,1,1]
    v_pk_mul_f32 v[124:125], v[124:125], v[198:199] op_sel_hi:[1,0]
    v_pk_mul_f32 v[126:127], v[126:127], v[198:199] op_sel_hi:[1,0]
    v_pk_fma_f32 v[124:125], v[204:205], v[198:199], v[124:125] op_sel:[0,1,0] op_sel_hi:[1,1,1]
    v_pk_fma_f32 v[126:127], v[206:207], v[198:199], v[126:127] op_sel:[0,1,0] op_sel_hi:[1,1,1]
    v_cvt_pk_bf16_f32 v20, v108, v109
    v_cvt_pk_bf16_f32 v21, v110, v111
    v_cvt_pk_bf16_f32 v22, v124, v125
    v_cvt_pk_bf16_f32 v23, v126, v127
    ds_write_b128 v6, v[20:23] offset:1024
    v_pk_mul_f32 v[96:97], v[96:97], v[192:193] op_sel_hi:[1,0]
    v_pk_mul_f32 v[98:99], v[98:99], v[192:193] op_sel_hi:[1,0]
    v_pk_fma_f32 v[96:97], v[200:201], v[192:193], v[96:97] op_sel:[0,1,0] op_sel_hi:[1,1,1]
    v_pk_fma_f32 v[98:99], v[202:203], v[192:193], v[98:99] op_sel:[0,1,0] op_sel_hi:[1,1,1]
    v_pk_mul_f32 v[112:113], v[112:113], v[192:193] op_sel_hi:[1,0]
    v_pk_mul_f32 v[114:115], v[114:115], v[192:193] op_sel_hi:[1,0]
    v_pk_fma_f32 v[112:113], v[204:205], v[192:193], v[112:113] op_sel:[0,1,0] op_sel_hi:[1,1,1]
    v_pk_fma_f32 v[114:115], v[206:207], v[192:193], v[114:115] op_sel:[0,1,0] op_sel_hi:[1,1,1]
    v_cvt_pk_bf16_f32 v8, v96, v97
    v_cvt_pk_bf16_f32 v9, v98, v99
    v_cvt_pk_bf16_f32 v10, v112, v113
    v_cvt_pk_bf16_f32 v11, v114, v115
    v_pk_mul_f32 v[100:101], v[100:101], v[194:195] op_sel_hi:[1,0]
    v_pk_mul_f32 v[102:103], v[102:103], v[194:195] op_sel_hi:[1,0]
    v_pk_fma_f32 v[100:101], v[200:201], v[194:195], v[100:101] op_sel:[0,1,0] op_sel_hi:[1,1,1]
    v_pk_fma_f32 v[102:103], v[202:203], v[194:195], v[102:103] op_sel:[0,1,0] op_sel_hi:[1,1,1]
    v_pk_mul_f32 v[116:117], v[116:117], v[194:195] op_sel_hi:[1,0]
    v_pk_mul_f32 v[118:119], v[118:119], v[194:195] op_sel_hi:[1,0]
    v_pk_fma_f32 v[116:117], v[204:205], v[194:195], v[116:117] op_sel:[0,1,0] op_sel_hi:[1,1,1]
    v_pk_fma_f32 v[118:119], v[206:207], v[194:195], v[118:119] op_sel:[0,1,0] op_sel_hi:[1,1,1]
    v_cvt_pk_bf16_f32 v12, v100, v101
    v_cvt_pk_bf16_f32 v13, v102, v103
    v_cvt_pk_bf16_f32 v14, v116, v117
    v_cvt_pk_bf16_f32 v15, v118, v119
    s_waitcnt vmcnt(0)
    v_mov_b32 v64, 0
    v_mov_b32 v65, 3
    s_mov_b64 exec, 1
    buffer_store_dword v65, v64, s[8:11], s32 offen
    s_mov_b64 exec, -1
    s_branch stx_367
slowst_366:
    v_pk_mul_f32 v[128:129], v[128:129], v[192:193] op_sel_hi:[1,0]
    v_pk_mul_f32 v[130:131], v[130:131], v[192:193] op_sel_hi:[1,0]
    v_pk_fma_f32 v[128:129], v[208:209], v[192:193], v[128:129] op_sel:[0,1,0] op_sel_hi:[1,1,1]
    v_pk_fma_f32 v[130:131], v[210:211], v[192:193], v[130:131] op_sel:[0,1,0] op_sel_hi:[1,1,1]
    v_pk_mul_f32 v[144:145], v[144:145], v[192:193] op_sel_hi:[1,0]
    v_pk_mul_f32 v[146:147], v[146:147], v[192:193] op_sel_hi:[1,0]
    v_pk_fma_f32 v[144:145], v[212:213], v[192:193], v[144:145] op_sel:[0,1,0] op_sel_hi:[1,1,1]
    v_pk_fma_f32 v[146:147], v[214:215], v[192:193], v[146:147] op_sel:[0,1,0] op_sel_hi:[1,1,1]
    v_cvt_pk_bf16_f32 v24, v128, v129
    v_cvt_pk_bf16_f32 v25, v130, v131
    v_cvt_pk_bf16_f32 v26, v144, v145
    v_cvt_pk_bf16_f32 v27, v146, v147
    buffer_store_dwordx4 v[24:27], v2, s[8:11], s33 offen offset:0 sc1
    v_pk_mul_f32 v[132:133], v[132:133], v[194:195] op_sel_hi:[1,0]
    v_pk_mul_f32 v[134:135], v[134:135], v[194:195] op_sel_hi:[1,0]
    v_pk_fma_f32 v[132:133], v[208:209], v[194:195], v[132:133] op_sel:[0,1,0] op_sel_hi:[1,1,1]
    v_pk_fma_f32 v[134:135], v[210:211], v[194:195], v[134:135] op_sel:[0,1,0] op_sel_hi:[1,1,1]
    v_pk_mul_f32 v[148:149], v[148:149], v[194:195] op_sel_hi:[1,0]
    v_pk_mul_f32 v[150:151], v[150:151], v[194:195] op_sel_hi:[1,0]
    v_pk_fma_f32 v[148:149], v[212:213], v[194:195], v[148:149] op_sel:[0,1,0] op_sel_hi:[1,1,1]
    v_pk_fma_f32 v[150:151], v[214:215], v[194:195], v[150:151] op_sel:[0,1,0] op_sel_hi:[1,1,1]
    v_cvt_pk_bf16_f32 v28, v132, v133
    v_cvt_pk_bf16_f32 v29, v134, v135
    v_cvt_pk_bf16_f32 v30, v148, v149
    v_cvt_pk_bf16_f32 v31, v150, v151
    buffer_store_dwordx4 v[28:31], v2, s[8:11], s33 offen offset:1024 sc1
    v_pk_mul_f32 v[136:137], v[136:137], v[196:197] op_sel_hi:[1,0]
    v_pk_mul_f32 v[138:139], v[138:139], v[196:197] op_sel_hi:[1,0]
    v_pk_fma_f32 v[136:137], v[208:209], v[196:197], v[136:137] op_sel:[0,1,0] op_sel_hi:[1,1,1]
    v_pk_fma_f32 v[138:139], v[210:211], v[196:197], v[138:139] op_sel:[0,1,0] op_sel_hi:[1,1,1]
    v_pk_mul_f32 v[152:153], v[152:153], v[196:197] op_sel_hi:[1,0]
    v_pk_mul_f32 v[154:155], v[154:155], v[196:197] op_sel_hi:[1,0]
    v_pk_fma_f32 v[152:153], v[212:213], v[196:197], v[152:153] op_sel:[0,1,0] op_sel_hi:[1,1,1]
    v_pk_fma_f32 v[154:155], v[214:215], v[196:197], v[154:155] op_sel:[0,1,0] op_sel_hi:[1,1,1]
    v_cvt_pk_bf16_f32 v32, v136, v137
    v_cvt_pk_bf16_f32 v33, v138, v139
    v_cvt_pk_bf16_f32 v34, v152, v153
    v_cvt_pk_bf16_f32 v35, v154, v155
    buffer_store_dwordx4 v[32:35], v2, s[8:11], s33 offen offset:2048 sc1
    v_pk_mul_f32 v[140:141], v[140:141], v[198:199] op_sel_hi:[1,0]
    v_pk_mul_f32 v[142:143], v[142:143], v[198:199] op_sel_hi:[1,0]
    v_pk_fma_f32 v[140:141], v[208:209], v[198:199], v[140:141] op_sel:[0,1,0] op_sel_hi:[1,1,1]
    v_pk_fma_f32 v[142:143], v[210:211], v[198:199], v[142:143] op_sel:[0,1,0] op_sel_hi:[1,1,1]
    v_pk_mul_f32 v[156:157], v[156:157], v[198:199] op_sel_hi:[1,0]
    v_pk_mul_f32 v[158:159], v[158:159], v[198:199] op_sel_hi:[1,0]
    v_pk_fma_f32 v[156:157], v[212:213], v[198:199], v[156:157] op_sel:[0,1,0] op_sel_hi:[1,1,1]
    v_pk_fma_f32 v[158:159], v[214:215], v[198:199], v[158:159] op_sel:[0,1,0] op_sel_hi:[1,1,1]
    v_cvt_pk_bf16_f32 v36, v140, v141
    v_cvt_pk_bf16_f32 v37, v142, v143
    v_cvt_pk_bf16_f32 v38, v156, v157
    v_cvt_pk_bf16_f32 v39, v158, v159
    buffer_store_dwordx4 v[36:39], v2, s[8:11], s33 offen offset:3072 sc1
    v_pk_mul_f32 v[160:161], v[160:161], v[216:217]
    v_pk_mul_f32 v[162:163], v[162:163], v[218:219]
    v_pk_fma_f32 v[160:161], v[232:233], v[248:249], v[160:161] op_sel_hi:[1,0,1]
    v_pk_fma_f32 v[162:163], v[234:235], v[248:249], v[162:163] op_sel_hi:[1,0,1]
    v_pk_mul_f32 v[164:165], v[164:165], v[220:221]
    v_pk_mul_f32 v[166:167], v[166:167], v[222:223]
    v_pk_fma_f32 v[164:165], v[236:237], v[248:249], v[164:165] op_sel_hi:[1,0,1]
    v_pk_fma_f32 v[166:167], v[238:239], v[248:249], v[166:167] op_sel_hi:[1,0,1]
    v_cvt_pk_bf16_f32 v40, v160, v161
    v_cvt_pk_bf16_f32 v41, v162, v163
    v_cvt_pk_bf16_f32 v42, v164, v165
    v_cvt_pk_bf16_f32 v43, v166, v167
    buffer_store_dwordx4 v[40:43], v2, s[8:11], s34 offen offset:0 sc1
    v_pk_mul_f32 v[176:177], v[176:177], v[216:217]
    v_pk_mul_f32 v[178:179], v[178:179], v[218:219]
    v_pk_fma_f32 v[176:177], v[232:233], v[250:251], v[176:177] op_sel_hi:[1,0,1]
    v_pk_fma_f32 v[178:179], v[234:235], v[250:251], v[178:179] op_sel_hi:[1,0,1]
    v_pk_mul_f32 v[180:181], v[180:181], v[220:221]
    v_pk_mul_f32 v[182:183], v[182:183], v[222:223]
    v_pk_fma_f32 v[180:181], v[236:237], v[250:251], v[180:181] op_sel_hi:[1,0,1]
    v_pk_fma_f32 v[182:183], v[238:239], v[250:251], v[182:183] op_sel_hi:[1,0,1]
    v_cvt_pk_bf16_f32 v44, v176, v177
    v_cvt_pk_bf16_f32 v45, v178, v179
    v_cvt_pk_bf16_f32 v46, v180, v181
    v_cvt_pk_bf16_f32 v47, v182, v183
    buffer_store_dwordx4 v[44:47], v2, s[8:11], s34 offen offset:1024 sc1
    v_pk_mul_f32 v[168:169], v[168:169], v[224:225]
    v_pk_mul_f32 v[170:171], v[170:171], v[226:227]
    v_pk_fma_f32 v[168:169], v[240:241], v[248:249], v[168:169] op_sel_hi:[1,0,1]
    v_pk_fma_f32 v[170:171], v[242:243], v[248:249], v[170:171] op_sel_hi:[1,0,1]
    v_pk_mul_f32 v[172:173], v[172:173], v[228:229]
    v_pk_mul_f32 v[174:175], v[174:175], v[230:231]
    v_pk_fma_f32 v[172:173], v[244:245], v[248:249], v[172:173] op_sel_hi:[1,0,1]
    v_pk_fma_f32 v[174:175], v[246:247], v[248:249], v[174:175] op_sel_hi:[1,0,1]
    v_cvt_pk_bf16_f32 v48, v168, v169
    v_cvt_pk_bf16_f32 v49, v170, v171
    v_cvt_pk_bf16_f32 v50, v172, v173
    v_cvt_pk_bf16_f32 v51, v174, v175
    buffer_store_dwordx4 v[48:51], v2, s[8:11], s34 offen offset:2048 sc1
    v_pk_mul_f32 v[184:185], v[184:185], v[224:225]
    v_pk_mul_f32 v[186:187], v[186:187], v[226:227]
    v_pk_fma_f32 v[184:185], v[240:241], v[250:251], v[184:185] op_sel_hi:[1,0,1]
    v_pk_fma_f32 v[186:187], v[242:243], v[250:251], v[186:187] op_sel_hi:[1,0,1]
    v_pk_mul_f32 v[188:189], v[188:189], v[228:229]
    v_pk_mul_f32 v[190:191], v[190:191], v[230:231]
    v_pk_fma_f32 v[188:189], v[244:245], v[250:251], v[188:189] op_sel_hi:[1,0,1]
    v_pk_fma_f32 v[190:191], v[246:247], v[250:251], v[190:191] op_sel_hi:[1,0,1]
    v_cvt_pk_bf16_f32 v52, v184, v185
    v_cvt_pk_bf16_f32 v53, v186, v187
    v_cvt_pk_bf16_f32 v54, v188, v189
    v_cvt_pk_bf16_f32 v55, v190, v191
    buffer_store_dwordx4 v[52:55], v2, s[8:11], s34 offen offset:3072 sc1
    s_waitcnt vmcnt(4)
    v_mov_b32 v64, 0
    v_mov_b32 v65, 1
    s_mov_b64 exec, 1
    buffer_store_dword v65, v64, s[8:11], s32 offen sc1
    s_mov_b64 exec, -1
    ds_write_b128 v5, v[24:27] offset:0
    ds_write_b128 v5, v[28:31] offset:1024
    ds_write_b128 v5, v[32:35] offset:2048
    ds_write_b128 v5, v[36:39] offset:3072
    ds_write_b128 v5, v[40:43] offset:49152
    ds_write_b128 v5, v[44:47] offset:50176
    ds_write_b128 v5, v[48:51] offset:51200
    ds_write_b128 v5, v[52:55] offset:52224
    v_pk_mul_f32 v[104:105], v[104:105], v[196:197] op_sel_hi:[1,0]
    v_pk_mul_f32 v[106:107], v[106:107], v[196:197] op_sel_hi:[1,0]
    v_pk_fma_f32 v[104:105], v[200:201], v[196:197], v[104:105] op_sel:[0,1,0] op_sel_hi:[1,1,1]
    v_pk_fma_f32 v[106:107], v[202:203], v[196:197], v[106:107] op_sel:[0,1,0] op_sel_hi:[1,1,1]
    v_pk_mul_f32 v[120:121], v[120:121], v[196:197] op_sel_hi:[1,0]
    v_pk_mul_f32 v[122:123], v[122:123], v[196:197] op_sel_hi:[1,0]
    v_pk_fma_f32 v[120:121], v[204:205], v[196:197], v[120:121] op_sel:[0,1,0] op_sel_hi:[1,1,1]
    v_pk_fma_f32 v[122:123], v[206:207], v[196:197], v[122:123] op_sel:[0,1,0] op_sel_hi:[1,1,1]
    v_cvt_pk_bf16_f32 v16, v104, v105
    v_cvt_pk_bf16_f32 v17, v106, v107
    v_cvt_pk_bf16_f32 v18, v120, v121
    v_cvt_pk_bf16_f32 v19, v122, v123
    ds_write_b128 v6, v[16:19] offset:0
    v_pk_mul_f32 v[108:109], v[108:109], v[198:199] op_sel_hi:[1,0]
    v_pk_mul_f32 v[110:111], v[110:111], v[198:199] op_sel_hi:[1,0]
    v_pk_fma_f32 v[108:109], v[200:201], v[198:199], v[108:109] op_sel:[0,1,0] op_sel_hi:[1,1,1]
    v_pk_fma_f32 v[110:111], v[202:203], v[198:199], v[110:111] op_sel:[0,1,0] op_sel_hi:[1,1,1]
    v_pk_mul_f32 v[124:125], v[124:125], v[198:199] op_sel_hi:[1,0]
    v_pk_mul_f32 v[126:127], v[126:127], v[198:199] op_sel_hi:[1,0]
    v_pk_fma_f32 v[124:125], v[204:205], v[198:199], v[124:125] op_sel:[0,1,0] op_sel_hi:[1,1,1]
    v_pk_fma_f32 v[126:127], v[206:207], v[198:199], v[126:127] op_sel:[0,1,0] op_sel_hi:[1,1,1]
    v_cvt_pk_bf16_f32 v20, v108, v109
    v_cvt_pk_bf16_f32 v21, v110, v111
    v_cvt_pk_bf16_f32 v22, v124, v125
    v_cvt_pk_bf16_f32 v23, v126, v127
    ds_write_b128 v6, v[20:23] offset:1024
    v_pk_mul_f32 v[96:97], v[96:97], v[192:193] op_sel_hi:[1,0]
    v_pk_mul_f32 v[98:99], v[98:99], v[192:193] op_sel_hi:[1,0]
    v_pk_fma_f32 v[96:97], v[200:201], v[192:193], v[96:97] op_sel:[0,1,0] op_sel_hi:[1,1,1]
    v_pk_fma_f32 v[98:99], v[202:203], v[192:193], v[98:99] op_sel:[0,1,0] op_sel_hi:[1,1,1]
    v_pk_mul_f32 v[112:113], v[112:113], v[192:193] op_sel_hi:[1,0]
    v_pk_mul_f32 v[114:115], v[114:115], v[192:193] op_sel_hi:[1,0]
    v_pk_fma_f32 v[112:113], v[204:205], v[192:193], v[112:113] op_sel:[0,1,0] op_sel_hi:[1,1,1]
    v_pk_fma_f32 v[114:115], v[206:207], v[192:193], v[114:115] op_sel:[0,1,0] op_sel_hi:[1,1,1]
    v_cvt_pk_bf16_f32 v8, v96, v97
    v_cvt_pk_bf16_f32 v9, v98, v99
    v_cvt_pk_bf16_f32 v10, v112, v113
    v_cvt_pk_bf16_f32 v11, v114, v115
    v_pk_mul_f32 v[100:101], v[100:101], v[194:195] op_sel_hi:[1,0]
    v_pk_mul_f32 v[102:103], v[102:103], v[194:195] op_sel_hi:[1,0]
    v_pk_fma_f32 v[100:101], v[200:201], v[194:195], v[100:101] op_sel:[0,1,0] op_sel_hi:[1,1,1]
    v_pk_fma_f32 v[102:103], v[202:203], v[194:195], v[102:103] op_sel:[0,1,0] op_sel_hi:[1,1,1]
    v_pk_mul_f32 v[116:117], v[116:117], v[194:195] op_sel_hi:[1,0]
    v_pk_mul_f32 v[118:119], v[118:119], v[194:195] op_sel_hi:[1,0]
    v_pk_fma_f32 v[116:117], v[204:205], v[194:195], v[116:117] op_sel:[0,1,0] op_sel_hi:[1,1,1]
    v_pk_fma_f32 v[118:119], v[206:207], v[194:195], v[118:119] op_sel:[0,1,0] op_sel_hi:[1,1,1]
    v_cvt_pk_bf16_f32 v12, v100, v101
    v_cvt_pk_bf16_f32 v13, v102, v103
    v_cvt_pk_bf16_f32 v14, v116, v117
    v_cvt_pk_bf16_f32 v15, v118, v119
    s_waitcnt vmcnt(0)
    v_mov_b32 v64, 0
    v_mov_b32 v65, 3
    s_mov_b64 exec, 1
    buffer_store_dword v65, v64, s[8:11], s32 offen sc1
    s_mov_b64 exec, -1
stx_367:
    s_lshl_b32 s38, s28, 1
    v_lshlrev_b32 v5, 2, v3
    v_mov_b32 v6, 0xf149f2ca
    v_add_u32 v7, 0, v5
    v_cmp_gt_u32 vcc, v7, v4
    s_nop 1
    v_cndmask_b32_e64 v56, v6, 0, vcc
    v_cndmask_b32 v60, 0, v6, vcc
    v_add_u32 v7, 1, v5
    v_cmp_gt_u32 vcc, v7, v4
    s_nop 1
    v_cndmask_b32_e64 v57, v6, 0, vcc
    v_cndmask_b32 v61, 0, v6, vcc
    v_add_u32 v7, 2, v5
    v_cmp_gt_u32 vcc, v7, v4
    s_nop 1
    v_cndmask_b32_e64 v58, v6, 0, vcc
    v_cndmask_b32 v62, 0, v6, vcc
    v_add_u32 v7, 3, v5
    v_cmp_gt_u32 vcc, v7, v4
    s_nop 1
    v_cndmask_b32_e64 v59, v6, 0, vcc
    v_cndmask_b32 v63, 0, v6, vcc

    s_lshl_b32 s36, s24, 2
    s_add_u32 s36, s36, s38
    s_sub_i32 s36, 8, s36
    s_max_i32 s36, s36, 0
    s_mul_i32 s37, s29, 24
    s_lshl_b32 s39, s38, 1
    s_add_u32 s37, s37, s39
    s_lshl_b32 s37, s37, 10
    v_lshl_add_u32 v5, v1, 4, s37
    v_add_u32 v7, 49152, v5

    s_add_u32 s34, s100, 32768
    s_lshl_b32 s35, s38, 12
    s_add_u32 s34, s34, s35
    s_lshl_b32 s35, s29, 10
    s_add_u32 s34, s34, s35
    s_add_u32 s35, s34, 2048
    s_lshl_b32 s33, s24, 4
    s_add_u32 s33, s33, s25
    s_mul_i32 s33, s33, 32
    s_add_u32 s33, s33, s20
    s_lshl_b32 s33, s33, 2
    s_add_u32 s33, s33, 44302336
    s_waitcnt lgkmcnt(0)
    s_barrier
    ds_read_b128 v[24:27], v5 offset:0
    ds_read_b128 v[28:31], v5 offset:1024
    ds_read_b128 v[32:35], v5 offset:2048
    ds_read_b128 v[36:39], v5 offset:3072
    ds_read_b128 v[40:43], v5 offset:4096
    ds_read_b128 v[44:47], v5 offset:5120
    ds_read_b128 v[48:51], v5 offset:6144
    ds_read_b128 v[52:55], v5 offset:7168
    v_mov_b32 v16, 0x3f803f80
    v_mov_b32 v17, 0x3f803f80
    v_mov_b32 v18, 0x3f803f80
    v_mov_b32 v19, 0x3f803f80
    v_mov_b32 v232, v6
    v_mov_b32 v233, v6
    v_mov_b32 v234, v6
    v_mov_b32 v235, v6
    v_mov_b64 v[208:209], 0
    v_mov_b64 v[210:211], 0
    v_mov_b64 v[212:213], 0
    v_mov_b64 v[214:215], 0
    v_mov_b64 v[216:217], 0
    v_mov_b64 v[218:219], 0
    v_mov_b64 v[220:221], 0
    v_mov_b64 v[222:223], 0
    v_mov_b64 v[224:225], 0
    v_mov_b64 v[226:227], 0
    v_mov_b64 v[228:229], 0
    v_mov_b64 v[230:231], 0
    s_cmp_lg_u32 s36, 0
    s_cbranch_scc1 sgen_368
    s_waitcnt lgkmcnt(7)
    v_mfma_f32_16x16x32_bf16 v[64:67], v[24:27], v[8:11], v[56:59]
    ds_read_b128 v[24:27], v5 offset:8192
    s_waitcnt lgkmcnt(7)
    v_mfma_f32_16x16x32_bf16 v[68:71], v[28:31], v[8:11], 0
    v_mfma_f32_16x16x32_bf16 v[140:143], v[28:31], v[12:15], v[56:59]
    ds_read_b128 v[28:31], v5 offset:9216
    s_waitcnt lgkmcnt(7)
    v_mfma_f32_16x16x32_bf16 v[72:75], v[32:35], v[8:11], 0
    v_mfma_f32_16x16x32_bf16 v[144:147], v[32:35], v[12:15], 0
    v_max3_f32 v232, v64, v65, v232
    v_max3_f32 v233, v66, v67, v233
    ds_read_b128 v[32:35], v5 offset:10240
    s_waitcnt lgkmcnt(7)
    v_mfma_f32_16x16x32_bf16 v[76:79], v[36:39], v[8:11], 0
    v_max3_f32 v232, v68, v69, v232
    v_max3_f32 v233, v70, v71, v233
    v_mfma_f32_16x16x32_bf16 v[148:151], v[36:39], v[12:15], 0
    v_max3_f32 v234, v140, v141, v234
    v_max3_f32 v235, v142, v143, v235
    ds_read_b128 v[36:39], v5 offset:11264
    s_waitcnt lgkmcnt(7)
    v_mfma_f32_16x16x32_bf16 v[80:83], v[40:43], v[8:11], 0
    v_max3_f32 v232, v72, v73, v232
    v_max3_f32 v233, v74, v75, v233
    v_mfma_f32_16x16x32_bf16 v[152:155], v[40:43], v[12:15], 0
    v_max3_f32 v234, v144, v145, v234
    v_max3_f32 v235, v146, v147, v235
    ds_read_b128 v[40:43], v5 offset:12288
    s_waitcnt lgkmcnt(7)
    v_mfma_f32_16x16x32_bf16 v[84:87], v[44:47], v[8:11], 0
    v_max3_f32 v232, v76, v77, v232
    v_max3_f32 v233, v78, v79, v233
    v_mfma_f32_16x16x32_bf16 v[156:159], v[44:47], v[12:15], 0
    v_max3_f32 v234, v148, v149, v234
    v_max3_f32 v235, v150, v151, v235
    ds_read_b128 v[44:47], v5 offset:13312
    s_waitcnt lgkmcnt(7)
    v_mfma_f32_16x16x32_bf16 v[88:91], v[48:51], v[8:11], 0
    v_max3_f32 v232, v80, v81, v232
    v_max3_f32 v233, v82, v83, v233
    v_mfma_f32_16x16x32_bf16 v[160:163], v[48:51], v[12:15], 0
    v_max3_f32 v234, v152, v153, v234
    v_max3_f32 v235, v154, v155, v235
    ds_read_b128 v[48:51], v5 offset:14336
    s_waitcnt lgkmcnt(7)
    v_mfma_f32_16x16x32_bf16 v[92:95], v[52:55], v[8:11], 0
    v_max3_f32 v232, v84, v85, v232
    v_max3_f32 v233, v86, v87, v233
    v_mfma_f32_16x16x32_bf16 v[164:167], v[52:55], v[12:15], 0
    v_max3_f32 v234, v156, v157, v234
    v_max3_f32 v235, v158, v159, v235
    ds_read_b128 v[52:55], v5 offset:15360
    s_waitcnt lgkmcnt(7)
    v_mfma_f32_16x16x32_bf16 v[96:99], v[24:27], v[8:11], 0
    v_max3_f32 v232, v88, v89, v232
    v_max3_f32 v233, v90, v91, v233
    v_mfma_f32_16x16x32_bf16 v[168:171], v[24:27], v[12:15], 0
    v_max3_f32 v234, v160, v161, v234
    v_max3_f32 v235, v162, v163, v235
    ds_read_b128 v[24:27], v5 offset:16384
    s_waitcnt lgkmcnt(7)
    v_mfma_f32_16x16x32_bf16 v[100:103], v[28:31], v[8:11], 0
    v_max3_f32 v232, v92, v93, v232
    v_max3_f32 v233, v94, v95, v233
    v_mfma_f32_16x16x32_bf16 v[172:175], v[28:31], v[12:15], 0
    v_max3_f32 v234, v164, v165, v234
    v_max3_f32 v235, v166, v167, v235
    ds_read_b128 v[28:31], v5 offset:17408
    s_waitcnt lgkmcnt(7)
    v_mfma_f32_16x16x32_bf16 v[104:107], v[32:35], v[8:11], 0
    v_max3_f32 v232, v96, v97, v232
    v_max3_f32 v233, v98, v99, v233
    v_mfma_f32_16x16x32_bf16 v[176:179], v[32:35], v[12:15], 0
    v_max3_f32 v234, v168, v169, v234
    v_max3_f32 v235, v170, v171, v235
    s_waitcnt lgkmcnt(6)
    v_mfma_f32_16x16x32_bf16 v[108:111], v[36:39], v[8:11], 0
    v_max3_f32 v232, v100, v101, v232
    v_max3_f32 v233, v102, v103, v233
    v_mfma_f32_16x16x32_bf16 v[180:183], v[36:39], v[12:15], 0
    v_max3_f32 v234, v172, v173, v234
    v_max3_f32 v235, v174, v175, v235
    s_waitcnt lgkmcnt(5)
    v_mfma_f32_16x16x32_bf16 v[112:115], v[40:43], v[8:11], 0
    v_max3_f32 v232, v104, v105, v232
    v_max3_f32 v233, v106, v107, v233
    v_mfma_f32_16x16x32_bf16 v[184:187], v[40:43], v[12:15], 0
    v_max3_f32 v234, v176, v177, v234
    v_max3_f32 v235, v178, v179, v235
    s_waitcnt lgkmcnt(4)
    v_mfma_f32_16x16x32_bf16 v[116:119], v[44:47], v[8:11], 0
    v_max3_f32 v232, v108, v109, v232
    v_max3_f32 v233, v110, v111, v233
    v_mfma_f32_16x16x32_bf16 v[188:191], v[44:47], v[12:15], 0
    v_max3_f32 v234, v180, v181, v234
    v_max3_f32 v235, v182, v183, v235
    s_waitcnt lgkmcnt(3)
    v_mfma_f32_16x16x32_bf16 v[120:123], v[48:51], v[8:11], 0
    v_max3_f32 v232, v112, v113, v232
    v_max3_f32 v233, v114, v115, v233
    v_mfma_f32_16x16x32_bf16 v[192:195], v[48:51], v[12:15], 0
    v_max3_f32 v234, v184, v185, v234
    v_max3_f32 v235, v186, v187, v235
    s_waitcnt lgkmcnt(2)
    v_mfma_f32_16x16x32_bf16 v[124:127], v[52:55], v[8:11], 0
    v_max3_f32 v232, v116, v117, v232
    v_max3_f32 v233, v118, v119, v233
    v_mfma_f32_16x16x32_bf16 v[196:199], v[52:55], v[12:15], 0
    v_max3_f32 v234, v188, v189, v234
    v_max3_f32 v235, v190, v191, v235
    s_waitcnt lgkmcnt(1)
    v_mfma_f32_16x16x32_bf16 v[128:131], v[24:27], v[8:11], v[60:63]
    v_max3_f32 v232, v120, v121, v232
    v_max3_f32 v233, v122, v123, v233
    v_mfma_f32_16x16x32_bf16 v[200:203], v[24:27], v[12:15], 0
    v_max3_f32 v234, v192, v193, v234
    v_max3_f32 v235, v194, v195, v235
    s_waitcnt lgkmcnt(0)
    v_mfma_f32_16x16x32_bf16 v[204:207], v[28:31], v[12:15], v[60:63]
    v_max3_f32 v232, v124, v125, v232
    v_max3_f32 v233, v126, v127, v233
    v_max3_f32 v234, v196, v197, v234
    v_max3_f32 v235, v198, v199, v235
    v_max3_f32 v232, v128, v129, v232
    v_max3_f32 v233, v130, v131, v233
    v_max3_f32 v234, v200, v201, v234
    v_max3_f32 v235, v202, v203, v235
    v_max3_f32 v234, v204, v205, v234
    v_max3_f32 v235, v206, v207, v235
    s_branch sx_369
sgen_368:
    s_waitcnt lgkmcnt(7)
    s_cmp_gt_u32 s36, 0
    s_cselect_b32 s30, 0xf149f2ca, 0
    v_mov_b32 v20, s30
    v_mov_b32 v21, s30
    v_mov_b32 v22, s30
    v_mov_b32 v23, s30
    s_nop 1
    v_mfma_f32_16x16x32_bf16 v[64:67], v[24:27], v[8:11], v[20:23]
    ds_read_b128 v[24:27], v5 offset:8192
    s_waitcnt lgkmcnt(7)
    v_mfma_f32_16x16x32_bf16 v[68:71], v[28:31], v[8:11], v[20:23]
    v_mfma_f32_16x16x32_bf16 v[140:143], v[28:31], v[12:15], v[20:23]
    ds_read_b128 v[28:31], v5 offset:9216
    s_waitcnt lgkmcnt(7)
    s_cmp_gt_u32 s36, 1
    s_cselect_b32 s30, 0xf149f2ca, 0
    v_mov_b32 v20, s30
    v_mov_b32 v21, s30
    v_mov_b32 v22, s30
    v_mov_b32 v23, s30
    s_nop 1
    v_mfma_f32_16x16x32_bf16 v[72:75], v[32:35], v[8:11], v[20:23]
    v_mfma_f32_16x16x32_bf16 v[144:147], v[32:35], v[12:15], v[20:23]
    v_max3_f32 v232, v64, v65, v232
    v_max3_f32 v233, v66, v67, v233
    ds_read_b128 v[32:35], v5 offset:10240
    s_waitcnt lgkmcnt(7)
    v_mfma_f32_16x16x32_bf16 v[76:79], v[36:39], v[8:11], v[20:23]
    v_max3_f32 v232, v68, v69, v232
    v_max3_f32 v233, v70, v71, v233
    v_mfma_f32_16x16x32_bf16 v[148:151], v[36:39], v[12:15], v[20:23]
    v_max3_f32 v234, v140, v141, v234
    v_max3_f32 v235, v142, v143, v235
    ds_read_b128 v[36:39], v5 offset:11264
    s_waitcnt lgkmcnt(7)
    s_cmp_gt_u32 s36, 2
    s_cselect_b32 s30, 0xf149f2ca, 0
    v_mov_b32 v20, s30
    v_mov_b32 v21, s30
    v_mov_b32 v22, s30
    v_mov_b32 v23, s30
    s_nop 1
    v_mfma_f32_16x16x32_bf16 v[80:83], v[40:43], v[8:11], v[20:23]
    v_max3_f32 v232, v72, v73, v232
    v_max3_f32 v233, v74, v75, v233
    v_mfma_f32_16x16x32_bf16 v[152:155], v[40:43], v[12:15], v[20:23]
    v_max3_f32 v234, v144, v145, v234
    v_max3_f32 v235, v146, v147, v235
    ds_read_b128 v[40:43], v5 offset:12288
    s_waitcnt lgkmcnt(7)
    v_mfma_f32_16x16x32_bf16 v[84:87], v[44:47], v[8:11], v[20:23]
    v_max3_f32 v232, v76, v77, v232
    v_max3_f32 v233, v78, v79, v233
    v_mfma_f32_16x16x32_bf16 v[156:159], v[44:47], v[12:15], v[20:23]
    v_max3_f32 v234, v148, v149, v234
    v_max3_f32 v235, v150, v151, v235
    ds_read_b128 v[44:47], v5 offset:13312
    s_waitcnt lgkmcnt(7)
    s_cmp_gt_u32 s36, 3
    s_cselect_b32 s30, 0xf149f2ca, 0
    v_mov_b32 v20, s30
    v_mov_b32 v21, s30
    v_mov_b32 v22, s30
    v_mov_b32 v23, s30
    s_nop 1
    v_mfma_f32_16x16x32_bf16 v[88:91], v[48:51], v[8:11], v[20:23]
    v_max3_f32 v232, v80, v81, v232
    v_max3_f32 v233, v82, v83, v233
    v_mfma_f32_16x16x32_bf16 v[160:163], v[48:51], v[12:15], v[20:23]
    v_max3_f32 v234, v152, v153, v234
    v_max3_f32 v235, v154, v155, v235
    ds_read_b128 v[48:51], v5 offset:14336
    s_waitcnt lgkmcnt(7)
    v_mfma_f32_16x16x32_bf16 v[92:95], v[52:55], v[8:11], v[20:23]
    v_max3_f32 v232, v84, v85, v232
    v_max3_f32 v233, v86, v87, v233
    v_mfma_f32_16x16x32_bf16 v[164:167], v[52:55], v[12:15], v[20:23]
    v_max3_f32 v234, v156, v157, v234
    v_max3_f32 v235, v158, v159, v235
    ds_read_b128 v[52:55], v5 offset:15360
    s_waitcnt lgkmcnt(7)
    s_cmp_gt_u32 s36, 4
    s_cselect_b32 s30, 0xf149f2ca, 0
    v_mov_b32 v20, s30
    v_mov_b32 v21, s30
    v_mov_b32 v22, s30
    v_mov_b32 v23, s30
    s_nop 1
    v_mfma_f32_16x16x32_bf16 v[96:99], v[24:27], v[8:11], v[20:23]
    v_max3_f32 v232, v88, v89, v232
    v_max3_f32 v233, v90, v91, v233
    v_mfma_f32_16x16x32_bf16 v[168:171], v[24:27], v[12:15], v[20:23]
    v_max3_f32 v234, v160, v161, v234
    v_max3_f32 v235, v162, v163, v235
    ds_read_b128 v[24:27], v5 offset:16384
    s_waitcnt lgkmcnt(7)
    v_mfma_f32_16x16x32_bf16 v[100:103], v[28:31], v[8:11], v[20:23]
    v_max3_f32 v232, v92, v93, v232
    v_max3_f32 v233, v94, v95, v233
    v_mfma_f32_16x16x32_bf16 v[172:175], v[28:31], v[12:15], v[20:23]
    v_max3_f32 v234, v164, v165, v234
    v_max3_f32 v235, v166, v167, v235
    ds_read_b128 v[28:31], v5 offset:17408
    s_waitcnt lgkmcnt(7)
    s_cmp_gt_u32 s36, 5
    s_cselect_b32 s30, 0xf149f2ca, 0
    v_mov_b32 v20, s30
    v_mov_b32 v21, s30
    v_mov_b32 v22, s30
    v_mov_b32 v23, s30
    s_nop 1
    v_mfma_f32_16x16x32_bf16 v[104:107], v[32:35], v[8:11], v[20:23]
    v_max3_f32 v232, v96, v97, v232
    v_max3_f32 v233, v98, v99, v233
    v_mfma_f32_16x16x32_bf16 v[176:179], v[32:35], v[12:15], v[20:23]
    v_max3_f32 v234, v168, v169, v234
    v_max3_f32 v235, v170, v171, v235
    s_waitcnt lgkmcnt(6)
    v_mfma_f32_16x16x32_bf16 v[108:111], v[36:39], v[8:11], v[20:23]
    v_max3_f32 v232, v100, v101, v232
    v_max3_f32 v233, v102, v103, v233
    v_mfma_f32_16x16x32_bf16 v[180:183], v[36:39], v[12:15], v[20:23]
    v_max3_f32 v234, v172, v173, v234
    v_max3_f32 v235, v174, v175, v235
    s_waitcnt lgkmcnt(5)
    s_cmp_gt_u32 s36, 6
    s_cselect_b32 s30, 0xf149f2ca, 0
    v_mov_b32 v20, s30
    v_mov_b32 v21, s30
    v_mov_b32 v22, s30
    v_mov_b32 v23, s30
    s_nop 1
    v_mfma_f32_16x16x32_bf16 v[112:115], v[40:43], v[8:11], v[20:23]
    v_max3_f32 v232, v104, v105, v232
    v_max3_f32 v233, v106, v107, v233
    v_mfma_f32_16x16x32_bf16 v[184:187], v[40:43], v[12:15], v[20:23]
    v_max3_f32 v234, v176, v177, v234
    v_max3_f32 v235, v178, v179, v235
    s_waitcnt lgkmcnt(4)
    v_mfma_f32_16x16x32_bf16 v[116:119], v[44:47], v[8:11], v[20:23]
    v_max3_f32 v232, v108, v109, v232
    v_max3_f32 v233, v110, v111, v233
    v_mfma_f32_16x16x32_bf16 v[188:191], v[44:47], v[12:15], v[20:23]
    v_max3_f32 v234, v180, v181, v234
    v_max3_f32 v235, v182, v183, v235
    s_waitcnt lgkmcnt(3)
    s_cmp_gt_u32 s36, 7
    s_cselect_b32 s30, 0xf149f2ca, 0
    v_mov_b32 v20, s30
    v_mov_b32 v21, s30
    v_mov_b32 v22, s30
    v_mov_b32 v23, s30
    s_nop 1
    v_mfma_f32_16x16x32_bf16 v[120:123], v[48:51], v[8:11], v[20:23]
    v_max3_f32 v232, v112, v113, v232
    v_max3_f32 v233, v114, v115, v233
    v_mfma_f32_16x16x32_bf16 v[192:195], v[48:51], v[12:15], v[20:23]
    v_max3_f32 v234, v184, v185, v234
    v_max3_f32 v235, v186, v187, v235
    s_waitcnt lgkmcnt(2)
    v_mfma_f32_16x16x32_bf16 v[124:127], v[52:55], v[8:11], v[20:23]
    v_max3_f32 v232, v116, v117, v232
    v_max3_f32 v233, v118, v119, v233
    v_mfma_f32_16x16x32_bf16 v[196:199], v[52:55], v[12:15], v[20:23]
    v_max3_f32 v234, v188, v189, v234
    v_max3_f32 v235, v190, v191, v235
    s_waitcnt lgkmcnt(1)
    v_mfma_f32_16x16x32_bf16 v[128:131], v[24:27], v[8:11], v[60:63]
    v_max3_f32 v232, v120, v121, v232
    v_max3_f32 v233, v122, v123, v233
    v_mfma_f32_16x16x32_bf16 v[200:203], v[24:27], v[12:15], 0
    v_max3_f32 v234, v192, v193, v234
    v_max3_f32 v235, v194, v195, v235
    s_waitcnt lgkmcnt(0)
    v_mfma_f32_16x16x32_bf16 v[204:207], v[28:31], v[12:15], v[60:63]
    v_max3_f32 v232, v124, v125, v232
    v_max3_f32 v233, v126, v127, v233
    v_max3_f32 v234, v196, v197, v234
    v_max3_f32 v235, v198, v199, v235
    v_max3_f32 v232, v128, v129, v232
    v_max3_f32 v233, v130, v131, v233
    v_max3_f32 v234, v200, v201, v234
    v_max3_f32 v235, v202, v203, v235
    v_max3_f32 v234, v204, v205, v234
    v_max3_f32 v235, v206, v207, v235
sx_369:
    s_mov_b32 s74, 0x3e8293ee
    s_mov_b32 s75, 0x3e8293ee
    v_max_f32 v232, v232, v233
    v_max_f32 v234, v234, v235
    v_mov_b32 v233, v232
    v_mov_b32 v235, v234
    s_nop 0
    v_permlane16_swap_b32 v232, v233
    v_permlane16_swap_b32 v234, v235
    v_max_f32 v232, v232, v233
    v_max_f32 v234, v234, v235
    v_mov_b32 v233, v232
    v_mov_b32 v235, v234
    s_nop 0
    v_permlane32_swap_b32 v232, v233
    v_permlane32_swap_b32 v234, v235
    v_max_f32 v232, v232, v233
    v_max_f32 v234, v234, v235
    v_mul_f32 v232, 0xbe8293ee, v232
    v_mul_f32 v234, 0xbe8293ee, v234
    v_pk_fma_f32 v[64:65], v[64:65], s[74:75], v[232:233] op_sel_hi:[1,1,0]
    v_pk_fma_f32 v[66:67], v[66:67], s[74:75], v[232:233] op_sel_hi:[1,1,0]
    v_pk_fma_f32 v[68:69], v[68:69], s[74:75], v[232:233] op_sel_hi:[1,1,0]
    v_pk_fma_f32 v[70:71], v[70:71], s[74:75], v[232:233] op_sel_hi:[1,1,0]
    v_pk_fma_f32 v[140:141], v[140:141], s[74:75], v[234:235] op_sel_hi:[1,1,0]
    v_pk_fma_f32 v[142:143], v[142:143], s[74:75], v[234:235] op_sel_hi:[1,1,0]
    v_exp_f32 v64, v64
    v_exp_f32 v65, v65
    v_exp_f32 v66, v66
    v_exp_f32 v67, v67
    v_exp_f32 v68, v68
    v_exp_f32 v69, v69
    v_exp_f32 v70, v70
    v_exp_f32 v71, v71
    v_exp_f32 v140, v140
    v_exp_f32 v141, v141
    v_exp_f32 v142, v142
    v_exp_f32 v143, v143
    v_cvt_pk_bf16_f32 v64, v64, v65
    v_cvt_pk_bf16_f32 v65, v66, v67
    v_cvt_pk_bf16_f32 v66, v68, v69
    v_cvt_pk_bf16_f32 v67, v70, v71
    v_cvt_pk_bf16_f32 v138, v140, v141
    v_cvt_pk_bf16_f32 v139, v142, v143
    v_mov_b64 v[136:137], 0
    v_pk_fma_f32 v[72:73], v[72:73], s[74:75], v[232:233] op_sel_hi:[1,1,0]
    v_pk_fma_f32 v[74:75], v[74:75], s[74:75], v[232:233] op_sel_hi:[1,1,0]
    v_pk_fma_f32 v[76:77], v[76:77], s[74:75], v[232:233] op_sel_hi:[1,1,0]
    v_pk_fma_f32 v[78:79], v[78:79], s[74:75], v[232:233] op_sel_hi:[1,1,0]
    v_pk_fma_f32 v[144:145], v[144:145], s[74:75], v[234:235] op_sel_hi:[1,1,0]
    v_pk_fma_f32 v[146:147], v[146:147], s[74:75], v[234:235] op_sel_hi:[1,1,0]
    v_pk_fma_f32 v[148:149], v[148:149], s[74:75], v[234:235] op_sel_hi:[1,1,0]
    v_pk_fma_f32 v[150:151], v[150:151], s[74:75], v[234:235] op_sel_hi:[1,1,0]
    v_exp_f32 v72, v72
    v_exp_f32 v73, v73
    v_exp_f32 v74, v74
    v_exp_f32 v75, v75
    v_exp_f32 v76, v76
    v_exp_f32 v77, v77
    v_exp_f32 v78, v78
    v_exp_f32 v79, v79
    v_exp_f32 v144, v144
    v_exp_f32 v145, v145
    v_exp_f32 v146, v146
    v_exp_f32 v147, v147
    v_exp_f32 v148, v148
    v_exp_f32 v149, v149
    v_exp_f32 v150, v150
    v_exp_f32 v151, v151
    v_cvt_pk_bf16_f32 v72, v72, v73
    v_cvt_pk_bf16_f32 v73, v74, v75
    v_cvt_pk_bf16_f32 v74, v76, v77
    v_cvt_pk_bf16_f32 v75, v78, v79
    v_cvt_pk_bf16_f32 v144, v144, v145
    v_cvt_pk_bf16_f32 v145, v146, v147
    v_cvt_pk_bf16_f32 v146, v148, v149
    v_cvt_pk_bf16_f32 v147, v150, v151
    v_pk_fma_f32 v[80:81], v[80:81], s[74:75], v[232:233] op_sel_hi:[1,1,0]
    v_pk_fma_f32 v[82:83], v[82:83], s[74:75], v[232:233] op_sel_hi:[1,1,0]
    v_pk_fma_f32 v[84:85], v[84:85], s[74:75], v[232:233] op_sel_hi:[1,1,0]
    v_pk_fma_f32 v[86:87], v[86:87], s[74:75], v[232:233] op_sel_hi:[1,1,0]
    v_pk_fma_f32 v[152:153], v[152:153], s[74:75], v[234:235] op_sel_hi:[1,1,0]
    v_pk_fma_f32 v[154:155], v[154:155], s[74:75], v[234:235] op_sel_hi:[1,1,0]
    v_pk_fma_f32 v[156:157], v[156:157], s[74:75], v[234:235] op_sel_hi:[1,1,0]
    v_pk_fma_f32 v[158:159], v[158:159], s[74:75], v[234:235] op_sel_hi:[1,1,0]
    v_exp_f32 v80, v80
    v_exp_f32 v81, v81
    v_exp_f32 v82, v82
    v_exp_f32 v83, v83
    v_exp_f32 v84, v84
    v_exp_f32 v85, v85
    v_exp_f32 v86, v86
    v_exp_f32 v87, v87
    v_exp_f32 v152, v152
    v_exp_f32 v153, v153
    v_exp_f32 v154, v154
    v_exp_f32 v155, v155
    v_exp_f32 v156, v156
    v_exp_f32 v157, v157
    v_exp_f32 v158, v158
    v_exp_f32 v159, v159
    v_cvt_pk_bf16_f32 v80, v80, v81
    v_cvt_pk_bf16_f32 v81, v82, v83
    v_cvt_pk_bf16_f32 v82, v84, v85
    v_cvt_pk_bf16_f32 v83, v86, v87
    v_cvt_pk_bf16_f32 v152, v152, v153
    v_cvt_pk_bf16_f32 v153, v154, v155
    v_cvt_pk_bf16_f32 v154, v156, v157
    v_cvt_pk_bf16_f32 v155, v158, v159
    v_pk_fma_f32 v[88:89], v[88:89], s[74:75], v[232:233] op_sel_hi:[1,1,0]
    v_pk_fma_f32 v[90:91], v[90:91], s[74:75], v[232:233] op_sel_hi:[1,1,0]
    v_pk_fma_f32 v[92:93], v[92:93], s[74:75], v[232:233] op_sel_hi:[1,1,0]
    v_pk_fma_f32 v[94:95], v[94:95], s[74:75], v[232:233] op_sel_hi:[1,1,0]
    v_pk_fma_f32 v[160:161], v[160:161], s[74:75], v[234:235] op_sel_hi:[1,1,0]
    v_pk_fma_f32 v[162:163], v[162:163], s[74:75], v[234:235] op_sel_hi:[1,1,0]
    v_pk_fma_f32 v[164:165], v[164:165], s[74:75], v[234:235] op_sel_hi:[1,1,0]
    v_pk_fma_f32 v[166:167], v[166:167], s[74:75], v[234:235] op_sel_hi:[1,1,0]
    v_exp_f32 v88, v88
    v_exp_f32 v89, v89
    v_exp_f32 v90, v90
    v_exp_f32 v91, v91
    v_exp_f32 v92, v92
    v_exp_f32 v93, v93
    v_exp_f32 v94, v94
    v_exp_f32 v95, v95
    v_exp_f32 v160, v160
    v_exp_f32 v161, v161
    v_exp_f32 v162, v162
    v_exp_f32 v163, v163
    v_exp_f32 v164, v164
    v_exp_f32 v165, v165
    v_exp_f32 v166, v166
    v_exp_f32 v167, v167
    v_cvt_pk_bf16_f32 v88, v88, v89
    v_cvt_pk_bf16_f32 v89, v90, v91
    v_cvt_pk_bf16_f32 v90, v92, v93
    v_cvt_pk_bf16_f32 v91, v94, v95
    v_cvt_pk_bf16_f32 v160, v160, v161
    v_cvt_pk_bf16_f32 v161, v162, v163
    v_cvt_pk_bf16_f32 v162, v164, v165
    v_cvt_pk_bf16_f32 v163, v166, v167
    s_barrier
    ds_read_b128 v[24:27], v7 offset:0
    ds_read_b128 v[28:31], v7 offset:1024
    ds_read_b128 v[32:35], v7 offset:2048
    ds_read_b128 v[36:39], v7 offset:3072
    ds_read_b128 v[40:43], v7 offset:4096
    ds_read_b128 v[44:47], v7 offset:5120
    ds_read_b128 v[48:51], v7 offset:6144
    ds_read_b128 v[52:55], v7 offset:7168
    v_pk_fma_f32 v[96:97], v[96:97], s[74:75], v[232:233] op_sel_hi:[1,1,0]
    v_pk_fma_f32 v[98:99], v[98:99], s[74:75], v[232:233] op_sel_hi:[1,1,0]
    v_pk_fma_f32 v[100:101], v[100:101], s[74:75], v[232:233] op_sel_hi:[1,1,0]
    v_pk_fma_f32 v[102:103], v[102:103], s[74:75], v[232:233] op_sel_hi:[1,1,0]
    v_pk_fma_f32 v[168:169], v[168:169], s[74:75], v[234:235] op_sel_hi:[1,1,0]
    v_pk_fma_f32 v[170:171], v[170:171], s[74:75], v[234:235] op_sel_hi:[1,1,0]
    v_pk_fma_f32 v[172:173], v[172:173], s[74:75], v[234:235] op_sel_hi:[1,1,0]
    v_pk_fma_f32 v[174:175], v[174:175], s[74:75], v[234:235] op_sel_hi:[1,1,0]
    v_exp_f32 v96, v96
    v_exp_f32 v97, v97
    v_exp_f32 v98, v98
    v_exp_f32 v99, v99
    v_exp_f32 v100, v100
    v_exp_f32 v101, v101
    v_exp_f32 v102, v102
    v_exp_f32 v103, v103
    v_exp_f32 v168, v168
    v_exp_f32 v169, v169
    v_exp_f32 v170, v170
    v_exp_f32 v171, v171
    v_exp_f32 v172, v172
    v_exp_f32 v173, v173
    v_exp_f32 v174, v174
    v_exp_f32 v175, v175
    v_cvt_pk_bf16_f32 v96, v96, v97
    v_cvt_pk_bf16_f32 v97, v98, v99
    v_cvt_pk_bf16_f32 v98, v100, v101
    v_cvt_pk_bf16_f32 v99, v102, v103
    v_cvt_pk_bf16_f32 v168, v168, v169
    v_cvt_pk_bf16_f32 v169, v170, v171
    v_cvt_pk_bf16_f32 v170, v172, v173
    v_cvt_pk_bf16_f32 v171, v174, v175
    s_waitcnt lgkmcnt(4)
    v_pk_fma_f32 v[104:105], v[104:105], s[74:75], v[232:233] op_sel_hi:[1,1,0]
    v_pk_fma_f32 v[106:107], v[106:107], s[74:75], v[232:233] op_sel_hi:[1,1,0]
    v_mfma_f32_16x16x32_bf16 v[208:211], v[24:27], v[64:67], v[208:211]
    v_pk_fma_f32 v[108:109], v[108:109], s[74:75], v[232:233] op_sel_hi:[1,1,0]
    v_pk_fma_f32 v[110:111], v[110:111], s[74:75], v[232:233] op_sel_hi:[1,1,0]
    v_mfma_f32_16x16x32_bf16 v[212:215], v[28:31], v[64:67], v[212:215]
    v_pk_fma_f32 v[176:177], v[176:177], s[74:75], v[234:235] op_sel_hi:[1,1,0]
    v_pk_fma_f32 v[178:179], v[178:179], s[74:75], v[234:235] op_sel_hi:[1,1,0]
    v_mfma_f32_16x16x32_bf16 v[216:219], v[16:19], v[64:67], v[216:219]
    v_pk_fma_f32 v[180:181], v[180:181], s[74:75], v[234:235] op_sel_hi:[1,1,0]
    v_pk_fma_f32 v[182:183], v[182:183], s[74:75], v[234:235] op_sel_hi:[1,1,0]
    v_mfma_f32_16x16x32_bf16 v[220:223], v[24:27], v[136:139], v[220:223]
    v_exp_f32 v104, v104
    v_exp_f32 v105, v105
    v_mfma_f32_16x16x32_bf16 v[224:227], v[28:31], v[136:139], v[224:227]
    v_exp_f32 v106, v106
    v_exp_f32 v107, v107
    v_mfma_f32_16x16x32_bf16 v[228:231], v[16:19], v[136:139], v[228:231]
    v_exp_f32 v108, v108
    v_exp_f32 v109, v109
    v_mfma_f32_16x16x32_bf16 v[208:211], v[32:35], v[72:75], v[208:211]
    v_exp_f32 v110, v110
    v_exp_f32 v111, v111
    v_mfma_f32_16x16x32_bf16 v[212:215], v[36:39], v[72:75], v[212:215]
    v_exp_f32 v176, v176
    v_exp_f32 v177, v177
    v_mfma_f32_16x16x32_bf16 v[216:219], v[16:19], v[72:75], v[216:219]
    v_exp_f32 v178, v178
    v_exp_f32 v179, v179
    v_mfma_f32_16x16x32_bf16 v[220:223], v[32:35], v[144:147], v[220:223]
    v_exp_f32 v180, v180
    v_exp_f32 v181, v181
    v_mfma_f32_16x16x32_bf16 v[224:227], v[36:39], v[144:147], v[224:227]
    v_exp_f32 v182, v182
    v_exp_f32 v183, v183
    v_mfma_f32_16x16x32_bf16 v[228:231], v[16:19], v[144:147], v[228:231]
    v_cvt_pk_bf16_f32 v104, v104, v105
    v_cvt_pk_bf16_f32 v105, v106, v107
    v_cvt_pk_bf16_f32 v106, v108, v109
    v_cvt_pk_bf16_f32 v107, v110, v111
    v_cvt_pk_bf16_f32 v176, v176, v177
    v_cvt_pk_bf16_f32 v177, v178, v179
    v_cvt_pk_bf16_f32 v178, v180, v181
    v_cvt_pk_bf16_f32 v179, v182, v183
    ds_read_b128 v[24:27], v7 offset:8192
    ds_read_b128 v[28:31], v7 offset:9216
    ds_read_b128 v[32:35], v7 offset:10240
    ds_read_b128 v[36:39], v7 offset:11264
    s_waitcnt lgkmcnt(4)
    v_pk_fma_f32 v[112:113], v[112:113], s[74:75], v[232:233] op_sel_hi:[1,1,0]
    v_pk_fma_f32 v[114:115], v[114:115], s[74:75], v[232:233] op_sel_hi:[1,1,0]
    v_mfma_f32_16x16x32_bf16 v[208:211], v[40:43], v[80:83], v[208:211]
    v_pk_fma_f32 v[116:117], v[116:117], s[74:75], v[232:233] op_sel_hi:[1,1,0]
    v_pk_fma_f32 v[118:119], v[118:119], s[74:75], v[232:233] op_sel_hi:[1,1,0]
    v_mfma_f32_16x16x32_bf16 v[212:215], v[44:47], v[80:83], v[212:215]
    v_pk_fma_f32 v[184:185], v[184:185], s[74:75], v[234:235] op_sel_hi:[1,1,0]
    v_pk_fma_f32 v[186:187], v[186:187], s[74:75], v[234:235] op_sel_hi:[1,1,0]
    v_mfma_f32_16x16x32_bf16 v[216:219], v[16:19], v[80:83], v[216:219]
    v_pk_fma_f32 v[188:189], v[188:189], s[74:75], v[234:235] op_sel_hi:[1,1,0]
    v_pk_fma_f32 v[190:191], v[190:191], s[74:75], v[234:235] op_sel_hi:[1,1,0]
    v_mfma_f32_16x16x32_bf16 v[220:223], v[40:43], v[152:155], v[220:223]
    v_exp_f32 v112, v112
    v_exp_f32 v113, v113
    v_mfma_f32_16x16x32_bf16 v[224:227], v[44:47], v[152:155], v[224:227]
    v_exp_f32 v114, v114
    v_exp_f32 v115, v115
    v_mfma_f32_16x16x32_bf16 v[228:231], v[16:19], v[152:155], v[228:231]
    v_exp_f32 v116, v116
    v_exp_f32 v117, v117
    v_mfma_f32_16x16x32_bf16 v[208:211], v[48:51], v[88:91], v[208:211]
    v_exp_f32 v118, v118
    v_exp_f32 v119, v119
    v_mfma_f32_16x16x32_bf16 v[212:215], v[52:55], v[88:91], v[212:215]
    v_exp_f32 v184, v184
    v_exp_f32 v185, v185
    v_mfma_f32_16x16x32_bf16 v[216:219], v[16:19], v[88:91], v[216:219]
    v_exp_f32 v186, v186
    v_exp_f32 v187, v187
    v_mfma_f32_16x16x32_bf16 v[220:223], v[48:51], v[160:163], v[220:223]
    v_exp_f32 v188, v188
    v_exp_f32 v189, v189
    v_mfma_f32_16x16x32_bf16 v[224:227], v[52:55], v[160:163], v[224:227]
    v_exp_f32 v190, v190
    v_exp_f32 v191, v191
    v_mfma_f32_16x16x32_bf16 v[228:231], v[16:19], v[160:163], v[228:231]
    v_cvt_pk_bf16_f32 v112, v112, v113
    v_cvt_pk_bf16_f32 v113, v114, v115
    v_cvt_pk_bf16_f32 v114, v116, v117
    v_cvt_pk_bf16_f32 v115, v118, v119
    v_cvt_pk_bf16_f32 v184, v184, v185
    v_cvt_pk_bf16_f32 v185, v186, v187
    v_cvt_pk_bf16_f32 v186, v188, v189
    v_cvt_pk_bf16_f32 v187, v190, v191
    ds_read_b128 v[40:43], v7 offset:12288
    ds_read_b128 v[44:47], v7 offset:13312
    ds_read_b128 v[48:51], v7 offset:14336
    ds_read_b128 v[52:55], v7 offset:15360
    s_waitcnt lgkmcnt(4)
    v_pk_fma_f32 v[120:121], v[120:121], s[74:75], v[232:233] op_sel_hi:[1,1,0]
    v_pk_fma_f32 v[122:123], v[122:123], s[74:75], v[232:233] op_sel_hi:[1,1,0]
    v_mfma_f32_16x16x32_bf16 v[208:211], v[24:27], v[96:99], v[208:211]
    v_pk_fma_f32 v[124:125], v[124:125], s[74:75], v[232:233] op_sel_hi:[1,1,0]
    v_pk_fma_f32 v[126:127], v[126:127], s[74:75], v[232:233] op_sel_hi:[1,1,0]
    v_mfma_f32_16x16x32_bf16 v[212:215], v[28:31], v[96:99], v[212:215]
    v_pk_fma_f32 v[192:193], v[192:193], s[74:75], v[234:235] op_sel_hi:[1,1,0]
    v_pk_fma_f32 v[194:195], v[194:195], s[74:75], v[234:235] op_sel_hi:[1,1,0]
    v_mfma_f32_16x16x32_bf16 v[216:219], v[16:19], v[96:99], v[216:219]
    v_pk_fma_f32 v[196:197], v[196:197], s[74:75], v[234:235] op_sel_hi:[1,1,0]
    v_pk_fma_f32 v[198:199], v[198:199], s[74:75], v[234:235] op_sel_hi:[1,1,0]
    v_mfma_f32_16x16x32_bf16 v[220:223], v[24:27], v[168:171], v[220:223]
    v_exp_f32 v120, v120
    v_exp_f32 v121, v121
    v_mfma_f32_16x16x32_bf16 v[224:227], v[28:31], v[168:171], v[224:227]
    v_exp_f32 v122, v122
    v_exp_f32 v123, v123
    v_mfma_f32_16x16x32_bf16 v[228:231], v[16:19], v[168:171], v[228:231]
    v_exp_f32 v124, v124
    v_exp_f32 v125, v125
    v_mfma_f32_16x16x32_bf16 v[208:211], v[32:35], v[104:107], v[208:211]
    v_exp_f32 v126, v126
    v_exp_f32 v127, v127
    v_mfma_f32_16x16x32_bf16 v[212:215], v[36:39], v[104:107], v[212:215]
    v_exp_f32 v192, v192
    v_exp_f32 v193, v193
    v_mfma_f32_16x16x32_bf16 v[216:219], v[16:19], v[104:107], v[216:219]
    v_exp_f32 v194, v194
    v_exp_f32 v195, v195
    v_mfma_f32_16x16x32_bf16 v[220:223], v[32:35], v[176:179], v[220:223]
    v_exp_f32 v196, v196
    v_exp_f32 v197, v197
    v_mfma_f32_16x16x32_bf16 v[224:227], v[36:39], v[176:179], v[224:227]
    v_exp_f32 v198, v198
    v_exp_f32 v199, v199
    v_mfma_f32_16x16x32_bf16 v[228:231], v[16:19], v[176:179], v[228:231]
    v_cvt_pk_bf16_f32 v120, v120, v121
    v_cvt_pk_bf16_f32 v121, v122, v123
    v_cvt_pk_bf16_f32 v122, v124, v125
    v_cvt_pk_bf16_f32 v123, v126, v127
    v_cvt_pk_bf16_f32 v192, v192, v193
    v_cvt_pk_bf16_f32 v193, v194, v195
    v_cvt_pk_bf16_f32 v194, v196, v197
    v_cvt_pk_bf16_f32 v195, v198, v199
    ds_read_b128 v[24:27], v7 offset:16384
    ds_read_b128 v[28:31], v7 offset:17408
    s_waitcnt lgkmcnt(2)
    v_pk_fma_f32 v[128:129], v[128:129], s[74:75], v[232:233] op_sel_hi:[1,1,0]
    v_pk_fma_f32 v[130:131], v[130:131], s[74:75], v[232:233] op_sel_hi:[1,1,0]
    v_mfma_f32_16x16x32_bf16 v[208:211], v[40:43], v[112:115], v[208:211]
    v_pk_fma_f32 v[200:201], v[200:201], s[74:75], v[234:235] op_sel_hi:[1,1,0]
    v_mfma_f32_16x16x32_bf16 v[212:215], v[44:47], v[112:115], v[212:215]
    v_pk_fma_f32 v[202:203], v[202:203], s[74:75], v[234:235] op_sel_hi:[1,1,0]
    v_mfma_f32_16x16x32_bf16 v[216:219], v[16:19], v[112:115], v[216:219]
    v_pk_fma_f32 v[204:205], v[204:205], s[74:75], v[234:235] op_sel_hi:[1,1,0]
    v_mfma_f32_16x16x32_bf16 v[220:223], v[40:43], v[184:187], v[220:223]
    v_pk_fma_f32 v[206:207], v[206:207], s[74:75], v[234:235] op_sel_hi:[1,1,0]
    v_mfma_f32_16x16x32_bf16 v[224:227], v[44:47], v[184:187], v[224:227]
    v_exp_f32 v128, v128
    v_mfma_f32_16x16x32_bf16 v[228:231], v[16:19], v[184:187], v[228:231]
    v_exp_f32 v129, v129
    v_mfma_f32_16x16x32_bf16 v[208:211], v[48:51], v[120:123], v[208:211]
    v_exp_f32 v130, v130
    v_mfma_f32_16x16x32_bf16 v[212:215], v[52:55], v[120:123], v[212:215]
    v_exp_f32 v131, v131
    v_mfma_f32_16x16x32_bf16 v[216:219], v[16:19], v[120:123], v[216:219]
    v_exp_f32 v200, v200
    v_mfma_f32_16x16x32_bf16 v[220:223], v[48:51], v[192:195], v[220:223]
    v_exp_f32 v201, v201
    v_mfma_f32_16x16x32_bf16 v[224:227], v[52:55], v[192:195], v[224:227]
    v_exp_f32 v202, v202
    v_mfma_f32_16x16x32_bf16 v[228:231], v[16:19], v[192:195], v[228:231]
    v_exp_f32 v203, v203
    v_exp_f32 v204, v204
    v_exp_f32 v205, v205
    v_exp_f32 v206, v206
    v_exp_f32 v207, v207
    v_cvt_pk_bf16_f32 v128, v128, v129
    v_cvt_pk_bf16_f32 v129, v130, v131
    v_cvt_pk_bf16_f32 v200, v200, v201
    v_cvt_pk_bf16_f32 v201, v202, v203
    v_cvt_pk_bf16_f32 v202, v204, v205
    v_cvt_pk_bf16_f32 v203, v206, v207
    v_mov_b64 v[130:131], 0
    s_waitcnt lgkmcnt(0)
    s_nop 0
    v_mfma_f32_16x16x32_bf16 v[208:211], v[24:27], v[128:131], v[208:211]
    v_mfma_f32_16x16x32_bf16 v[212:215], v[28:31], v[128:131], v[212:215]
    v_mfma_f32_16x16x32_bf16 v[216:219], v[16:19], v[128:131], v[216:219]
    v_mfma_f32_16x16x32_bf16 v[220:223], v[24:27], v[200:203], v[220:223]
    v_mfma_f32_16x16x32_bf16 v[224:227], v[28:31], v[200:203], v[224:227]
    v_mfma_f32_16x16x32_bf16 v[228:231], v[16:19], v[200:203], v[228:231]
    v_lshlrev_b32 v2, 4, v1
    s_nop 3
    v_rcp_f32 v216, v216
    s_nop 0
    v_pk_mul_f32 v[208:209], v[208:209], v[216:217] op_sel_hi:[1,0]
    v_pk_mul_f32 v[210:211], v[210:211], v[216:217] op_sel_hi:[1,0]
    v_pk_mul_f32 v[212:213], v[212:213], v[216:217] op_sel_hi:[1,0]
    v_pk_mul_f32 v[214:215], v[214:215], v[216:217] op_sel_hi:[1,0]
    v_cvt_pk_bf16_f32 v24, v208, v209
    v_cvt_pk_bf16_f32 v25, v210, v211
    v_cvt_pk_bf16_f32 v26, v212, v213
    v_cvt_pk_bf16_f32 v27, v214, v215
    buffer_store_dwordx4 v[24:27], v2, s[8:11], s34 offen sc1
    v_rcp_f32 v228, v228
    s_nop 0
    v_pk_mul_f32 v[220:221], v[220:221], v[228:229] op_sel_hi:[1,0]
    v_pk_mul_f32 v[222:223], v[222:223], v[228:229] op_sel_hi:[1,0]
    v_pk_mul_f32 v[224:225], v[224:225], v[228:229] op_sel_hi:[1,0]
    v_pk_mul_f32 v[226:227], v[226:227], v[228:229] op_sel_hi:[1,0]
    v_cvt_pk_bf16_f32 v28, v220, v221
    v_cvt_pk_bf16_f32 v29, v222, v223
    v_cvt_pk_bf16_f32 v30, v224, v225
    v_cvt_pk_bf16_f32 v31, v226, v227
    buffer_store_dwordx4 v[28:31], v2, s[8:11], s35 offen sc1
    s_and_b32 s24, s22, 3
    s_lshl_b32 s24, s24, 2
    s_bfe_u32 s30, s23, 0x20001
    s_add_u32 s24, s24, s30
    s_lshr_b32 s25, s22, 2
    s_lshl_b32 s25, s25, 2
    s_lshr_b32 s30, s23, 3
    s_add_u32 s25, s25, s30
    s_lshl_b32 s25, s25, 1
    s_and_b32 s30, s23, 1
    s_add_u32 s25, s25, s30
    s_mov_b32 s12, s52
    s_and_b32 s13, s53, 0xffff
    s_mov_b32 s14, 2097152
    s_mov_b32 s15, 0x20000
    s_lshl_b32 s26, s25, 7
    s_mov_b32 s67, 0
    s_lshl_b32 s101, s25, 1
    s_and_b32 s101, s101, 0

    s_lshl_b32 s69, s29, 12
    s_lshl_b32 s70, s29, 11
    v_lshrrev_b32 v246, 3, v1
    s_lshl_b32 s30, s29, 5
    v_add_u32 v246, s30, v246
    v_mul_u32_u24 v246, 2048, v246
    v_and_b32 v247, 1, v1
    v_lshl_add_u32 v246, v247, 4, v246
    v_add_u32 v246, s26, v246
    v_bfe_u32 v247, v1, 1, 2

    v_xor_b32 v245, v247, v3
    v_lshl_add_u32 v236, v245, 5, v246
    v_add_u32 v237, 15360, v236
    v_add_u32 v238, 30720, v236
    v_add_u32 v239, 30720, v237
    v_and_b32 v113, 1, v3
    v_lshlrev_b32 v113, 1, v113
    v_lshrrev_b32 v112, 1, v3
    v_or_b32 v113, v113, v112
    v_lshlrev_b32 v113, 4, v113
    v_lshl_add_u32 v112, v4, 11, v113

    s_lshl_b32 s35, s24, 1
    s_add_u32 s35, s35, s28
    s_lshl_b32 s36, s25, 1
    s_add_u32 s36, s36, s29
    s_lshl_b32 s32, s35, 17
    s_lshl_b32 s31, s36, 6
    s_add_u32 s32, s32, s31

    s_mul_i32 s30, s28, 8192
    v_lshl_add_u32 v56, v1, 4, s30
    v_add_u32 v57, 0x10000, v56
    v_bfe_u32 v5, v1, 2, 2
    v_and_b32 v6, 3, v1
    v_lshl_add_u32 v7, v3, 2, v5
    v_bfe_u32 v2, v7, 1, 2
    v_mov_b32 v9, v7
    v_lshlrev_b32 v7, 7, v7
    v_lshl_add_u32 v7, v6, 3, v7
    s_mul_i32 s30, s29, 2
    s_add_u32 s30, s30, 0
    v_xor_b32 v8, s30, v2
    v_lshl_add_u32 v58, v8, 5, v7
    s_mul_i32 s30, s29, 0
    s_add_u32 s30, s30, 65536
    v_add_u32 v58, s30, v58
    v_add_u32 v60, 0x10000, v58
    s_mul_i32 s30, s29, 2
    s_add_u32 s30, s30, 1
    v_xor_b32 v8, s30, v2
    v_lshl_add_u32 v59, v8, 5, v7
    s_mul_i32 s30, s29, 0
    s_add_u32 s30, s30, 65536
    v_add_u32 v59, s30, v59
    v_add_u32 v61, 0x10000, v59
    s_waitcnt vmcnt(0)
    v_mov_b32 v5, 0
    v_mov_b32 v6, 1
    s_mov_b64 exec, 1
    buffer_store_dword v6, v5, s[8:11], s33 offen sc1
    s_mov_b64 exec, -1
    s_cmp_lg_u32 s28, 0
    s_cbranch_scc1 b3a_370
    s_add_u32 s99, s67, 0
    s_add_u32 m0, s69, 106496
    s_add_u32 s31, s99, 0
    buffer_load_dwordx4 v236, s[12:15], s31 offen offset:0  lds
    buffer_load_dwordx4 v237, s[12:15], s31 offen offset:1024  lds
    buffer_load_dwordx4 v238, s[12:15], s31 offen offset:2048  lds
    buffer_load_dwordx4 v239, s[12:15], s31 offen offset:3072  lds
    s_add_u32 s99, s67, 131072
    s_add_u32 m0, s69, 114688
    s_add_u32 s31, s99, 0
    buffer_load_dwordx4 v236, s[12:15], s31 offen offset:0  lds
    buffer_load_dwordx4 v237, s[12:15], s31 offen offset:1024  lds
    buffer_load_dwordx4 v238, s[12:15], s31 offen offset:2048  lds
    buffer_load_dwordx4 v239, s[12:15], s31 offen offset:3072  lds
    s_add_u32 s99, s67, 262144
    s_add_u32 m0, s69, 122880
    s_add_u32 s31, s99, 0
    buffer_load_dwordx4 v236, s[12:15], s31 offen offset:0  lds
    buffer_load_dwordx4 v237, s[12:15], s31 offen offset:1024  lds
    buffer_load_dwordx4 v238, s[12:15], s31 offen offset:2048  lds
    buffer_load_dwordx4 v239, s[12:15], s31 offen offset:3072  lds
    s_branch b3b_371
b3a_370:
    s_add_u32 s99, s67, 524288
    s_add_u32 m0, s69, 131072
    s_add_u32 s31, s99, 0
    buffer_load_dwordx4 v236, s[12:15], s31 offen offset:0  lds
    buffer_load_dwordx4 v237, s[12:15], s31 offen offset:1024  lds
    buffer_load_dwordx4 v238, s[12:15], s31 offen offset:2048  lds
    buffer_load_dwordx4 v239, s[12:15], s31 offen offset:3072  lds
    s_add_u32 s99, s67, 655360
    s_add_u32 m0, s69, 139264
    s_add_u32 s31, s99, 0
    buffer_load_dwordx4 v236, s[12:15], s31 offen offset:0  lds
    buffer_load_dwordx4 v237, s[12:15], s31 offen offset:1024  lds
    buffer_load_dwordx4 v238, s[12:15], s31 offen offset:2048  lds
    buffer_load_dwordx4 v239, s[12:15], s31 offen offset:3072  lds
    s_add_u32 s99, s67, 786432
    s_add_u32 m0, s69, 147456
    s_add_u32 s31, s99, 0
    buffer_load_dwordx4 v236, s[12:15], s31 offen offset:0  lds
    buffer_load_dwordx4 v237, s[12:15], s31 offen offset:1024  lds
    buffer_load_dwordx4 v238, s[12:15], s31 offen offset:2048  lds
    buffer_load_dwordx4 v239, s[12:15], s31 offen offset:3072  lds
b3b_371:
    s_barrier
    s_add_u32 s31, s32, 0
    buffer_load_dwordx4 v[96:99], v112, s[4:7], s31 offen
    s_add_u32 s31, s32, 32768
    buffer_load_dwordx4 v[100:103], v112, s[4:7], s31 offen
    s_add_u32 s31, s32, 65536
    buffer_load_dwordx4 v[104:107], v112, s[4:7], s31 offen
    s_add_u32 s31, s32, 98304
    buffer_load_dwordx4 v[108:111], v112, s[4:7], s31 offen
    s_waitcnt vmcnt(4)

    s_lshl_b32 s37, s35, 17
    s_lshl_b32 s31, s36, 10
    s_add_u32 s37, s37, s31
    s_add_u32 s37, s37, 20971520
    s_lshl_b32 s38, s35, 14
    s_lshl_b32 s31, s36, 9
    s_add_u32 s38, s38, s31
    s_add_u32 s38, s38, 41943040

    s_lshl_b32 s32, s24, 4
    s_add_u32 s32, s32, s25
    s_mul_i32 s32, s32, 32
    s_add_u32 s32, s32, s21
    s_lshl_b32 s32, s32, 2
    s_add_u32 s32, s32, 44335104
    s_barrier
    ds_read_b64_tr_b16 v[24:25], v58 offset:40960
    ds_read_b64_tr_b16 v[26:27], v58 offset:43008
    ds_read_b128 v[8:11], v56 offset:0
    ds_read_b128 v[12:15], v56 offset:2048
    ds_read_b128 v[16:19], v56 offset:4096
    ds_read_b128 v[20:23], v56 offset:6144
    ds_read_b64_tr_b16 v[28:29], v59 offset:40960
    ds_read_b64_tr_b16 v[30:31], v59 offset:43008
    s_waitcnt lgkmcnt(0)
    v_mfma_f32_16x16x32_bf16 v[64:67], v[24:27], v[8:11], 0
    ds_read_b64_tr_b16 v[48:49], v58 offset:45056
    ds_read_b64_tr_b16 v[50:51], v58 offset:47104
    v_mfma_f32_16x16x32_bf16 v[68:71], v[24:27], v[12:15], 0
    ds_read_b128 v[32:35], v56 offset:1024
    v_mfma_f32_16x16x32_bf16 v[72:75], v[24:27], v[16:19], 0
    ds_read_b128 v[36:39], v56 offset:3072
    v_mfma_f32_16x16x32_bf16 v[76:79], v[24:27], v[20:23], 0
    ds_read_b128 v[40:43], v56 offset:5120
    ds_read_b128 v[44:47], v56 offset:7168
    v_mfma_f32_16x16x32_bf16 v[92:95], v[28:31], v[20:23], 0
    ds_read_b64_tr_b16 v[52:53], v59 offset:45056
    v_mfma_f32_16x16x32_bf16 v[88:91], v[28:31], v[16:19], 0
    ds_read_b64_tr_b16 v[54:55], v59 offset:47104
    v_mfma_f32_16x16x32_bf16 v[84:87], v[28:31], v[12:15], 0
    v_mfma_f32_16x16x32_bf16 v[80:83], v[28:31], v[8:11], 0
    s_waitcnt lgkmcnt(0)
    s_barrier
    v_mfma_f32_16x16x32_bf16 v[64:67], v[48:51], v[32:35], v[64:67]
    ds_read_b64_tr_b16 v[24:25], v58 offset:49152
    ds_read_b64_tr_b16 v[26:27], v58 offset:51200
    v_mfma_f32_16x16x32_bf16 v[68:71], v[48:51], v[36:39], v[68:71]
    ds_read_b128 v[8:11], v56 offset:16384
    v_mfma_f32_16x16x32_bf16 v[72:75], v[48:51], v[40:43], v[72:75]
    ds_read_b128 v[12:15], v56 offset:18432
    v_mfma_f32_16x16x32_bf16 v[76:79], v[48:51], v[44:47], v[76:79]
    ds_read_b128 v[16:19], v56 offset:20480
    ds_read_b128 v[20:23], v56 offset:22528
    v_mfma_f32_16x16x32_bf16 v[92:95], v[52:55], v[44:47], v[92:95]
    ds_read_b64_tr_b16 v[28:29], v59 offset:49152
    v_mfma_f32_16x16x32_bf16 v[88:91], v[52:55], v[40:43], v[88:91]
    ds_read_b64_tr_b16 v[30:31], v59 offset:51200
    v_mfma_f32_16x16x32_bf16 v[84:87], v[52:55], v[36:39], v[84:87]
    v_mfma_f32_16x16x32_bf16 v[80:83], v[52:55], v[32:35], v[80:83]
    s_waitcnt lgkmcnt(0)
    v_mfma_f32_16x16x32_bf16 v[64:67], v[24:27], v[8:11], v[64:67]
    ds_read_b64_tr_b16 v[48:49], v58 offset:53248
    ds_read_b64_tr_b16 v[50:51], v58 offset:55296
    v_mfma_f32_16x16x32_bf16 v[68:71], v[24:27], v[12:15], v[68:71]
    ds_read_b128 v[32:35], v56 offset:17408
    v_mfma_f32_16x16x32_bf16 v[72:75], v[24:27], v[16:19], v[72:75]
    ds_read_b128 v[36:39], v56 offset:19456
    v_mfma_f32_16x16x32_bf16 v[76:79], v[24:27], v[20:23], v[76:79]
    ds_read_b128 v[40:43], v56 offset:21504
    ds_read_b128 v[44:47], v56 offset:23552
    v_mfma_f32_16x16x32_bf16 v[92:95], v[28:31], v[20:23], v[92:95]
    ds_read_b64_tr_b16 v[52:53], v59 offset:53248
    v_mfma_f32_16x16x32_bf16 v[88:91], v[28:31], v[16:19], v[88:91]
    ds_read_b64_tr_b16 v[54:55], v59 offset:55296
    v_mfma_f32_16x16x32_bf16 v[84:87], v[28:31], v[12:15], v[84:87]
    v_mfma_f32_16x16x32_bf16 v[80:83], v[28:31], v[8:11], v[80:83]
    s_waitcnt lgkmcnt(0)
    s_barrier
    v_mfma_f32_16x16x32_bf16 v[64:67], v[48:51], v[32:35], v[64:67]
    ds_read_b64_tr_b16 v[24:25], v58 offset:57344
    ds_read_b64_tr_b16 v[26:27], v58 offset:59392
    v_mfma_f32_16x16x32_bf16 v[68:71], v[48:51], v[36:39], v[68:71]
    ds_read_b128 v[8:11], v56 offset:32768
    v_mfma_f32_16x16x32_bf16 v[72:75], v[48:51], v[40:43], v[72:75]
    ds_read_b128 v[12:15], v56 offset:34816
    v_mfma_f32_16x16x32_bf16 v[76:79], v[48:51], v[44:47], v[76:79]
    ds_read_b128 v[16:19], v56 offset:36864
    ds_read_b128 v[20:23], v56 offset:38912
    v_mfma_f32_16x16x32_bf16 v[92:95], v[52:55], v[44:47], v[92:95]
    ds_read_b64_tr_b16 v[28:29], v59 offset:57344
    v_mfma_f32_16x16x32_bf16 v[88:91], v[52:55], v[40:43], v[88:91]
    ds_read_b64_tr_b16 v[30:31], v59 offset:59392
    v_mfma_f32_16x16x32_bf16 v[84:87], v[52:55], v[36:39], v[84:87]
    v_mfma_f32_16x16x32_bf16 v[80:83], v[52:55], v[32:35], v[80:83]
    s_waitcnt lgkmcnt(0)
    v_mfma_f32_16x16x32_bf16 v[64:67], v[24:27], v[8:11], v[64:67]
    ds_read_b64_tr_b16 v[48:49], v58 offset:61440
    ds_read_b64_tr_b16 v[50:51], v58 offset:63488
    v_mfma_f32_16x16x32_bf16 v[68:71], v[24:27], v[12:15], v[68:71]
    ds_read_b128 v[32:35], v56 offset:33792
    v_mfma_f32_16x16x32_bf16 v[72:75], v[24:27], v[16:19], v[72:75]
    ds_read_b128 v[36:39], v56 offset:35840
    v_mfma_f32_16x16x32_bf16 v[76:79], v[24:27], v[20:23], v[76:79]
    ds_read_b128 v[40:43], v56 offset:37888
    ds_read_b128 v[44:47], v56 offset:39936
    v_mfma_f32_16x16x32_bf16 v[92:95], v[28:31], v[20:23], v[92:95]
    ds_read_b64_tr_b16 v[52:53], v59 offset:61440
    v_mfma_f32_16x16x32_bf16 v[88:91], v[28:31], v[16:19], v[88:91]
    ds_read_b64_tr_b16 v[54:55], v59 offset:63488
    v_mfma_f32_16x16x32_bf16 v[84:87], v[28:31], v[12:15], v[84:87]
    v_mfma_f32_16x16x32_bf16 v[80:83], v[28:31], v[8:11], v[80:83]
    s_waitcnt lgkmcnt(0)
    s_barrier
    v_mfma_f32_16x16x32_bf16 v[64:67], v[48:51], v[32:35], v[64:67]
    ds_read_b64_tr_b16 v[24:25], v60 offset:0
    ds_read_b64_tr_b16 v[26:27], v60 offset:2048
    v_mfma_f32_16x16x32_bf16 v[68:71], v[48:51], v[36:39], v[68:71]
    ds_read_b128 v[8:11], v56 offset:49152
    v_mfma_f32_16x16x32_bf16 v[72:75], v[48:51], v[40:43], v[72:75]
    ds_read_b128 v[12:15], v56 offset:51200
    v_mfma_f32_16x16x32_bf16 v[76:79], v[48:51], v[44:47], v[76:79]
    ds_read_b128 v[16:19], v56 offset:53248
    ds_read_b128 v[20:23], v56 offset:55296
    v_mfma_f32_16x16x32_bf16 v[92:95], v[52:55], v[44:47], v[92:95]
    ds_read_b64_tr_b16 v[28:29], v61 offset:0
    v_mfma_f32_16x16x32_bf16 v[88:91], v[52:55], v[40:43], v[88:91]
    ds_read_b64_tr_b16 v[30:31], v61 offset:2048
    v_mfma_f32_16x16x32_bf16 v[84:87], v[52:55], v[36:39], v[84:87]
    v_mfma_f32_16x16x32_bf16 v[80:83], v[52:55], v[32:35], v[80:83]
    s_waitcnt lgkmcnt(0)
    v_mfma_f32_16x16x32_bf16 v[64:67], v[24:27], v[8:11], v[64:67]
    ds_read_b64_tr_b16 v[48:49], v60 offset:4096
    ds_read_b64_tr_b16 v[50:51], v60 offset:6144
    v_mfma_f32_16x16x32_bf16 v[68:71], v[24:27], v[12:15], v[68:71]
    ds_read_b128 v[32:35], v56 offset:50176
    v_mfma_f32_16x16x32_bf16 v[72:75], v[24:27], v[16:19], v[72:75]
    ds_read_b128 v[36:39], v56 offset:52224
    v_mfma_f32_16x16x32_bf16 v[76:79], v[24:27], v[20:23], v[76:79]
    ds_read_b128 v[40:43], v56 offset:54272
    ds_read_b128 v[44:47], v56 offset:56320
    v_mfma_f32_16x16x32_bf16 v[92:95], v[28:31], v[20:23], v[92:95]
    ds_read_b64_tr_b16 v[52:53], v61 offset:4096
    v_mfma_f32_16x16x32_bf16 v[88:91], v[28:31], v[16:19], v[88:91]
    ds_read_b64_tr_b16 v[54:55], v61 offset:6144
    v_mfma_f32_16x16x32_bf16 v[84:87], v[28:31], v[12:15], v[84:87]
    v_mfma_f32_16x16x32_bf16 v[80:83], v[28:31], v[8:11], v[80:83]
    s_waitcnt lgkmcnt(0)
    s_barrier
    v_mfma_f32_16x16x32_bf16 v[64:67], v[48:51], v[32:35], v[64:67]
    ds_read_b64_tr_b16 v[24:25], v60 offset:8192
    ds_read_b64_tr_b16 v[26:27], v60 offset:10240
    v_mfma_f32_16x16x32_bf16 v[68:71], v[48:51], v[36:39], v[68:71]
    ds_read_b128 v[8:11], v56 offset:0
    v_mfma_f32_16x16x32_bf16 v[72:75], v[48:51], v[40:43], v[72:75]
    ds_read_b128 v[12:15], v56 offset:2048
    v_mfma_f32_16x16x32_bf16 v[76:79], v[48:51], v[44:47], v[76:79]
    ds_read_b128 v[16:19], v56 offset:4096
    ds_read_b128 v[20:23], v56 offset:6144
    v_mfma_f32_16x16x32_bf16 v[92:95], v[52:55], v[44:47], v[92:95]
    ds_read_b64_tr_b16 v[28:29], v61 offset:8192
    v_mfma_f32_16x16x32_bf16 v[88:91], v[52:55], v[40:43], v[88:91]
    ds_read_b64_tr_b16 v[30:31], v61 offset:10240
    v_mfma_f32_16x16x32_bf16 v[84:87], v[52:55], v[36:39], v[84:87]
    v_mfma_f32_16x16x32_bf16 v[80:83], v[52:55], v[32:35], v[80:83]
    s_waitcnt lgkmcnt(0)
    v_mfma_f32_16x16x32_bf16 v[64:67], v[24:27], v[8:11], v[64:67]
    ds_read_b64_tr_b16 v[48:49], v60 offset:12288
    ds_read_b64_tr_b16 v[50:51], v60 offset:14336
    v_mfma_f32_16x16x32_bf16 v[68:71], v[24:27], v[12:15], v[68:71]
    ds_read_b128 v[32:35], v56 offset:1024
    v_mfma_f32_16x16x32_bf16 v[72:75], v[24:27], v[16:19], v[72:75]
    ds_read_b128 v[36:39], v56 offset:3072
    v_mfma_f32_16x16x32_bf16 v[76:79], v[24:27], v[20:23], v[76:79]
    ds_read_b128 v[40:43], v56 offset:5120
    ds_read_b128 v[44:47], v56 offset:7168
    v_mfma_f32_16x16x32_bf16 v[92:95], v[28:31], v[20:23], v[92:95]
    ds_read_b64_tr_b16 v[52:53], v61 offset:12288
    v_mfma_f32_16x16x32_bf16 v[88:91], v[28:31], v[16:19], v[88:91]
    ds_read_b64_tr_b16 v[54:55], v61 offset:14336
    v_mfma_f32_16x16x32_bf16 v[84:87], v[28:31], v[12:15], v[84:87]
    v_mfma_f32_16x16x32_bf16 v[80:83], v[28:31], v[8:11], v[80:83]
    s_waitcnt lgkmcnt(0)
    s_barrier
    v_mfma_f32_16x16x32_bf16 v[64:67], v[48:51], v[32:35], v[64:67]
    ds_read_b64_tr_b16 v[24:25], v60 offset:16384
    ds_read_b64_tr_b16 v[26:27], v60 offset:18432
    v_mfma_f32_16x16x32_bf16 v[68:71], v[48:51], v[36:39], v[68:71]
    ds_read_b128 v[8:11], v56 offset:16384
    v_mfma_f32_16x16x32_bf16 v[72:75], v[48:51], v[40:43], v[72:75]
    ds_read_b128 v[12:15], v56 offset:18432
    v_mfma_f32_16x16x32_bf16 v[76:79], v[48:51], v[44:47], v[76:79]
    ds_read_b128 v[16:19], v56 offset:20480
    ds_read_b128 v[20:23], v56 offset:22528
    v_mfma_f32_16x16x32_bf16 v[92:95], v[52:55], v[44:47], v[92:95]
    ds_read_b64_tr_b16 v[28:29], v61 offset:16384
    v_mfma_f32_16x16x32_bf16 v[88:91], v[52:55], v[40:43], v[88:91]
    ds_read_b64_tr_b16 v[30:31], v61 offset:18432
    v_mfma_f32_16x16x32_bf16 v[84:87], v[52:55], v[36:39], v[84:87]
    v_mfma_f32_16x16x32_bf16 v[80:83], v[52:55], v[32:35], v[80:83]
    s_waitcnt lgkmcnt(0)
    v_mfma_f32_16x16x32_bf16 v[64:67], v[24:27], v[8:11], v[64:67]
    ds_read_b64_tr_b16 v[48:49], v60 offset:20480
    ds_read_b64_tr_b16 v[50:51], v60 offset:22528
    v_mfma_f32_16x16x32_bf16 v[68:71], v[24:27], v[12:15], v[68:71]
    ds_read_b128 v[32:35], v56 offset:17408
    v_mfma_f32_16x16x32_bf16 v[72:75], v[24:27], v[16:19], v[72:75]
    ds_read_b128 v[36:39], v56 offset:19456
    v_mfma_f32_16x16x32_bf16 v[76:79], v[24:27], v[20:23], v[76:79]
    ds_read_b128 v[40:43], v56 offset:21504
    ds_read_b128 v[44:47], v56 offset:23552
    v_mfma_f32_16x16x32_bf16 v[92:95], v[28:31], v[20:23], v[92:95]
    ds_read_b64_tr_b16 v[52:53], v61 offset:20480
    v_mfma_f32_16x16x32_bf16 v[88:91], v[28:31], v[16:19], v[88:91]
    ds_read_b64_tr_b16 v[54:55], v61 offset:22528
    v_mfma_f32_16x16x32_bf16 v[84:87], v[28:31], v[12:15], v[84:87]
    v_mfma_f32_16x16x32_bf16 v[80:83], v[28:31], v[8:11], v[80:83]
    s_waitcnt lgkmcnt(0)
    s_barrier
    v_mfma_f32_16x16x32_bf16 v[64:67], v[48:51], v[32:35], v[64:67]
    ds_read_b64_tr_b16 v[24:25], v58 offset:0
    ds_read_b64_tr_b16 v[26:27], v58 offset:2048
    v_mfma_f32_16x16x32_bf16 v[68:71], v[48:51], v[36:39], v[68:71]
    ds_read_b128 v[8:11], v56 offset:32768
    v_mfma_f32_16x16x32_bf16 v[72:75], v[48:51], v[40:43], v[72:75]
    ds_read_b128 v[12:15], v56 offset:34816
    v_mfma_f32_16x16x32_bf16 v[76:79], v[48:51], v[44:47], v[76:79]
    ds_read_b128 v[16:19], v56 offset:36864
    ds_read_b128 v[20:23], v56 offset:38912
    v_mfma_f32_16x16x32_bf16 v[92:95], v[52:55], v[44:47], v[92:95]
    ds_read_b64_tr_b16 v[28:29], v59 offset:0
    v_mfma_f32_16x16x32_bf16 v[88:91], v[52:55], v[40:43], v[88:91]
    ds_read_b64_tr_b16 v[30:31], v59 offset:2048
    v_mfma_f32_16x16x32_bf16 v[84:87], v[52:55], v[36:39], v[84:87]
    v_mfma_f32_16x16x32_bf16 v[80:83], v[52:55], v[32:35], v[80:83]
    s_waitcnt lgkmcnt(0)
    v_mfma_f32_16x16x32_bf16 v[64:67], v[24:27], v[8:11], v[64:67]
    ds_read_b64_tr_b16 v[48:49], v58 offset:4096
    ds_read_b64_tr_b16 v[50:51], v58 offset:6144
    v_mfma_f32_16x16x32_bf16 v[68:71], v[24:27], v[12:15], v[68:71]
    ds_read_b128 v[32:35], v56 offset:33792
    v_mfma_f32_16x16x32_bf16 v[72:75], v[24:27], v[16:19], v[72:75]
    ds_read_b128 v[36:39], v56 offset:35840
    v_mfma_f32_16x16x32_bf16 v[76:79], v[24:27], v[20:23], v[76:79]
    ds_read_b128 v[40:43], v56 offset:37888
    ds_read_b128 v[44:47], v56 offset:39936
    v_mfma_f32_16x16x32_bf16 v[92:95], v[28:31], v[20:23], v[92:95]
    ds_read_b64_tr_b16 v[52:53], v59 offset:4096
    v_mfma_f32_16x16x32_bf16 v[88:91], v[28:31], v[16:19], v[88:91]
    ds_read_b64_tr_b16 v[54:55], v59 offset:6144
    v_mfma_f32_16x16x32_bf16 v[84:87], v[28:31], v[12:15], v[84:87]
    v_mfma_f32_16x16x32_bf16 v[80:83], v[28:31], v[8:11], v[80:83]
    s_waitcnt lgkmcnt(0)
    s_barrier
    v_mfma_f32_16x16x32_bf16 v[64:67], v[48:51], v[32:35], v[64:67]
    ds_read_b64_tr_b16 v[24:25], v58 offset:8192
    ds_read_b64_tr_b16 v[26:27], v58 offset:10240
    v_mfma_f32_16x16x32_bf16 v[68:71], v[48:51], v[36:39], v[68:71]
    ds_read_b128 v[8:11], v56 offset:49152
    v_mfma_f32_16x16x32_bf16 v[72:75], v[48:51], v[40:43], v[72:75]
    ds_read_b128 v[12:15], v56 offset:51200
    v_mfma_f32_16x16x32_bf16 v[76:79], v[48:51], v[44:47], v[76:79]
    ds_read_b128 v[16:19], v56 offset:53248
    ds_read_b128 v[20:23], v56 offset:55296
    v_mfma_f32_16x16x32_bf16 v[92:95], v[52:55], v[44:47], v[92:95]
    ds_read_b64_tr_b16 v[28:29], v59 offset:8192
    v_mfma_f32_16x16x32_bf16 v[88:91], v[52:55], v[40:43], v[88:91]
    ds_read_b64_tr_b16 v[30:31], v59 offset:10240
    v_mfma_f32_16x16x32_bf16 v[84:87], v[52:55], v[36:39], v[84:87]
    v_mfma_f32_16x16x32_bf16 v[80:83], v[52:55], v[32:35], v[80:83]
    s_waitcnt lgkmcnt(0)
    v_mfma_f32_16x16x32_bf16 v[64:67], v[24:27], v[8:11], v[64:67]
    ds_read_b64_tr_b16 v[48:49], v58 offset:12288
    ds_read_b64_tr_b16 v[50:51], v58 offset:14336
    v_mfma_f32_16x16x32_bf16 v[68:71], v[24:27], v[12:15], v[68:71]
    ds_read_b128 v[32:35], v56 offset:50176
    v_mfma_f32_16x16x32_bf16 v[72:75], v[24:27], v[16:19], v[72:75]
    ds_read_b128 v[36:39], v56 offset:52224
    v_mfma_f32_16x16x32_bf16 v[76:79], v[24:27], v[20:23], v[76:79]
    ds_read_b128 v[40:43], v56 offset:54272
    ds_read_b128 v[44:47], v56 offset:56320
    v_mfma_f32_16x16x32_bf16 v[92:95], v[28:31], v[20:23], v[92:95]
    ds_read_b64_tr_b16 v[52:53], v59 offset:12288
    v_mfma_f32_16x16x32_bf16 v[88:91], v[28:31], v[16:19], v[88:91]
    ds_read_b64_tr_b16 v[54:55], v59 offset:14336
    v_mfma_f32_16x16x32_bf16 v[84:87], v[28:31], v[12:15], v[84:87]
    v_mfma_f32_16x16x32_bf16 v[80:83], v[28:31], v[8:11], v[80:83]
    s_waitcnt lgkmcnt(0)
    s_barrier
    v_mfma_f32_16x16x32_bf16 v[64:67], v[48:51], v[32:35], v[64:67]
    ds_read_b64_tr_b16 v[24:25], v58 offset:16384
    ds_read_b64_tr_b16 v[26:27], v58 offset:18432
    v_mfma_f32_16x16x32_bf16 v[68:71], v[48:51], v[36:39], v[68:71]
    ds_read_b128 v[8:11], v56 offset:0
    v_mfma_f32_16x16x32_bf16 v[72:75], v[48:51], v[40:43], v[72:75]
    ds_read_b128 v[12:15], v56 offset:2048
    v_mfma_f32_16x16x32_bf16 v[76:79], v[48:51], v[44:47], v[76:79]
    ds_read_b128 v[16:19], v56 offset:4096
    ds_read_b128 v[20:23], v56 offset:6144
    v_mfma_f32_16x16x32_bf16 v[92:95], v[52:55], v[44:47], v[92:95]
    ds_read_b64_tr_b16 v[28:29], v59 offset:16384
    v_mfma_f32_16x16x32_bf16 v[88:91], v[52:55], v[40:43], v[88:91]
    ds_read_b64_tr_b16 v[30:31], v59 offset:18432
    v_mfma_f32_16x16x32_bf16 v[84:87], v[52:55], v[36:39], v[84:87]
    v_mfma_f32_16x16x32_bf16 v[80:83], v[52:55], v[32:35], v[80:83]
    s_waitcnt lgkmcnt(0)
    v_mfma_f32_16x16x32_bf16 v[64:67], v[24:27], v[8:11], v[64:67]
    ds_read_b64_tr_b16 v[48:49], v58 offset:20480
    ds_read_b64_tr_b16 v[50:51], v58 offset:22528
    v_mfma_f32_16x16x32_bf16 v[68:71], v[24:27], v[12:15], v[68:71]
    ds_read_b128 v[32:35], v56 offset:1024
    v_mfma_f32_16x16x32_bf16 v[72:75], v[24:27], v[16:19], v[72:75]
    ds_read_b128 v[36:39], v56 offset:3072
    v_mfma_f32_16x16x32_bf16 v[76:79], v[24:27], v[20:23], v[76:79]
    ds_read_b128 v[40:43], v56 offset:5120
    ds_read_b128 v[44:47], v56 offset:7168
    v_mfma_f32_16x16x32_bf16 v[92:95], v[28:31], v[20:23], v[92:95]
    ds_read_b64_tr_b16 v[52:53], v59 offset:20480
    v_mfma_f32_16x16x32_bf16 v[88:91], v[28:31], v[16:19], v[88:91]
    ds_read_b64_tr_b16 v[54:55], v59 offset:22528
    v_mfma_f32_16x16x32_bf16 v[84:87], v[28:31], v[12:15], v[84:87]
    v_mfma_f32_16x16x32_bf16 v[80:83], v[28:31], v[8:11], v[80:83]
    s_waitcnt lgkmcnt(0)
    s_barrier
    v_mfma_f32_16x16x32_bf16 v[64:67], v[48:51], v[32:35], v[64:67]
    ds_read_b64_tr_b16 v[24:25], v58 offset:24576
    ds_read_b64_tr_b16 v[26:27], v58 offset:26624
    v_mfma_f32_16x16x32_bf16 v[68:71], v[48:51], v[36:39], v[68:71]
    ds_read_b128 v[8:11], v56 offset:16384
    v_mfma_f32_16x16x32_bf16 v[72:75], v[48:51], v[40:43], v[72:75]
    ds_read_b128 v[12:15], v56 offset:18432
    v_mfma_f32_16x16x32_bf16 v[76:79], v[48:51], v[44:47], v[76:79]
    ds_read_b128 v[16:19], v56 offset:20480
    ds_read_b128 v[20:23], v56 offset:22528
    v_mfma_f32_16x16x32_bf16 v[92:95], v[52:55], v[44:47], v[92:95]
    ds_read_b64_tr_b16 v[28:29], v59 offset:24576
    v_mfma_f32_16x16x32_bf16 v[88:91], v[52:55], v[40:43], v[88:91]
    ds_read_b64_tr_b16 v[30:31], v59 offset:26624
    v_mfma_f32_16x16x32_bf16 v[84:87], v[52:55], v[36:39], v[84:87]
    v_mfma_f32_16x16x32_bf16 v[80:83], v[52:55], v[32:35], v[80:83]
    s_waitcnt lgkmcnt(0)
    v_mfma_f32_16x16x32_bf16 v[64:67], v[24:27], v[8:11], v[64:67]
    ds_read_b64_tr_b16 v[48:49], v58 offset:28672
    ds_read_b64_tr_b16 v[50:51], v58 offset:30720
    v_mfma_f32_16x16x32_bf16 v[68:71], v[24:27], v[12:15], v[68:71]
    ds_read_b128 v[32:35], v56 offset:17408
    v_mfma_f32_16x16x32_bf16 v[72:75], v[24:27], v[16:19], v[72:75]
    ds_read_b128 v[36:39], v56 offset:19456
    v_mfma_f32_16x16x32_bf16 v[76:79], v[24:27], v[20:23], v[76:79]
    ds_read_b128 v[40:43], v56 offset:21504
    ds_read_b128 v[44:47], v56 offset:23552
    v_mfma_f32_16x16x32_bf16 v[92:95], v[28:31], v[20:23], v[92:95]
    ds_read_b64_tr_b16 v[52:53], v59 offset:28672
    v_mfma_f32_16x16x32_bf16 v[88:91], v[28:31], v[16:19], v[88:91]
    ds_read_b64_tr_b16 v[54:55], v59 offset:30720
    v_mfma_f32_16x16x32_bf16 v[84:87], v[28:31], v[12:15], v[84:87]
    v_mfma_f32_16x16x32_bf16 v[80:83], v[28:31], v[8:11], v[80:83]
    s_waitcnt lgkmcnt(0)
    s_barrier
    v_mfma_f32_16x16x32_bf16 v[64:67], v[48:51], v[32:35], v[64:67]
    ds_read_b64_tr_b16 v[24:25], v58 offset:32768
    ds_read_b64_tr_b16 v[26:27], v58 offset:34816
    v_mfma_f32_16x16x32_bf16 v[68:71], v[48:51], v[36:39], v[68:71]
    ds_read_b128 v[8:11], v56 offset:32768
    v_mfma_f32_16x16x32_bf16 v[72:75], v[48:51], v[40:43], v[72:75]
    ds_read_b128 v[12:15], v56 offset:34816
    v_mfma_f32_16x16x32_bf16 v[76:79], v[48:51], v[44:47], v[76:79]
    ds_read_b128 v[16:19], v56 offset:36864
    ds_read_b128 v[20:23], v56 offset:38912
    v_mfma_f32_16x16x32_bf16 v[92:95], v[52:55], v[44:47], v[92:95]
    ds_read_b64_tr_b16 v[28:29], v59 offset:32768
    v_mfma_f32_16x16x32_bf16 v[88:91], v[52:55], v[40:43], v[88:91]
    ds_read_b64_tr_b16 v[30:31], v59 offset:34816
    v_mfma_f32_16x16x32_bf16 v[84:87], v[52:55], v[36:39], v[84:87]
    v_mfma_f32_16x16x32_bf16 v[80:83], v[52:55], v[32:35], v[80:83]
    s_waitcnt lgkmcnt(0)
    v_mfma_f32_16x16x32_bf16 v[64:67], v[24:27], v[8:11], v[64:67]
    ds_read_b64_tr_b16 v[48:49], v58 offset:36864
    ds_read_b64_tr_b16 v[50:51], v58 offset:38912
    v_mfma_f32_16x16x32_bf16 v[68:71], v[24:27], v[12:15], v[68:71]
    ds_read_b128 v[32:35], v56 offset:33792
    v_mfma_f32_16x16x32_bf16 v[72:75], v[24:27], v[16:19], v[72:75]
    ds_read_b128 v[36:39], v56 offset:35840
    v_mfma_f32_16x16x32_bf16 v[76:79], v[24:27], v[20:23], v[76:79]
    ds_read_b128 v[40:43], v56 offset:37888
    ds_read_b128 v[44:47], v56 offset:39936
    v_mfma_f32_16x16x32_bf16 v[92:95], v[28:31], v[20:23], v[92:95]
    ds_read_b64_tr_b16 v[52:53], v59 offset:36864
    v_mfma_f32_16x16x32_bf16 v[88:91], v[28:31], v[16:19], v[88:91]
    ds_read_b64_tr_b16 v[54:55], v59 offset:38912
    v_mfma_f32_16x16x32_bf16 v[84:87], v[28:31], v[12:15], v[84:87]
    v_mfma_f32_16x16x32_bf16 v[80:83], v[28:31], v[8:11], v[80:83]
    s_waitcnt lgkmcnt(0)
    s_barrier
    v_mfma_f32_16x16x32_bf16 v[64:67], v[48:51], v[32:35], v[64:67]
    ds_read_b64_tr_b16 v[24:25], v58 offset:40960
    ds_read_b64_tr_b16 v[26:27], v58 offset:43008
    v_mfma_f32_16x16x32_bf16 v[68:71], v[48:51], v[36:39], v[68:71]
    ds_read_b128 v[8:11], v56 offset:49152
    v_mfma_f32_16x16x32_bf16 v[72:75], v[48:51], v[40:43], v[72:75]
    ds_read_b128 v[12:15], v56 offset:51200
    v_mfma_f32_16x16x32_bf16 v[76:79], v[48:51], v[44:47], v[76:79]
    ds_read_b128 v[16:19], v56 offset:53248
    ds_read_b128 v[20:23], v56 offset:55296
    v_mfma_f32_16x16x32_bf16 v[92:95], v[52:55], v[44:47], v[92:95]
    ds_read_b64_tr_b16 v[28:29], v59 offset:40960
    v_mfma_f32_16x16x32_bf16 v[88:91], v[52:55], v[40:43], v[88:91]
    ds_read_b64_tr_b16 v[30:31], v59 offset:43008
    v_mfma_f32_16x16x32_bf16 v[84:87], v[52:55], v[36:39], v[84:87]
    v_mfma_f32_16x16x32_bf16 v[80:83], v[52:55], v[32:35], v[80:83]
    s_waitcnt lgkmcnt(0)
    v_mfma_f32_16x16x32_bf16 v[64:67], v[24:27], v[8:11], v[64:67]
    ds_read_b64_tr_b16 v[48:49], v58 offset:45056
    ds_read_b64_tr_b16 v[50:51], v58 offset:47104
    v_mfma_f32_16x16x32_bf16 v[68:71], v[24:27], v[12:15], v[68:71]
    ds_read_b128 v[32:35], v56 offset:50176
    v_mfma_f32_16x16x32_bf16 v[72:75], v[24:27], v[16:19], v[72:75]
    ds_read_b128 v[36:39], v56 offset:52224
    v_mfma_f32_16x16x32_bf16 v[76:79], v[24:27], v[20:23], v[76:79]
    ds_read_b128 v[40:43], v56 offset:54272
    ds_read_b128 v[44:47], v56 offset:56320
    v_mfma_f32_16x16x32_bf16 v[92:95], v[28:31], v[20:23], v[92:95]
    ds_read_b64_tr_b16 v[52:53], v59 offset:45056
    v_mfma_f32_16x16x32_bf16 v[88:91], v[28:31], v[16:19], v[88:91]
    ds_read_b64_tr_b16 v[54:55], v59 offset:47104
    v_mfma_f32_16x16x32_bf16 v[84:87], v[28:31], v[12:15], v[84:87]
    v_mfma_f32_16x16x32_bf16 v[80:83], v[28:31], v[8:11], v[80:83]
    s_waitcnt lgkmcnt(0)
    s_barrier
    v_mfma_f32_16x16x32_bf16 v[64:67], v[48:51], v[32:35], v[64:67]
    ds_read_b64_tr_b16 v[24:25], v58 offset:49152
    ds_read_b64_tr_b16 v[26:27], v58 offset:51200
    v_mfma_f32_16x16x32_bf16 v[68:71], v[48:51], v[36:39], v[68:71]
    ds_read_b128 v[8:11], v56 offset:0
    v_mfma_f32_16x16x32_bf16 v[72:75], v[48:51], v[40:43], v[72:75]
    ds_read_b128 v[12:15], v56 offset:2048
    v_mfma_f32_16x16x32_bf16 v[76:79], v[48:51], v[44:47], v[76:79]
    ds_read_b128 v[16:19], v56 offset:4096
    ds_read_b128 v[20:23], v56 offset:6144
    v_mfma_f32_16x16x32_bf16 v[92:95], v[52:55], v[44:47], v[92:95]
    ds_read_b64_tr_b16 v[28:29], v59 offset:49152
    v_mfma_f32_16x16x32_bf16 v[88:91], v[52:55], v[40:43], v[88:91]
    ds_read_b64_tr_b16 v[30:31], v59 offset:51200
    v_mfma_f32_16x16x32_bf16 v[84:87], v[52:55], v[36:39], v[84:87]
    v_mfma_f32_16x16x32_bf16 v[80:83], v[52:55], v[32:35], v[80:83]
    s_waitcnt lgkmcnt(0)
    v_mfma_f32_16x16x32_bf16 v[64:67], v[24:27], v[8:11], v[64:67]
    ds_read_b64_tr_b16 v[48:49], v58 offset:53248
    ds_read_b64_tr_b16 v[50:51], v58 offset:55296
    v_mfma_f32_16x16x32_bf16 v[68:71], v[24:27], v[12:15], v[68:71]
    ds_read_b128 v[32:35], v56 offset:1024
    v_mfma_f32_16x16x32_bf16 v[72:75], v[24:27], v[16:19], v[72:75]
    ds_read_b128 v[36:39], v56 offset:3072
    v_mfma_f32_16x16x32_bf16 v[76:79], v[24:27], v[20:23], v[76:79]
    ds_read_b128 v[40:43], v56 offset:5120
    ds_read_b128 v[44:47], v56 offset:7168
    v_mfma_f32_16x16x32_bf16 v[92:95], v[28:31], v[20:23], v[92:95]
    ds_read_b64_tr_b16 v[52:53], v59 offset:53248
    v_mfma_f32_16x16x32_bf16 v[88:91], v[28:31], v[16:19], v[88:91]
    ds_read_b64_tr_b16 v[54:55], v59 offset:55296
    v_mfma_f32_16x16x32_bf16 v[84:87], v[28:31], v[12:15], v[84:87]
    v_mfma_f32_16x16x32_bf16 v[80:83], v[28:31], v[8:11], v[80:83]
    s_waitcnt lgkmcnt(0)
    s_barrier
    v_mfma_f32_16x16x32_bf16 v[64:67], v[48:51], v[32:35], v[64:67]
    ds_read_b64_tr_b16 v[24:25], v58 offset:57344
    ds_read_b64_tr_b16 v[26:27], v58 offset:59392
    v_mfma_f32_16x16x32_bf16 v[68:71], v[48:51], v[36:39], v[68:71]
    ds_read_b128 v[8:11], v56 offset:16384
    v_mfma_f32_16x16x32_bf16 v[72:75], v[48:51], v[40:43], v[72:75]
    ds_read_b128 v[12:15], v56 offset:18432
    v_mfma_f32_16x16x32_bf16 v[76:79], v[48:51], v[44:47], v[76:79]
    ds_read_b128 v[16:19], v56 offset:20480
    ds_read_b128 v[20:23], v56 offset:22528
    v_mfma_f32_16x16x32_bf16 v[92:95], v[52:55], v[44:47], v[92:95]
    ds_read_b64_tr_b16 v[28:29], v59 offset:57344
    v_mfma_f32_16x16x32_bf16 v[88:91], v[52:55], v[40:43], v[88:91]
    ds_read_b64_tr_b16 v[30:31], v59 offset:59392
    v_mfma_f32_16x16x32_bf16 v[84:87], v[52:55], v[36:39], v[84:87]
    v_mfma_f32_16x16x32_bf16 v[80:83], v[52:55], v[32:35], v[80:83]
    s_waitcnt lgkmcnt(0)
    v_mfma_f32_16x16x32_bf16 v[64:67], v[24:27], v[8:11], v[64:67]
    ds_read_b64_tr_b16 v[48:49], v58 offset:61440
    ds_read_b64_tr_b16 v[50:51], v58 offset:63488
    v_mfma_f32_16x16x32_bf16 v[68:71], v[24:27], v[12:15], v[68:71]
    ds_read_b128 v[32:35], v56 offset:17408
    v_mfma_f32_16x16x32_bf16 v[72:75], v[24:27], v[16:19], v[72:75]
    ds_read_b128 v[36:39], v56 offset:19456
    v_mfma_f32_16x16x32_bf16 v[76:79], v[24:27], v[20:23], v[76:79]
    ds_read_b128 v[40:43], v56 offset:21504
    ds_read_b128 v[44:47], v56 offset:23552
    v_mfma_f32_16x16x32_bf16 v[92:95], v[28:31], v[20:23], v[92:95]
    ds_read_b64_tr_b16 v[52:53], v59 offset:61440
    v_mfma_f32_16x16x32_bf16 v[88:91], v[28:31], v[16:19], v[88:91]
    ds_read_b64_tr_b16 v[54:55], v59 offset:63488
    v_mfma_f32_16x16x32_bf16 v[84:87], v[28:31], v[12:15], v[84:87]
    v_mfma_f32_16x16x32_bf16 v[80:83], v[28:31], v[8:11], v[80:83]
    s_waitcnt lgkmcnt(0)
    s_barrier
    v_mfma_f32_16x16x32_bf16 v[64:67], v[48:51], v[32:35], v[64:67]
    ds_read_b64_tr_b16 v[24:25], v60 offset:0
    ds_read_b64_tr_b16 v[26:27], v60 offset:2048
    v_mfma_f32_16x16x32_bf16 v[68:71], v[48:51], v[36:39], v[68:71]
    ds_read_b128 v[8:11], v56 offset:32768
    v_mfma_f32_16x16x32_bf16 v[72:75], v[48:51], v[40:43], v[72:75]
    ds_read_b128 v[12:15], v56 offset:34816
    v_mfma_f32_16x16x32_bf16 v[76:79], v[48:51], v[44:47], v[76:79]
    ds_read_b128 v[16:19], v56 offset:36864
    ds_read_b128 v[20:23], v56 offset:38912
    v_mfma_f32_16x16x32_bf16 v[92:95], v[52:55], v[44:47], v[92:95]
    ds_read_b64_tr_b16 v[28:29], v61 offset:0
    v_mfma_f32_16x16x32_bf16 v[88:91], v[52:55], v[40:43], v[88:91]
    ds_read_b64_tr_b16 v[30:31], v61 offset:2048
    v_mfma_f32_16x16x32_bf16 v[84:87], v[52:55], v[36:39], v[84:87]
    v_mfma_f32_16x16x32_bf16 v[80:83], v[52:55], v[32:35], v[80:83]
    s_waitcnt lgkmcnt(0)
    v_mfma_f32_16x16x32_bf16 v[64:67], v[24:27], v[8:11], v[64:67]
    ds_read_b64_tr_b16 v[48:49], v60 offset:4096
    ds_read_b64_tr_b16 v[50:51], v60 offset:6144
    v_mfma_f32_16x16x32_bf16 v[68:71], v[24:27], v[12:15], v[68:71]
    ds_read_b128 v[32:35], v56 offset:33792
    v_mfma_f32_16x16x32_bf16 v[72:75], v[24:27], v[16:19], v[72:75]
    ds_read_b128 v[36:39], v56 offset:35840
    v_mfma_f32_16x16x32_bf16 v[76:79], v[24:27], v[20:23], v[76:79]
    ds_read_b128 v[40:43], v56 offset:37888
    ds_read_b128 v[44:47], v56 offset:39936
    v_mfma_f32_16x16x32_bf16 v[92:95], v[28:31], v[20:23], v[92:95]
    ds_read_b64_tr_b16 v[52:53], v61 offset:4096
    v_mfma_f32_16x16x32_bf16 v[88:91], v[28:31], v[16:19], v[88:91]
    ds_read_b64_tr_b16 v[54:55], v61 offset:6144
    v_mfma_f32_16x16x32_bf16 v[84:87], v[28:31], v[12:15], v[84:87]
    v_mfma_f32_16x16x32_bf16 v[80:83], v[28:31], v[8:11], v[80:83]
    s_waitcnt lgkmcnt(0)
    s_barrier
    v_mfma_f32_16x16x32_bf16 v[64:67], v[48:51], v[32:35], v[64:67]
    ds_read_b64_tr_b16 v[24:25], v60 offset:8192
    ds_read_b64_tr_b16 v[26:27], v60 offset:10240
    v_mfma_f32_16x16x32_bf16 v[68:71], v[48:51], v[36:39], v[68:71]
    ds_read_b128 v[8:11], v56 offset:49152
    v_mfma_f32_16x16x32_bf16 v[72:75], v[48:51], v[40:43], v[72:75]
    ds_read_b128 v[12:15], v56 offset:51200
    v_mfma_f32_16x16x32_bf16 v[76:79], v[48:51], v[44:47], v[76:79]
    ds_read_b128 v[16:19], v56 offset:53248
    ds_read_b128 v[20:23], v56 offset:55296
    v_mfma_f32_16x16x32_bf16 v[92:95], v[52:55], v[44:47], v[92:95]
    ds_read_b64_tr_b16 v[28:29], v61 offset:8192
    v_mfma_f32_16x16x32_bf16 v[88:91], v[52:55], v[40:43], v[88:91]
    ds_read_b64_tr_b16 v[30:31], v61 offset:10240
    v_mfma_f32_16x16x32_bf16 v[84:87], v[52:55], v[36:39], v[84:87]
    v_mfma_f32_16x16x32_bf16 v[80:83], v[52:55], v[32:35], v[80:83]
    s_waitcnt lgkmcnt(0)
    v_mfma_f32_16x16x32_bf16 v[64:67], v[24:27], v[8:11], v[64:67]
    ds_read_b64_tr_b16 v[48:49], v60 offset:12288
    ds_read_b64_tr_b16 v[50:51], v60 offset:14336
    s_waitcnt vmcnt(0)
    v_lshlrev_b32 v2, 4, v1
    v_permlane16_swap_b32 v96, v98
    v_permlane16_swap_b32 v97, v99
    v_permlane16_swap_b32 v100, v102
    v_permlane16_swap_b32 v101, v103
    v_mfma_f32_16x16x32_bf16 v[68:71], v[24:27], v[12:15], v[68:71]
    ds_read_b128 v[32:35], v56 offset:50176
    v_permlane16_swap_b32 v104, v106
    v_permlane16_swap_b32 v105, v107
    v_permlane16_swap_b32 v108, v110
    v_permlane16_swap_b32 v109, v111
    v_lshlrev_b32 v120, 16, v96
    v_and_b32 v121, 0xffff0000, v96
    v_mfma_f32_16x16x32_bf16 v[72:75], v[24:27], v[16:19], v[72:75]
    ds_read_b128 v[36:39], v56 offset:52224
    v_lshlrev_b32 v122, 16, v97
    v_and_b32 v123, 0xffff0000, v97
    v_lshlrev_b32 v124, 16, v98
    v_and_b32 v125, 0xffff0000, v98
    v_lshlrev_b32 v126, 16, v99
    v_and_b32 v127, 0xffff0000, v99
    v_mfma_f32_16x16x32_bf16 v[76:79], v[24:27], v[20:23], v[76:79]
    ds_read_b128 v[40:43], v56 offset:54272
    ds_read_b128 v[44:47], v56 offset:56320
    v_lshlrev_b32 v128, 16, v100
    v_and_b32 v129, 0xffff0000, v100
    v_lshlrev_b32 v130, 16, v101
    v_and_b32 v131, 0xffff0000, v101
    v_lshlrev_b32 v132, 16, v102
    v_and_b32 v133, 0xffff0000, v102
    v_mfma_f32_16x16x32_bf16 v[92:95], v[28:31], v[20:23], v[92:95]
    ds_read_b64_tr_b16 v[52:53], v61 offset:12288
    v_lshlrev_b32 v134, 16, v103
    v_and_b32 v135, 0xffff0000, v103
    v_lshlrev_b32 v136, 16, v104
    v_and_b32 v137, 0xffff0000, v104
    v_lshlrev_b32 v138, 16, v105
    v_and_b32 v139, 0xffff0000, v105
    v_mfma_f32_16x16x32_bf16 v[88:91], v[28:31], v[16:19], v[88:91]
    ds_read_b64_tr_b16 v[54:55], v61 offset:14336
    v_lshlrev_b32 v140, 16, v106
    v_and_b32 v141, 0xffff0000, v106
    v_lshlrev_b32 v142, 16, v107
    v_and_b32 v143, 0xffff0000, v107
    v_lshlrev_b32 v144, 16, v108
    v_and_b32 v145, 0xffff0000, v108
    v_mfma_f32_16x16x32_bf16 v[84:87], v[28:31], v[12:15], v[84:87]
    v_lshlrev_b32 v146, 16, v109
    v_and_b32 v147, 0xffff0000, v109
    v_lshlrev_b32 v148, 16, v110
    v_and_b32 v149, 0xffff0000, v110
    v_lshlrev_b32 v150, 16, v111
    v_and_b32 v151, 0xffff0000, v111
    v_mfma_f32_16x16x32_bf16 v[80:83], v[28:31], v[8:11], v[80:83]
    s_waitcnt lgkmcnt(0)
    s_barrier
    v_mfma_f32_16x16x32_bf16 v[64:67], v[48:51], v[32:35], v[64:67]
    v_mfma_f32_16x16x32_bf16 v[68:71], v[48:51], v[36:39], v[68:71]
    v_mfma_f32_16x16x32_bf16 v[72:75], v[48:51], v[40:43], v[72:75]
    v_mfma_f32_16x16x32_bf16 v[76:79], v[48:51], v[44:47], v[76:79]
    v_mfma_f32_16x16x32_bf16 v[92:95], v[52:55], v[44:47], v[92:95]
    v_mfma_f32_16x16x32_bf16 v[88:91], v[52:55], v[40:43], v[88:91]
    v_mfma_f32_16x16x32_bf16 v[84:87], v[52:55], v[36:39], v[84:87]
    v_mfma_f32_16x16x32_bf16 v[80:83], v[52:55], v[32:35], v[80:83]
    s_nop 0
    v_pk_add_f32 v[12:13], v[64:65], v[120:121]
    v_pk_add_f32 v[14:15], v[66:67], v[122:123]
    s_nop 4
    v_pk_add_f32 v[16:17], v[80:81], v[124:125]
    v_pk_add_f32 v[18:19], v[82:83], v[126:127]
    v_cvt_pk_bf16_f32 v96, v12, v13
    v_cvt_pk_bf16_f32 v97, v14, v15
    v_cvt_pk_bf16_f32 v98, v16, v17
    v_cvt_pk_bf16_f32 v99, v18, v19
    s_add_u32 s31, s37, 0
    buffer_store_dwordx4 v[96:99], v2, s[8:11], s31 offen sc1
    v_pk_add_f32 v[12:13], v[68:69], v[128:129]
    v_pk_add_f32 v[14:15], v[70:71], v[130:131]
    v_pk_add_f32 v[16:17], v[84:85], v[132:133]
    v_pk_add_f32 v[18:19], v[86:87], v[134:135]
    v_cvt_pk_bf16_f32 v100, v12, v13
    v_cvt_pk_bf16_f32 v101, v14, v15
    v_cvt_pk_bf16_f32 v102, v16, v17
    v_cvt_pk_bf16_f32 v103, v18, v19
    s_add_u32 s31, s37, 32768
    buffer_store_dwordx4 v[100:103], v2, s[8:11], s31 offen sc1
    v_pk_add_f32 v[12:13], v[72:73], v[136:137]
    v_pk_add_f32 v[14:15], v[74:75], v[138:139]
    v_pk_add_f32 v[16:17], v[88:89], v[140:141]
    v_pk_add_f32 v[18:19], v[90:91], v[142:143]
    v_cvt_pk_bf16_f32 v104, v12, v13
    v_cvt_pk_bf16_f32 v105, v14, v15
    v_cvt_pk_bf16_f32 v106, v16, v17
    v_cvt_pk_bf16_f32 v107, v18, v19
    s_add_u32 s31, s37, 65536
    buffer_store_dwordx4 v[104:107], v2, s[8:11], s31 offen sc1
    v_pk_add_f32 v[12:13], v[76:77], v[144:145]
    v_pk_add_f32 v[14:15], v[78:79], v[146:147]
    v_pk_add_f32 v[16:17], v[92:93], v[148:149]
    v_pk_add_f32 v[18:19], v[94:95], v[150:151]
    v_cvt_pk_bf16_f32 v108, v12, v13
    v_cvt_pk_bf16_f32 v109, v14, v15
    v_cvt_pk_bf16_f32 v110, v16, v17
    v_cvt_pk_bf16_f32 v111, v18, v19
    s_add_u32 s31, s37, 98304
    buffer_store_dwordx4 v[108:111], v2, s[8:11], s31 offen sc1
    v_lshlrev_b32 v120, 16, v96
    v_and_b32 v121, 0xffff0000, v96
    v_lshlrev_b32 v122, 16, v97
    v_and_b32 v123, 0xffff0000, v97
    v_lshlrev_b32 v124, 16, v98
    v_and_b32 v125, 0xffff0000, v98
    v_lshlrev_b32 v126, 16, v99
    v_and_b32 v127, 0xffff0000, v99
    v_pk_add_f32 v[12:13], v[120:121], v[122:123]
    v_pk_add_f32 v[14:15], v[124:125], v[126:127]
    v_pk_add_f32 v[12:13], v[12:13], v[14:15]
    v_add_f32 v32, v12, v13
    v_lshlrev_b32 v128, 16, v100
    v_and_b32 v129, 0xffff0000, v100
    v_lshlrev_b32 v130, 16, v101
    v_and_b32 v131, 0xffff0000, v101
    v_lshlrev_b32 v132, 16, v102
    v_and_b32 v133, 0xffff0000, v102
    v_lshlrev_b32 v134, 16, v103
    v_and_b32 v135, 0xffff0000, v103
    v_pk_add_f32 v[12:13], v[128:129], v[130:131]
    v_pk_add_f32 v[14:15], v[132:133], v[134:135]
    v_pk_add_f32 v[12:13], v[12:13], v[14:15]
    v_add_f32 v34, v12, v13
    v_lshlrev_b32 v136, 16, v104
    v_and_b32 v137, 0xffff0000, v104
    v_lshlrev_b32 v138, 16, v105
    v_and_b32 v139, 0xffff0000, v105
    v_lshlrev_b32 v140, 16, v106
    v_and_b32 v141, 0xffff0000, v106
    v_lshlrev_b32 v142, 16, v107
    v_and_b32 v143, 0xffff0000, v107
    v_pk_add_f32 v[12:13], v[136:137], v[138:139]
    v_pk_add_f32 v[14:15], v[140:141], v[142:143]
    v_pk_add_f32 v[12:13], v[12:13], v[14:15]
    v_add_f32 v36, v12, v13
    v_lshlrev_b32 v144, 16, v108
    v_and_b32 v145, 0xffff0000, v108
    v_lshlrev_b32 v146, 16, v109
    v_and_b32 v147, 0xffff0000, v109
    v_lshlrev_b32 v148, 16, v110
    v_and_b32 v149, 0xffff0000, v110
    v_lshlrev_b32 v150, 16, v111
    v_and_b32 v151, 0xffff0000, v111
    v_pk_add_f32 v[12:13], v[144:145], v[146:147]
    v_pk_add_f32 v[14:15], v[148:149], v[150:151]
    v_pk_add_f32 v[12:13], v[12:13], v[14:15]
    v_add_f32 v38, v12, v13
    v_mov_b32 v16, v32
    v_mov_b32 v17, v34
    v_mov_b32 v18, v36
    v_mov_b32 v19, v38
    v_permlane16_swap_b32 v32, v16
    v_permlane16_swap_b32 v34, v17
    v_permlane16_swap_b32 v36, v18
    v_permlane16_swap_b32 v38, v19
    v_add_f32 v32, v32, v16
    v_add_f32 v34, v34, v17
    v_add_f32 v36, v36, v18
    v_add_f32 v38, v38, v19
    v_mov_b32 v16, v32
    v_mov_b32 v17, v34
    v_mov_b32 v18, v36
    v_mov_b32 v19, v38
    v_permlane32_swap_b32 v32, v16
    v_permlane32_swap_b32 v34, v17
    v_permlane32_swap_b32 v36, v18
    v_permlane32_swap_b32 v38, v19
    v_add_f32 v32, v32, v16
    v_add_f32 v34, v34, v17
    v_add_f32 v36, v36, v18
    v_add_f32 v38, v38, v19
    v_mul_f32 v12, 0x3d000000, v32
    v_pk_add_f32 v[120:121], v[120:121], v[12:13] op_sel_hi:[1,0] neg_lo:[0,1] neg_hi:[0,1]
    v_pk_add_f32 v[122:123], v[122:123], v[12:13] op_sel_hi:[1,0] neg_lo:[0,1] neg_hi:[0,1]
    v_pk_add_f32 v[124:125], v[124:125], v[12:13] op_sel_hi:[1,0] neg_lo:[0,1] neg_hi:[0,1]
    v_pk_add_f32 v[126:127], v[126:127], v[12:13] op_sel_hi:[1,0] neg_lo:[0,1] neg_hi:[0,1]
    v_pk_mul_f32 v[14:15], v[120:121], v[120:121]
    v_pk_fma_f32 v[14:15], v[122:123], v[122:123], v[14:15]
    v_pk_fma_f32 v[14:15], v[124:125], v[124:125], v[14:15]
    v_pk_fma_f32 v[14:15], v[126:127], v[126:127], v[14:15]
    v_add_f32 v33, v14, v15
    v_mul_f32 v12, 0x3d000000, v34
    v_pk_add_f32 v[128:129], v[128:129], v[12:13] op_sel_hi:[1,0] neg_lo:[0,1] neg_hi:[0,1]
    v_pk_add_f32 v[130:131], v[130:131], v[12:13] op_sel_hi:[1,0] neg_lo:[0,1] neg_hi:[0,1]
    v_pk_add_f32 v[132:133], v[132:133], v[12:13] op_sel_hi:[1,0] neg_lo:[0,1] neg_hi:[0,1]
    v_pk_add_f32 v[134:135], v[134:135], v[12:13] op_sel_hi:[1,0] neg_lo:[0,1] neg_hi:[0,1]
    v_pk_mul_f32 v[14:15], v[128:129], v[128:129]
    v_pk_fma_f32 v[14:15], v[130:131], v[130:131], v[14:15]
    v_pk_fma_f32 v[14:15], v[132:133], v[132:133], v[14:15]
    v_pk_fma_f32 v[14:15], v[134:135], v[134:135], v[14:15]
    v_add_f32 v35, v14, v15
    v_mul_f32 v12, 0x3d000000, v36
    v_pk_add_f32 v[136:137], v[136:137], v[12:13] op_sel_hi:[1,0] neg_lo:[0,1] neg_hi:[0,1]
    v_pk_add_f32 v[138:139], v[138:139], v[12:13] op_sel_hi:[1,0] neg_lo:[0,1] neg_hi:[0,1]
    v_pk_add_f32 v[140:141], v[140:141], v[12:13] op_sel_hi:[1,0] neg_lo:[0,1] neg_hi:[0,1]
    v_pk_add_f32 v[142:143], v[142:143], v[12:13] op_sel_hi:[1,0] neg_lo:[0,1] neg_hi:[0,1]
    v_pk_mul_f32 v[14:15], v[136:137], v[136:137]
    v_pk_fma_f32 v[14:15], v[138:139], v[138:139], v[14:15]
    v_pk_fma_f32 v[14:15], v[140:141], v[140:141], v[14:15]
    v_pk_fma_f32 v[14:15], v[142:143], v[142:143], v[14:15]
    v_add_f32 v37, v14, v15
    v_mul_f32 v12, 0x3d000000, v38
    v_pk_add_f32 v[144:145], v[144:145], v[12:13] op_sel_hi:[1,0] neg_lo:[0,1] neg_hi:[0,1]
    v_pk_add_f32 v[146:147], v[146:147], v[12:13] op_sel_hi:[1,0] neg_lo:[0,1] neg_hi:[0,1]
    v_pk_add_f32 v[148:149], v[148:149], v[12:13] op_sel_hi:[1,0] neg_lo:[0,1] neg_hi:[0,1]
    v_pk_add_f32 v[150:151], v[150:151], v[12:13] op_sel_hi:[1,0] neg_lo:[0,1] neg_hi:[0,1]
    v_pk_mul_f32 v[14:15], v[144:145], v[144:145]
    v_pk_fma_f32 v[14:15], v[146:147], v[146:147], v[14:15]
    v_pk_fma_f32 v[14:15], v[148:149], v[148:149], v[14:15]
    v_pk_fma_f32 v[14:15], v[150:151], v[150:151], v[14:15]
    v_add_f32 v39, v14, v15
    v_mov_b32 v16, v33
    v_mov_b32 v17, v35
    v_mov_b32 v18, v37
    v_mov_b32 v19, v39
    v_permlane16_swap_b32 v33, v16
    v_permlane16_swap_b32 v35, v17
    v_permlane16_swap_b32 v37, v18
    v_permlane16_swap_b32 v39, v19
    v_add_f32 v33, v33, v16
    v_add_f32 v35, v35, v17
    v_add_f32 v37, v37, v18
    v_add_f32 v39, v39, v19
    v_mov_b32 v16, v33
    v_mov_b32 v17, v35
    v_mov_b32 v18, v37
    v_mov_b32 v19, v39
    v_permlane32_swap_b32 v33, v16
    v_permlane32_swap_b32 v35, v17
    v_permlane32_swap_b32 v37, v18
    v_permlane32_swap_b32 v39, v19
    v_add_f32 v33, v33, v16
    v_add_f32 v35, v35, v17
    v_add_f32 v37, v37, v18
    v_add_f32 v39, v39, v19
    v_cmp_eq_u32 vcc, 1, v3
    s_nop 1
    v_cndmask_b32 v32, v32, v34, vcc
    v_cndmask_b32 v33, v33, v35, vcc
    v_cmp_eq_u32 vcc, 2, v3
    s_nop 1
    v_cndmask_b32 v32, v32, v36, vcc
    v_cndmask_b32 v33, v33, v37, vcc
    v_cmp_eq_u32 vcc, 3, v3
    s_nop 1
    v_cndmask_b32 v32, v32, v38, vcc
    v_cndmask_b32 v33, v33, v39, vcc
    v_lshlrev_b32 v2, 3, v1
    buffer_store_dwordx2 v[32:33], v2, s[8:11], s38 offen sc1
    s_waitcnt vmcnt(1)
    v_mov_b32 v5, 0
    v_mov_b32 v6, 1
    s_mov_b64 exec, 1
    buffer_store_dword v6, v5, s[8:11], s32 offen sc1
    s_mov_b64 exec, -1
    v_mov_b32 v255, 2
    ds_write_b32 v252, v255 offset:3072
    s_and_b32 s24, s22, 1
    s_lshl_b32 s24, s24, 3
    s_and_b32 s30, s23, 7
    s_add_u32 s24, s24, s30
    s_lshr_b32 s25, s22, 1
    s_lshl_b32 s25, s25, 2
    s_lshr_b32 s30, s23, 3
    s_add_u32 s25, s25, s30
    s_mul_i32 s30, s28, 8192
    v_lshl_add_u32 v96, v1, 4, s30
    v_add_u32 v97, 0x10000, v96
    v_bfe_u32 v5, v1, 2, 2
    v_and_b32 v6, 3, v1
    v_lshl_add_u32 v7, v3, 2, v5
    v_bfe_u32 v2, v7, 1, 2
    v_mov_b32 v9, v7
    v_lshlrev_b32 v7, 7, v7
    v_lshl_add_u32 v7, v6, 3, v7
    s_mul_i32 s30, s29, 0
    s_add_u32 s30, s30, 0
    v_xor_b32 v8, s30, v2
    v_lshl_add_u32 v98, v8, 5, v7
    s_mul_i32 s30, s29, 49152
    s_add_u32 s30, s30, 49152
    v_add_u32 v98, s30, v98
    s_mul_i32 s30, s29, 0
    s_add_u32 s30, s30, 1
    v_xor_b32 v8, s30, v2
    v_lshl_add_u32 v99, v8, 5, v7
    s_mul_i32 s30, s29, 49152
    s_add_u32 s30, s30, 49152
    v_add_u32 v99, s30, v99
    s_mul_i32 s30, s29, 0
    s_add_u32 s30, s30, 2
    v_xor_b32 v8, s30, v2
    v_lshl_add_u32 v100, v8, 5, v7
    s_mul_i32 s30, s29, 49152
    s_add_u32 s30, s30, 49152
    v_add_u32 v100, s30, v100
    s_mul_i32 s30, s29, 0
    s_add_u32 s30, s30, 3
    v_xor_b32 v8, s30, v2
    v_lshl_add_u32 v101, v8, 5, v7
    s_mul_i32 s30, s29, 49152
    s_add_u32 s30, s30, 49152
    v_add_u32 v101, s30, v101
    s_mul_i32 s30, s29, 2
    s_add_u32 s30, s30, 0
    v_xor_b32 v8, s30, v2
    v_lshl_add_u32 v102, v8, 5, v7
    s_mul_i32 s30, s29, 0
    s_add_u32 s30, s30, 73728
    v_add_u32 v102, s30, v102
    s_mul_i32 s30, s29, 2
    s_add_u32 s30, s30, 1
    v_xor_b32 v8, s30, v2
    v_lshl_add_u32 v103, v8, 5, v7
    s_mul_i32 s30, s29, 0
    s_add_u32 s30, s30, 73728
    v_add_u32 v103, s30, v103
    v_bfe_u32 v8, v9, 2, 1
    v_xor_b32 v8, s29, v8
    v_lshlrev_b32 v8, 5, v8
    v_lshl_add_u32 v8, v9, 6, v8
    v_lshl_add_u32 v8, v6, 3, v8
    v_add_u32 v104, 122880, v8
    v_mov_b64 v[108:109], 0
    v_mov_b64 v[110:111], 0
    v_mov_b64 v[112:113], 0
    v_mov_b64 v[114:115], 0
    v_mov_b64 v[116:117], 0
    v_mov_b64 v[118:119], 0
    v_mov_b64 v[120:121], 0
    v_mov_b64 v[122:123], 0
    v_mov_b64 v[124:125], 0
    v_mov_b64 v[126:127], 0
    v_mov_b64 v[128:129], 0
    v_mov_b64 v[130:131], 0
    v_mov_b64 v[132:133], 0
    v_mov_b64 v[134:135], 0
    v_mov_b64 v[136:137], 0
    v_mov_b64 v[138:139], 0
    v_mov_b64 v[140:141], 0
    v_mov_b64 v[142:143], 0
    v_mov_b64 v[144:145], 0
    v_mov_b64 v[146:147], 0
    v_mov_b64 v[148:149], 0
    v_mov_b64 v[150:151], 0
    v_mov_b64 v[152:153], 0
    v_mov_b64 v[154:155], 0
    v_mov_b64 v[156:157], 0
    v_mov_b64 v[158:159], 0
    v_mov_b64 v[160:161], 0
    v_mov_b64 v[162:163], 0
    v_mov_b64 v[164:165], 0
    v_mov_b64 v[166:167], 0
    v_mov_b64 v[168:169], 0
    v_mov_b64 v[170:171], 0
    v_mov_b64 v[172:173], 0
    v_mov_b64 v[174:175], 0
    v_mov_b64 v[176:177], 0
    v_mov_b64 v[178:179], 0
    v_mov_b64 v[180:181], 0
    v_mov_b64 v[182:183], 0
    v_mov_b64 v[184:185], 0
    v_mov_b64 v[186:187], 0
    v_mov_b64 v[188:189], 0
    v_mov_b64 v[190:191], 0
    v_mov_b64 v[192:193], 0
    v_mov_b64 v[194:195], 0
    v_mov_b64 v[196:197], 0
    v_mov_b64 v[198:199], 0
    v_mov_b64 v[200:201], 0
    v_mov_b64 v[202:203], 0
    v_mov_b64 v[204:205], 0
    v_mov_b64 v[206:207], 0
    v_mov_b64 v[208:209], 0
    v_mov_b64 v[210:211], 0
    v_mov_b64 v[212:213], 0
    v_mov_b64 v[214:215], 0
    v_mov_b64 v[216:217], 0
    v_mov_b64 v[218:219], 0
    s_mov_b32 s40, s32
    s_cmp_lg_u32 s54, 0
    s_cselect_b32 s37, 25165824, 0

    s_and_b32 s39, s25, 1
    s_add_u32 s32, s100, s37
    s_lshl_b32 s33, s28, 12
    s_add_u32 s32, s32, s33
    s_lshl_b32 s34, s29, 2
    s_add_u32 s34, s34, s39
    s_add_u32 s35, s39, s29
    s_add_u32 s35, s35, 2
    s_xor_b32 s36, s39, 1
    s_mul_i32 s36, s36, 6
    s_lshl_b32 s34, s34, 13
    s_lshl_b32 s35, s35, 13
    s_lshl_b32 s36, s36, 13
    s_add_u32 s34, s34, s32
    s_add_u32 s35, s35, s32
    s_add_u32 s36, s36, s32
    s_lshl_b32 s37, s29, 3
    s_add_u32 s36, s36, s37
    s_add_u32 s37, s34, 8192
    s_mov_b32 s74, 0xbfb8aa3b
    s_mov_b32 s75, 0xbfb8aa3b

    s_lshl_b32 s38, s24, 2
    s_lshr_b32 s30, s25, 2
    s_add_u32 s38, s38, s30
    s_lshl_b32 s38, s38, 3
    s_and_b32 s30, s25, 3
    s_add_u32 s38, s38, s30
    s_lshl_b32 s38, s38, 2
    s_add_u32 s38, s38, s21
    s_lshl_b32 s38, s38, 2
    s_add_u32 s38, s38, 44171264
    s_barrier
    ds_read_b64_tr_b16 v[24:25], v98 offset:0
    ds_read_b64_tr_b16 v[26:27], v98 offset:2048
    ds_read_b128 v[8:11], v96 offset:0
    ds_read_b128 v[12:15], v96 offset:2048
    ds_read_b128 v[16:19], v96 offset:4096
    ds_read_b128 v[20:23], v96 offset:6144
    ds_read_b64_tr_b16 v[28:29], v99 offset:0
    ds_read_b64_tr_b16 v[30:31], v99 offset:2048
    ds_read_b64_tr_b16 v[32:33], v100 offset:0
    ds_read_b64_tr_b16 v[34:35], v100 offset:2048
    ds_read_b64_tr_b16 v[36:37], v101 offset:0
    ds_read_b64_tr_b16 v[38:39], v101 offset:2048
    ds_read_b64_tr_b16 v[40:41], v102 offset:0
    ds_read_b64_tr_b16 v[42:43], v102 offset:2048
    ds_read_b64_tr_b16 v[44:45], v103 offset:0
    ds_read_b64_tr_b16 v[46:47], v103 offset:2048
    ds_read_b64_tr_b16 v[48:49], v104 offset:0
    ds_read_b64_tr_b16 v[50:51], v104 offset:1024
    s_waitcnt vmcnt(0)
    v_mov_b32 v5, 0
    v_mov_b32 v6, 3
    s_mov_b64 exec, 1
    buffer_store_dword v6, v5, s[8:11], s40 offen sc1
    s_mov_b64 exec, -1
    s_mov_b32 s72, 5
w1_cloop:
    s_waitcnt lgkmcnt(0)
    v_mfma_f32_16x16x32_bf16 v[108:111], v[24:27], v[8:11], v[108:111]
    ds_read_b64_tr_b16 v[68:69], v98 offset:4096
    v_mfma_f32_16x16x32_bf16 v[112:115], v[24:27], v[12:15], v[112:115]
    ds_read_b64_tr_b16 v[70:71], v98 offset:6144
    v_mfma_f32_16x16x32_bf16 v[116:119], v[24:27], v[16:19], v[116:119]
    ds_read_b128 v[52:55], v96 offset:1024
    v_mfma_f32_16x16x32_bf16 v[120:123], v[24:27], v[20:23], v[120:123]
    ds_read_b128 v[56:59], v96 offset:3072
    v_mfma_f32_16x16x32_bf16 v[136:139], v[28:31], v[20:23], v[136:139]
    ds_read_b128 v[60:63], v96 offset:5120
    v_mfma_f32_16x16x32_bf16 v[132:135], v[28:31], v[16:19], v[132:135]
    ds_read_b128 v[64:67], v96 offset:7168
    v_mfma_f32_16x16x32_bf16 v[128:131], v[28:31], v[12:15], v[128:131]
    v_mfma_f32_16x16x32_bf16 v[124:127], v[28:31], v[8:11], v[124:127]
    ds_read_b64_tr_b16 v[72:73], v99 offset:4096
    v_mfma_f32_16x16x32_bf16 v[140:143], v[32:35], v[8:11], v[140:143]
    ds_read_b64_tr_b16 v[74:75], v99 offset:6144
    v_mfma_f32_16x16x32_bf16 v[144:147], v[32:35], v[12:15], v[144:147]
    ds_read_b64_tr_b16 v[76:77], v100 offset:4096
    v_mfma_f32_16x16x32_bf16 v[148:151], v[32:35], v[16:19], v[148:151]
    ds_read_b64_tr_b16 v[78:79], v100 offset:6144
    v_mfma_f32_16x16x32_bf16 v[152:155], v[32:35], v[20:23], v[152:155]
    ds_read_b64_tr_b16 v[80:81], v101 offset:4096
    v_mfma_f32_16x16x32_bf16 v[168:171], v[36:39], v[20:23], v[168:171]
    ds_read_b64_tr_b16 v[82:83], v101 offset:6144
    v_mfma_f32_16x16x32_bf16 v[164:167], v[36:39], v[16:19], v[164:167]
    v_mfma_f32_16x16x32_bf16 v[160:163], v[36:39], v[12:15], v[160:163]
    ds_read_b64_tr_b16 v[84:85], v102 offset:4096
    v_mfma_f32_16x16x32_bf16 v[156:159], v[36:39], v[8:11], v[156:159]
    ds_read_b64_tr_b16 v[86:87], v102 offset:6144
    v_mfma_f32_16x16x32_bf16 v[172:175], v[40:43], v[8:11], v[172:175]
    ds_read_b64_tr_b16 v[88:89], v103 offset:4096
    v_mfma_f32_16x16x32_bf16 v[176:179], v[40:43], v[12:15], v[176:179]
    ds_read_b64_tr_b16 v[90:91], v103 offset:6144
    v_mfma_f32_16x16x32_bf16 v[180:183], v[40:43], v[16:19], v[180:183]
    ds_read_b64_tr_b16 v[92:93], v104 offset:2048
    v_mfma_f32_16x16x32_bf16 v[184:187], v[40:43], v[20:23], v[184:187]
    ds_read_b64_tr_b16 v[94:95], v104 offset:3072
    v_mfma_f32_16x16x32_bf16 v[200:203], v[44:47], v[20:23], v[200:203]
    v_mfma_f32_16x16x32_bf16 v[196:199], v[44:47], v[16:19], v[196:199]
    v_mfma_f32_16x16x32_bf16 v[192:195], v[44:47], v[12:15], v[192:195]
    v_mfma_f32_16x16x32_bf16 v[188:191], v[44:47], v[8:11], v[188:191]
    v_mfma_f32_16x16x32_bf16 v[204:207], v[48:51], v[8:11], v[204:207]
    v_mfma_f32_16x16x32_bf16 v[208:211], v[48:51], v[12:15], v[208:211]
    v_mfma_f32_16x16x32_bf16 v[212:215], v[48:51], v[16:19], v[212:215]
    v_mfma_f32_16x16x32_bf16 v[216:219], v[48:51], v[20:23], v[216:219]
    s_waitcnt lgkmcnt(0)
    s_barrier
    v_mfma_f32_16x16x32_bf16 v[108:111], v[68:71], v[52:55], v[108:111]
    ds_read_b64_tr_b16 v[24:25], v98 offset:8192
    v_mfma_f32_16x16x32_bf16 v[112:115], v[68:71], v[56:59], v[112:115]
    ds_read_b64_tr_b16 v[26:27], v98 offset:10240
    v_mfma_f32_16x16x32_bf16 v[116:119], v[68:71], v[60:63], v[116:119]
    ds_read_b128 v[8:11], v96 offset:16384
    v_mfma_f32_16x16x32_bf16 v[120:123], v[68:71], v[64:67], v[120:123]
    ds_read_b128 v[12:15], v96 offset:18432
    v_mfma_f32_16x16x32_bf16 v[136:139], v[72:75], v[64:67], v[136:139]
    ds_read_b128 v[16:19], v96 offset:20480
    v_mfma_f32_16x16x32_bf16 v[132:135], v[72:75], v[60:63], v[132:135]
    ds_read_b128 v[20:23], v96 offset:22528
    v_mfma_f32_16x16x32_bf16 v[128:131], v[72:75], v[56:59], v[128:131]
    v_mfma_f32_16x16x32_bf16 v[124:127], v[72:75], v[52:55], v[124:127]
    ds_read_b64_tr_b16 v[28:29], v99 offset:8192
    v_mfma_f32_16x16x32_bf16 v[140:143], v[76:79], v[52:55], v[140:143]
    ds_read_b64_tr_b16 v[30:31], v99 offset:10240
    v_mfma_f32_16x16x32_bf16 v[144:147], v[76:79], v[56:59], v[144:147]
    ds_read_b64_tr_b16 v[32:33], v100 offset:8192
    v_mfma_f32_16x16x32_bf16 v[148:151], v[76:79], v[60:63], v[148:151]
    ds_read_b64_tr_b16 v[34:35], v100 offset:10240
    v_mfma_f32_16x16x32_bf16 v[152:155], v[76:79], v[64:67], v[152:155]
    ds_read_b64_tr_b16 v[36:37], v101 offset:8192
    v_mfma_f32_16x16x32_bf16 v[168:171], v[80:83], v[64:67], v[168:171]
    ds_read_b64_tr_b16 v[38:39], v101 offset:10240
    v_mfma_f32_16x16x32_bf16 v[164:167], v[80:83], v[60:63], v[164:167]
    v_mfma_f32_16x16x32_bf16 v[160:163], v[80:83], v[56:59], v[160:163]
    ds_read_b64_tr_b16 v[40:41], v102 offset:8192
    v_mfma_f32_16x16x32_bf16 v[156:159], v[80:83], v[52:55], v[156:159]
    ds_read_b64_tr_b16 v[42:43], v102 offset:10240
    v_mfma_f32_16x16x32_bf16 v[172:175], v[84:87], v[52:55], v[172:175]
    ds_read_b64_tr_b16 v[44:45], v103 offset:8192
    v_mfma_f32_16x16x32_bf16 v[176:179], v[84:87], v[56:59], v[176:179]
    ds_read_b64_tr_b16 v[46:47], v103 offset:10240
    v_mfma_f32_16x16x32_bf16 v[180:183], v[84:87], v[60:63], v[180:183]
    ds_read_b64_tr_b16 v[48:49], v104 offset:4096
    v_mfma_f32_16x16x32_bf16 v[184:187], v[84:87], v[64:67], v[184:187]
    ds_read_b64_tr_b16 v[50:51], v104 offset:5120
    v_mfma_f32_16x16x32_bf16 v[200:203], v[88:91], v[64:67], v[200:203]
    v_mfma_f32_16x16x32_bf16 v[196:199], v[88:91], v[60:63], v[196:199]
    v_mfma_f32_16x16x32_bf16 v[192:195], v[88:91], v[56:59], v[192:195]
    v_mfma_f32_16x16x32_bf16 v[188:191], v[88:91], v[52:55], v[188:191]
    v_mfma_f32_16x16x32_bf16 v[204:207], v[92:95], v[52:55], v[204:207]
    v_mfma_f32_16x16x32_bf16 v[208:211], v[92:95], v[56:59], v[208:211]
    v_mfma_f32_16x16x32_bf16 v[212:215], v[92:95], v[60:63], v[212:215]
    v_mfma_f32_16x16x32_bf16 v[216:219], v[92:95], v[64:67], v[216:219]
    s_waitcnt lgkmcnt(0)
    v_mfma_f32_16x16x32_bf16 v[108:111], v[24:27], v[8:11], v[108:111]
    ds_read_b64_tr_b16 v[68:69], v98 offset:12288
    v_mfma_f32_16x16x32_bf16 v[112:115], v[24:27], v[12:15], v[112:115]
    ds_read_b64_tr_b16 v[70:71], v98 offset:14336
    v_mfma_f32_16x16x32_bf16 v[116:119], v[24:27], v[16:19], v[116:119]
    ds_read_b128 v[52:55], v96 offset:17408
    v_mfma_f32_16x16x32_bf16 v[120:123], v[24:27], v[20:23], v[120:123]
    ds_read_b128 v[56:59], v96 offset:19456
    v_mfma_f32_16x16x32_bf16 v[136:139], v[28:31], v[20:23], v[136:139]
    ds_read_b128 v[60:63], v96 offset:21504
    v_mfma_f32_16x16x32_bf16 v[132:135], v[28:31], v[16:19], v[132:135]
    ds_read_b128 v[64:67], v96 offset:23552
    v_mfma_f32_16x16x32_bf16 v[128:131], v[28:31], v[12:15], v[128:131]
    v_mfma_f32_16x16x32_bf16 v[124:127], v[28:31], v[8:11], v[124:127]
    ds_read_b64_tr_b16 v[72:73], v99 offset:12288
    v_mfma_f32_16x16x32_bf16 v[140:143], v[32:35], v[8:11], v[140:143]
    ds_read_b64_tr_b16 v[74:75], v99 offset:14336
    v_mfma_f32_16x16x32_bf16 v[144:147], v[32:35], v[12:15], v[144:147]
    ds_read_b64_tr_b16 v[76:77], v100 offset:12288
    v_mfma_f32_16x16x32_bf16 v[148:151], v[32:35], v[16:19], v[148:151]
    ds_read_b64_tr_b16 v[78:79], v100 offset:14336
    v_mfma_f32_16x16x32_bf16 v[152:155], v[32:35], v[20:23], v[152:155]
    ds_read_b64_tr_b16 v[80:81], v101 offset:12288
    v_mfma_f32_16x16x32_bf16 v[168:171], v[36:39], v[20:23], v[168:171]
    ds_read_b64_tr_b16 v[82:83], v101 offset:14336
    v_mfma_f32_16x16x32_bf16 v[164:167], v[36:39], v[16:19], v[164:167]
    v_mfma_f32_16x16x32_bf16 v[160:163], v[36:39], v[12:15], v[160:163]
    ds_read_b64_tr_b16 v[84:85], v102 offset:12288
    v_mfma_f32_16x16x32_bf16 v[156:159], v[36:39], v[8:11], v[156:159]
    ds_read_b64_tr_b16 v[86:87], v102 offset:14336
    v_mfma_f32_16x16x32_bf16 v[172:175], v[40:43], v[8:11], v[172:175]
    ds_read_b64_tr_b16 v[88:89], v103 offset:12288
    v_mfma_f32_16x16x32_bf16 v[176:179], v[40:43], v[12:15], v[176:179]
    ds_read_b64_tr_b16 v[90:91], v103 offset:14336
    v_mfma_f32_16x16x32_bf16 v[180:183], v[40:43], v[16:19], v[180:183]
    ds_read_b64_tr_b16 v[92:93], v104 offset:6144
    v_mfma_f32_16x16x32_bf16 v[184:187], v[40:43], v[20:23], v[184:187]
    ds_read_b64_tr_b16 v[94:95], v104 offset:7168
    v_mfma_f32_16x16x32_bf16 v[200:203], v[44:47], v[20:23], v[200:203]
    v_mfma_f32_16x16x32_bf16 v[196:199], v[44:47], v[16:19], v[196:199]
    v_mfma_f32_16x16x32_bf16 v[192:195], v[44:47], v[12:15], v[192:195]
    v_mfma_f32_16x16x32_bf16 v[188:191], v[44:47], v[8:11], v[188:191]
    v_mfma_f32_16x16x32_bf16 v[204:207], v[48:51], v[8:11], v[204:207]
    v_mfma_f32_16x16x32_bf16 v[208:211], v[48:51], v[12:15], v[208:211]
    v_mfma_f32_16x16x32_bf16 v[212:215], v[48:51], v[16:19], v[212:215]
    v_mfma_f32_16x16x32_bf16 v[216:219], v[48:51], v[20:23], v[216:219]
    s_waitcnt lgkmcnt(0)
    s_barrier
    v_mfma_f32_16x16x32_bf16 v[108:111], v[68:71], v[52:55], v[108:111]
    ds_read_b64_tr_b16 v[24:25], v98 offset:16384
    v_mfma_f32_16x16x32_bf16 v[112:115], v[68:71], v[56:59], v[112:115]
    ds_read_b64_tr_b16 v[26:27], v98 offset:18432
    v_mfma_f32_16x16x32_bf16 v[116:119], v[68:71], v[60:63], v[116:119]
    ds_read_b128 v[8:11], v96 offset:32768
    v_mfma_f32_16x16x32_bf16 v[120:123], v[68:71], v[64:67], v[120:123]
    ds_read_b128 v[12:15], v96 offset:34816
    v_mfma_f32_16x16x32_bf16 v[136:139], v[72:75], v[64:67], v[136:139]
    ds_read_b128 v[16:19], v96 offset:36864
    v_mfma_f32_16x16x32_bf16 v[132:135], v[72:75], v[60:63], v[132:135]
    ds_read_b128 v[20:23], v96 offset:38912
    v_mfma_f32_16x16x32_bf16 v[128:131], v[72:75], v[56:59], v[128:131]
    v_mfma_f32_16x16x32_bf16 v[124:127], v[72:75], v[52:55], v[124:127]
    ds_read_b64_tr_b16 v[28:29], v99 offset:16384
    v_mfma_f32_16x16x32_bf16 v[140:143], v[76:79], v[52:55], v[140:143]
    ds_read_b64_tr_b16 v[30:31], v99 offset:18432
    v_mfma_f32_16x16x32_bf16 v[144:147], v[76:79], v[56:59], v[144:147]
    ds_read_b64_tr_b16 v[32:33], v100 offset:16384
    v_mfma_f32_16x16x32_bf16 v[148:151], v[76:79], v[60:63], v[148:151]
    ds_read_b64_tr_b16 v[34:35], v100 offset:18432
    v_mfma_f32_16x16x32_bf16 v[152:155], v[76:79], v[64:67], v[152:155]
    ds_read_b64_tr_b16 v[36:37], v101 offset:16384
    v_mfma_f32_16x16x32_bf16 v[168:171], v[80:83], v[64:67], v[168:171]
    ds_read_b64_tr_b16 v[38:39], v101 offset:18432
    v_mfma_f32_16x16x32_bf16 v[164:167], v[80:83], v[60:63], v[164:167]
    v_mfma_f32_16x16x32_bf16 v[160:163], v[80:83], v[56:59], v[160:163]
    ds_read_b64_tr_b16 v[40:41], v102 offset:16384
    v_mfma_f32_16x16x32_bf16 v[156:159], v[80:83], v[52:55], v[156:159]
    ds_read_b64_tr_b16 v[42:43], v102 offset:18432
    v_mfma_f32_16x16x32_bf16 v[172:175], v[84:87], v[52:55], v[172:175]
    ds_read_b64_tr_b16 v[44:45], v103 offset:16384
    v_mfma_f32_16x16x32_bf16 v[176:179], v[84:87], v[56:59], v[176:179]
    ds_read_b64_tr_b16 v[46:47], v103 offset:18432
    v_mfma_f32_16x16x32_bf16 v[180:183], v[84:87], v[60:63], v[180:183]
    ds_read_b64_tr_b16 v[48:49], v104 offset:8192
    v_mfma_f32_16x16x32_bf16 v[184:187], v[84:87], v[64:67], v[184:187]
    ds_read_b64_tr_b16 v[50:51], v104 offset:9216
    v_mfma_f32_16x16x32_bf16 v[200:203], v[88:91], v[64:67], v[200:203]
    v_mfma_f32_16x16x32_bf16 v[196:199], v[88:91], v[60:63], v[196:199]
    v_mfma_f32_16x16x32_bf16 v[192:195], v[88:91], v[56:59], v[192:195]
    v_mfma_f32_16x16x32_bf16 v[188:191], v[88:91], v[52:55], v[188:191]
    v_mfma_f32_16x16x32_bf16 v[204:207], v[92:95], v[52:55], v[204:207]
    v_mfma_f32_16x16x32_bf16 v[208:211], v[92:95], v[56:59], v[208:211]
    v_mfma_f32_16x16x32_bf16 v[212:215], v[92:95], v[60:63], v[212:215]
    v_mfma_f32_16x16x32_bf16 v[216:219], v[92:95], v[64:67], v[216:219]
    s_waitcnt lgkmcnt(0)
    v_mfma_f32_16x16x32_bf16 v[108:111], v[24:27], v[8:11], v[108:111]
    ds_read_b64_tr_b16 v[68:69], v98 offset:20480
    v_mfma_f32_16x16x32_bf16 v[112:115], v[24:27], v[12:15], v[112:115]
    ds_read_b64_tr_b16 v[70:71], v98 offset:22528
    v_mfma_f32_16x16x32_bf16 v[116:119], v[24:27], v[16:19], v[116:119]
    ds_read_b128 v[52:55], v96 offset:33792
    v_mfma_f32_16x16x32_bf16 v[120:123], v[24:27], v[20:23], v[120:123]
    ds_read_b128 v[56:59], v96 offset:35840
    v_mfma_f32_16x16x32_bf16 v[136:139], v[28:31], v[20:23], v[136:139]
    ds_read_b128 v[60:63], v96 offset:37888
    v_mfma_f32_16x16x32_bf16 v[132:135], v[28:31], v[16:19], v[132:135]
    ds_read_b128 v[64:67], v96 offset:39936
    v_mfma_f32_16x16x32_bf16 v[128:131], v[28:31], v[12:15], v[128:131]
    v_mfma_f32_16x16x32_bf16 v[124:127], v[28:31], v[8:11], v[124:127]
    ds_read_b64_tr_b16 v[72:73], v99 offset:20480
    v_mfma_f32_16x16x32_bf16 v[140:143], v[32:35], v[8:11], v[140:143]
    ds_read_b64_tr_b16 v[74:75], v99 offset:22528
    v_mfma_f32_16x16x32_bf16 v[144:147], v[32:35], v[12:15], v[144:147]
    ds_read_b64_tr_b16 v[76:77], v100 offset:20480
    v_mfma_f32_16x16x32_bf16 v[148:151], v[32:35], v[16:19], v[148:151]
    ds_read_b64_tr_b16 v[78:79], v100 offset:22528
    v_mfma_f32_16x16x32_bf16 v[152:155], v[32:35], v[20:23], v[152:155]
    ds_read_b64_tr_b16 v[80:81], v101 offset:20480
    v_mfma_f32_16x16x32_bf16 v[168:171], v[36:39], v[20:23], v[168:171]
    ds_read_b64_tr_b16 v[82:83], v101 offset:22528
    v_mfma_f32_16x16x32_bf16 v[164:167], v[36:39], v[16:19], v[164:167]
    v_mfma_f32_16x16x32_bf16 v[160:163], v[36:39], v[12:15], v[160:163]
    ds_read_b64_tr_b16 v[84:85], v102 offset:20480
    v_mfma_f32_16x16x32_bf16 v[156:159], v[36:39], v[8:11], v[156:159]
    ds_read_b64_tr_b16 v[86:87], v102 offset:22528
    v_mfma_f32_16x16x32_bf16 v[172:175], v[40:43], v[8:11], v[172:175]
    ds_read_b64_tr_b16 v[88:89], v103 offset:20480
    v_mfma_f32_16x16x32_bf16 v[176:179], v[40:43], v[12:15], v[176:179]
    ds_read_b64_tr_b16 v[90:91], v103 offset:22528
    v_mfma_f32_16x16x32_bf16 v[180:183], v[40:43], v[16:19], v[180:183]
    ds_read_b64_tr_b16 v[92:93], v104 offset:10240
    v_mfma_f32_16x16x32_bf16 v[184:187], v[40:43], v[20:23], v[184:187]
    ds_read_b64_tr_b16 v[94:95], v104 offset:11264
    v_mfma_f32_16x16x32_bf16 v[200:203], v[44:47], v[20:23], v[200:203]
    v_mfma_f32_16x16x32_bf16 v[196:199], v[44:47], v[16:19], v[196:199]
    v_mfma_f32_16x16x32_bf16 v[192:195], v[44:47], v[12:15], v[192:195]
    v_mfma_f32_16x16x32_bf16 v[188:191], v[44:47], v[8:11], v[188:191]
    v_mfma_f32_16x16x32_bf16 v[204:207], v[48:51], v[8:11], v[204:207]
    v_mfma_f32_16x16x32_bf16 v[208:211], v[48:51], v[12:15], v[208:211]
    v_mfma_f32_16x16x32_bf16 v[212:215], v[48:51], v[16:19], v[212:215]
    v_mfma_f32_16x16x32_bf16 v[216:219], v[48:51], v[20:23], v[216:219]
    s_waitcnt lgkmcnt(0)
    s_barrier
    v_mfma_f32_16x16x32_bf16 v[108:111], v[68:71], v[52:55], v[108:111]
    ds_read_b64_tr_b16 v[24:25], v98 offset:0
    v_mfma_f32_16x16x32_bf16 v[112:115], v[68:71], v[56:59], v[112:115]
    ds_read_b64_tr_b16 v[26:27], v98 offset:2048
    v_mfma_f32_16x16x32_bf16 v[116:119], v[68:71], v[60:63], v[116:119]
    ds_read_b128 v[8:11], v96 offset:0
    v_mfma_f32_16x16x32_bf16 v[120:123], v[68:71], v[64:67], v[120:123]
    ds_read_b128 v[12:15], v96 offset:2048
    v_mfma_f32_16x16x32_bf16 v[136:139], v[72:75], v[64:67], v[136:139]
    ds_read_b128 v[16:19], v96 offset:4096
    v_mfma_f32_16x16x32_bf16 v[132:135], v[72:75], v[60:63], v[132:135]
    ds_read_b128 v[20:23], v96 offset:6144
    v_mfma_f32_16x16x32_bf16 v[128:131], v[72:75], v[56:59], v[128:131]
    v_mfma_f32_16x16x32_bf16 v[124:127], v[72:75], v[52:55], v[124:127]
    ds_read_b64_tr_b16 v[28:29], v99 offset:0
    v_mfma_f32_16x16x32_bf16 v[140:143], v[76:79], v[52:55], v[140:143]
    ds_read_b64_tr_b16 v[30:31], v99 offset:2048
    v_mfma_f32_16x16x32_bf16 v[144:147], v[76:79], v[56:59], v[144:147]
    ds_read_b64_tr_b16 v[32:33], v100 offset:0
    v_mfma_f32_16x16x32_bf16 v[148:151], v[76:79], v[60:63], v[148:151]
    ds_read_b64_tr_b16 v[34:35], v100 offset:2048
    v_mfma_f32_16x16x32_bf16 v[152:155], v[76:79], v[64:67], v[152:155]
    ds_read_b64_tr_b16 v[36:37], v101 offset:0
    v_mfma_f32_16x16x32_bf16 v[168:171], v[80:83], v[64:67], v[168:171]
    ds_read_b64_tr_b16 v[38:39], v101 offset:2048
    v_mfma_f32_16x16x32_bf16 v[164:167], v[80:83], v[60:63], v[164:167]
    v_mfma_f32_16x16x32_bf16 v[160:163], v[80:83], v[56:59], v[160:163]
    ds_read_b64_tr_b16 v[40:41], v102 offset:0
    v_mfma_f32_16x16x32_bf16 v[156:159], v[80:83], v[52:55], v[156:159]
    ds_read_b64_tr_b16 v[42:43], v102 offset:2048
    v_mfma_f32_16x16x32_bf16 v[172:175], v[84:87], v[52:55], v[172:175]
    ds_read_b64_tr_b16 v[44:45], v103 offset:0
    v_mfma_f32_16x16x32_bf16 v[176:179], v[84:87], v[56:59], v[176:179]
    ds_read_b64_tr_b16 v[46:47], v103 offset:2048
    v_mfma_f32_16x16x32_bf16 v[180:183], v[84:87], v[60:63], v[180:183]
    ds_read_b64_tr_b16 v[48:49], v104 offset:0
    v_mfma_f32_16x16x32_bf16 v[184:187], v[84:87], v[64:67], v[184:187]
    ds_read_b64_tr_b16 v[50:51], v104 offset:1024
    v_mfma_f32_16x16x32_bf16 v[200:203], v[88:91], v[64:67], v[200:203]
    v_mfma_f32_16x16x32_bf16 v[196:199], v[88:91], v[60:63], v[196:199]
    v_mfma_f32_16x16x32_bf16 v[192:195], v[88:91], v[56:59], v[192:195]
    v_mfma_f32_16x16x32_bf16 v[188:191], v[88:91], v[52:55], v[188:191]
    v_mfma_f32_16x16x32_bf16 v[204:207], v[92:95], v[52:55], v[204:207]
    v_mfma_f32_16x16x32_bf16 v[208:211], v[92:95], v[56:59], v[208:211]
    v_mfma_f32_16x16x32_bf16 v[212:215], v[92:95], v[60:63], v[212:215]
    v_mfma_f32_16x16x32_bf16 v[216:219], v[92:95], v[64:67], v[216:219]
    s_sub_u32 s72, s72, 1
    s_cmp_lg_u32 s72, 0
    s_cbranch_scc1 w1_cloop
    s_waitcnt lgkmcnt(0)
    v_mfma_f32_16x16x32_bf16 v[108:111], v[24:27], v[8:11], v[108:111]
    ds_read_b64_tr_b16 v[68:69], v98 offset:4096
    s_lshl_b32 s30, s28, 9
    v_mfma_f32_16x16x32_bf16 v[112:115], v[24:27], v[12:15], v[112:115]
    ds_read_b64_tr_b16 v[70:71], v98 offset:6144
    s_add_u32 s30, s30, 157696
    v_mfma_f32_16x16x32_bf16 v[116:119], v[24:27], v[16:19], v[116:119]
    ds_read_b128 v[52:55], v96 offset:1024
    v_lshl_add_u32 v2, v4, 3, s30
    v_mfma_f32_16x16x32_bf16 v[120:123], v[24:27], v[20:23], v[120:123]
    ds_read_b128 v[56:59], v96 offset:3072
    s_lshl_b32 s31, s39, 7
    v_mfma_f32_16x16x32_bf16 v[136:139], v[28:31], v[20:23], v[136:139]
    ds_read_b128 v[60:63], v96 offset:5120
    s_lshl_b32 s32, s29, 9
    v_mfma_f32_16x16x32_bf16 v[132:135], v[28:31], v[16:19], v[132:135]
    ds_read_b128 v[64:67], v96 offset:7168
    s_add_u32 s32, s32, s31
    v_mfma_f32_16x16x32_bf16 v[128:131], v[28:31], v[12:15], v[128:131]
    s_add_u32 s32, s32, 158720
    v_mfma_f32_16x16x32_bf16 v[124:127], v[28:31], v[8:11], v[124:127]
    ds_read_b64_tr_b16 v[72:73], v99 offset:4096
    v_lshl_add_u32 v5, v3, 4, s32
    v_mfma_f32_16x16x32_bf16 v[140:143], v[32:35], v[8:11], v[140:143]
    ds_read_b64_tr_b16 v[74:75], v99 offset:6144
    s_lshl_b32 s32, s29, 7
    v_mfma_f32_16x16x32_bf16 v[144:147], v[32:35], v[12:15], v[144:147]
    ds_read_b64_tr_b16 v[76:77], v100 offset:4096
    s_add_u32 s32, s32, s31
    v_mfma_f32_16x16x32_bf16 v[148:151], v[32:35], v[16:19], v[148:151]
    ds_read_b64_tr_b16 v[78:79], v100 offset:6144
    s_add_u32 s32, s32, 158976
    v_mfma_f32_16x16x32_bf16 v[152:155], v[32:35], v[20:23], v[152:155]
    ds_read_b64_tr_b16 v[80:81], v101 offset:4096
    v_lshl_add_u32 v6, v3, 4, s32
    v_mfma_f32_16x16x32_bf16 v[168:171], v[36:39], v[20:23], v[168:171]
    ds_read_b64_tr_b16 v[82:83], v101 offset:6144
    s_xor_b32 s33, s39, 1
    v_mfma_f32_16x16x32_bf16 v[164:167], v[36:39], v[16:19], v[164:167]
    s_mul_i32 s33, s33, 768
    v_mfma_f32_16x16x32_bf16 v[160:163], v[36:39], v[12:15], v[160:163]
    ds_read_b64_tr_b16 v[84:85], v102 offset:4096
    s_lshl_b32 s32, s29, 6
    v_mfma_f32_16x16x32_bf16 v[156:159], v[36:39], v[8:11], v[156:159]
    ds_read_b64_tr_b16 v[86:87], v102 offset:6144
    s_add_u32 s32, s32, s33
    v_mfma_f32_16x16x32_bf16 v[172:175], v[40:43], v[8:11], v[172:175]
    ds_read_b64_tr_b16 v[88:89], v103 offset:4096
    s_add_u32 s32, s32, 158720
    v_mfma_f32_16x16x32_bf16 v[176:179], v[40:43], v[12:15], v[176:179]
    ds_read_b64_tr_b16 v[90:91], v103 offset:6144
    v_lshl_add_u32 v7, v3, 4, s32
    v_mfma_f32_16x16x32_bf16 v[180:183], v[40:43], v[16:19], v[180:183]
    ds_read_b64_tr_b16 v[92:93], v104 offset:2048
    v_mfma_f32_16x16x32_bf16 v[184:187], v[40:43], v[20:23], v[184:187]
    ds_read_b64_tr_b16 v[94:95], v104 offset:3072
    v_mfma_f32_16x16x32_bf16 v[200:203], v[44:47], v[20:23], v[200:203]
    v_mfma_f32_16x16x32_bf16 v[196:199], v[44:47], v[16:19], v[196:199]
    v_mfma_f32_16x16x32_bf16 v[192:195], v[44:47], v[12:15], v[192:195]
    v_mfma_f32_16x16x32_bf16 v[188:191], v[44:47], v[8:11], v[188:191]
    v_mfma_f32_16x16x32_bf16 v[204:207], v[48:51], v[8:11], v[204:207]
    v_mfma_f32_16x16x32_bf16 v[208:211], v[48:51], v[12:15], v[208:211]
    v_mfma_f32_16x16x32_bf16 v[212:215], v[48:51], v[16:19], v[212:215]
    v_mfma_f32_16x16x32_bf16 v[216:219], v[48:51], v[20:23], v[216:219]
    s_waitcnt lgkmcnt(0)
    s_barrier
    v_mfma_f32_16x16x32_bf16 v[108:111], v[68:71], v[52:55], v[108:111]
    ds_read_b64 v[8:9], v2 offset:0
    v_mfma_f32_16x16x32_bf16 v[112:115], v[68:71], v[56:59], v[112:115]
    ds_read_b64 v[10:11], v2 offset:128
    v_mfma_f32_16x16x32_bf16 v[116:119], v[68:71], v[60:63], v[116:119]
    v_mfma_f32_16x16x32_bf16 v[120:123], v[68:71], v[64:67], v[120:123]
    ds_read_b64 v[12:13], v2 offset:256
    v_mfma_f32_16x16x32_bf16 v[136:139], v[72:75], v[64:67], v[136:139]
    v_mfma_f32_16x16x32_bf16 v[132:135], v[72:75], v[60:63], v[132:135]
    ds_read_b64 v[14:15], v2 offset:384
    v_mfma_f32_16x16x32_bf16 v[128:131], v[72:75], v[56:59], v[128:131]
    v_mfma_f32_16x16x32_bf16 v[124:127], v[72:75], v[52:55], v[124:127]
    ds_read_b128 v[16:19], v5 offset:0
    v_mfma_f32_16x16x32_bf16 v[140:143], v[76:79], v[52:55], v[140:143]
    v_mfma_f32_16x16x32_bf16 v[144:147], v[76:79], v[56:59], v[144:147]
    ds_read_b128 v[20:23], v5 offset:64
    v_mfma_f32_16x16x32_bf16 v[148:151], v[76:79], v[60:63], v[148:151]
    v_mfma_f32_16x16x32_bf16 v[152:155], v[76:79], v[64:67], v[152:155]
    ds_read_b128 v[24:27], v5 offset:128
    v_mfma_f32_16x16x32_bf16 v[168:171], v[80:83], v[64:67], v[168:171]
    v_mfma_f32_16x16x32_bf16 v[164:167], v[80:83], v[60:63], v[164:167]
    ds_read_b128 v[28:31], v5 offset:192
    v_mfma_f32_16x16x32_bf16 v[160:163], v[80:83], v[56:59], v[160:163]
    v_mfma_f32_16x16x32_bf16 v[156:159], v[80:83], v[52:55], v[156:159]
    ds_read_b128 v[32:35], v6 offset:0
    v_mfma_f32_16x16x32_bf16 v[172:175], v[84:87], v[52:55], v[172:175]
    v_mfma_f32_16x16x32_bf16 v[176:179], v[84:87], v[56:59], v[176:179]
    ds_read_b128 v[36:39], v6 offset:64
    v_mfma_f32_16x16x32_bf16 v[180:183], v[84:87], v[60:63], v[180:183]
    v_mfma_f32_16x16x32_bf16 v[184:187], v[84:87], v[64:67], v[184:187]
    ds_read_b128 v[40:43], v7
    v_mfma_f32_16x16x32_bf16 v[200:203], v[88:91], v[64:67], v[200:203]
    v_mfma_f32_16x16x32_bf16 v[196:199], v[88:91], v[60:63], v[196:199]
    v_mfma_f32_16x16x32_bf16 v[192:195], v[88:91], v[56:59], v[192:195]
    v_mfma_f32_16x16x32_bf16 v[188:191], v[88:91], v[52:55], v[188:191]
    v_mfma_f32_16x16x32_bf16 v[204:207], v[92:95], v[52:55], v[204:207]
    v_mfma_f32_16x16x32_bf16 v[208:211], v[92:95], v[56:59], v[208:211]
    v_mfma_f32_16x16x32_bf16 v[212:215], v[92:95], v[60:63], v[212:215]
    v_mfma_f32_16x16x32_bf16 v[216:219], v[92:95], v[64:67], v[216:219]
    s_waitcnt lgkmcnt(0)
    v_lshlrev_b32 v2, 4, v1
    s_cmp_lg_u32 s54, 0
    s_cbranch_scc1 slowst_372
    v_pk_mul_f32 v[108:109], v[108:109], v[8:9] op_sel:[0,1] op_sel_hi:[1,1]
    v_pk_mul_f32 v[110:111], v[110:111], v[8:9] op_sel:[0,1] op_sel_hi:[1,1]
    v_pk_mul_f32 v[124:125], v[124:125], v[8:9] op_sel:[0,1] op_sel_hi:[1,1]
    v_pk_mul_f32 v[126:127], v[126:127], v[8:9] op_sel:[0,1] op_sel_hi:[1,1]
    v_pk_fma_f32 v[108:109], v[16:17], v[8:9], v[108:109] op_sel_hi:[1,0,1]
    v_pk_fma_f32 v[110:111], v[18:19], v[8:9], v[110:111] op_sel_hi:[1,0,1]
    v_pk_fma_f32 v[124:125], v[20:21], v[8:9], v[124:125] op_sel_hi:[1,0,1]
    v_pk_fma_f32 v[126:127], v[22:23], v[8:9], v[126:127] op_sel_hi:[1,0,1]
    v_exp_f32 v56, v108
    v_exp_f32 v57, v109
    v_exp_f32 v58, v110
    v_exp_f32 v59, v111
    v_exp_f32 v60, v124
    v_exp_f32 v61, v125
    v_exp_f32 v62, v126
    v_exp_f32 v63, v127
    v_pk_mul_f32 v[112:113], v[112:113], v[10:11] op_sel:[0,1] op_sel_hi:[1,1]
    v_pk_mul_f32 v[114:115], v[114:115], v[10:11] op_sel:[0,1] op_sel_hi:[1,1]
    v_pk_mul_f32 v[128:129], v[128:129], v[10:11] op_sel:[0,1] op_sel_hi:[1,1]
    v_pk_mul_f32 v[130:131], v[130:131], v[10:11] op_sel:[0,1] op_sel_hi:[1,1]
    v_pk_fma_f32 v[112:113], v[16:17], v[10:11], v[112:113] op_sel_hi:[1,0,1]
    v_pk_fma_f32 v[114:115], v[18:19], v[10:11], v[114:115] op_sel_hi:[1,0,1]
    v_pk_fma_f32 v[128:129], v[20:21], v[10:11], v[128:129] op_sel_hi:[1,0,1]
    v_pk_fma_f32 v[130:131], v[22:23], v[10:11], v[130:131] op_sel_hi:[1,0,1]
    v_pk_fma_f32 v[56:57], v[56:57], s[74:75], s[74:75]
    v_pk_fma_f32 v[58:59], v[58:59], s[74:75], s[74:75]
    v_pk_fma_f32 v[60:61], v[60:61], s[74:75], s[74:75]
    v_pk_fma_f32 v[62:63], v[62:63], s[74:75], s[74:75]
    v_rcp_f32 v56, v56
    v_rcp_f32 v57, v57
    v_rcp_f32 v58, v58
    v_rcp_f32 v59, v59
    v_rcp_f32 v60, v60
    v_rcp_f32 v61, v61
    v_rcp_f32 v62, v62
    v_rcp_f32 v63, v63
    v_exp_f32 v64, v112
    v_exp_f32 v65, v113
    v_exp_f32 v66, v114
    v_exp_f32 v67, v115
    v_exp_f32 v68, v128
    v_exp_f32 v69, v129
    v_exp_f32 v70, v130
    v_exp_f32 v71, v131
    v_pk_mul_f32 v[116:117], v[116:117], v[12:13] op_sel:[0,1] op_sel_hi:[1,1]
    v_pk_mul_f32 v[118:119], v[118:119], v[12:13] op_sel:[0,1] op_sel_hi:[1,1]
    v_pk_mul_f32 v[132:133], v[132:133], v[12:13] op_sel:[0,1] op_sel_hi:[1,1]
    v_pk_mul_f32 v[134:135], v[134:135], v[12:13] op_sel:[0,1] op_sel_hi:[1,1]
    v_pk_fma_f32 v[116:117], v[16:17], v[12:13], v[116:117] op_sel_hi:[1,0,1]
    v_pk_fma_f32 v[118:119], v[18:19], v[12:13], v[118:119] op_sel_hi:[1,0,1]
    v_pk_fma_f32 v[132:133], v[20:21], v[12:13], v[132:133] op_sel_hi:[1,0,1]
    v_pk_fma_f32 v[134:135], v[22:23], v[12:13], v[134:135] op_sel_hi:[1,0,1]
    v_pk_fma_f32 v[64:65], v[64:65], s[74:75], s[74:75]
    v_pk_fma_f32 v[66:67], v[66:67], s[74:75], s[74:75]
    v_pk_fma_f32 v[68:69], v[68:69], s[74:75], s[74:75]
    v_pk_fma_f32 v[70:71], v[70:71], s[74:75], s[74:75]
    v_pk_mul_f32 v[108:109], v[108:109], v[56:57]
    v_pk_mul_f32 v[110:111], v[110:111], v[58:59]
    v_pk_mul_f32 v[124:125], v[124:125], v[60:61]
    v_pk_mul_f32 v[126:127], v[126:127], v[62:63]
    v_cvt_pk_bf16_f32 v80, v108, v109
    v_cvt_pk_bf16_f32 v81, v110, v111
    v_cvt_pk_bf16_f32 v82, v124, v125
    v_cvt_pk_bf16_f32 v83, v126, v127
    buffer_store_dwordx4 v[80:83], v2, s[8:11], s34 offen offset:0
    v_rcp_f32 v64, v64
    v_rcp_f32 v65, v65
    v_rcp_f32 v66, v66
    v_rcp_f32 v67, v67
    v_rcp_f32 v68, v68
    v_rcp_f32 v69, v69
    v_rcp_f32 v70, v70
    v_rcp_f32 v71, v71
    v_exp_f32 v72, v116
    v_exp_f32 v73, v117
    v_exp_f32 v74, v118
    v_exp_f32 v75, v119
    v_exp_f32 v76, v132
    v_exp_f32 v77, v133
    v_exp_f32 v78, v134
    v_exp_f32 v79, v135
    v_pk_mul_f32 v[120:121], v[120:121], v[14:15] op_sel:[0,1] op_sel_hi:[1,1]
    v_pk_mul_f32 v[122:123], v[122:123], v[14:15] op_sel:[0,1] op_sel_hi:[1,1]
    v_pk_mul_f32 v[136:137], v[136:137], v[14:15] op_sel:[0,1] op_sel_hi:[1,1]
    v_pk_mul_f32 v[138:139], v[138:139], v[14:15] op_sel:[0,1] op_sel_hi:[1,1]
    v_pk_fma_f32 v[120:121], v[16:17], v[14:15], v[120:121] op_sel_hi:[1,0,1]
    v_pk_fma_f32 v[122:123], v[18:19], v[14:15], v[122:123] op_sel_hi:[1,0,1]
    v_pk_fma_f32 v[136:137], v[20:21], v[14:15], v[136:137] op_sel_hi:[1,0,1]
    v_pk_fma_f32 v[138:139], v[22:23], v[14:15], v[138:139] op_sel_hi:[1,0,1]
    v_pk_fma_f32 v[72:73], v[72:73], s[74:75], s[74:75]
    v_pk_fma_f32 v[74:75], v[74:75], s[74:75], s[74:75]
    v_pk_fma_f32 v[76:77], v[76:77], s[74:75], s[74:75]
    v_pk_fma_f32 v[78:79], v[78:79], s[74:75], s[74:75]
    v_pk_mul_f32 v[112:113], v[112:113], v[64:65]
    v_pk_mul_f32 v[114:115], v[114:115], v[66:67]
    v_pk_mul_f32 v[128:129], v[128:129], v[68:69]
    v_pk_mul_f32 v[130:131], v[130:131], v[70:71]
    v_cvt_pk_bf16_f32 v84, v112, v113
    v_cvt_pk_bf16_f32 v85, v114, v115
    v_cvt_pk_bf16_f32 v86, v128, v129
    v_cvt_pk_bf16_f32 v87, v130, v131
    buffer_store_dwordx4 v[84:87], v2, s[8:11], s34 offen offset:1024
    v_rcp_f32 v72, v72
    v_rcp_f32 v73, v73
    v_rcp_f32 v74, v74
    v_rcp_f32 v75, v75
    v_rcp_f32 v76, v76
    v_rcp_f32 v77, v77
    v_rcp_f32 v78, v78
    v_rcp_f32 v79, v79
    v_exp_f32 v56, v120
    v_exp_f32 v57, v121
    v_exp_f32 v58, v122
    v_exp_f32 v59, v123
    v_exp_f32 v60, v136
    v_exp_f32 v61, v137
    v_exp_f32 v62, v138
    v_exp_f32 v63, v139
    v_pk_mul_f32 v[140:141], v[140:141], v[8:9] op_sel:[0,1] op_sel_hi:[1,1]
    v_pk_mul_f32 v[142:143], v[142:143], v[8:9] op_sel:[0,1] op_sel_hi:[1,1]
    v_pk_mul_f32 v[156:157], v[156:157], v[8:9] op_sel:[0,1] op_sel_hi:[1,1]
    v_pk_mul_f32 v[158:159], v[158:159], v[8:9] op_sel:[0,1] op_sel_hi:[1,1]
    v_pk_fma_f32 v[140:141], v[24:25], v[8:9], v[140:141] op_sel_hi:[1,0,1]
    v_pk_fma_f32 v[142:143], v[26:27], v[8:9], v[142:143] op_sel_hi:[1,0,1]
    v_pk_fma_f32 v[156:157], v[28:29], v[8:9], v[156:157] op_sel_hi:[1,0,1]
    v_pk_fma_f32 v[158:159], v[30:31], v[8:9], v[158:159] op_sel_hi:[1,0,1]
    v_pk_fma_f32 v[56:57], v[56:57], s[74:75], s[74:75]
    v_pk_fma_f32 v[58:59], v[58:59], s[74:75], s[74:75]
    v_pk_fma_f32 v[60:61], v[60:61], s[74:75], s[74:75]
    v_pk_fma_f32 v[62:63], v[62:63], s[74:75], s[74:75]
    v_pk_mul_f32 v[116:117], v[116:117], v[72:73]
    v_pk_mul_f32 v[118:119], v[118:119], v[74:75]
    v_pk_mul_f32 v[132:133], v[132:133], v[76:77]
    v_pk_mul_f32 v[134:135], v[134:135], v[78:79]
    v_cvt_pk_bf16_f32 v88, v116, v117
    v_cvt_pk_bf16_f32 v89, v118, v119
    v_cvt_pk_bf16_f32 v90, v132, v133
    v_cvt_pk_bf16_f32 v91, v134, v135
    buffer_store_dwordx4 v[88:91], v2, s[8:11], s34 offen offset:2048
    v_rcp_f32 v56, v56
    v_rcp_f32 v57, v57
    v_rcp_f32 v58, v58
    v_rcp_f32 v59, v59
    v_rcp_f32 v60, v60
    v_rcp_f32 v61, v61
    v_rcp_f32 v62, v62
    v_rcp_f32 v63, v63
    v_exp_f32 v64, v140
    v_exp_f32 v65, v141
    v_exp_f32 v66, v142
    v_exp_f32 v67, v143
    v_exp_f32 v68, v156
    v_exp_f32 v69, v157
    v_exp_f32 v70, v158
    v_exp_f32 v71, v159
    v_pk_mul_f32 v[144:145], v[144:145], v[10:11] op_sel:[0,1] op_sel_hi:[1,1]
    v_pk_mul_f32 v[146:147], v[146:147], v[10:11] op_sel:[0,1] op_sel_hi:[1,1]
    v_pk_mul_f32 v[160:161], v[160:161], v[10:11] op_sel:[0,1] op_sel_hi:[1,1]
    v_pk_mul_f32 v[162:163], v[162:163], v[10:11] op_sel:[0,1] op_sel_hi:[1,1]
    v_pk_fma_f32 v[144:145], v[24:25], v[10:11], v[144:145] op_sel_hi:[1,0,1]
    v_pk_fma_f32 v[146:147], v[26:27], v[10:11], v[146:147] op_sel_hi:[1,0,1]
    v_pk_fma_f32 v[160:161], v[28:29], v[10:11], v[160:161] op_sel_hi:[1,0,1]
    v_pk_fma_f32 v[162:163], v[30:31], v[10:11], v[162:163] op_sel_hi:[1,0,1]
    v_pk_fma_f32 v[64:65], v[64:65], s[74:75], s[74:75]
    v_pk_fma_f32 v[66:67], v[66:67], s[74:75], s[74:75]
    v_pk_fma_f32 v[68:69], v[68:69], s[74:75], s[74:75]
    v_pk_fma_f32 v[70:71], v[70:71], s[74:75], s[74:75]
    v_pk_mul_f32 v[120:121], v[120:121], v[56:57]
    v_pk_mul_f32 v[122:123], v[122:123], v[58:59]
    v_pk_mul_f32 v[136:137], v[136:137], v[60:61]
    v_pk_mul_f32 v[138:139], v[138:139], v[62:63]
    v_cvt_pk_bf16_f32 v92, v120, v121
    v_cvt_pk_bf16_f32 v93, v122, v123
    v_cvt_pk_bf16_f32 v94, v136, v137
    v_cvt_pk_bf16_f32 v95, v138, v139
    buffer_store_dwordx4 v[92:95], v2, s[8:11], s34 offen offset:3072
    v_rcp_f32 v64, v64
    v_rcp_f32 v65, v65
    v_rcp_f32 v66, v66
    v_rcp_f32 v67, v67
    v_rcp_f32 v68, v68
    v_rcp_f32 v69, v69
    v_rcp_f32 v70, v70
    v_rcp_f32 v71, v71
    v_exp_f32 v72, v144
    v_exp_f32 v73, v145
    v_exp_f32 v74, v146
    v_exp_f32 v75, v147
    v_exp_f32 v76, v160
    v_exp_f32 v77, v161
    v_exp_f32 v78, v162
    v_exp_f32 v79, v163
    v_pk_mul_f32 v[148:149], v[148:149], v[12:13] op_sel:[0,1] op_sel_hi:[1,1]
    v_pk_mul_f32 v[150:151], v[150:151], v[12:13] op_sel:[0,1] op_sel_hi:[1,1]
    v_pk_mul_f32 v[164:165], v[164:165], v[12:13] op_sel:[0,1] op_sel_hi:[1,1]
    v_pk_mul_f32 v[166:167], v[166:167], v[12:13] op_sel:[0,1] op_sel_hi:[1,1]
    v_pk_fma_f32 v[148:149], v[24:25], v[12:13], v[148:149] op_sel_hi:[1,0,1]
    v_pk_fma_f32 v[150:151], v[26:27], v[12:13], v[150:151] op_sel_hi:[1,0,1]
    v_pk_fma_f32 v[164:165], v[28:29], v[12:13], v[164:165] op_sel_hi:[1,0,1]
    v_pk_fma_f32 v[166:167], v[30:31], v[12:13], v[166:167] op_sel_hi:[1,0,1]
    v_pk_fma_f32 v[72:73], v[72:73], s[74:75], s[74:75]
    v_pk_fma_f32 v[74:75], v[74:75], s[74:75], s[74:75]
    v_pk_fma_f32 v[76:77], v[76:77], s[74:75], s[74:75]
    v_pk_fma_f32 v[78:79], v[78:79], s[74:75], s[74:75]
    v_pk_mul_f32 v[140:141], v[140:141], v[64:65]
    v_pk_mul_f32 v[142:143], v[142:143], v[66:67]
    v_pk_mul_f32 v[156:157], v[156:157], v[68:69]
    v_pk_mul_f32 v[158:159], v[158:159], v[70:71]
    v_cvt_pk_bf16_f32 v80, v140, v141
    v_cvt_pk_bf16_f32 v81, v142, v143
    v_cvt_pk_bf16_f32 v82, v156, v157
    v_cvt_pk_bf16_f32 v83, v158, v159
    buffer_store_dwordx4 v[80:83], v2, s[8:11], s37 offen offset:0
    v_rcp_f32 v72, v72
    v_rcp_f32 v73, v73
    v_rcp_f32 v74, v74
    v_rcp_f32 v75, v75
    v_rcp_f32 v76, v76
    v_rcp_f32 v77, v77
    v_rcp_f32 v78, v78
    v_rcp_f32 v79, v79
    v_exp_f32 v56, v148
    v_exp_f32 v57, v149
    v_exp_f32 v58, v150
    v_exp_f32 v59, v151
    v_exp_f32 v60, v164
    v_exp_f32 v61, v165
    v_exp_f32 v62, v166
    v_exp_f32 v63, v167
    v_pk_mul_f32 v[152:153], v[152:153], v[14:15] op_sel:[0,1] op_sel_hi:[1,1]
    v_pk_mul_f32 v[154:155], v[154:155], v[14:15] op_sel:[0,1] op_sel_hi:[1,1]
    v_pk_mul_f32 v[168:169], v[168:169], v[14:15] op_sel:[0,1] op_sel_hi:[1,1]
    v_pk_mul_f32 v[170:171], v[170:171], v[14:15] op_sel:[0,1] op_sel_hi:[1,1]
    v_pk_fma_f32 v[152:153], v[24:25], v[14:15], v[152:153] op_sel_hi:[1,0,1]
    v_pk_fma_f32 v[154:155], v[26:27], v[14:15], v[154:155] op_sel_hi:[1,0,1]
    v_pk_fma_f32 v[168:169], v[28:29], v[14:15], v[168:169] op_sel_hi:[1,0,1]
    v_pk_fma_f32 v[170:171], v[30:31], v[14:15], v[170:171] op_sel_hi:[1,0,1]
    v_pk_fma_f32 v[56:57], v[56:57], s[74:75], s[74:75]
    v_pk_fma_f32 v[58:59], v[58:59], s[74:75], s[74:75]
    v_pk_fma_f32 v[60:61], v[60:61], s[74:75], s[74:75]
    v_pk_fma_f32 v[62:63], v[62:63], s[74:75], s[74:75]
    v_pk_mul_f32 v[144:145], v[144:145], v[72:73]
    v_pk_mul_f32 v[146:147], v[146:147], v[74:75]
    v_pk_mul_f32 v[160:161], v[160:161], v[76:77]
    v_pk_mul_f32 v[162:163], v[162:163], v[78:79]
    v_cvt_pk_bf16_f32 v84, v144, v145
    v_cvt_pk_bf16_f32 v85, v146, v147
    v_cvt_pk_bf16_f32 v86, v160, v161
    v_cvt_pk_bf16_f32 v87, v162, v163
    buffer_store_dwordx4 v[84:87], v2, s[8:11], s37 offen offset:1024
    v_rcp_f32 v56, v56
    v_rcp_f32 v57, v57
    v_rcp_f32 v58, v58
    v_rcp_f32 v59, v59
    v_rcp_f32 v60, v60
    v_rcp_f32 v61, v61
    v_rcp_f32 v62, v62
    v_rcp_f32 v63, v63
    v_exp_f32 v64, v152
    v_exp_f32 v65, v153
    v_exp_f32 v66, v154
    v_exp_f32 v67, v155
    v_exp_f32 v68, v168
    v_exp_f32 v69, v169
    v_exp_f32 v70, v170
    v_exp_f32 v71, v171
    v_pk_mul_f32 v[172:173], v[172:173], v[8:9] op_sel:[0,1] op_sel_hi:[1,1]
    v_pk_mul_f32 v[174:175], v[174:175], v[8:9] op_sel:[0,1] op_sel_hi:[1,1]
    v_pk_mul_f32 v[188:189], v[188:189], v[8:9] op_sel:[0,1] op_sel_hi:[1,1]
    v_pk_mul_f32 v[190:191], v[190:191], v[8:9] op_sel:[0,1] op_sel_hi:[1,1]
    v_pk_fma_f32 v[172:173], v[32:33], v[8:9], v[172:173] op_sel_hi:[1,0,1]
    v_pk_fma_f32 v[174:175], v[34:35], v[8:9], v[174:175] op_sel_hi:[1,0,1]
    v_pk_fma_f32 v[188:189], v[36:37], v[8:9], v[188:189] op_sel_hi:[1,0,1]
    v_pk_fma_f32 v[190:191], v[38:39], v[8:9], v[190:191] op_sel_hi:[1,0,1]
    v_pk_fma_f32 v[64:65], v[64:65], s[74:75], s[74:75]
    v_pk_fma_f32 v[66:67], v[66:67], s[74:75], s[74:75]
    v_pk_fma_f32 v[68:69], v[68:69], s[74:75], s[74:75]
    v_pk_fma_f32 v[70:71], v[70:71], s[74:75], s[74:75]
    v_pk_mul_f32 v[148:149], v[148:149], v[56:57]
    v_pk_mul_f32 v[150:151], v[150:151], v[58:59]
    v_pk_mul_f32 v[164:165], v[164:165], v[60:61]
    v_pk_mul_f32 v[166:167], v[166:167], v[62:63]
    v_cvt_pk_bf16_f32 v88, v148, v149
    v_cvt_pk_bf16_f32 v89, v150, v151
    v_cvt_pk_bf16_f32 v90, v164, v165
    v_cvt_pk_bf16_f32 v91, v166, v167
    buffer_store_dwordx4 v[88:91], v2, s[8:11], s37 offen offset:2048
    v_rcp_f32 v64, v64
    v_rcp_f32 v65, v65
    v_rcp_f32 v66, v66
    v_rcp_f32 v67, v67
    v_rcp_f32 v68, v68
    v_rcp_f32 v69, v69
    v_rcp_f32 v70, v70
    v_rcp_f32 v71, v71
    v_exp_f32 v72, v172
    v_exp_f32 v73, v173
    v_exp_f32 v74, v174
    v_exp_f32 v75, v175
    v_exp_f32 v76, v188
    v_exp_f32 v77, v189
    v_exp_f32 v78, v190
    v_exp_f32 v79, v191
    v_pk_mul_f32 v[176:177], v[176:177], v[10:11] op_sel:[0,1] op_sel_hi:[1,1]
    v_pk_mul_f32 v[178:179], v[178:179], v[10:11] op_sel:[0,1] op_sel_hi:[1,1]
    v_pk_mul_f32 v[192:193], v[192:193], v[10:11] op_sel:[0,1] op_sel_hi:[1,1]
    v_pk_mul_f32 v[194:195], v[194:195], v[10:11] op_sel:[0,1] op_sel_hi:[1,1]
    v_pk_fma_f32 v[176:177], v[32:33], v[10:11], v[176:177] op_sel_hi:[1,0,1]
    v_pk_fma_f32 v[178:179], v[34:35], v[10:11], v[178:179] op_sel_hi:[1,0,1]
    v_pk_fma_f32 v[192:193], v[36:37], v[10:11], v[192:193] op_sel_hi:[1,0,1]
    v_pk_fma_f32 v[194:195], v[38:39], v[10:11], v[194:195] op_sel_hi:[1,0,1]
    v_pk_fma_f32 v[72:73], v[72:73], s[74:75], s[74:75]
    v_pk_fma_f32 v[74:75], v[74:75], s[74:75], s[74:75]
    v_pk_fma_f32 v[76:77], v[76:77], s[74:75], s[74:75]
    v_pk_fma_f32 v[78:79], v[78:79], s[74:75], s[74:75]
    v_pk_mul_f32 v[152:153], v[152:153], v[64:65]
    v_pk_mul_f32 v[154:155], v[154:155], v[66:67]
    v_pk_mul_f32 v[168:169], v[168:169], v[68:69]
    v_pk_mul_f32 v[170:171], v[170:171], v[70:71]
    v_cvt_pk_bf16_f32 v92, v152, v153
    v_cvt_pk_bf16_f32 v93, v154, v155
    v_cvt_pk_bf16_f32 v94, v168, v169
    v_cvt_pk_bf16_f32 v95, v170, v171
    buffer_store_dwordx4 v[92:95], v2, s[8:11], s37 offen offset:3072
    v_rcp_f32 v72, v72
    v_rcp_f32 v73, v73
    v_rcp_f32 v74, v74
    v_rcp_f32 v75, v75
    v_rcp_f32 v76, v76
    v_rcp_f32 v77, v77
    v_rcp_f32 v78, v78
    v_rcp_f32 v79, v79
    v_exp_f32 v56, v176
    v_exp_f32 v57, v177
    v_exp_f32 v58, v178
    v_exp_f32 v59, v179
    v_exp_f32 v60, v192
    v_exp_f32 v61, v193
    v_exp_f32 v62, v194
    v_exp_f32 v63, v195
    v_pk_mul_f32 v[180:181], v[180:181], v[12:13] op_sel:[0,1] op_sel_hi:[1,1]
    v_pk_mul_f32 v[182:183], v[182:183], v[12:13] op_sel:[0,1] op_sel_hi:[1,1]
    v_pk_mul_f32 v[196:197], v[196:197], v[12:13] op_sel:[0,1] op_sel_hi:[1,1]
    v_pk_mul_f32 v[198:199], v[198:199], v[12:13] op_sel:[0,1] op_sel_hi:[1,1]
    v_pk_fma_f32 v[180:181], v[32:33], v[12:13], v[180:181] op_sel_hi:[1,0,1]
    v_pk_fma_f32 v[182:183], v[34:35], v[12:13], v[182:183] op_sel_hi:[1,0,1]
    v_pk_fma_f32 v[196:197], v[36:37], v[12:13], v[196:197] op_sel_hi:[1,0,1]
    v_pk_fma_f32 v[198:199], v[38:39], v[12:13], v[198:199] op_sel_hi:[1,0,1]
    v_pk_fma_f32 v[56:57], v[56:57], s[74:75], s[74:75]
    v_pk_fma_f32 v[58:59], v[58:59], s[74:75], s[74:75]
    v_pk_fma_f32 v[60:61], v[60:61], s[74:75], s[74:75]
    v_pk_fma_f32 v[62:63], v[62:63], s[74:75], s[74:75]
    v_pk_mul_f32 v[172:173], v[172:173], v[72:73]
    v_pk_mul_f32 v[174:175], v[174:175], v[74:75]
    v_pk_mul_f32 v[188:189], v[188:189], v[76:77]
    v_pk_mul_f32 v[190:191], v[190:191], v[78:79]
    v_cvt_pk_bf16_f32 v80, v172, v173
    v_cvt_pk_bf16_f32 v81, v174, v175
    v_cvt_pk_bf16_f32 v82, v188, v189
    v_cvt_pk_bf16_f32 v83, v190, v191
    buffer_store_dwordx4 v[80:83], v2, s[8:11], s35 offen offset:0
    v_rcp_f32 v56, v56
    v_rcp_f32 v57, v57
    v_rcp_f32 v58, v58
    v_rcp_f32 v59, v59
    v_rcp_f32 v60, v60
    v_rcp_f32 v61, v61
    v_rcp_f32 v62, v62
    v_rcp_f32 v63, v63
    v_exp_f32 v64, v180
    v_exp_f32 v65, v181
    v_exp_f32 v66, v182
    v_exp_f32 v67, v183
    v_exp_f32 v68, v196
    v_exp_f32 v69, v197
    v_exp_f32 v70, v198
    v_exp_f32 v71, v199
    v_pk_mul_f32 v[184:185], v[184:185], v[14:15] op_sel:[0,1] op_sel_hi:[1,1]
    v_pk_mul_f32 v[186:187], v[186:187], v[14:15] op_sel:[0,1] op_sel_hi:[1,1]
    v_pk_mul_f32 v[200:201], v[200:201], v[14:15] op_sel:[0,1] op_sel_hi:[1,1]
    v_pk_mul_f32 v[202:203], v[202:203], v[14:15] op_sel:[0,1] op_sel_hi:[1,1]
    v_pk_fma_f32 v[184:185], v[32:33], v[14:15], v[184:185] op_sel_hi:[1,0,1]
    v_pk_fma_f32 v[186:187], v[34:35], v[14:15], v[186:187] op_sel_hi:[1,0,1]
    v_pk_fma_f32 v[200:201], v[36:37], v[14:15], v[200:201] op_sel_hi:[1,0,1]
    v_pk_fma_f32 v[202:203], v[38:39], v[14:15], v[202:203] op_sel_hi:[1,0,1]
    v_pk_fma_f32 v[64:65], v[64:65], s[74:75], s[74:75]
    v_pk_fma_f32 v[66:67], v[66:67], s[74:75], s[74:75]
    v_pk_fma_f32 v[68:69], v[68:69], s[74:75], s[74:75]
    v_pk_fma_f32 v[70:71], v[70:71], s[74:75], s[74:75]
    v_pk_mul_f32 v[176:177], v[176:177], v[56:57]
    v_pk_mul_f32 v[178:179], v[178:179], v[58:59]
    v_pk_mul_f32 v[192:193], v[192:193], v[60:61]
    v_pk_mul_f32 v[194:195], v[194:195], v[62:63]
    v_cvt_pk_bf16_f32 v84, v176, v177
    v_cvt_pk_bf16_f32 v85, v178, v179
    v_cvt_pk_bf16_f32 v86, v192, v193
    v_cvt_pk_bf16_f32 v87, v194, v195
    buffer_store_dwordx4 v[84:87], v2, s[8:11], s35 offen offset:1024
    v_rcp_f32 v64, v64
    v_rcp_f32 v65, v65
    v_rcp_f32 v66, v66
    v_rcp_f32 v67, v67
    v_rcp_f32 v68, v68
    v_rcp_f32 v69, v69
    v_rcp_f32 v70, v70
    v_rcp_f32 v71, v71
    s_waitcnt vmcnt(2)
    v_mov_b32 v5, 0
    v_mov_b32 v6, 1
    s_mov_b64 exec, 1
    buffer_store_dword v6, v5, s[8:11], s38 offen
    s_mov_b64 exec, -1
    v_exp_f32 v72, v184
    v_exp_f32 v73, v185
    v_exp_f32 v74, v186
    v_exp_f32 v75, v187
    v_exp_f32 v76, v200
    v_exp_f32 v77, v201
    v_exp_f32 v78, v202
    v_exp_f32 v79, v203
    v_pk_mul_f32 v[204:205], v[204:205], v[8:9] op_sel:[0,1] op_sel_hi:[1,1]
    v_pk_mul_f32 v[206:207], v[206:207], v[8:9] op_sel:[0,1] op_sel_hi:[1,1]
    v_pk_fma_f32 v[204:205], v[40:41], v[8:9], v[204:205] op_sel_hi:[1,0,1]
    v_pk_fma_f32 v[206:207], v[42:43], v[8:9], v[206:207] op_sel_hi:[1,0,1]
    v_pk_fma_f32 v[72:73], v[72:73], s[74:75], s[74:75]
    v_pk_fma_f32 v[74:75], v[74:75], s[74:75], s[74:75]
    v_pk_fma_f32 v[76:77], v[76:77], s[74:75], s[74:75]
    v_pk_fma_f32 v[78:79], v[78:79], s[74:75], s[74:75]
    v_pk_mul_f32 v[180:181], v[180:181], v[64:65]
    v_pk_mul_f32 v[182:183], v[182:183], v[66:67]
    v_pk_mul_f32 v[196:197], v[196:197], v[68:69]
    v_pk_mul_f32 v[198:199], v[198:199], v[70:71]
    v_cvt_pk_bf16_f32 v88, v180, v181
    v_cvt_pk_bf16_f32 v89, v182, v183
    v_cvt_pk_bf16_f32 v90, v196, v197
    v_cvt_pk_bf16_f32 v91, v198, v199
    buffer_store_dwordx4 v[88:91], v2, s[8:11], s35 offen offset:2048
    v_rcp_f32 v72, v72
    v_rcp_f32 v73, v73
    v_rcp_f32 v74, v74
    v_rcp_f32 v75, v75
    v_rcp_f32 v76, v76
    v_rcp_f32 v77, v77
    v_rcp_f32 v78, v78
    v_rcp_f32 v79, v79
    v_exp_f32 v56, v204
    v_exp_f32 v57, v205
    v_exp_f32 v58, v206
    v_exp_f32 v59, v207
    v_pk_mul_f32 v[208:209], v[208:209], v[10:11] op_sel:[0,1] op_sel_hi:[1,1]
    v_pk_mul_f32 v[210:211], v[210:211], v[10:11] op_sel:[0,1] op_sel_hi:[1,1]
    v_pk_fma_f32 v[208:209], v[40:41], v[10:11], v[208:209] op_sel_hi:[1,0,1]
    v_pk_fma_f32 v[210:211], v[42:43], v[10:11], v[210:211] op_sel_hi:[1,0,1]
    v_pk_fma_f32 v[56:57], v[56:57], s[74:75], s[74:75]
    v_pk_fma_f32 v[58:59], v[58:59], s[74:75], s[74:75]
    v_pk_mul_f32 v[184:185], v[184:185], v[72:73]
    v_pk_mul_f32 v[186:187], v[186:187], v[74:75]
    v_pk_mul_f32 v[200:201], v[200:201], v[76:77]
    v_pk_mul_f32 v[202:203], v[202:203], v[78:79]
    v_cvt_pk_bf16_f32 v92, v184, v185
    v_cvt_pk_bf16_f32 v93, v186, v187
    v_cvt_pk_bf16_f32 v94, v200, v201
    v_cvt_pk_bf16_f32 v95, v202, v203
    buffer_store_dwordx4 v[92:95], v2, s[8:11], s35 offen offset:3072
    v_rcp_f32 v56, v56
    v_rcp_f32 v57, v57
    v_rcp_f32 v58, v58
    v_rcp_f32 v59, v59
    v_exp_f32 v64, v208
    v_exp_f32 v65, v209
    v_exp_f32 v66, v210
    v_exp_f32 v67, v211
    v_pk_mul_f32 v[212:213], v[212:213], v[12:13] op_sel:[0,1] op_sel_hi:[1,1]
    v_pk_mul_f32 v[214:215], v[214:215], v[12:13] op_sel:[0,1] op_sel_hi:[1,1]
    v_pk_fma_f32 v[212:213], v[40:41], v[12:13], v[212:213] op_sel_hi:[1,0,1]
    v_pk_fma_f32 v[214:215], v[42:43], v[12:13], v[214:215] op_sel_hi:[1,0,1]
    v_pk_fma_f32 v[64:65], v[64:65], s[74:75], s[74:75]
    v_pk_fma_f32 v[66:67], v[66:67], s[74:75], s[74:75]
    v_pk_mul_f32 v[204:205], v[204:205], v[56:57]
    v_pk_mul_f32 v[206:207], v[206:207], v[58:59]
    v_cvt_pk_bf16_f32 v80, v204, v205
    v_cvt_pk_bf16_f32 v81, v206, v207
    buffer_store_dwordx2 v[80:81], v2, s[8:11], s36 offen offset:0
    v_rcp_f32 v64, v64
    v_rcp_f32 v65, v65
    v_rcp_f32 v66, v66
    v_rcp_f32 v67, v67
    v_exp_f32 v72, v212
    v_exp_f32 v73, v213
    v_exp_f32 v74, v214
    v_exp_f32 v75, v215
    v_pk_mul_f32 v[216:217], v[216:217], v[14:15] op_sel:[0,1] op_sel_hi:[1,1]
    v_pk_mul_f32 v[218:219], v[218:219], v[14:15] op_sel:[0,1] op_sel_hi:[1,1]
    v_pk_fma_f32 v[216:217], v[40:41], v[14:15], v[216:217] op_sel_hi:[1,0,1]
    v_pk_fma_f32 v[218:219], v[42:43], v[14:15], v[218:219] op_sel_hi:[1,0,1]
    v_pk_fma_f32 v[72:73], v[72:73], s[74:75], s[74:75]
    v_pk_fma_f32 v[74:75], v[74:75], s[74:75], s[74:75]
    v_pk_mul_f32 v[208:209], v[208:209], v[64:65]
    v_pk_mul_f32 v[210:211], v[210:211], v[66:67]
    v_cvt_pk_bf16_f32 v84, v208, v209
    v_cvt_pk_bf16_f32 v85, v210, v211
    buffer_store_dwordx2 v[84:85], v2, s[8:11], s36 offen offset:1024
    v_rcp_f32 v72, v72
    v_rcp_f32 v73, v73
    v_rcp_f32 v74, v74
    v_rcp_f32 v75, v75
    v_exp_f32 v56, v216
    v_exp_f32 v57, v217
    v_exp_f32 v58, v218
    v_exp_f32 v59, v219
    v_pk_fma_f32 v[56:57], v[56:57], s[74:75], s[74:75]
    v_pk_fma_f32 v[58:59], v[58:59], s[74:75], s[74:75]
    v_pk_mul_f32 v[212:213], v[212:213], v[72:73]
    v_pk_mul_f32 v[214:215], v[214:215], v[74:75]
    v_cvt_pk_bf16_f32 v88, v212, v213
    v_cvt_pk_bf16_f32 v89, v214, v215
    buffer_store_dwordx2 v[88:89], v2, s[8:11], s36 offen offset:2048
    v_rcp_f32 v56, v56
    v_rcp_f32 v57, v57
    v_rcp_f32 v58, v58
    v_rcp_f32 v59, v59
    v_pk_mul_f32 v[216:217], v[216:217], v[56:57]
    v_pk_mul_f32 v[218:219], v[218:219], v[58:59]
    v_cvt_pk_bf16_f32 v92, v216, v217
    v_cvt_pk_bf16_f32 v93, v218, v219
    buffer_store_dwordx2 v[92:93], v2, s[8:11], s36 offen offset:3072
    s_and_b32 s24, s22, 1
    s_lshl_b32 s24, s24, 3
    s_and_b32 s30, s23, 6
    s_add_u32 s24, s24, s30
    s_and_b32 s25, s23, 1
    s_lshl_b32 s25, s25, 2
    s_lshr_b32 s30, s23, 3
    s_add_u32 s25, s25, s30
    s_lshr_b32 s71, s22, 1
    s_add_u32 s30, s71, 0
    s_and_b32 s30, s30, 3
    s_lshl_b32 s30, s30, 11
    s_lshl_b32 s31, s28, 14
    s_add_u32 s30, s30, s31
    v_lshl_add_u32 v104, v1, 4, s30
    v_add_u32 v108, 0x10000, v104
    s_add_u32 s30, s71, 1
    s_and_b32 s30, s30, 3
    s_lshl_b32 s30, s30, 11
    s_lshl_b32 s31, s28, 14
    s_add_u32 s30, s30, s31
    v_lshl_add_u32 v105, v1, 4, s30
    v_add_u32 v109, 0x10000, v105
    s_add_u32 s30, s71, 2
    s_and_b32 s30, s30, 3
    s_lshl_b32 s30, s30, 11
    s_lshl_b32 s31, s28, 14
    s_add_u32 s30, s30, s31
    v_lshl_add_u32 v106, v1, 4, s30
    v_add_u32 v110, 0x10000, v106
    s_add_u32 s30, s71, 3
    s_and_b32 s30, s30, 3
    s_lshl_b32 s30, s30, 11
    s_lshl_b32 s31, s28, 14
    s_add_u32 s30, s30, s31
    v_lshl_add_u32 v107, v1, 4, s30
    v_add_u32 v111, 0x10000, v107
    v_bfe_u32 v5, v1, 2, 2
    v_and_b32 v6, 3, v1
    v_lshl_add_u32 v7, v3, 2, v5
    v_bfe_u32 v2, v7, 1, 2
    v_mov_b32 v9, v7
    v_lshlrev_b32 v7, 7, v7
    v_lshl_add_u32 v7, v6, 3, v7
    s_mul_i32 s30, s29, 0
    s_add_u32 s30, s30, 0
    v_xor_b32 v8, s30, v2
    v_lshl_add_u32 v112, v8, 5, v7
    s_mul_i32 s30, s29, 24576
    s_add_u32 s30, s30, 98304
    v_add_u32 v112, s30, v112
    s_mul_i32 s30, s29, 0
    s_add_u32 s30, s30, 1
    v_xor_b32 v8, s30, v2
    v_lshl_add_u32 v113, v8, 5, v7
    s_mul_i32 s30, s29, 24576
    s_add_u32 s30, s30, 98304
    v_add_u32 v113, s30, v113
    s_mul_i32 s30, s29, 0
    s_add_u32 s30, s30, 2
    v_xor_b32 v8, s30, v2
    v_lshl_add_u32 v114, v8, 5, v7
    s_mul_i32 s30, s29, 24576
    s_add_u32 s30, s30, 98304
    v_add_u32 v114, s30, v114
    s_mul_i32 s30, s29, 0
    s_add_u32 s30, s30, 3
    v_xor_b32 v8, s30, v2
    v_lshl_add_u32 v115, v8, 5, v7
    s_mul_i32 s30, s29, 24576
    s_add_u32 s30, s30, 98304
    v_add_u32 v115, s30, v115
    s_branch stx_373
slowst_372:
    v_pk_mul_f32 v[108:109], v[108:109], v[8:9] op_sel:[0,1] op_sel_hi:[1,1]
    v_pk_mul_f32 v[110:111], v[110:111], v[8:9] op_sel:[0,1] op_sel_hi:[1,1]
    v_pk_mul_f32 v[124:125], v[124:125], v[8:9] op_sel:[0,1] op_sel_hi:[1,1]
    v_pk_mul_f32 v[126:127], v[126:127], v[8:9] op_sel:[0,1] op_sel_hi:[1,1]
    v_pk_fma_f32 v[108:109], v[16:17], v[8:9], v[108:109] op_sel_hi:[1,0,1]
    v_pk_fma_f32 v[110:111], v[18:19], v[8:9], v[110:111] op_sel_hi:[1,0,1]
    v_pk_fma_f32 v[124:125], v[20:21], v[8:9], v[124:125] op_sel_hi:[1,0,1]
    v_pk_fma_f32 v[126:127], v[22:23], v[8:9], v[126:127] op_sel_hi:[1,0,1]
    v_exp_f32 v56, v108
    v_exp_f32 v57, v109
    v_exp_f32 v58, v110
    v_exp_f32 v59, v111
    v_exp_f32 v60, v124
    v_exp_f32 v61, v125
    v_exp_f32 v62, v126
    v_exp_f32 v63, v127
    v_pk_mul_f32 v[112:113], v[112:113], v[10:11] op_sel:[0,1] op_sel_hi:[1,1]
    v_pk_mul_f32 v[114:115], v[114:115], v[10:11] op_sel:[0,1] op_sel_hi:[1,1]
    v_pk_mul_f32 v[128:129], v[128:129], v[10:11] op_sel:[0,1] op_sel_hi:[1,1]
    v_pk_mul_f32 v[130:131], v[130:131], v[10:11] op_sel:[0,1] op_sel_hi:[1,1]
    v_pk_fma_f32 v[112:113], v[16:17], v[10:11], v[112:113] op_sel_hi:[1,0,1]
    v_pk_fma_f32 v[114:115], v[18:19], v[10:11], v[114:115] op_sel_hi:[1,0,1]
    v_pk_fma_f32 v[128:129], v[20:21], v[10:11], v[128:129] op_sel_hi:[1,0,1]
    v_pk_fma_f32 v[130:131], v[22:23], v[10:11], v[130:131] op_sel_hi:[1,0,1]
    v_pk_fma_f32 v[56:57], v[56:57], s[74:75], s[74:75]
    v_pk_fma_f32 v[58:59], v[58:59], s[74:75], s[74:75]
    v_pk_fma_f32 v[60:61], v[60:61], s[74:75], s[74:75]
    v_pk_fma_f32 v[62:63], v[62:63], s[74:75], s[74:75]
    v_rcp_f32 v56, v56
    v_rcp_f32 v57, v57
    v_rcp_f32 v58, v58
    v_rcp_f32 v59, v59
    v_rcp_f32 v60, v60
    v_rcp_f32 v61, v61
    v_rcp_f32 v62, v62
    v_rcp_f32 v63, v63
    v_exp_f32 v64, v112
    v_exp_f32 v65, v113
    v_exp_f32 v66, v114
    v_exp_f32 v67, v115
    v_exp_f32 v68, v128
    v_exp_f32 v69, v129
    v_exp_f32 v70, v130
    v_exp_f32 v71, v131
    v_pk_mul_f32 v[116:117], v[116:117], v[12:13] op_sel:[0,1] op_sel_hi:[1,1]
    v_pk_mul_f32 v[118:119], v[118:119], v[12:13] op_sel:[0,1] op_sel_hi:[1,1]
    v_pk_mul_f32 v[132:133], v[132:133], v[12:13] op_sel:[0,1] op_sel_hi:[1,1]
    v_pk_mul_f32 v[134:135], v[134:135], v[12:13] op_sel:[0,1] op_sel_hi:[1,1]
    v_pk_fma_f32 v[116:117], v[16:17], v[12:13], v[116:117] op_sel_hi:[1,0,1]
    v_pk_fma_f32 v[118:119], v[18:19], v[12:13], v[118:119] op_sel_hi:[1,0,1]
    v_pk_fma_f32 v[132:133], v[20:21], v[12:13], v[132:133] op_sel_hi:[1,0,1]
    v_pk_fma_f32 v[134:135], v[22:23], v[12:13], v[134:135] op_sel_hi:[1,0,1]
    v_pk_fma_f32 v[64:65], v[64:65], s[74:75], s[74:75]
    v_pk_fma_f32 v[66:67], v[66:67], s[74:75], s[74:75]
    v_pk_fma_f32 v[68:69], v[68:69], s[74:75], s[74:75]
    v_pk_fma_f32 v[70:71], v[70:71], s[74:75], s[74:75]
    v_pk_mul_f32 v[108:109], v[108:109], v[56:57]
    v_pk_mul_f32 v[110:111], v[110:111], v[58:59]
    v_pk_mul_f32 v[124:125], v[124:125], v[60:61]
    v_pk_mul_f32 v[126:127], v[126:127], v[62:63]
    v_cvt_pk_bf16_f32 v80, v108, v109
    v_cvt_pk_bf16_f32 v81, v110, v111
    v_cvt_pk_bf16_f32 v82, v124, v125
    v_cvt_pk_bf16_f32 v83, v126, v127
    buffer_store_dwordx4 v[80:83], v2, s[8:11], s34 offen offset:0 sc1
    v_rcp_f32 v64, v64
    v_rcp_f32 v65, v65
    v_rcp_f32 v66, v66
    v_rcp_f32 v67, v67
    v_rcp_f32 v68, v68
    v_rcp_f32 v69, v69
    v_rcp_f32 v70, v70
    v_rcp_f32 v71, v71
    v_exp_f32 v72, v116
    v_exp_f32 v73, v117
    v_exp_f32 v74, v118
    v_exp_f32 v75, v119
    v_exp_f32 v76, v132
    v_exp_f32 v77, v133
    v_exp_f32 v78, v134
    v_exp_f32 v79, v135
    v_pk_mul_f32 v[120:121], v[120:121], v[14:15] op_sel:[0,1] op_sel_hi:[1,1]
    v_pk_mul_f32 v[122:123], v[122:123], v[14:15] op_sel:[0,1] op_sel_hi:[1,1]
    v_pk_mul_f32 v[136:137], v[136:137], v[14:15] op_sel:[0,1] op_sel_hi:[1,1]
    v_pk_mul_f32 v[138:139], v[138:139], v[14:15] op_sel:[0,1] op_sel_hi:[1,1]
    v_pk_fma_f32 v[120:121], v[16:17], v[14:15], v[120:121] op_sel_hi:[1,0,1]
    v_pk_fma_f32 v[122:123], v[18:19], v[14:15], v[122:123] op_sel_hi:[1,0,1]
    v_pk_fma_f32 v[136:137], v[20:21], v[14:15], v[136:137] op_sel_hi:[1,0,1]
    v_pk_fma_f32 v[138:139], v[22:23], v[14:15], v[138:139] op_sel_hi:[1,0,1]
    v_pk_fma_f32 v[72:73], v[72:73], s[74:75], s[74:75]
    v_pk_fma_f32 v[74:75], v[74:75], s[74:75], s[74:75]
    v_pk_fma_f32 v[76:77], v[76:77], s[74:75], s[74:75]
    v_pk_fma_f32 v[78:79], v[78:79], s[74:75], s[74:75]
    v_pk_mul_f32 v[112:113], v[112:113], v[64:65]
    v_pk_mul_f32 v[114:115], v[114:115], v[66:67]
    v_pk_mul_f32 v[128:129], v[128:129], v[68:69]
    v_pk_mul_f32 v[130:131], v[130:131], v[70:71]
    v_cvt_pk_bf16_f32 v84, v112, v113
    v_cvt_pk_bf16_f32 v85, v114, v115
    v_cvt_pk_bf16_f32 v86, v128, v129
    v_cvt_pk_bf16_f32 v87, v130, v131
    buffer_store_dwordx4 v[84:87], v2, s[8:11], s34 offen offset:1024 sc1
    v_rcp_f32 v72, v72
    v_rcp_f32 v73, v73
    v_rcp_f32 v74, v74
    v_rcp_f32 v75, v75
    v_rcp_f32 v76, v76
    v_rcp_f32 v77, v77
    v_rcp_f32 v78, v78
    v_rcp_f32 v79, v79
    v_exp_f32 v56, v120
    v_exp_f32 v57, v121
    v_exp_f32 v58, v122
    v_exp_f32 v59, v123
    v_exp_f32 v60, v136
    v_exp_f32 v61, v137
    v_exp_f32 v62, v138
    v_exp_f32 v63, v139
    v_pk_mul_f32 v[140:141], v[140:141], v[8:9] op_sel:[0,1] op_sel_hi:[1,1]
    v_pk_mul_f32 v[142:143], v[142:143], v[8:9] op_sel:[0,1] op_sel_hi:[1,1]
    v_pk_mul_f32 v[156:157], v[156:157], v[8:9] op_sel:[0,1] op_sel_hi:[1,1]
    v_pk_mul_f32 v[158:159], v[158:159], v[8:9] op_sel:[0,1] op_sel_hi:[1,1]
    v_pk_fma_f32 v[140:141], v[24:25], v[8:9], v[140:141] op_sel_hi:[1,0,1]
    v_pk_fma_f32 v[142:143], v[26:27], v[8:9], v[142:143] op_sel_hi:[1,0,1]
    v_pk_fma_f32 v[156:157], v[28:29], v[8:9], v[156:157] op_sel_hi:[1,0,1]
    v_pk_fma_f32 v[158:159], v[30:31], v[8:9], v[158:159] op_sel_hi:[1,0,1]
    v_pk_fma_f32 v[56:57], v[56:57], s[74:75], s[74:75]
    v_pk_fma_f32 v[58:59], v[58:59], s[74:75], s[74:75]
    v_pk_fma_f32 v[60:61], v[60:61], s[74:75], s[74:75]
    v_pk_fma_f32 v[62:63], v[62:63], s[74:75], s[74:75]
    v_pk_mul_f32 v[116:117], v[116:117], v[72:73]
    v_pk_mul_f32 v[118:119], v[118:119], v[74:75]
    v_pk_mul_f32 v[132:133], v[132:133], v[76:77]
    v_pk_mul_f32 v[134:135], v[134:135], v[78:79]
    v_cvt_pk_bf16_f32 v88, v116, v117
    v_cvt_pk_bf16_f32 v89, v118, v119
    v_cvt_pk_bf16_f32 v90, v132, v133
    v_cvt_pk_bf16_f32 v91, v134, v135
    buffer_store_dwordx4 v[88:91], v2, s[8:11], s34 offen offset:2048 sc1
    v_rcp_f32 v56, v56
    v_rcp_f32 v57, v57
    v_rcp_f32 v58, v58
    v_rcp_f32 v59, v59
    v_rcp_f32 v60, v60
    v_rcp_f32 v61, v61
    v_rcp_f32 v62, v62
    v_rcp_f32 v63, v63
    v_exp_f32 v64, v140
    v_exp_f32 v65, v141
    v_exp_f32 v66, v142
    v_exp_f32 v67, v143
    v_exp_f32 v68, v156
    v_exp_f32 v69, v157
    v_exp_f32 v70, v158
    v_exp_f32 v71, v159
    v_pk_mul_f32 v[144:145], v[144:145], v[10:11] op_sel:[0,1] op_sel_hi:[1,1]
    v_pk_mul_f32 v[146:147], v[146:147], v[10:11] op_sel:[0,1] op_sel_hi:[1,1]
    v_pk_mul_f32 v[160:161], v[160:161], v[10:11] op_sel:[0,1] op_sel_hi:[1,1]
    v_pk_mul_f32 v[162:163], v[162:163], v[10:11] op_sel:[0,1] op_sel_hi:[1,1]
    v_pk_fma_f32 v[144:145], v[24:25], v[10:11], v[144:145] op_sel_hi:[1,0,1]
    v_pk_fma_f32 v[146:147], v[26:27], v[10:11], v[146:147] op_sel_hi:[1,0,1]
    v_pk_fma_f32 v[160:161], v[28:29], v[10:11], v[160:161] op_sel_hi:[1,0,1]
    v_pk_fma_f32 v[162:163], v[30:31], v[10:11], v[162:163] op_sel_hi:[1,0,1]
    v_pk_fma_f32 v[64:65], v[64:65], s[74:75], s[74:75]
    v_pk_fma_f32 v[66:67], v[66:67], s[74:75], s[74:75]
    v_pk_fma_f32 v[68:69], v[68:69], s[74:75], s[74:75]
    v_pk_fma_f32 v[70:71], v[70:71], s[74:75], s[74:75]
    v_pk_mul_f32 v[120:121], v[120:121], v[56:57]
    v_pk_mul_f32 v[122:123], v[122:123], v[58:59]
    v_pk_mul_f32 v[136:137], v[136:137], v[60:61]
    v_pk_mul_f32 v[138:139], v[138:139], v[62:63]
    v_cvt_pk_bf16_f32 v92, v120, v121
    v_cvt_pk_bf16_f32 v93, v122, v123
    v_cvt_pk_bf16_f32 v94, v136, v137
    v_cvt_pk_bf16_f32 v95, v138, v139
    buffer_store_dwordx4 v[92:95], v2, s[8:11], s34 offen offset:3072 sc1
    v_rcp_f32 v64, v64
    v_rcp_f32 v65, v65
    v_rcp_f32 v66, v66
    v_rcp_f32 v67, v67
    v_rcp_f32 v68, v68
    v_rcp_f32 v69, v69
    v_rcp_f32 v70, v70
    v_rcp_f32 v71, v71
    v_exp_f32 v72, v144
    v_exp_f32 v73, v145
    v_exp_f32 v74, v146
    v_exp_f32 v75, v147
    v_exp_f32 v76, v160
    v_exp_f32 v77, v161
    v_exp_f32 v78, v162
    v_exp_f32 v79, v163
    v_pk_mul_f32 v[148:149], v[148:149], v[12:13] op_sel:[0,1] op_sel_hi:[1,1]
    v_pk_mul_f32 v[150:151], v[150:151], v[12:13] op_sel:[0,1] op_sel_hi:[1,1]
    v_pk_mul_f32 v[164:165], v[164:165], v[12:13] op_sel:[0,1] op_sel_hi:[1,1]
    v_pk_mul_f32 v[166:167], v[166:167], v[12:13] op_sel:[0,1] op_sel_hi:[1,1]
    v_pk_fma_f32 v[148:149], v[24:25], v[12:13], v[148:149] op_sel_hi:[1,0,1]
    v_pk_fma_f32 v[150:151], v[26:27], v[12:13], v[150:151] op_sel_hi:[1,0,1]
    v_pk_fma_f32 v[164:165], v[28:29], v[12:13], v[164:165] op_sel_hi:[1,0,1]
    v_pk_fma_f32 v[166:167], v[30:31], v[12:13], v[166:167] op_sel_hi:[1,0,1]
    v_pk_fma_f32 v[72:73], v[72:73], s[74:75], s[74:75]
    v_pk_fma_f32 v[74:75], v[74:75], s[74:75], s[74:75]
    v_pk_fma_f32 v[76:77], v[76:77], s[74:75], s[74:75]
    v_pk_fma_f32 v[78:79], v[78:79], s[74:75], s[74:75]
    v_pk_mul_f32 v[140:141], v[140:141], v[64:65]
    v_pk_mul_f32 v[142:143], v[142:143], v[66:67]
    v_pk_mul_f32 v[156:157], v[156:157], v[68:69]
    v_pk_mul_f32 v[158:159], v[158:159], v[70:71]
    v_cvt_pk_bf16_f32 v80, v140, v141
    v_cvt_pk_bf16_f32 v81, v142, v143
    v_cvt_pk_bf16_f32 v82, v156, v157
    v_cvt_pk_bf16_f32 v83, v158, v159
    buffer_store_dwordx4 v[80:83], v2, s[8:11], s37 offen offset:0 sc1
    v_rcp_f32 v72, v72
    v_rcp_f32 v73, v73
    v_rcp_f32 v74, v74
    v_rcp_f32 v75, v75
    v_rcp_f32 v76, v76
    v_rcp_f32 v77, v77
    v_rcp_f32 v78, v78
    v_rcp_f32 v79, v79
    v_exp_f32 v56, v148
    v_exp_f32 v57, v149
    v_exp_f32 v58, v150
    v_exp_f32 v59, v151
    v_exp_f32 v60, v164
    v_exp_f32 v61, v165
    v_exp_f32 v62, v166
    v_exp_f32 v63, v167
    v_pk_mul_f32 v[152:153], v[152:153], v[14:15] op_sel:[0,1] op_sel_hi:[1,1]
    v_pk_mul_f32 v[154:155], v[154:155], v[14:15] op_sel:[0,1] op_sel_hi:[1,1]
    v_pk_mul_f32 v[168:169], v[168:169], v[14:15] op_sel:[0,1] op_sel_hi:[1,1]
    v_pk_mul_f32 v[170:171], v[170:171], v[14:15] op_sel:[0,1] op_sel_hi:[1,1]
    v_pk_fma_f32 v[152:153], v[24:25], v[14:15], v[152:153] op_sel_hi:[1,0,1]
    v_pk_fma_f32 v[154:155], v[26:27], v[14:15], v[154:155] op_sel_hi:[1,0,1]
    v_pk_fma_f32 v[168:169], v[28:29], v[14:15], v[168:169] op_sel_hi:[1,0,1]
    v_pk_fma_f32 v[170:171], v[30:31], v[14:15], v[170:171] op_sel_hi:[1,0,1]
    v_pk_fma_f32 v[56:57], v[56:57], s[74:75], s[74:75]
    v_pk_fma_f32 v[58:59], v[58:59], s[74:75], s[74:75]
    v_pk_fma_f32 v[60:61], v[60:61], s[74:75], s[74:75]
    v_pk_fma_f32 v[62:63], v[62:63], s[74:75], s[74:75]
    v_pk_mul_f32 v[144:145], v[144:145], v[72:73]
    v_pk_mul_f32 v[146:147], v[146:147], v[74:75]
    v_pk_mul_f32 v[160:161], v[160:161], v[76:77]
    v_pk_mul_f32 v[162:163], v[162:163], v[78:79]
    v_cvt_pk_bf16_f32 v84, v144, v145
    v_cvt_pk_bf16_f32 v85, v146, v147
    v_cvt_pk_bf16_f32 v86, v160, v161
    v_cvt_pk_bf16_f32 v87, v162, v163
    buffer_store_dwordx4 v[84:87], v2, s[8:11], s37 offen offset:1024 sc1
    v_rcp_f32 v56, v56
    v_rcp_f32 v57, v57
    v_rcp_f32 v58, v58
    v_rcp_f32 v59, v59
    v_rcp_f32 v60, v60
    v_rcp_f32 v61, v61
    v_rcp_f32 v62, v62
    v_rcp_f32 v63, v63
    v_exp_f32 v64, v152
    v_exp_f32 v65, v153
    v_exp_f32 v66, v154
    v_exp_f32 v67, v155
    v_exp_f32 v68, v168
    v_exp_f32 v69, v169
    v_exp_f32 v70, v170
    v_exp_f32 v71, v171
    v_pk_mul_f32 v[172:173], v[172:173], v[8:9] op_sel:[0,1] op_sel_hi:[1,1]
    v_pk_mul_f32 v[174:175], v[174:175], v[8:9] op_sel:[0,1] op_sel_hi:[1,1]
    v_pk_mul_f32 v[188:189], v[188:189], v[8:9] op_sel:[0,1] op_sel_hi:[1,1]
    v_pk_mul_f32 v[190:191], v[190:191], v[8:9] op_sel:[0,1] op_sel_hi:[1,1]
    v_pk_fma_f32 v[172:173], v[32:33], v[8:9], v[172:173] op_sel_hi:[1,0,1]
    v_pk_fma_f32 v[174:175], v[34:35], v[8:9], v[174:175] op_sel_hi:[1,0,1]
    v_pk_fma_f32 v[188:189], v[36:37], v[8:9], v[188:189] op_sel_hi:[1,0,1]
    v_pk_fma_f32 v[190:191], v[38:39], v[8:9], v[190:191] op_sel_hi:[1,0,1]
    v_pk_fma_f32 v[64:65], v[64:65], s[74:75], s[74:75]
    v_pk_fma_f32 v[66:67], v[66:67], s[74:75], s[74:75]
    v_pk_fma_f32 v[68:69], v[68:69], s[74:75], s[74:75]
    v_pk_fma_f32 v[70:71], v[70:71], s[74:75], s[74:75]
    v_pk_mul_f32 v[148:149], v[148:149], v[56:57]
    v_pk_mul_f32 v[150:151], v[150:151], v[58:59]
    v_pk_mul_f32 v[164:165], v[164:165], v[60:61]
    v_pk_mul_f32 v[166:167], v[166:167], v[62:63]
    v_cvt_pk_bf16_f32 v88, v148, v149
    v_cvt_pk_bf16_f32 v89, v150, v151
    v_cvt_pk_bf16_f32 v90, v164, v165
    v_cvt_pk_bf16_f32 v91, v166, v167
    buffer_store_dwordx4 v[88:91], v2, s[8:11], s37 offen offset:2048 sc1
    v_rcp_f32 v64, v64
    v_rcp_f32 v65, v65
    v_rcp_f32 v66, v66
    v_rcp_f32 v67, v67
    v_rcp_f32 v68, v68
    v_rcp_f32 v69, v69
    v_rcp_f32 v70, v70
    v_rcp_f32 v71, v71
    v_exp_f32 v72, v172
    v_exp_f32 v73, v173
    v_exp_f32 v74, v174
    v_exp_f32 v75, v175
    v_exp_f32 v76, v188
    v_exp_f32 v77, v189
    v_exp_f32 v78, v190
    v_exp_f32 v79, v191
    v_pk_mul_f32 v[176:177], v[176:177], v[10:11] op_sel:[0,1] op_sel_hi:[1,1]
    v_pk_mul_f32 v[178:179], v[178:179], v[10:11] op_sel:[0,1] op_sel_hi:[1,1]
    v_pk_mul_f32 v[192:193], v[192:193], v[10:11] op_sel:[0,1] op_sel_hi:[1,1]
    v_pk_mul_f32 v[194:195], v[194:195], v[10:11] op_sel:[0,1] op_sel_hi:[1,1]
    v_pk_fma_f32 v[176:177], v[32:33], v[10:11], v[176:177] op_sel_hi:[1,0,1]
    v_pk_fma_f32 v[178:179], v[34:35], v[10:11], v[178:179] op_sel_hi:[1,0,1]
    v_pk_fma_f32 v[192:193], v[36:37], v[10:11], v[192:193] op_sel_hi:[1,0,1]
    v_pk_fma_f32 v[194:195], v[38:39], v[10:11], v[194:195] op_sel_hi:[1,0,1]
    v_pk_fma_f32 v[72:73], v[72:73], s[74:75], s[74:75]
    v_pk_fma_f32 v[74:75], v[74:75], s[74:75], s[74:75]
    v_pk_fma_f32 v[76:77], v[76:77], s[74:75], s[74:75]
    v_pk_fma_f32 v[78:79], v[78:79], s[74:75], s[74:75]
    v_pk_mul_f32 v[152:153], v[152:153], v[64:65]
    v_pk_mul_f32 v[154:155], v[154:155], v[66:67]
    v_pk_mul_f32 v[168:169], v[168:169], v[68:69]
    v_pk_mul_f32 v[170:171], v[170:171], v[70:71]
    v_cvt_pk_bf16_f32 v92, v152, v153
    v_cvt_pk_bf16_f32 v93, v154, v155
    v_cvt_pk_bf16_f32 v94, v168, v169
    v_cvt_pk_bf16_f32 v95, v170, v171
    buffer_store_dwordx4 v[92:95], v2, s[8:11], s37 offen offset:3072 sc1
    v_rcp_f32 v72, v72
    v_rcp_f32 v73, v73
    v_rcp_f32 v74, v74
    v_rcp_f32 v75, v75
    v_rcp_f32 v76, v76
    v_rcp_f32 v77, v77
    v_rcp_f32 v78, v78
    v_rcp_f32 v79, v79
    v_exp_f32 v56, v176
    v_exp_f32 v57, v177
    v_exp_f32 v58, v178
    v_exp_f32 v59, v179
    v_exp_f32 v60, v192
    v_exp_f32 v61, v193
    v_exp_f32 v62, v194
    v_exp_f32 v63, v195
    v_pk_mul_f32 v[180:181], v[180:181], v[12:13] op_sel:[0,1] op_sel_hi:[1,1]
    v_pk_mul_f32 v[182:183], v[182:183], v[12:13] op_sel:[0,1] op_sel_hi:[1,1]
    v_pk_mul_f32 v[196:197], v[196:197], v[12:13] op_sel:[0,1] op_sel_hi:[1,1]
    v_pk_mul_f32 v[198:199], v[198:199], v[12:13] op_sel:[0,1] op_sel_hi:[1,1]
    v_pk_fma_f32 v[180:181], v[32:33], v[12:13], v[180:181] op_sel_hi:[1,0,1]
    v_pk_fma_f32 v[182:183], v[34:35], v[12:13], v[182:183] op_sel_hi:[1,0,1]
    v_pk_fma_f32 v[196:197], v[36:37], v[12:13], v[196:197] op_sel_hi:[1,0,1]
    v_pk_fma_f32 v[198:199], v[38:39], v[12:13], v[198:199] op_sel_hi:[1,0,1]
    v_pk_fma_f32 v[56:57], v[56:57], s[74:75], s[74:75]
    v_pk_fma_f32 v[58:59], v[58:59], s[74:75], s[74:75]
    v_pk_fma_f32 v[60:61], v[60:61], s[74:75], s[74:75]
    v_pk_fma_f32 v[62:63], v[62:63], s[74:75], s[74:75]
    v_pk_mul_f32 v[172:173], v[172:173], v[72:73]
    v_pk_mul_f32 v[174:175], v[174:175], v[74:75]
    v_pk_mul_f32 v[188:189], v[188:189], v[76:77]
    v_pk_mul_f32 v[190:191], v[190:191], v[78:79]
    v_cvt_pk_bf16_f32 v80, v172, v173
    v_cvt_pk_bf16_f32 v81, v174, v175
    v_cvt_pk_bf16_f32 v82, v188, v189
    v_cvt_pk_bf16_f32 v83, v190, v191
    buffer_store_dwordx4 v[80:83], v2, s[8:11], s35 offen offset:0 sc1
    v_rcp_f32 v56, v56
    v_rcp_f32 v57, v57
    v_rcp_f32 v58, v58
    v_rcp_f32 v59, v59
    v_rcp_f32 v60, v60
    v_rcp_f32 v61, v61
    v_rcp_f32 v62, v62
    v_rcp_f32 v63, v63
    v_exp_f32 v64, v180
    v_exp_f32 v65, v181
    v_exp_f32 v66, v182
    v_exp_f32 v67, v183
    v_exp_f32 v68, v196
    v_exp_f32 v69, v197
    v_exp_f32 v70, v198
    v_exp_f32 v71, v199
    v_pk_mul_f32 v[184:185], v[184:185], v[14:15] op_sel:[0,1] op_sel_hi:[1,1]
    v_pk_mul_f32 v[186:187], v[186:187], v[14:15] op_sel:[0,1] op_sel_hi:[1,1]
    v_pk_mul_f32 v[200:201], v[200:201], v[14:15] op_sel:[0,1] op_sel_hi:[1,1]
    v_pk_mul_f32 v[202:203], v[202:203], v[14:15] op_sel:[0,1] op_sel_hi:[1,1]
    v_pk_fma_f32 v[184:185], v[32:33], v[14:15], v[184:185] op_sel_hi:[1,0,1]
    v_pk_fma_f32 v[186:187], v[34:35], v[14:15], v[186:187] op_sel_hi:[1,0,1]
    v_pk_fma_f32 v[200:201], v[36:37], v[14:15], v[200:201] op_sel_hi:[1,0,1]
    v_pk_fma_f32 v[202:203], v[38:39], v[14:15], v[202:203] op_sel_hi:[1,0,1]
    v_pk_fma_f32 v[64:65], v[64:65], s[74:75], s[74:75]
    v_pk_fma_f32 v[66:67], v[66:67], s[74:75], s[74:75]
    v_pk_fma_f32 v[68:69], v[68:69], s[74:75], s[74:75]
    v_pk_fma_f32 v[70:71], v[70:71], s[74:75], s[74:75]
    v_pk_mul_f32 v[176:177], v[176:177], v[56:57]
    v_pk_mul_f32 v[178:179], v[178:179], v[58:59]
    v_pk_mul_f32 v[192:193], v[192:193], v[60:61]
    v_pk_mul_f32 v[194:195], v[194:195], v[62:63]
    v_cvt_pk_bf16_f32 v84, v176, v177
    v_cvt_pk_bf16_f32 v85, v178, v179
    v_cvt_pk_bf16_f32 v86, v192, v193
    v_cvt_pk_bf16_f32 v87, v194, v195
    buffer_store_dwordx4 v[84:87], v2, s[8:11], s35 offen offset:1024 sc1
    v_rcp_f32 v64, v64
    v_rcp_f32 v65, v65
    v_rcp_f32 v66, v66
    v_rcp_f32 v67, v67
    v_rcp_f32 v68, v68
    v_rcp_f32 v69, v69
    v_rcp_f32 v70, v70
    v_rcp_f32 v71, v71
    s_waitcnt vmcnt(2)
    v_mov_b32 v5, 0
    v_mov_b32 v6, 1
    s_mov_b64 exec, 1
    buffer_store_dword v6, v5, s[8:11], s38 offen sc1
    s_mov_b64 exec, -1
    v_exp_f32 v72, v184
    v_exp_f32 v73, v185
    v_exp_f32 v74, v186
    v_exp_f32 v75, v187
    v_exp_f32 v76, v200
    v_exp_f32 v77, v201
    v_exp_f32 v78, v202
    v_exp_f32 v79, v203
    v_pk_mul_f32 v[204:205], v[204:205], v[8:9] op_sel:[0,1] op_sel_hi:[1,1]
    v_pk_mul_f32 v[206:207], v[206:207], v[8:9] op_sel:[0,1] op_sel_hi:[1,1]
    v_pk_fma_f32 v[204:205], v[40:41], v[8:9], v[204:205] op_sel_hi:[1,0,1]
    v_pk_fma_f32 v[206:207], v[42:43], v[8:9], v[206:207] op_sel_hi:[1,0,1]
    v_pk_fma_f32 v[72:73], v[72:73], s[74:75], s[74:75]
    v_pk_fma_f32 v[74:75], v[74:75], s[74:75], s[74:75]
    v_pk_fma_f32 v[76:77], v[76:77], s[74:75], s[74:75]
    v_pk_fma_f32 v[78:79], v[78:79], s[74:75], s[74:75]
    v_pk_mul_f32 v[180:181], v[180:181], v[64:65]
    v_pk_mul_f32 v[182:183], v[182:183], v[66:67]
    v_pk_mul_f32 v[196:197], v[196:197], v[68:69]
    v_pk_mul_f32 v[198:199], v[198:199], v[70:71]
    v_cvt_pk_bf16_f32 v88, v180, v181
    v_cvt_pk_bf16_f32 v89, v182, v183
    v_cvt_pk_bf16_f32 v90, v196, v197
    v_cvt_pk_bf16_f32 v91, v198, v199
    buffer_store_dwordx4 v[88:91], v2, s[8:11], s35 offen offset:2048 sc1
    v_rcp_f32 v72, v72
    v_rcp_f32 v73, v73
    v_rcp_f32 v74, v74
    v_rcp_f32 v75, v75
    v_rcp_f32 v76, v76
    v_rcp_f32 v77, v77
    v_rcp_f32 v78, v78
    v_rcp_f32 v79, v79
    v_exp_f32 v56, v204
    v_exp_f32 v57, v205
    v_exp_f32 v58, v206
    v_exp_f32 v59, v207
    v_pk_mul_f32 v[208:209], v[208:209], v[10:11] op_sel:[0,1] op_sel_hi:[1,1]
    v_pk_mul_f32 v[210:211], v[210:211], v[10:11] op_sel:[0,1] op_sel_hi:[1,1]
    v_pk_fma_f32 v[208:209], v[40:41], v[10:11], v[208:209] op_sel_hi:[1,0,1]
    v_pk_fma_f32 v[210:211], v[42:43], v[10:11], v[210:211] op_sel_hi:[1,0,1]
    v_pk_fma_f32 v[56:57], v[56:57], s[74:75], s[74:75]
    v_pk_fma_f32 v[58:59], v[58:59], s[74:75], s[74:75]
    v_pk_mul_f32 v[184:185], v[184:185], v[72:73]
    v_pk_mul_f32 v[186:187], v[186:187], v[74:75]
    v_pk_mul_f32 v[200:201], v[200:201], v[76:77]
    v_pk_mul_f32 v[202:203], v[202:203], v[78:79]
    v_cvt_pk_bf16_f32 v92, v184, v185
    v_cvt_pk_bf16_f32 v93, v186, v187
    v_cvt_pk_bf16_f32 v94, v200, v201
    v_cvt_pk_bf16_f32 v95, v202, v203
    buffer_store_dwordx4 v[92:95], v2, s[8:11], s35 offen offset:3072 sc1
    v_rcp_f32 v56, v56
    v_rcp_f32 v57, v57
    v_rcp_f32 v58, v58
    v_rcp_f32 v59, v59
    v_exp_f32 v64, v208
    v_exp_f32 v65, v209
    v_exp_f32 v66, v210
    v_exp_f32 v67, v211
    v_pk_mul_f32 v[212:213], v[212:213], v[12:13] op_sel:[0,1] op_sel_hi:[1,1]
    v_pk_mul_f32 v[214:215], v[214:215], v[12:13] op_sel:[0,1] op_sel_hi:[1,1]
    v_pk_fma_f32 v[212:213], v[40:41], v[12:13], v[212:213] op_sel_hi:[1,0,1]
    v_pk_fma_f32 v[214:215], v[42:43], v[12:13], v[214:215] op_sel_hi:[1,0,1]
    v_pk_fma_f32 v[64:65], v[64:65], s[74:75], s[74:75]
    v_pk_fma_f32 v[66:67], v[66:67], s[74:75], s[74:75]
    v_pk_mul_f32 v[204:205], v[204:205], v[56:57]
    v_pk_mul_f32 v[206:207], v[206:207], v[58:59]
    v_cvt_pk_bf16_f32 v80, v204, v205
    v_cvt_pk_bf16_f32 v81, v206, v207
    buffer_store_dwordx2 v[80:81], v2, s[8:11], s36 offen offset:0 sc1
    v_rcp_f32 v64, v64
    v_rcp_f32 v65, v65
    v_rcp_f32 v66, v66
    v_rcp_f32 v67, v67
    v_exp_f32 v72, v212
    v_exp_f32 v73, v213
    v_exp_f32 v74, v214
    v_exp_f32 v75, v215
    v_pk_mul_f32 v[216:217], v[216:217], v[14:15] op_sel:[0,1] op_sel_hi:[1,1]
    v_pk_mul_f32 v[218:219], v[218:219], v[14:15] op_sel:[0,1] op_sel_hi:[1,1]
    v_pk_fma_f32 v[216:217], v[40:41], v[14:15], v[216:217] op_sel_hi:[1,0,1]
    v_pk_fma_f32 v[218:219], v[42:43], v[14:15], v[218:219] op_sel_hi:[1,0,1]
    v_pk_fma_f32 v[72:73], v[72:73], s[74:75], s[74:75]
    v_pk_fma_f32 v[74:75], v[74:75], s[74:75], s[74:75]
    v_pk_mul_f32 v[208:209], v[208:209], v[64:65]
    v_pk_mul_f32 v[210:211], v[210:211], v[66:67]
    v_cvt_pk_bf16_f32 v84, v208, v209
    v_cvt_pk_bf16_f32 v85, v210, v211
    buffer_store_dwordx2 v[84:85], v2, s[8:11], s36 offen offset:1024 sc1
    v_rcp_f32 v72, v72
    v_rcp_f32 v73, v73
    v_rcp_f32 v74, v74
    v_rcp_f32 v75, v75
    v_exp_f32 v56, v216
    v_exp_f32 v57, v217
    v_exp_f32 v58, v218
    v_exp_f32 v59, v219
    v_pk_fma_f32 v[56:57], v[56:57], s[74:75], s[74:75]
    v_pk_fma_f32 v[58:59], v[58:59], s[74:75], s[74:75]
    v_pk_mul_f32 v[212:213], v[212:213], v[72:73]
    v_pk_mul_f32 v[214:215], v[214:215], v[74:75]
    v_cvt_pk_bf16_f32 v88, v212, v213
    v_cvt_pk_bf16_f32 v89, v214, v215
    buffer_store_dwordx2 v[88:89], v2, s[8:11], s36 offen offset:2048 sc1
    v_rcp_f32 v56, v56
    v_rcp_f32 v57, v57
    v_rcp_f32 v58, v58
    v_rcp_f32 v59, v59
    v_pk_mul_f32 v[216:217], v[216:217], v[56:57]
    v_pk_mul_f32 v[218:219], v[218:219], v[58:59]
    v_cvt_pk_bf16_f32 v92, v216, v217
    v_cvt_pk_bf16_f32 v93, v218, v219
    buffer_store_dwordx2 v[92:93], v2, s[8:11], s36 offen offset:3072 sc1
    s_and_b32 s24, s22, 1
    s_lshl_b32 s24, s24, 3
    s_and_b32 s30, s23, 6
    s_add_u32 s24, s24, s30
    s_and_b32 s25, s23, 1
    s_lshl_b32 s25, s25, 2
    s_lshr_b32 s30, s23, 3
    s_add_u32 s25, s25, s30
    s_lshr_b32 s71, s22, 1
    s_add_u32 s30, s71, 0
    s_and_b32 s30, s30, 3
    s_lshl_b32 s30, s30, 11
    s_lshl_b32 s31, s28, 14
    s_add_u32 s30, s30, s31
    v_lshl_add_u32 v104, v1, 4, s30
    v_add_u32 v108, 0x10000, v104
    s_add_u32 s30, s71, 1
    s_and_b32 s30, s30, 3
    s_lshl_b32 s30, s30, 11
    s_lshl_b32 s31, s28, 14
    s_add_u32 s30, s30, s31
    v_lshl_add_u32 v105, v1, 4, s30
    v_add_u32 v109, 0x10000, v105
    s_add_u32 s30, s71, 2
    s_and_b32 s30, s30, 3
    s_lshl_b32 s30, s30, 11
    s_lshl_b32 s31, s28, 14
    s_add_u32 s30, s30, s31
    v_lshl_add_u32 v106, v1, 4, s30
    v_add_u32 v110, 0x10000, v106
    s_add_u32 s30, s71, 3
    s_and_b32 s30, s30, 3
    s_lshl_b32 s30, s30, 11
    s_lshl_b32 s31, s28, 14
    s_add_u32 s30, s30, s31
    v_lshl_add_u32 v107, v1, 4, s30
    v_add_u32 v111, 0x10000, v107
    v_bfe_u32 v5, v1, 2, 2
    v_and_b32 v6, 3, v1
    v_lshl_add_u32 v7, v3, 2, v5
    v_bfe_u32 v2, v7, 1, 2
    v_mov_b32 v9, v7
    v_lshlrev_b32 v7, 7, v7
    v_lshl_add_u32 v7, v6, 3, v7
    s_mul_i32 s30, s29, 0
    s_add_u32 s30, s30, 0
    v_xor_b32 v8, s30, v2
    v_lshl_add_u32 v112, v8, 5, v7
    s_mul_i32 s30, s29, 24576
    s_add_u32 s30, s30, 98304
    v_add_u32 v112, s30, v112
    s_mul_i32 s30, s29, 0
    s_add_u32 s30, s30, 1
    v_xor_b32 v8, s30, v2
    v_lshl_add_u32 v113, v8, 5, v7
    s_mul_i32 s30, s29, 24576
    s_add_u32 s30, s30, 98304
    v_add_u32 v113, s30, v113
    s_mul_i32 s30, s29, 0
    s_add_u32 s30, s30, 2
    v_xor_b32 v8, s30, v2
    v_lshl_add_u32 v114, v8, 5, v7
    s_mul_i32 s30, s29, 24576
    s_add_u32 s30, s30, 98304
    v_add_u32 v114, s30, v114
    s_mul_i32 s30, s29, 0
    s_add_u32 s30, s30, 3
    v_xor_b32 v8, s30, v2
    v_lshl_add_u32 v115, v8, 5, v7
    s_mul_i32 s30, s29, 24576
    s_add_u32 s30, s30, 98304
    v_add_u32 v115, s30, v115
stx_373:
    s_barrier
    ds_read_b64_tr_b16 v[40:41], v112 offset:0
    ds_read_b64_tr_b16 v[42:43], v112 offset:2048
    ds_read_b128 v[8:11], v104 offset:0
    ds_read_b128 v[12:15], v104 offset:1024
    ds_read_b128 v[16:19], v105 offset:0
    ds_read_b128 v[20:23], v105 offset:1024
    ds_read_b128 v[24:27], v106 offset:0
    ds_read_b128 v[28:31], v106 offset:1024
    ds_read_b128 v[32:35], v107 offset:0
    ds_read_b128 v[36:39], v107 offset:1024
    ds_read_b64_tr_b16 v[44:45], v113 offset:0
    ds_read_b64_tr_b16 v[46:47], v113 offset:2048
    ds_read_b64_tr_b16 v[48:49], v114 offset:0
    ds_read_b64_tr_b16 v[50:51], v114 offset:2048
    ds_read_b64_tr_b16 v[52:53], v115 offset:0
    ds_read_b64_tr_b16 v[54:55], v115 offset:2048
    s_waitcnt vmcnt(0)
    s_cmp_lg_u32 s54, 0
    s_cbranch_scc1 slowst_374
    v_mov_b32 v5, 0
    v_mov_b32 v6, 3
    s_mov_b64 exec, 1
    buffer_store_dword v6, v5, s[8:11], s38 offen
    s_mov_b64 exec, -1
    s_branch stx_375
slowst_374:
    v_mov_b32 v5, 0
    v_mov_b32 v6, 3
    s_mov_b64 exec, 1
    buffer_store_dword v6, v5, s[8:11], s38 offen sc1
    s_mov_b64 exec, -1
stx_375:
    s_waitcnt lgkmcnt(0)
    v_mfma_f32_16x16x32_bf16 v[116:119], v[40:43], v[8:11], 0
    ds_read_b64_tr_b16 v[88:89], v112 offset:4096
    v_mfma_f32_16x16x32_bf16 v[120:123], v[40:43], v[12:15], 0
    ds_read_b64_tr_b16 v[90:91], v112 offset:6144
    v_mfma_f32_16x16x32_bf16 v[124:127], v[40:43], v[16:19], 0
    v_mfma_f32_16x16x32_bf16 v[128:131], v[40:43], v[20:23], 0
    ds_read_b128 v[56:59], v104 offset:8192
    v_mfma_f32_16x16x32_bf16 v[132:135], v[40:43], v[24:27], 0
    ds_read_b128 v[60:63], v104 offset:9216
    v_mfma_f32_16x16x32_bf16 v[136:139], v[40:43], v[28:31], 0
    v_mfma_f32_16x16x32_bf16 v[140:143], v[40:43], v[32:35], 0
    ds_read_b128 v[64:67], v105 offset:8192
    v_mfma_f32_16x16x32_bf16 v[144:147], v[40:43], v[36:39], 0
    ds_read_b128 v[68:71], v105 offset:9216
    v_mfma_f32_16x16x32_bf16 v[176:179], v[44:47], v[36:39], 0
    v_mfma_f32_16x16x32_bf16 v[172:175], v[44:47], v[32:35], 0
    ds_read_b128 v[72:75], v106 offset:8192
    v_mfma_f32_16x16x32_bf16 v[168:171], v[44:47], v[28:31], 0
    ds_read_b128 v[76:79], v106 offset:9216
    v_mfma_f32_16x16x32_bf16 v[164:167], v[44:47], v[24:27], 0
    v_mfma_f32_16x16x32_bf16 v[160:163], v[44:47], v[20:23], 0
    ds_read_b128 v[80:83], v107 offset:8192
    v_mfma_f32_16x16x32_bf16 v[156:159], v[44:47], v[16:19], 0
    ds_read_b128 v[84:87], v107 offset:9216
    v_mfma_f32_16x16x32_bf16 v[152:155], v[44:47], v[12:15], 0
    v_mfma_f32_16x16x32_bf16 v[148:151], v[44:47], v[8:11], 0
    ds_read_b64_tr_b16 v[92:93], v113 offset:4096
    v_mfma_f32_16x16x32_bf16 v[180:183], v[48:51], v[8:11], 0
    ds_read_b64_tr_b16 v[94:95], v113 offset:6144
    v_mfma_f32_16x16x32_bf16 v[184:187], v[48:51], v[12:15], 0
    v_mfma_f32_16x16x32_bf16 v[188:191], v[48:51], v[16:19], 0
    ds_read_b64_tr_b16 v[96:97], v114 offset:4096
    v_mfma_f32_16x16x32_bf16 v[192:195], v[48:51], v[20:23], 0
    ds_read_b64_tr_b16 v[98:99], v114 offset:6144
    v_mfma_f32_16x16x32_bf16 v[196:199], v[48:51], v[24:27], 0
    v_mfma_f32_16x16x32_bf16 v[200:203], v[48:51], v[28:31], 0
    ds_read_b64_tr_b16 v[100:101], v115 offset:4096
    v_mfma_f32_16x16x32_bf16 v[204:207], v[48:51], v[32:35], 0
    ds_read_b64_tr_b16 v[102:103], v115 offset:6144
    v_mfma_f32_16x16x32_bf16 v[208:211], v[48:51], v[36:39], 0
    v_mfma_f32_16x16x32_bf16 v[240:243], v[52:55], v[36:39], 0
    v_mfma_f32_16x16x32_bf16 v[236:239], v[52:55], v[32:35], 0
    v_mfma_f32_16x16x32_bf16 v[232:235], v[52:55], v[28:31], 0
    v_mfma_f32_16x16x32_bf16 v[228:231], v[52:55], v[24:27], 0
    v_mfma_f32_16x16x32_bf16 v[224:227], v[52:55], v[20:23], 0
    v_mfma_f32_16x16x32_bf16 v[220:223], v[52:55], v[16:19], 0
    v_mfma_f32_16x16x32_bf16 v[216:219], v[52:55], v[12:15], 0
    v_mfma_f32_16x16x32_bf16 v[212:215], v[52:55], v[8:11], 0
    s_waitcnt lgkmcnt(0)
    s_barrier
    v_mfma_f32_16x16x32_bf16 v[116:119], v[88:91], v[56:59], v[116:119]
    ds_read_b64_tr_b16 v[40:41], v112 offset:8192
    v_mfma_f32_16x16x32_bf16 v[120:123], v[88:91], v[60:63], v[120:123]
    ds_read_b64_tr_b16 v[42:43], v112 offset:10240
    v_mfma_f32_16x16x32_bf16 v[124:127], v[88:91], v[64:67], v[124:127]
    v_mfma_f32_16x16x32_bf16 v[128:131], v[88:91], v[68:71], v[128:131]
    ds_read_b128 v[8:11], v104 offset:32768
    v_mfma_f32_16x16x32_bf16 v[132:135], v[88:91], v[72:75], v[132:135]
    ds_read_b128 v[12:15], v104 offset:33792
    v_mfma_f32_16x16x32_bf16 v[136:139], v[88:91], v[76:79], v[136:139]
    v_mfma_f32_16x16x32_bf16 v[140:143], v[88:91], v[80:83], v[140:143]
    ds_read_b128 v[16:19], v105 offset:32768
    v_mfma_f32_16x16x32_bf16 v[144:147], v[88:91], v[84:87], v[144:147]
    ds_read_b128 v[20:23], v105 offset:33792
    v_mfma_f32_16x16x32_bf16 v[176:179], v[92:95], v[84:87], v[176:179]
    v_mfma_f32_16x16x32_bf16 v[172:175], v[92:95], v[80:83], v[172:175]
    ds_read_b128 v[24:27], v106 offset:32768
    v_mfma_f32_16x16x32_bf16 v[168:171], v[92:95], v[76:79], v[168:171]
    ds_read_b128 v[28:31], v106 offset:33792
    v_mfma_f32_16x16x32_bf16 v[164:167], v[92:95], v[72:75], v[164:167]
    v_mfma_f32_16x16x32_bf16 v[160:163], v[92:95], v[68:71], v[160:163]
    ds_read_b128 v[32:35], v107 offset:32768
    v_mfma_f32_16x16x32_bf16 v[156:159], v[92:95], v[64:67], v[156:159]
    ds_read_b128 v[36:39], v107 offset:33792
    v_mfma_f32_16x16x32_bf16 v[152:155], v[92:95], v[60:63], v[152:155]
    v_mfma_f32_16x16x32_bf16 v[148:151], v[92:95], v[56:59], v[148:151]
    ds_read_b64_tr_b16 v[44:45], v113 offset:8192
    v_mfma_f32_16x16x32_bf16 v[180:183], v[96:99], v[56:59], v[180:183]
    ds_read_b64_tr_b16 v[46:47], v113 offset:10240
    v_mfma_f32_16x16x32_bf16 v[184:187], v[96:99], v[60:63], v[184:187]
    v_mfma_f32_16x16x32_bf16 v[188:191], v[96:99], v[64:67], v[188:191]
    ds_read_b64_tr_b16 v[48:49], v114 offset:8192
    v_mfma_f32_16x16x32_bf16 v[192:195], v[96:99], v[68:71], v[192:195]
    ds_read_b64_tr_b16 v[50:51], v114 offset:10240
    v_mfma_f32_16x16x32_bf16 v[196:199], v[96:99], v[72:75], v[196:199]
    v_mfma_f32_16x16x32_bf16 v[200:203], v[96:99], v[76:79], v[200:203]
    ds_read_b64_tr_b16 v[52:53], v115 offset:8192
    v_mfma_f32_16x16x32_bf16 v[204:207], v[96:99], v[80:83], v[204:207]
    ds_read_b64_tr_b16 v[54:55], v115 offset:10240
    v_mfma_f32_16x16x32_bf16 v[208:211], v[96:99], v[84:87], v[208:211]
    v_mfma_f32_16x16x32_bf16 v[240:243], v[100:103], v[84:87], v[240:243]
    v_mfma_f32_16x16x32_bf16 v[236:239], v[100:103], v[80:83], v[236:239]
    v_mfma_f32_16x16x32_bf16 v[232:235], v[100:103], v[76:79], v[232:235]
    v_mfma_f32_16x16x32_bf16 v[228:231], v[100:103], v[72:75], v[228:231]
    v_mfma_f32_16x16x32_bf16 v[224:227], v[100:103], v[68:71], v[224:227]
    v_mfma_f32_16x16x32_bf16 v[220:223], v[100:103], v[64:67], v[220:223]
    v_mfma_f32_16x16x32_bf16 v[216:219], v[100:103], v[60:63], v[216:219]
    v_mfma_f32_16x16x32_bf16 v[212:215], v[100:103], v[56:59], v[212:215]
    s_waitcnt lgkmcnt(0)
    v_mfma_f32_16x16x32_bf16 v[116:119], v[40:43], v[8:11], v[116:119]
    ds_read_b64_tr_b16 v[88:89], v112 offset:12288
    v_mfma_f32_16x16x32_bf16 v[120:123], v[40:43], v[12:15], v[120:123]
    ds_read_b64_tr_b16 v[90:91], v112 offset:14336
    v_mfma_f32_16x16x32_bf16 v[124:127], v[40:43], v[16:19], v[124:127]
    v_mfma_f32_16x16x32_bf16 v[128:131], v[40:43], v[20:23], v[128:131]
    ds_read_b128 v[56:59], v104 offset:40960
    v_mfma_f32_16x16x32_bf16 v[132:135], v[40:43], v[24:27], v[132:135]
    ds_read_b128 v[60:63], v104 offset:41984
    v_mfma_f32_16x16x32_bf16 v[136:139], v[40:43], v[28:31], v[136:139]
    v_mfma_f32_16x16x32_bf16 v[140:143], v[40:43], v[32:35], v[140:143]
    ds_read_b128 v[64:67], v105 offset:40960
    v_mfma_f32_16x16x32_bf16 v[144:147], v[40:43], v[36:39], v[144:147]
    ds_read_b128 v[68:71], v105 offset:41984
    v_mfma_f32_16x16x32_bf16 v[176:179], v[44:47], v[36:39], v[176:179]
    v_mfma_f32_16x16x32_bf16 v[172:175], v[44:47], v[32:35], v[172:175]
    ds_read_b128 v[72:75], v106 offset:40960
    v_mfma_f32_16x16x32_bf16 v[168:171], v[44:47], v[28:31], v[168:171]
    ds_read_b128 v[76:79], v106 offset:41984
    v_mfma_f32_16x16x32_bf16 v[164:167], v[44:47], v[24:27], v[164:167]
    v_mfma_f32_16x16x32_bf16 v[160:163], v[44:47], v[20:23], v[160:163]
    ds_read_b128 v[80:83], v107 offset:40960
    v_mfma_f32_16x16x32_bf16 v[156:159], v[44:47], v[16:19], v[156:159]
    ds_read_b128 v[84:87], v107 offset:41984
    v_mfma_f32_16x16x32_bf16 v[152:155], v[44:47], v[12:15], v[152:155]
    v_mfma_f32_16x16x32_bf16 v[148:151], v[44:47], v[8:11], v[148:151]
    ds_read_b64_tr_b16 v[92:93], v113 offset:12288
    v_mfma_f32_16x16x32_bf16 v[180:183], v[48:51], v[8:11], v[180:183]
    ds_read_b64_tr_b16 v[94:95], v113 offset:14336
    v_mfma_f32_16x16x32_bf16 v[184:187], v[48:51], v[12:15], v[184:187]
    v_mfma_f32_16x16x32_bf16 v[188:191], v[48:51], v[16:19], v[188:191]
    ds_read_b64_tr_b16 v[96:97], v114 offset:12288
    v_mfma_f32_16x16x32_bf16 v[192:195], v[48:51], v[20:23], v[192:195]
    ds_read_b64_tr_b16 v[98:99], v114 offset:14336
    v_mfma_f32_16x16x32_bf16 v[196:199], v[48:51], v[24:27], v[196:199]
    v_mfma_f32_16x16x32_bf16 v[200:203], v[48:51], v[28:31], v[200:203]
    ds_read_b64_tr_b16 v[100:101], v115 offset:12288
    v_mfma_f32_16x16x32_bf16 v[204:207], v[48:51], v[32:35], v[204:207]
    ds_read_b64_tr_b16 v[102:103], v115 offset:14336
    v_mfma_f32_16x16x32_bf16 v[208:211], v[48:51], v[36:39], v[208:211]
    v_mfma_f32_16x16x32_bf16 v[240:243], v[52:55], v[36:39], v[240:243]
    v_mfma_f32_16x16x32_bf16 v[236:239], v[52:55], v[32:35], v[236:239]
    v_mfma_f32_16x16x32_bf16 v[232:235], v[52:55], v[28:31], v[232:235]
    v_mfma_f32_16x16x32_bf16 v[228:231], v[52:55], v[24:27], v[228:231]
    v_mfma_f32_16x16x32_bf16 v[224:227], v[52:55], v[20:23], v[224:227]
    v_mfma_f32_16x16x32_bf16 v[220:223], v[52:55], v[16:19], v[220:223]
    v_mfma_f32_16x16x32_bf16 v[216:219], v[52:55], v[12:15], v[216:219]
    v_mfma_f32_16x16x32_bf16 v[212:215], v[52:55], v[8:11], v[212:215]
    s_waitcnt lgkmcnt(0)
    s_barrier
    v_mfma_f32_16x16x32_bf16 v[116:119], v[88:91], v[56:59], v[116:119]
    ds_read_b64_tr_b16 v[40:41], v112 offset:16384
    v_mfma_f32_16x16x32_bf16 v[120:123], v[88:91], v[60:63], v[120:123]
    ds_read_b64_tr_b16 v[42:43], v112 offset:18432
    v_mfma_f32_16x16x32_bf16 v[124:127], v[88:91], v[64:67], v[124:127]
    v_mfma_f32_16x16x32_bf16 v[128:131], v[88:91], v[68:71], v[128:131]
    ds_read_b128 v[8:11], v108 offset:0
    v_mfma_f32_16x16x32_bf16 v[132:135], v[88:91], v[72:75], v[132:135]
    ds_read_b128 v[12:15], v108 offset:1024
    v_mfma_f32_16x16x32_bf16 v[136:139], v[88:91], v[76:79], v[136:139]
    v_mfma_f32_16x16x32_bf16 v[140:143], v[88:91], v[80:83], v[140:143]
    ds_read_b128 v[16:19], v109 offset:0
    v_mfma_f32_16x16x32_bf16 v[144:147], v[88:91], v[84:87], v[144:147]
    ds_read_b128 v[20:23], v109 offset:1024
    v_mfma_f32_16x16x32_bf16 v[176:179], v[92:95], v[84:87], v[176:179]
    v_mfma_f32_16x16x32_bf16 v[172:175], v[92:95], v[80:83], v[172:175]
    ds_read_b128 v[24:27], v110 offset:0
    v_mfma_f32_16x16x32_bf16 v[168:171], v[92:95], v[76:79], v[168:171]
    ds_read_b128 v[28:31], v110 offset:1024
    v_mfma_f32_16x16x32_bf16 v[164:167], v[92:95], v[72:75], v[164:167]
    v_mfma_f32_16x16x32_bf16 v[160:163], v[92:95], v[68:71], v[160:163]
    ds_read_b128 v[32:35], v111 offset:0
    v_mfma_f32_16x16x32_bf16 v[156:159], v[92:95], v[64:67], v[156:159]
    ds_read_b128 v[36:39], v111 offset:1024
    v_mfma_f32_16x16x32_bf16 v[152:155], v[92:95], v[60:63], v[152:155]
    v_mfma_f32_16x16x32_bf16 v[148:151], v[92:95], v[56:59], v[148:151]
    ds_read_b64_tr_b16 v[44:45], v113 offset:16384
    v_mfma_f32_16x16x32_bf16 v[180:183], v[96:99], v[56:59], v[180:183]
    ds_read_b64_tr_b16 v[46:47], v113 offset:18432
    v_mfma_f32_16x16x32_bf16 v[184:187], v[96:99], v[60:63], v[184:187]
    v_mfma_f32_16x16x32_bf16 v[188:191], v[96:99], v[64:67], v[188:191]
    ds_read_b64_tr_b16 v[48:49], v114 offset:16384
    v_mfma_f32_16x16x32_bf16 v[192:195], v[96:99], v[68:71], v[192:195]
    ds_read_b64_tr_b16 v[50:51], v114 offset:18432
    v_mfma_f32_16x16x32_bf16 v[196:199], v[96:99], v[72:75], v[196:199]
    v_mfma_f32_16x16x32_bf16 v[200:203], v[96:99], v[76:79], v[200:203]
    ds_read_b64_tr_b16 v[52:53], v115 offset:16384
    v_mfma_f32_16x16x32_bf16 v[204:207], v[96:99], v[80:83], v[204:207]
    ds_read_b64_tr_b16 v[54:55], v115 offset:18432
    v_mfma_f32_16x16x32_bf16 v[208:211], v[96:99], v[84:87], v[208:211]
    v_mfma_f32_16x16x32_bf16 v[240:243], v[100:103], v[84:87], v[240:243]
    v_mfma_f32_16x16x32_bf16 v[236:239], v[100:103], v[80:83], v[236:239]
    v_mfma_f32_16x16x32_bf16 v[232:235], v[100:103], v[76:79], v[232:235]
    v_mfma_f32_16x16x32_bf16 v[228:231], v[100:103], v[72:75], v[228:231]
    v_mfma_f32_16x16x32_bf16 v[224:227], v[100:103], v[68:71], v[224:227]
    v_mfma_f32_16x16x32_bf16 v[220:223], v[100:103], v[64:67], v[220:223]
    v_mfma_f32_16x16x32_bf16 v[216:219], v[100:103], v[60:63], v[216:219]
    v_mfma_f32_16x16x32_bf16 v[212:215], v[100:103], v[56:59], v[212:215]
    s_mov_b32 s72, 3
w2_cloop:
    s_waitcnt lgkmcnt(0)
    v_mfma_f32_16x16x32_bf16 v[116:119], v[40:43], v[8:11], v[116:119]
    ds_read_b64_tr_b16 v[88:89], v112 offset:20480
    v_mfma_f32_16x16x32_bf16 v[120:123], v[40:43], v[12:15], v[120:123]
    ds_read_b64_tr_b16 v[90:91], v112 offset:22528
    v_mfma_f32_16x16x32_bf16 v[124:127], v[40:43], v[16:19], v[124:127]
    v_mfma_f32_16x16x32_bf16 v[128:131], v[40:43], v[20:23], v[128:131]
    ds_read_b128 v[56:59], v108 offset:8192
    v_mfma_f32_16x16x32_bf16 v[132:135], v[40:43], v[24:27], v[132:135]
    ds_read_b128 v[60:63], v108 offset:9216
    v_mfma_f32_16x16x32_bf16 v[136:139], v[40:43], v[28:31], v[136:139]
    v_mfma_f32_16x16x32_bf16 v[140:143], v[40:43], v[32:35], v[140:143]
    ds_read_b128 v[64:67], v109 offset:8192
    v_mfma_f32_16x16x32_bf16 v[144:147], v[40:43], v[36:39], v[144:147]
    ds_read_b128 v[68:71], v109 offset:9216
    v_mfma_f32_16x16x32_bf16 v[176:179], v[44:47], v[36:39], v[176:179]
    v_mfma_f32_16x16x32_bf16 v[172:175], v[44:47], v[32:35], v[172:175]
    ds_read_b128 v[72:75], v110 offset:8192
    v_mfma_f32_16x16x32_bf16 v[168:171], v[44:47], v[28:31], v[168:171]
    ds_read_b128 v[76:79], v110 offset:9216
    v_mfma_f32_16x16x32_bf16 v[164:167], v[44:47], v[24:27], v[164:167]
    v_mfma_f32_16x16x32_bf16 v[160:163], v[44:47], v[20:23], v[160:163]
    ds_read_b128 v[80:83], v111 offset:8192
    v_mfma_f32_16x16x32_bf16 v[156:159], v[44:47], v[16:19], v[156:159]
    ds_read_b128 v[84:87], v111 offset:9216
    v_mfma_f32_16x16x32_bf16 v[152:155], v[44:47], v[12:15], v[152:155]
    v_mfma_f32_16x16x32_bf16 v[148:151], v[44:47], v[8:11], v[148:151]
    ds_read_b64_tr_b16 v[92:93], v113 offset:20480
    v_mfma_f32_16x16x32_bf16 v[180:183], v[48:51], v[8:11], v[180:183]
    ds_read_b64_tr_b16 v[94:95], v113 offset:22528
    v_mfma_f32_16x16x32_bf16 v[184:187], v[48:51], v[12:15], v[184:187]
    v_mfma_f32_16x16x32_bf16 v[188:191], v[48:51], v[16:19], v[188:191]
    ds_read_b64_tr_b16 v[96:97], v114 offset:20480
    v_mfma_f32_16x16x32_bf16 v[192:195], v[48:51], v[20:23], v[192:195]
    ds_read_b64_tr_b16 v[98:99], v114 offset:22528
    v_mfma_f32_16x16x32_bf16 v[196:199], v[48:51], v[24:27], v[196:199]
    v_mfma_f32_16x16x32_bf16 v[200:203], v[48:51], v[28:31], v[200:203]
    ds_read_b64_tr_b16 v[100:101], v115 offset:20480
    v_mfma_f32_16x16x32_bf16 v[204:207], v[48:51], v[32:35], v[204:207]
    ds_read_b64_tr_b16 v[102:103], v115 offset:22528
    v_mfma_f32_16x16x32_bf16 v[208:211], v[48:51], v[36:39], v[208:211]
    v_mfma_f32_16x16x32_bf16 v[240:243], v[52:55], v[36:39], v[240:243]
    v_mfma_f32_16x16x32_bf16 v[236:239], v[52:55], v[32:35], v[236:239]
    v_mfma_f32_16x16x32_bf16 v[232:235], v[52:55], v[28:31], v[232:235]
    v_mfma_f32_16x16x32_bf16 v[228:231], v[52:55], v[24:27], v[228:231]
    v_mfma_f32_16x16x32_bf16 v[224:227], v[52:55], v[20:23], v[224:227]
    v_mfma_f32_16x16x32_bf16 v[220:223], v[52:55], v[16:19], v[220:223]
    v_mfma_f32_16x16x32_bf16 v[216:219], v[52:55], v[12:15], v[216:219]
    v_mfma_f32_16x16x32_bf16 v[212:215], v[52:55], v[8:11], v[212:215]
    s_waitcnt lgkmcnt(0)
    s_barrier
    v_mfma_f32_16x16x32_bf16 v[116:119], v[88:91], v[56:59], v[116:119]
    ds_read_b64_tr_b16 v[40:41], v112 offset:0
    v_mfma_f32_16x16x32_bf16 v[120:123], v[88:91], v[60:63], v[120:123]
    ds_read_b64_tr_b16 v[42:43], v112 offset:2048
    v_mfma_f32_16x16x32_bf16 v[124:127], v[88:91], v[64:67], v[124:127]
    v_mfma_f32_16x16x32_bf16 v[128:131], v[88:91], v[68:71], v[128:131]
    ds_read_b128 v[8:11], v104 offset:0
    v_mfma_f32_16x16x32_bf16 v[132:135], v[88:91], v[72:75], v[132:135]
    ds_read_b128 v[12:15], v104 offset:1024
    v_mfma_f32_16x16x32_bf16 v[136:139], v[88:91], v[76:79], v[136:139]
    v_mfma_f32_16x16x32_bf16 v[140:143], v[88:91], v[80:83], v[140:143]
    ds_read_b128 v[16:19], v105 offset:0
    v_mfma_f32_16x16x32_bf16 v[144:147], v[88:91], v[84:87], v[144:147]
    ds_read_b128 v[20:23], v105 offset:1024
    v_mfma_f32_16x16x32_bf16 v[176:179], v[92:95], v[84:87], v[176:179]
    v_mfma_f32_16x16x32_bf16 v[172:175], v[92:95], v[80:83], v[172:175]
    ds_read_b128 v[24:27], v106 offset:0
    v_mfma_f32_16x16x32_bf16 v[168:171], v[92:95], v[76:79], v[168:171]
    ds_read_b128 v[28:31], v106 offset:1024
    v_mfma_f32_16x16x32_bf16 v[164:167], v[92:95], v[72:75], v[164:167]
    v_mfma_f32_16x16x32_bf16 v[160:163], v[92:95], v[68:71], v[160:163]
    ds_read_b128 v[32:35], v107 offset:0
    v_mfma_f32_16x16x32_bf16 v[156:159], v[92:95], v[64:67], v[156:159]
    ds_read_b128 v[36:39], v107 offset:1024
    v_mfma_f32_16x16x32_bf16 v[152:155], v[92:95], v[60:63], v[152:155]
    v_mfma_f32_16x16x32_bf16 v[148:151], v[92:95], v[56:59], v[148:151]
    ds_read_b64_tr_b16 v[44:45], v113 offset:0
    v_mfma_f32_16x16x32_bf16 v[180:183], v[96:99], v[56:59], v[180:183]
    ds_read_b64_tr_b16 v[46:47], v113 offset:2048
    v_mfma_f32_16x16x32_bf16 v[184:187], v[96:99], v[60:63], v[184:187]
    v_mfma_f32_16x16x32_bf16 v[188:191], v[96:99], v[64:67], v[188:191]
    ds_read_b64_tr_b16 v[48:49], v114 offset:0
    v_mfma_f32_16x16x32_bf16 v[192:195], v[96:99], v[68:71], v[192:195]
    ds_read_b64_tr_b16 v[50:51], v114 offset:2048
    v_mfma_f32_16x16x32_bf16 v[196:199], v[96:99], v[72:75], v[196:199]
    v_mfma_f32_16x16x32_bf16 v[200:203], v[96:99], v[76:79], v[200:203]
    ds_read_b64_tr_b16 v[52:53], v115 offset:0
    v_mfma_f32_16x16x32_bf16 v[204:207], v[96:99], v[80:83], v[204:207]
    ds_read_b64_tr_b16 v[54:55], v115 offset:2048
    v_mfma_f32_16x16x32_bf16 v[208:211], v[96:99], v[84:87], v[208:211]
    v_mfma_f32_16x16x32_bf16 v[240:243], v[100:103], v[84:87], v[240:243]
    v_mfma_f32_16x16x32_bf16 v[236:239], v[100:103], v[80:83], v[236:239]
    v_mfma_f32_16x16x32_bf16 v[232:235], v[100:103], v[76:79], v[232:235]
    v_mfma_f32_16x16x32_bf16 v[228:231], v[100:103], v[72:75], v[228:231]
    v_mfma_f32_16x16x32_bf16 v[224:227], v[100:103], v[68:71], v[224:227]
    v_mfma_f32_16x16x32_bf16 v[220:223], v[100:103], v[64:67], v[220:223]
    v_mfma_f32_16x16x32_bf16 v[216:219], v[100:103], v[60:63], v[216:219]
    v_mfma_f32_16x16x32_bf16 v[212:215], v[100:103], v[56:59], v[212:215]
    s_waitcnt lgkmcnt(0)
    v_mfma_f32_16x16x32_bf16 v[116:119], v[40:43], v[8:11], v[116:119]
    ds_read_b64_tr_b16 v[88:89], v112 offset:4096
    v_mfma_f32_16x16x32_bf16 v[120:123], v[40:43], v[12:15], v[120:123]
    ds_read_b64_tr_b16 v[90:91], v112 offset:6144
    v_mfma_f32_16x16x32_bf16 v[124:127], v[40:43], v[16:19], v[124:127]
    v_mfma_f32_16x16x32_bf16 v[128:131], v[40:43], v[20:23], v[128:131]
    ds_read_b128 v[56:59], v104 offset:8192
    v_mfma_f32_16x16x32_bf16 v[132:135], v[40:43], v[24:27], v[132:135]
    ds_read_b128 v[60:63], v104 offset:9216
    v_mfma_f32_16x16x32_bf16 v[136:139], v[40:43], v[28:31], v[136:139]
    v_mfma_f32_16x16x32_bf16 v[140:143], v[40:43], v[32:35], v[140:143]
    ds_read_b128 v[64:67], v105 offset:8192
    v_mfma_f32_16x16x32_bf16 v[144:147], v[40:43], v[36:39], v[144:147]
    ds_read_b128 v[68:71], v105 offset:9216
    v_mfma_f32_16x16x32_bf16 v[176:179], v[44:47], v[36:39], v[176:179]
    v_mfma_f32_16x16x32_bf16 v[172:175], v[44:47], v[32:35], v[172:175]
    ds_read_b128 v[72:75], v106 offset:8192
    v_mfma_f32_16x16x32_bf16 v[168:171], v[44:47], v[28:31], v[168:171]
    ds_read_b128 v[76:79], v106 offset:9216
    v_mfma_f32_16x16x32_bf16 v[164:167], v[44:47], v[24:27], v[164:167]
    v_mfma_f32_16x16x32_bf16 v[160:163], v[44:47], v[20:23], v[160:163]
    ds_read_b128 v[80:83], v107 offset:8192
    v_mfma_f32_16x16x32_bf16 v[156:159], v[44:47], v[16:19], v[156:159]
    ds_read_b128 v[84:87], v107 offset:9216
    v_mfma_f32_16x16x32_bf16 v[152:155], v[44:47], v[12:15], v[152:155]
    v_mfma_f32_16x16x32_bf16 v[148:151], v[44:47], v[8:11], v[148:151]
    ds_read_b64_tr_b16 v[92:93], v113 offset:4096
    v_mfma_f32_16x16x32_bf16 v[180:183], v[48:51], v[8:11], v[180:183]
    ds_read_b64_tr_b16 v[94:95], v113 offset:6144
    v_mfma_f32_16x16x32_bf16 v[184:187], v[48:51], v[12:15], v[184:187]
    v_mfma_f32_16x16x32_bf16 v[188:191], v[48:51], v[16:19], v[188:191]
    ds_read_b64_tr_b16 v[96:97], v114 offset:4096
    v_mfma_f32_16x16x32_bf16 v[192:195], v[48:51], v[20:23], v[192:195]
    ds_read_b64_tr_b16 v[98:99], v114 offset:6144
    v_mfma_f32_16x16x32_bf16 v[196:199], v[48:51], v[24:27], v[196:199]
    v_mfma_f32_16x16x32_bf16 v[200:203], v[48:51], v[28:31], v[200:203]
    ds_read_b64_tr_b16 v[100:101], v115 offset:4096
    v_mfma_f32_16x16x32_bf16 v[204:207], v[48:51], v[32:35], v[204:207]
    ds_read_b64_tr_b16 v[102:103], v115 offset:6144
    v_mfma_f32_16x16x32_bf16 v[208:211], v[48:51], v[36:39], v[208:211]
    v_mfma_f32_16x16x32_bf16 v[240:243], v[52:55], v[36:39], v[240:243]
    v_mfma_f32_16x16x32_bf16 v[236:239], v[52:55], v[32:35], v[236:239]
    v_mfma_f32_16x16x32_bf16 v[232:235], v[52:55], v[28:31], v[232:235]
    v_mfma_f32_16x16x32_bf16 v[228:231], v[52:55], v[24:27], v[228:231]
    v_mfma_f32_16x16x32_bf16 v[224:227], v[52:55], v[20:23], v[224:227]
    v_mfma_f32_16x16x32_bf16 v[220:223], v[52:55], v[16:19], v[220:223]
    v_mfma_f32_16x16x32_bf16 v[216:219], v[52:55], v[12:15], v[216:219]
    v_mfma_f32_16x16x32_bf16 v[212:215], v[52:55], v[8:11], v[212:215]
    s_waitcnt lgkmcnt(0)
    s_barrier
    v_mfma_f32_16x16x32_bf16 v[116:119], v[88:91], v[56:59], v[116:119]
    ds_read_b64_tr_b16 v[40:41], v112 offset:8192
    v_mfma_f32_16x16x32_bf16 v[120:123], v[88:91], v[60:63], v[120:123]
    ds_read_b64_tr_b16 v[42:43], v112 offset:10240
    v_mfma_f32_16x16x32_bf16 v[124:127], v[88:91], v[64:67], v[124:127]
    v_mfma_f32_16x16x32_bf16 v[128:131], v[88:91], v[68:71], v[128:131]
    ds_read_b128 v[8:11], v104 offset:32768
    v_mfma_f32_16x16x32_bf16 v[132:135], v[88:91], v[72:75], v[132:135]
    ds_read_b128 v[12:15], v104 offset:33792
    v_mfma_f32_16x16x32_bf16 v[136:139], v[88:91], v[76:79], v[136:139]
    v_mfma_f32_16x16x32_bf16 v[140:143], v[88:91], v[80:83], v[140:143]
    ds_read_b128 v[16:19], v105 offset:32768
    v_mfma_f32_16x16x32_bf16 v[144:147], v[88:91], v[84:87], v[144:147]
    ds_read_b128 v[20:23], v105 offset:33792
    v_mfma_f32_16x16x32_bf16 v[176:179], v[92:95], v[84:87], v[176:179]
    v_mfma_f32_16x16x32_bf16 v[172:175], v[92:95], v[80:83], v[172:175]
    ds_read_b128 v[24:27], v106 offset:32768
    v_mfma_f32_16x16x32_bf16 v[168:171], v[92:95], v[76:79], v[168:171]
    ds_read_b128 v[28:31], v106 offset:33792
    v_mfma_f32_16x16x32_bf16 v[164:167], v[92:95], v[72:75], v[164:167]
    v_mfma_f32_16x16x32_bf16 v[160:163], v[92:95], v[68:71], v[160:163]
    ds_read_b128 v[32:35], v107 offset:32768
    v_mfma_f32_16x16x32_bf16 v[156:159], v[92:95], v[64:67], v[156:159]
    ds_read_b128 v[36:39], v107 offset:33792
    v_mfma_f32_16x16x32_bf16 v[152:155], v[92:95], v[60:63], v[152:155]
    v_mfma_f32_16x16x32_bf16 v[148:151], v[92:95], v[56:59], v[148:151]
    ds_read_b64_tr_b16 v[44:45], v113 offset:8192
    v_mfma_f32_16x16x32_bf16 v[180:183], v[96:99], v[56:59], v[180:183]
    ds_read_b64_tr_b16 v[46:47], v113 offset:10240
    v_mfma_f32_16x16x32_bf16 v[184:187], v[96:99], v[60:63], v[184:187]
    v_mfma_f32_16x16x32_bf16 v[188:191], v[96:99], v[64:67], v[188:191]
    ds_read_b64_tr_b16 v[48:49], v114 offset:8192
    v_mfma_f32_16x16x32_bf16 v[192:195], v[96:99], v[68:71], v[192:195]
    ds_read_b64_tr_b16 v[50:51], v114 offset:10240
    v_mfma_f32_16x16x32_bf16 v[196:199], v[96:99], v[72:75], v[196:199]
    v_mfma_f32_16x16x32_bf16 v[200:203], v[96:99], v[76:79], v[200:203]
    ds_read_b64_tr_b16 v[52:53], v115 offset:8192
    v_mfma_f32_16x16x32_bf16 v[204:207], v[96:99], v[80:83], v[204:207]
    ds_read_b64_tr_b16 v[54:55], v115 offset:10240
    v_mfma_f32_16x16x32_bf16 v[208:211], v[96:99], v[84:87], v[208:211]
    v_mfma_f32_16x16x32_bf16 v[240:243], v[100:103], v[84:87], v[240:243]
    v_mfma_f32_16x16x32_bf16 v[236:239], v[100:103], v[80:83], v[236:239]
    v_mfma_f32_16x16x32_bf16 v[232:235], v[100:103], v[76:79], v[232:235]
    v_mfma_f32_16x16x32_bf16 v[228:231], v[100:103], v[72:75], v[228:231]
    v_mfma_f32_16x16x32_bf16 v[224:227], v[100:103], v[68:71], v[224:227]
    v_mfma_f32_16x16x32_bf16 v[220:223], v[100:103], v[64:67], v[220:223]
    v_mfma_f32_16x16x32_bf16 v[216:219], v[100:103], v[60:63], v[216:219]
    v_mfma_f32_16x16x32_bf16 v[212:215], v[100:103], v[56:59], v[212:215]
    s_waitcnt lgkmcnt(0)
    v_mfma_f32_16x16x32_bf16 v[116:119], v[40:43], v[8:11], v[116:119]
    ds_read_b64_tr_b16 v[88:89], v112 offset:12288
    v_mfma_f32_16x16x32_bf16 v[120:123], v[40:43], v[12:15], v[120:123]
    ds_read_b64_tr_b16 v[90:91], v112 offset:14336
    v_mfma_f32_16x16x32_bf16 v[124:127], v[40:43], v[16:19], v[124:127]
    v_mfma_f32_16x16x32_bf16 v[128:131], v[40:43], v[20:23], v[128:131]
    ds_read_b128 v[56:59], v104 offset:40960
    v_mfma_f32_16x16x32_bf16 v[132:135], v[40:43], v[24:27], v[132:135]
    ds_read_b128 v[60:63], v104 offset:41984
    v_mfma_f32_16x16x32_bf16 v[136:139], v[40:43], v[28:31], v[136:139]
    v_mfma_f32_16x16x32_bf16 v[140:143], v[40:43], v[32:35], v[140:143]
    ds_read_b128 v[64:67], v105 offset:40960
    v_mfma_f32_16x16x32_bf16 v[144:147], v[40:43], v[36:39], v[144:147]
    ds_read_b128 v[68:71], v105 offset:41984
    v_mfma_f32_16x16x32_bf16 v[176:179], v[44:47], v[36:39], v[176:179]
    v_mfma_f32_16x16x32_bf16 v[172:175], v[44:47], v[32:35], v[172:175]
    ds_read_b128 v[72:75], v106 offset:40960
    v_mfma_f32_16x16x32_bf16 v[168:171], v[44:47], v[28:31], v[168:171]
    ds_read_b128 v[76:79], v106 offset:41984
    v_mfma_f32_16x16x32_bf16 v[164:167], v[44:47], v[24:27], v[164:167]
    v_mfma_f32_16x16x32_bf16 v[160:163], v[44:47], v[20:23], v[160:163]
    ds_read_b128 v[80:83], v107 offset:40960
    v_mfma_f32_16x16x32_bf16 v[156:159], v[44:47], v[16:19], v[156:159]
    ds_read_b128 v[84:87], v107 offset:41984
    v_mfma_f32_16x16x32_bf16 v[152:155], v[44:47], v[12:15], v[152:155]
    v_mfma_f32_16x16x32_bf16 v[148:151], v[44:47], v[8:11], v[148:151]
    ds_read_b64_tr_b16 v[92:93], v113 offset:12288
    v_mfma_f32_16x16x32_bf16 v[180:183], v[48:51], v[8:11], v[180:183]
    ds_read_b64_tr_b16 v[94:95], v113 offset:14336
    v_mfma_f32_16x16x32_bf16 v[184:187], v[48:51], v[12:15], v[184:187]
    v_mfma_f32_16x16x32_bf16 v[188:191], v[48:51], v[16:19], v[188:191]
    ds_read_b64_tr_b16 v[96:97], v114 offset:12288
    v_mfma_f32_16x16x32_bf16 v[192:195], v[48:51], v[20:23], v[192:195]
    ds_read_b64_tr_b16 v[98:99], v114 offset:14336
    v_mfma_f32_16x16x32_bf16 v[196:199], v[48:51], v[24:27], v[196:199]
    v_mfma_f32_16x16x32_bf16 v[200:203], v[48:51], v[28:31], v[200:203]
    ds_read_b64_tr_b16 v[100:101], v115 offset:12288
    v_mfma_f32_16x16x32_bf16 v[204:207], v[48:51], v[32:35], v[204:207]
    ds_read_b64_tr_b16 v[102:103], v115 offset:14336
    v_mfma_f32_16x16x32_bf16 v[208:211], v[48:51], v[36:39], v[208:211]
    v_mfma_f32_16x16x32_bf16 v[240:243], v[52:55], v[36:39], v[240:243]
    v_mfma_f32_16x16x32_bf16 v[236:239], v[52:55], v[32:35], v[236:239]
    v_mfma_f32_16x16x32_bf16 v[232:235], v[52:55], v[28:31], v[232:235]
    v_mfma_f32_16x16x32_bf16 v[228:231], v[52:55], v[24:27], v[228:231]
    v_mfma_f32_16x16x32_bf16 v[224:227], v[52:55], v[20:23], v[224:227]
    v_mfma_f32_16x16x32_bf16 v[220:223], v[52:55], v[16:19], v[220:223]
    v_mfma_f32_16x16x32_bf16 v[216:219], v[52:55], v[12:15], v[216:219]
    v_mfma_f32_16x16x32_bf16 v[212:215], v[52:55], v[8:11], v[212:215]
    s_waitcnt lgkmcnt(0)
    s_barrier
    v_mfma_f32_16x16x32_bf16 v[116:119], v[88:91], v[56:59], v[116:119]
    ds_read_b64_tr_b16 v[40:41], v112 offset:16384
    v_mfma_f32_16x16x32_bf16 v[120:123], v[88:91], v[60:63], v[120:123]
    ds_read_b64_tr_b16 v[42:43], v112 offset:18432
    v_mfma_f32_16x16x32_bf16 v[124:127], v[88:91], v[64:67], v[124:127]
    v_mfma_f32_16x16x32_bf16 v[128:131], v[88:91], v[68:71], v[128:131]
    ds_read_b128 v[8:11], v108 offset:0
    v_mfma_f32_16x16x32_bf16 v[132:135], v[88:91], v[72:75], v[132:135]
    ds_read_b128 v[12:15], v108 offset:1024
    v_mfma_f32_16x16x32_bf16 v[136:139], v[88:91], v[76:79], v[136:139]
    v_mfma_f32_16x16x32_bf16 v[140:143], v[88:91], v[80:83], v[140:143]
    ds_read_b128 v[16:19], v109 offset:0
    v_mfma_f32_16x16x32_bf16 v[144:147], v[88:91], v[84:87], v[144:147]
    ds_read_b128 v[20:23], v109 offset:1024
    v_mfma_f32_16x16x32_bf16 v[176:179], v[92:95], v[84:87], v[176:179]
    v_mfma_f32_16x16x32_bf16 v[172:175], v[92:95], v[80:83], v[172:175]
    ds_read_b128 v[24:27], v110 offset:0
    v_mfma_f32_16x16x32_bf16 v[168:171], v[92:95], v[76:79], v[168:171]
    ds_read_b128 v[28:31], v110 offset:1024
    v_mfma_f32_16x16x32_bf16 v[164:167], v[92:95], v[72:75], v[164:167]
    v_mfma_f32_16x16x32_bf16 v[160:163], v[92:95], v[68:71], v[160:163]
    ds_read_b128 v[32:35], v111 offset:0
    v_mfma_f32_16x16x32_bf16 v[156:159], v[92:95], v[64:67], v[156:159]
    ds_read_b128 v[36:39], v111 offset:1024
    v_mfma_f32_16x16x32_bf16 v[152:155], v[92:95], v[60:63], v[152:155]
    v_mfma_f32_16x16x32_bf16 v[148:151], v[92:95], v[56:59], v[148:151]
    ds_read_b64_tr_b16 v[44:45], v113 offset:16384
    v_mfma_f32_16x16x32_bf16 v[180:183], v[96:99], v[56:59], v[180:183]
    ds_read_b64_tr_b16 v[46:47], v113 offset:18432
    v_mfma_f32_16x16x32_bf16 v[184:187], v[96:99], v[60:63], v[184:187]
    v_mfma_f32_16x16x32_bf16 v[188:191], v[96:99], v[64:67], v[188:191]
    ds_read_b64_tr_b16 v[48:49], v114 offset:16384
    v_mfma_f32_16x16x32_bf16 v[192:195], v[96:99], v[68:71], v[192:195]
    ds_read_b64_tr_b16 v[50:51], v114 offset:18432
    v_mfma_f32_16x16x32_bf16 v[196:199], v[96:99], v[72:75], v[196:199]
    v_mfma_f32_16x16x32_bf16 v[200:203], v[96:99], v[76:79], v[200:203]
    ds_read_b64_tr_b16 v[52:53], v115 offset:16384
    v_mfma_f32_16x16x32_bf16 v[204:207], v[96:99], v[80:83], v[204:207]
    ds_read_b64_tr_b16 v[54:55], v115 offset:18432
    v_mfma_f32_16x16x32_bf16 v[208:211], v[96:99], v[84:87], v[208:211]
    v_mfma_f32_16x16x32_bf16 v[240:243], v[100:103], v[84:87], v[240:243]
    v_mfma_f32_16x16x32_bf16 v[236:239], v[100:103], v[80:83], v[236:239]
    v_mfma_f32_16x16x32_bf16 v[232:235], v[100:103], v[76:79], v[232:235]
    v_mfma_f32_16x16x32_bf16 v[228:231], v[100:103], v[72:75], v[228:231]
    v_mfma_f32_16x16x32_bf16 v[224:227], v[100:103], v[68:71], v[224:227]
    v_mfma_f32_16x16x32_bf16 v[220:223], v[100:103], v[64:67], v[220:223]
    v_mfma_f32_16x16x32_bf16 v[216:219], v[100:103], v[60:63], v[216:219]
    v_mfma_f32_16x16x32_bf16 v[212:215], v[100:103], v[56:59], v[212:215]
    s_sub_u32 s72, s72, 1
    s_cmp_lg_u32 s72, 0
    s_cbranch_scc1 w2_cloop
    s_waitcnt lgkmcnt(0)
    v_mfma_f32_16x16x32_bf16 v[116:119], v[40:43], v[8:11], v[116:119]
    ds_read_b64_tr_b16 v[88:89], v112 offset:20480
    s_mov_b32 s16, s60
    s_and_b32 s17, s61, 0xffff
    v_mfma_f32_16x16x32_bf16 v[120:123], v[40:43], v[12:15], v[120:123]
    ds_read_b64_tr_b16 v[90:91], v112 offset:22528
    s_mov_b32 s18, 4194304
    s_mov_b32 s19, 0x20000
    v_mfma_f32_16x16x32_bf16 v[124:127], v[40:43], v[16:19], v[124:127]
    s_lshl_b32 s33, s24, 3
    s_add_u32 s33, s33, s25
    v_mfma_f32_16x16x32_bf16 v[128:131], v[40:43], v[20:23], v[128:131]
    ds_read_b128 v[56:59], v108 offset:8192
    s_mul_i32 s34, s33, 262144
    s_add_u32 s34, s34, 54525952
    v_mfma_f32_16x16x32_bf16 v[132:135], v[40:43], v[24:27], v[132:135]
    ds_read_b128 v[60:63], v108 offset:9216
    s_mul_i32 s30, s21, 4096
    s_add_u32 s34, s34, s30
    v_mfma_f32_16x16x32_bf16 v[136:139], v[40:43], v[28:31], v[136:139]
    s_lshl_b32 s35, s24, 3
    s_lshl_b32 s30, s28, 3
    v_mfma_f32_16x16x32_bf16 v[140:143], v[40:43], v[32:35], v[140:143]
    ds_read_b128 v[64:67], v109 offset:8192
    s_add_u32 s35, s35, s30
    s_lshl_b32 s30, s71, 1
    v_mfma_f32_16x16x32_bf16 v[144:147], v[40:43], v[36:39], v[144:147]
    ds_read_b128 v[68:71], v109 offset:9216
    s_add_u32 s35, s35, s30
    s_lshl_b32 s36, s25, 2
    v_mfma_f32_16x16x32_bf16 v[176:179], v[44:47], v[36:39], v[176:179]
    s_lshl_b32 s30, s29, 1
    s_add_u32 s36, s36, s30
    v_mfma_f32_16x16x32_bf16 v[172:175], v[44:47], v[32:35], v[172:175]
    ds_read_b128 v[72:75], v110 offset:8192
    s_lshl_b32 s38, s35, 15
    s_lshl_b32 s31, s36, 10
    v_mfma_f32_16x16x32_bf16 v[168:171], v[44:47], v[28:31], v[168:171]
    ds_read_b128 v[76:79], v110 offset:9216
    s_add_u32 s38, s38, s31
    s_add_u32 s38, s38, 20971520
    v_mfma_f32_16x16x32_bf16 v[164:167], v[44:47], v[24:27], v[164:167]
    s_lshl_b32 s37, s33, 9
    s_lshl_b32 s31, s21, 7
    v_mfma_f32_16x16x32_bf16 v[160:163], v[44:47], v[20:23], v[160:163]
    ds_read_b128 v[80:83], v111 offset:8192
    s_add_u32 s37, s37, s31
    s_add_u32 s37, s37, 44040192
    v_mfma_f32_16x16x32_bf16 v[156:159], v[44:47], v[16:19], v[156:159]
    ds_read_b128 v[84:87], v111 offset:9216
    s_lshl_b32 s31, s71, 4
    s_add_u32 s32, s37, s31
    v_mfma_f32_16x16x32_bf16 v[152:155], v[44:47], v[12:15], v[152:155]
    s_lshl_b32 s39, s71, 2
    s_add_u32 s31, s71, 1
    v_mfma_f32_16x16x32_bf16 v[148:151], v[44:47], v[8:11], v[148:151]
    ds_read_b64_tr_b16 v[92:93], v113 offset:20480
    s_and_b32 s31, s31, 3
    s_lshl_b32 s30, s31, 2
    v_mfma_f32_16x16x32_bf16 v[180:183], v[48:51], v[8:11], v[180:183]
    ds_read_b64_tr_b16 v[94:95], v113 offset:22528
    s_add_u32 s30, s30, s71
    s_mul_i32 s30, s30, 16384
    v_mfma_f32_16x16x32_bf16 v[184:187], v[48:51], v[12:15], v[184:187]
    s_add_u32 s40, s30, s34
    s_add_u32 s31, s31, s39
    v_mfma_f32_16x16x32_bf16 v[188:191], v[48:51], v[16:19], v[188:191]
    ds_read_b64_tr_b16 v[96:97], v114 offset:20480
    s_mul_i32 s31, s31, 16384
    s_add_u32 s43, s31, s34
    v_mfma_f32_16x16x32_bf16 v[192:195], v[48:51], v[20:23], v[192:195]
    ds_read_b64_tr_b16 v[98:99], v114 offset:22528
    s_add_u32 s31, s71, 2
    s_and_b32 s31, s31, 3
    v_mfma_f32_16x16x32_bf16 v[196:199], v[48:51], v[24:27], v[196:199]
    s_lshl_b32 s30, s31, 2
    s_add_u32 s30, s30, s71
    v_mfma_f32_16x16x32_bf16 v[200:203], v[48:51], v[28:31], v[200:203]
    ds_read_b64_tr_b16 v[100:101], v115 offset:20480
    s_mul_i32 s30, s30, 16384
    s_add_u32 s41, s30, s34
    v_mfma_f32_16x16x32_bf16 v[204:207], v[48:51], v[32:35], v[204:207]
    ds_read_b64_tr_b16 v[102:103], v115 offset:22528
    s_add_u32 s31, s31, s39
    s_mul_i32 s31, s31, 16384
    v_mfma_f32_16x16x32_bf16 v[208:211], v[48:51], v[36:39], v[208:211]
    s_add_u32 s44, s31, s34
    s_add_u32 s31, s71, 3
    v_mfma_f32_16x16x32_bf16 v[240:243], v[52:55], v[36:39], v[240:243]
    s_and_b32 s31, s31, 3
    s_lshl_b32 s30, s31, 2
    v_mfma_f32_16x16x32_bf16 v[236:239], v[52:55], v[32:35], v[236:239]
    s_add_u32 s30, s30, s71
    s_mul_i32 s30, s30, 16384
    v_mfma_f32_16x16x32_bf16 v[232:235], v[52:55], v[28:31], v[232:235]
    s_add_u32 s42, s30, s34
    s_add_u32 s31, s31, s39
    v_mfma_f32_16x16x32_bf16 v[228:231], v[52:55], v[24:27], v[228:231]
    s_mul_i32 s31, s31, 16384
    s_add_u32 s45, s31, s34
    v_mfma_f32_16x16x32_bf16 v[224:227], v[52:55], v[20:23], v[224:227]
    s_lshl_b32 s46, s35, 15
    s_lshl_b32 s31, s36, 6
    v_mfma_f32_16x16x32_bf16 v[220:223], v[52:55], v[16:19], v[220:223]
    s_add_u32 s46, s46, s31
    s_add_u32 s47, s38, 32768
    v_mfma_f32_16x16x32_bf16 v[216:219], v[52:55], v[12:15], v[216:219]
    v_mfma_f32_16x16x32_bf16 v[212:215], v[52:55], v[8:11], v[212:215]
    s_waitcnt lgkmcnt(0)
    s_barrier
    v_mfma_f32_16x16x32_bf16 v[116:119], v[88:91], v[56:59], v[116:119]
    v_lshlrev_b32 v2, 4, v1
    v_mfma_f32_16x16x32_bf16 v[120:123], v[88:91], v[60:63], v[120:123]
    ds_read_b128 v[40:43], v105 offset:0
    v_mfma_f32_16x16x32_bf16 v[124:127], v[88:91], v[64:67], v[124:127]
    ds_read_b128 v[44:47], v105 offset:8192
    v_mfma_f32_16x16x32_bf16 v[128:131], v[88:91], v[68:71], v[128:131]
    ds_read_b128 v[48:51], v105 offset:32768
    v_mfma_f32_16x16x32_bf16 v[132:135], v[88:91], v[72:75], v[132:135]
    ds_read_b128 v[52:55], v105 offset:40960
    v_mfma_f32_16x16x32_bf16 v[136:139], v[88:91], v[76:79], v[136:139]
    ds_read_b64_tr_b16 v[8:9], v112 offset:0
    v_mfma_f32_16x16x32_bf16 v[140:143], v[88:91], v[80:83], v[140:143]
    ds_read_b64_tr_b16 v[10:11], v112 offset:2048
    v_mfma_f32_16x16x32_bf16 v[144:147], v[88:91], v[84:87], v[144:147]
    v_mfma_f32_16x16x32_bf16 v[176:179], v[92:95], v[84:87], v[176:179]
    ds_read_b64_tr_b16 v[12:13], v113 offset:0
    v_mfma_f32_16x16x32_bf16 v[172:175], v[92:95], v[80:83], v[172:175]
    ds_read_b64_tr_b16 v[14:15], v113 offset:2048
    v_mfma_f32_16x16x32_bf16 v[168:171], v[92:95], v[76:79], v[168:171]
    ds_read_b64_tr_b16 v[16:17], v114 offset:0
    v_mfma_f32_16x16x32_bf16 v[164:167], v[92:95], v[72:75], v[164:167]
    ds_read_b64_tr_b16 v[18:19], v114 offset:2048
    v_mfma_f32_16x16x32_bf16 v[160:163], v[92:95], v[68:71], v[160:163]
    ds_read_b64_tr_b16 v[20:21], v115 offset:0
    v_mfma_f32_16x16x32_bf16 v[156:159], v[92:95], v[64:67], v[156:159]
    ds_read_b64_tr_b16 v[22:23], v115 offset:2048
    v_mfma_f32_16x16x32_bf16 v[152:155], v[92:95], v[60:63], v[152:155]
    ds_read_b64_tr_b16 v[24:25], v112 offset:4096
    v_mfma_f32_16x16x32_bf16 v[148:151], v[92:95], v[56:59], v[148:151]
    v_mfma_f32_16x16x32_bf16 v[180:183], v[96:99], v[56:59], v[180:183]
    ds_read_b64_tr_b16 v[26:27], v112 offset:6144
    v_mfma_f32_16x16x32_bf16 v[184:187], v[96:99], v[60:63], v[184:187]
    ds_read_b64_tr_b16 v[28:29], v113 offset:4096
    v_mfma_f32_16x16x32_bf16 v[188:191], v[96:99], v[64:67], v[188:191]
    ds_read_b64_tr_b16 v[30:31], v113 offset:6144
    v_mfma_f32_16x16x32_bf16 v[192:195], v[96:99], v[68:71], v[192:195]
    ds_read_b64_tr_b16 v[32:33], v114 offset:4096
    v_mfma_f32_16x16x32_bf16 v[196:199], v[96:99], v[72:75], v[196:199]
    ds_read_b64_tr_b16 v[34:35], v114 offset:6144
    v_mfma_f32_16x16x32_bf16 v[200:203], v[96:99], v[76:79], v[200:203]
    ds_read_b64_tr_b16 v[36:37], v115 offset:4096
    v_mfma_f32_16x16x32_bf16 v[204:207], v[96:99], v[80:83], v[204:207]
    ds_read_b64_tr_b16 v[38:39], v115 offset:6144
    v_mfma_f32_16x16x32_bf16 v[208:211], v[96:99], v[84:87], v[208:211]
    v_mfma_f32_16x16x32_bf16 v[240:243], v[100:103], v[84:87], v[240:243]
    v_mfma_f32_16x16x32_bf16 v[236:239], v[100:103], v[80:83], v[236:239]
    v_mfma_f32_16x16x32_bf16 v[232:235], v[100:103], v[76:79], v[232:235]
    v_mfma_f32_16x16x32_bf16 v[228:231], v[100:103], v[72:75], v[228:231]
    v_mfma_f32_16x16x32_bf16 v[224:227], v[100:103], v[68:71], v[224:227]
    v_mfma_f32_16x16x32_bf16 v[220:223], v[100:103], v[64:67], v[220:223]
    v_mfma_f32_16x16x32_bf16 v[216:219], v[100:103], v[60:63], v[216:219]
    v_mfma_f32_16x16x32_bf16 v[212:215], v[100:103], v[56:59], v[212:215]
    s_waitcnt lgkmcnt(0)
    v_mfma_f32_16x16x32_bf16 v[124:127], v[8:11], v[40:43], v[124:127]
    ds_read_b64_tr_b16 v[56:57], v112 offset:8192
    ds_read_b64_tr_b16 v[58:59], v112 offset:10240
    v_mfma_f32_16x16x32_bf16 v[124:127], v[24:27], v[44:47], v[124:127]
    ds_read_b64_tr_b16 v[60:61], v113 offset:8192
    ds_read_b64_tr_b16 v[62:63], v113 offset:10240
    v_mfma_f32_16x16x32_bf16 v[156:159], v[12:15], v[40:43], v[156:159]
    ds_read_b64_tr_b16 v[64:65], v114 offset:8192
    ds_read_b64_tr_b16 v[66:67], v114 offset:10240
    v_mfma_f32_16x16x32_bf16 v[156:159], v[28:31], v[44:47], v[156:159]
    ds_read_b64_tr_b16 v[68:69], v115 offset:8192
    ds_read_b64_tr_b16 v[70:71], v115 offset:10240
    v_mfma_f32_16x16x32_bf16 v[188:191], v[16:19], v[40:43], v[188:191]
    ds_read_b64_tr_b16 v[72:73], v112 offset:12288
    ds_read_b64_tr_b16 v[74:75], v112 offset:14336
    v_mfma_f32_16x16x32_bf16 v[188:191], v[32:35], v[44:47], v[188:191]
    ds_read_b64_tr_b16 v[76:77], v113 offset:12288
    ds_read_b64_tr_b16 v[78:79], v113 offset:14336
    v_mfma_f32_16x16x32_bf16 v[220:223], v[20:23], v[40:43], v[220:223]
    ds_read_b64_tr_b16 v[80:81], v114 offset:12288
    ds_read_b64_tr_b16 v[82:83], v114 offset:14336
    v_mfma_f32_16x16x32_bf16 v[220:223], v[36:39], v[44:47], v[220:223]
    ds_read_b64_tr_b16 v[84:85], v115 offset:12288
    ds_read_b64_tr_b16 v[86:87], v115 offset:14336
    s_waitcnt lgkmcnt(8)
    v_mfma_f32_16x16x32_bf16 v[124:127], v[56:59], v[48:51], v[124:127]
    ds_read_b128 v[88:91], v105 offset:1024
    v_mfma_f32_16x16x32_bf16 v[156:159], v[60:63], v[48:51], v[156:159]
    ds_read_b128 v[92:95], v105 offset:9216
    v_mfma_f32_16x16x32_bf16 v[188:191], v[64:67], v[48:51], v[188:191]
    ds_read_b128 v[96:99], v105 offset:33792
    v_mfma_f32_16x16x32_bf16 v[220:223], v[68:71], v[48:51], v[220:223]
    ds_read_b128 v[100:103], v105 offset:41984
    s_waitcnt lgkmcnt(4)
    v_mfma_f32_16x16x32_bf16 v[124:127], v[72:75], v[52:55], v[124:127]
    v_mfma_f32_16x16x32_bf16 v[156:159], v[76:79], v[52:55], v[156:159]
    v_mfma_f32_16x16x32_bf16 v[188:191], v[80:83], v[52:55], v[188:191]
    v_mfma_f32_16x16x32_bf16 v[220:223], v[84:87], v[52:55], v[220:223]
    s_waitcnt lgkmcnt(0)
    v_mfma_f32_16x16x32_bf16 v[128:131], v[8:11], v[88:91], v[128:131]
    ds_read_b128 v[40:43], v106 offset:0
    v_mfma_f32_16x16x32_bf16 v[128:131], v[24:27], v[92:95], v[128:131]
    ds_read_b128 v[44:47], v106 offset:8192
    v_mfma_f32_16x16x32_bf16 v[128:131], v[56:59], v[96:99], v[128:131]
    ds_read_b128 v[48:51], v106 offset:32768
    v_mfma_f32_16x16x32_bf16 v[128:131], v[72:75], v[100:103], v[128:131]
    ds_read_b128 v[52:55], v106 offset:40960
    v_mfma_f32_16x16x32_bf16 v[160:163], v[12:15], v[88:91], v[160:163]
    v_cvt_pk_bf16_f32 v124, v124, v125
    v_mfma_f32_16x16x32_bf16 v[160:163], v[28:31], v[92:95], v[160:163]
    v_cvt_pk_bf16_f32 v125, v126, v127
    v_mfma_f32_16x16x32_bf16 v[160:163], v[60:63], v[96:99], v[160:163]
    v_cvt_pk_bf16_f32 v126, v156, v157
    v_mfma_f32_16x16x32_bf16 v[160:163], v[76:79], v[100:103], v[160:163]
    v_cvt_pk_bf16_f32 v127, v158, v159
    v_mfma_f32_16x16x32_bf16 v[192:195], v[16:19], v[88:91], v[192:195]
    buffer_store_dwordx4 v[124:127], v2, s[8:11], s40 offen offset:0 sc1
    v_mfma_f32_16x16x32_bf16 v[192:195], v[32:35], v[92:95], v[192:195]
    v_cvt_pk_bf16_f32 v188, v188, v189
    v_mfma_f32_16x16x32_bf16 v[192:195], v[64:67], v[96:99], v[192:195]
    v_cvt_pk_bf16_f32 v189, v190, v191
    v_mfma_f32_16x16x32_bf16 v[192:195], v[80:83], v[100:103], v[192:195]
    v_cvt_pk_bf16_f32 v190, v220, v221
    v_mfma_f32_16x16x32_bf16 v[224:227], v[20:23], v[88:91], v[224:227]
    v_cvt_pk_bf16_f32 v191, v222, v223
    v_mfma_f32_16x16x32_bf16 v[224:227], v[36:39], v[92:95], v[224:227]
    buffer_store_dwordx4 v[188:191], v2, s[8:11], s40 offen offset:1024 sc1
    v_mfma_f32_16x16x32_bf16 v[224:227], v[68:71], v[96:99], v[224:227]
    v_mfma_f32_16x16x32_bf16 v[224:227], v[84:87], v[100:103], v[224:227]
    s_waitcnt lgkmcnt(0)
    v_mfma_f32_16x16x32_bf16 v[132:135], v[8:11], v[40:43], v[132:135]
    ds_read_b128 v[88:91], v106 offset:1024
    v_mfma_f32_16x16x32_bf16 v[132:135], v[24:27], v[44:47], v[132:135]
    ds_read_b128 v[92:95], v106 offset:9216
    v_mfma_f32_16x16x32_bf16 v[132:135], v[56:59], v[48:51], v[132:135]
    ds_read_b128 v[96:99], v106 offset:33792
    v_mfma_f32_16x16x32_bf16 v[132:135], v[72:75], v[52:55], v[132:135]
    ds_read_b128 v[100:103], v106 offset:41984
    v_mfma_f32_16x16x32_bf16 v[164:167], v[12:15], v[40:43], v[164:167]
    v_cvt_pk_bf16_f32 v128, v128, v129
    v_mfma_f32_16x16x32_bf16 v[164:167], v[28:31], v[44:47], v[164:167]
    v_cvt_pk_bf16_f32 v129, v130, v131
    v_mfma_f32_16x16x32_bf16 v[164:167], v[60:63], v[48:51], v[164:167]
    v_cvt_pk_bf16_f32 v130, v160, v161
    v_mfma_f32_16x16x32_bf16 v[164:167], v[76:79], v[52:55], v[164:167]
    v_cvt_pk_bf16_f32 v131, v162, v163
    v_mfma_f32_16x16x32_bf16 v[196:199], v[16:19], v[40:43], v[196:199]
    buffer_store_dwordx4 v[128:131], v2, s[8:11], s40 offen offset:2048 sc1
    v_mfma_f32_16x16x32_bf16 v[196:199], v[32:35], v[44:47], v[196:199]
    v_cvt_pk_bf16_f32 v192, v192, v193
    v_mfma_f32_16x16x32_bf16 v[196:199], v[64:67], v[48:51], v[196:199]
    v_cvt_pk_bf16_f32 v193, v194, v195
    v_mfma_f32_16x16x32_bf16 v[196:199], v[80:83], v[52:55], v[196:199]
    v_cvt_pk_bf16_f32 v194, v224, v225
    v_mfma_f32_16x16x32_bf16 v[228:231], v[20:23], v[40:43], v[228:231]
    v_cvt_pk_bf16_f32 v195, v226, v227
    v_mfma_f32_16x16x32_bf16 v[228:231], v[36:39], v[44:47], v[228:231]
    buffer_store_dwordx4 v[192:195], v2, s[8:11], s40 offen offset:3072 sc1
    v_mfma_f32_16x16x32_bf16 v[228:231], v[68:71], v[48:51], v[228:231]
    v_mfma_f32_16x16x32_bf16 v[228:231], v[84:87], v[52:55], v[228:231]
    s_waitcnt lgkmcnt(0)
    v_mfma_f32_16x16x32_bf16 v[136:139], v[8:11], v[88:91], v[136:139]
    ds_read_b128 v[40:43], v107 offset:0
    v_mfma_f32_16x16x32_bf16 v[136:139], v[24:27], v[92:95], v[136:139]
    ds_read_b128 v[44:47], v107 offset:8192
    v_mfma_f32_16x16x32_bf16 v[136:139], v[56:59], v[96:99], v[136:139]
    ds_read_b128 v[48:51], v107 offset:32768
    v_mfma_f32_16x16x32_bf16 v[136:139], v[72:75], v[100:103], v[136:139]
    ds_read_b128 v[52:55], v107 offset:40960
    v_mfma_f32_16x16x32_bf16 v[168:171], v[12:15], v[88:91], v[168:171]
    v_cvt_pk_bf16_f32 v132, v132, v133
    v_mfma_f32_16x16x32_bf16 v[168:171], v[28:31], v[92:95], v[168:171]
    v_cvt_pk_bf16_f32 v133, v134, v135
    v_mfma_f32_16x16x32_bf16 v[168:171], v[60:63], v[96:99], v[168:171]
    v_cvt_pk_bf16_f32 v134, v164, v165
    v_mfma_f32_16x16x32_bf16 v[168:171], v[76:79], v[100:103], v[168:171]
    v_cvt_pk_bf16_f32 v135, v166, v167
    v_mfma_f32_16x16x32_bf16 v[200:203], v[16:19], v[88:91], v[200:203]
    buffer_store_dwordx4 v[132:135], v2, s[8:11], s41 offen offset:0 sc1
    v_mfma_f32_16x16x32_bf16 v[200:203], v[32:35], v[92:95], v[200:203]
    v_cvt_pk_bf16_f32 v196, v196, v197
    v_mfma_f32_16x16x32_bf16 v[200:203], v[64:67], v[96:99], v[200:203]
    v_cvt_pk_bf16_f32 v197, v198, v199
    v_mfma_f32_16x16x32_bf16 v[200:203], v[80:83], v[100:103], v[200:203]
    v_cvt_pk_bf16_f32 v198, v228, v229
    v_mfma_f32_16x16x32_bf16 v[232:235], v[20:23], v[88:91], v[232:235]
    v_cvt_pk_bf16_f32 v199, v230, v231
    v_mfma_f32_16x16x32_bf16 v[232:235], v[36:39], v[92:95], v[232:235]
    buffer_store_dwordx4 v[196:199], v2, s[8:11], s41 offen offset:1024 sc1
    v_mfma_f32_16x16x32_bf16 v[232:235], v[68:71], v[96:99], v[232:235]
    buffer_load_dwordx4 v[156:159], v2, s[8:11], s38 offen offset:0 sc1
    v_mfma_f32_16x16x32_bf16 v[232:235], v[84:87], v[100:103], v[232:235]
    buffer_load_dwordx4 v[220:223], v2, s[8:11], s38 offen offset:1024 sc1
    buffer_load_dwordx4 v[160:163], v2, s[8:11], s47 offen offset:0 sc1
    buffer_load_dwordx4 v[224:227], v2, s[8:11], s47 offen offset:1024 sc1
    s_waitcnt lgkmcnt(0)
    v_mfma_f32_16x16x32_bf16 v[140:143], v[8:11], v[40:43], v[140:143]
    ds_read_b128 v[88:91], v107 offset:1024
    v_mfma_f32_16x16x32_bf16 v[140:143], v[24:27], v[44:47], v[140:143]
    ds_read_b128 v[92:95], v107 offset:9216
    v_mfma_f32_16x16x32_bf16 v[140:143], v[56:59], v[48:51], v[140:143]
    ds_read_b128 v[96:99], v107 offset:33792
    v_mfma_f32_16x16x32_bf16 v[140:143], v[72:75], v[52:55], v[140:143]
    ds_read_b128 v[100:103], v107 offset:41984
    v_mfma_f32_16x16x32_bf16 v[172:175], v[12:15], v[40:43], v[172:175]
    v_cvt_pk_bf16_f32 v136, v136, v137
    v_mfma_f32_16x16x32_bf16 v[172:175], v[28:31], v[44:47], v[172:175]
    v_cvt_pk_bf16_f32 v137, v138, v139
    v_mfma_f32_16x16x32_bf16 v[172:175], v[60:63], v[48:51], v[172:175]
    v_cvt_pk_bf16_f32 v138, v168, v169
    v_mfma_f32_16x16x32_bf16 v[172:175], v[76:79], v[52:55], v[172:175]
    v_cvt_pk_bf16_f32 v139, v170, v171
    v_mfma_f32_16x16x32_bf16 v[204:207], v[16:19], v[40:43], v[204:207]
    buffer_store_dwordx4 v[136:139], v2, s[8:11], s41 offen offset:2048 sc1
    v_mfma_f32_16x16x32_bf16 v[204:207], v[32:35], v[44:47], v[204:207]
    v_cvt_pk_bf16_f32 v200, v200, v201
    v_mfma_f32_16x16x32_bf16 v[204:207], v[64:67], v[48:51], v[204:207]
    v_cvt_pk_bf16_f32 v201, v202, v203
    v_mfma_f32_16x16x32_bf16 v[204:207], v[80:83], v[52:55], v[204:207]
    v_cvt_pk_bf16_f32 v202, v232, v233
    v_mfma_f32_16x16x32_bf16 v[236:239], v[20:23], v[40:43], v[236:239]
    v_cvt_pk_bf16_f32 v203, v234, v235
    v_mfma_f32_16x16x32_bf16 v[236:239], v[36:39], v[44:47], v[236:239]
    buffer_store_dwordx4 v[200:203], v2, s[8:11], s41 offen offset:3072 sc1
    v_mfma_f32_16x16x32_bf16 v[236:239], v[68:71], v[48:51], v[236:239]
    v_mfma_f32_16x16x32_bf16 v[236:239], v[84:87], v[52:55], v[236:239]
    s_waitcnt lgkmcnt(0)
    v_mfma_f32_16x16x32_bf16 v[144:147], v[8:11], v[88:91], v[144:147]
    ds_read_b128 v[40:43], v104 offset:0
    v_mfma_f32_16x16x32_bf16 v[144:147], v[24:27], v[92:95], v[144:147]
    ds_read_b128 v[44:47], v104 offset:8192
    v_mfma_f32_16x16x32_bf16 v[144:147], v[56:59], v[96:99], v[144:147]
    ds_read_b128 v[48:51], v104 offset:32768
    v_mfma_f32_16x16x32_bf16 v[144:147], v[72:75], v[100:103], v[144:147]
    ds_read_b128 v[52:55], v104 offset:40960
    v_mfma_f32_16x16x32_bf16 v[176:179], v[12:15], v[88:91], v[176:179]
    v_cvt_pk_bf16_f32 v140, v140, v141
    v_mfma_f32_16x16x32_bf16 v[176:179], v[28:31], v[92:95], v[176:179]
    v_cvt_pk_bf16_f32 v141, v142, v143
    v_mfma_f32_16x16x32_bf16 v[176:179], v[60:63], v[96:99], v[176:179]
    v_cvt_pk_bf16_f32 v142, v172, v173
    v_mfma_f32_16x16x32_bf16 v[176:179], v[76:79], v[100:103], v[176:179]
    v_cvt_pk_bf16_f32 v143, v174, v175
    v_mfma_f32_16x16x32_bf16 v[208:211], v[16:19], v[88:91], v[208:211]
    buffer_store_dwordx4 v[140:143], v2, s[8:11], s42 offen offset:0 sc1
    v_mfma_f32_16x16x32_bf16 v[208:211], v[32:35], v[92:95], v[208:211]
    v_cvt_pk_bf16_f32 v204, v204, v205
    v_mfma_f32_16x16x32_bf16 v[208:211], v[64:67], v[96:99], v[208:211]
    v_cvt_pk_bf16_f32 v205, v206, v207
    v_mfma_f32_16x16x32_bf16 v[208:211], v[80:83], v[100:103], v[208:211]
    v_cvt_pk_bf16_f32 v206, v236, v237
    v_mfma_f32_16x16x32_bf16 v[240:243], v[20:23], v[88:91], v[240:243]
    v_cvt_pk_bf16_f32 v207, v238, v239
    v_mfma_f32_16x16x32_bf16 v[240:243], v[36:39], v[92:95], v[240:243]
    buffer_store_dwordx4 v[204:207], v2, s[8:11], s42 offen offset:1024 sc1
    v_mfma_f32_16x16x32_bf16 v[240:243], v[68:71], v[96:99], v[240:243]
    v_mfma_f32_16x16x32_bf16 v[240:243], v[84:87], v[100:103], v[240:243]
    s_waitcnt lgkmcnt(0)
    v_mfma_f32_16x16x32_bf16 v[116:119], v[8:11], v[40:43], v[116:119]
    ds_read_b128 v[88:91], v104 offset:1024
    v_mfma_f32_16x16x32_bf16 v[116:119], v[24:27], v[44:47], v[116:119]
    ds_read_b128 v[92:95], v104 offset:9216
    v_mfma_f32_16x16x32_bf16 v[116:119], v[56:59], v[48:51], v[116:119]
    ds_read_b128 v[96:99], v104 offset:33792
    v_mfma_f32_16x16x32_bf16 v[116:119], v[72:75], v[52:55], v[116:119]
    ds_read_b128 v[100:103], v104 offset:41984
    v_mfma_f32_16x16x32_bf16 v[148:151], v[12:15], v[40:43], v[148:151]
    v_cvt_pk_bf16_f32 v144, v144, v145
    v_mfma_f32_16x16x32_bf16 v[148:151], v[28:31], v[44:47], v[148:151]
    v_cvt_pk_bf16_f32 v145, v146, v147
    v_mfma_f32_16x16x32_bf16 v[148:151], v[60:63], v[48:51], v[148:151]
    v_cvt_pk_bf16_f32 v146, v176, v177
    v_mfma_f32_16x16x32_bf16 v[148:151], v[76:79], v[52:55], v[148:151]
    v_cvt_pk_bf16_f32 v147, v178, v179
    v_mfma_f32_16x16x32_bf16 v[180:183], v[16:19], v[40:43], v[180:183]
    buffer_store_dwordx4 v[144:147], v2, s[8:11], s42 offen offset:2048 sc1
    v_mfma_f32_16x16x32_bf16 v[180:183], v[32:35], v[44:47], v[180:183]
    v_cvt_pk_bf16_f32 v208, v208, v209
    v_mfma_f32_16x16x32_bf16 v[180:183], v[64:67], v[48:51], v[180:183]
    v_cvt_pk_bf16_f32 v209, v210, v211
    v_mfma_f32_16x16x32_bf16 v[180:183], v[80:83], v[52:55], v[180:183]
    v_cvt_pk_bf16_f32 v210, v240, v241
    v_mfma_f32_16x16x32_bf16 v[212:215], v[20:23], v[40:43], v[212:215]
    v_cvt_pk_bf16_f32 v211, v242, v243
    v_mfma_f32_16x16x32_bf16 v[212:215], v[36:39], v[44:47], v[212:215]
    buffer_store_dwordx4 v[208:211], v2, s[8:11], s42 offen offset:3072 sc1
    v_mfma_f32_16x16x32_bf16 v[212:215], v[68:71], v[48:51], v[212:215]
    v_mfma_f32_16x16x32_bf16 v[212:215], v[84:87], v[52:55], v[212:215]
    s_waitcnt lgkmcnt(0)
    v_mfma_f32_16x16x32_bf16 v[120:123], v[8:11], v[88:91], v[120:123]
    v_mov_b32 v5, 0
    v_mfma_f32_16x16x32_bf16 v[120:123], v[24:27], v[92:95], v[120:123]
    v_mov_b32 v6, 1
    v_mfma_f32_16x16x32_bf16 v[120:123], v[56:59], v[96:99], v[120:123]
    s_waitcnt vmcnt(12)
    v_mfma_f32_16x16x32_bf16 v[120:123], v[72:75], v[100:103], v[120:123]
    s_mov_b64 exec, 1
    buffer_store_byte v6, v5, s[8:11], s32 offen offset:1 sc1
    s_mov_b64 exec, -1
    v_mfma_f32_16x16x32_bf16 v[152:155], v[12:15], v[88:91], v[152:155]
    v_mfma_f32_16x16x32_bf16 v[152:155], v[28:31], v[92:95], v[152:155]
    v_mfma_f32_16x16x32_bf16 v[152:155], v[60:63], v[96:99], v[152:155]
    v_mfma_f32_16x16x32_bf16 v[152:155], v[76:79], v[100:103], v[152:155]
    v_mfma_f32_16x16x32_bf16 v[184:187], v[16:19], v[88:91], v[184:187]
    v_mfma_f32_16x16x32_bf16 v[184:187], v[32:35], v[92:95], v[184:187]
    v_mfma_f32_16x16x32_bf16 v[184:187], v[64:67], v[96:99], v[184:187]
    v_mfma_f32_16x16x32_bf16 v[184:187], v[80:83], v[100:103], v[184:187]
    v_mfma_f32_16x16x32_bf16 v[216:219], v[20:23], v[88:91], v[216:219]
    v_mfma_f32_16x16x32_bf16 v[216:219], v[36:39], v[92:95], v[216:219]
    v_mfma_f32_16x16x32_bf16 v[216:219], v[68:71], v[96:99], v[216:219]
    v_mfma_f32_16x16x32_bf16 v[216:219], v[84:87], v[100:103], v[216:219]
    v_and_b32 v63, 1, v3
    v_lshlrev_b32 v63, 1, v63
    v_lshrrev_b32 v62, 1, v3
    v_or_b32 v63, v63, v62
    v_lshlrev_b32 v63, 4, v63
    v_lshl_add_u32 v62, v4, 11, v63
    s_waitcnt vmcnt(5)
    s_mov_b64 exec, 1
    buffer_store_byte v6, v5, s[8:11], s32 offen offset:2 sc1
    s_mov_b64 exec, -1
    v_lshlrev_b32 v40, 16, v156
    v_and_b32 v41, 0xffff0000, v156
    v_lshlrev_b32 v42, 16, v157
    v_and_b32 v43, 0xffff0000, v157
    v_lshlrev_b32 v44, 16, v158
    v_and_b32 v45, 0xffff0000, v158
    v_lshlrev_b32 v46, 16, v159
    v_and_b32 v47, 0xffff0000, v159
    v_pk_add_f32 v[116:117], v[116:117], v[40:41]
    v_pk_add_f32 v[118:119], v[118:119], v[42:43]
    v_pk_add_f32 v[148:149], v[148:149], v[44:45]
    v_pk_add_f32 v[150:151], v[150:151], v[46:47]
    v_lshlrev_b32 v40, 16, v220
    v_and_b32 v41, 0xffff0000, v220
    v_lshlrev_b32 v42, 16, v221
    v_and_b32 v43, 0xffff0000, v221
    v_lshlrev_b32 v44, 16, v222
    v_and_b32 v45, 0xffff0000, v222
    v_lshlrev_b32 v46, 16, v223
    v_and_b32 v47, 0xffff0000, v223
    v_pk_add_f32 v[180:181], v[180:181], v[40:41]
    v_pk_add_f32 v[182:183], v[182:183], v[42:43]
    v_pk_add_f32 v[212:213], v[212:213], v[44:45]
    v_pk_add_f32 v[214:215], v[214:215], v[46:47]
    v_lshlrev_b32 v40, 16, v160
    v_and_b32 v41, 0xffff0000, v160
    v_lshlrev_b32 v42, 16, v161
    v_and_b32 v43, 0xffff0000, v161
    v_lshlrev_b32 v44, 16, v162
    v_and_b32 v45, 0xffff0000, v162
    v_lshlrev_b32 v46, 16, v163
    v_and_b32 v47, 0xffff0000, v163
    v_pk_add_f32 v[120:121], v[120:121], v[40:41]
    v_pk_add_f32 v[122:123], v[122:123], v[42:43]
    v_pk_add_f32 v[152:153], v[152:153], v[44:45]
    v_pk_add_f32 v[154:155], v[154:155], v[46:47]
    v_lshlrev_b32 v40, 16, v224
    v_and_b32 v41, 0xffff0000, v224
    v_lshlrev_b32 v42, 16, v225
    v_and_b32 v43, 0xffff0000, v225
    v_lshlrev_b32 v44, 16, v226
    v_and_b32 v45, 0xffff0000, v226
    v_lshlrev_b32 v46, 16, v227
    v_and_b32 v47, 0xffff0000, v227
    v_pk_add_f32 v[184:185], v[184:185], v[40:41]
    v_pk_add_f32 v[186:187], v[186:187], v[42:43]
    v_pk_add_f32 v[216:217], v[216:217], v[44:45]
    v_pk_add_f32 v[218:219], v[218:219], v[46:47]
    v_sub_u32 v61, s71, v1
    v_and_b32 v61, 3, v61
    v_lshlrev_b32 v61, 3, v61
    s_waitcnt vmcnt(2)
    s_mov_b64 exec, 1
    buffer_store_byte v6, v5, s[8:11], s32 offen offset:3 sc1
    s_mov_b64 exec, -1
    s_mov_b32 s72, 0
    s_mov_b32 s33, 0
    s_sub_u32 s30, s71, 1
    s_and_b32 s30, s30, 3
    s_bitcmp1_b32 s33, s30
    s_cbranch_scc1 lvx_377
lv_376:
    s_mov_b64 exec, 0xf
    buffer_load_dword v60, v2, s[8:11], s37 offen sc1
    s_add_u32 s72, s72, 1
    s_waitcnt vmcnt(0)
    v_bfe_u32 v60, v60, v61, 1
    v_cmp_eq_u32 vcc, 1, v60
    s_mov_b64 exec, -1
    s_mov_b32 s33, vcc_lo
    s_cmp_gt_u32 s72, 524288
    s_cbranch_scc1 lvx_377
    s_bitcmp1_b32 s33, s30
    s_cbranch_scc0 lv_376
lvx_377:
    buffer_load_dwordx4 v[96:99], v2, s[8:11], s45 offen offset:0 sc1
    buffer_load_dwordx4 v[100:103], v2, s[8:11], s45 offen offset:1024 sc1
    buffer_load_dwordx4 v[104:107], v2, s[8:11], s45 offen offset:2048 sc1
    buffer_load_dwordx4 v[108:111], v2, s[8:11], s45 offen offset:3072 sc1
    s_sub_u32 s30, s71, 2
    s_and_b32 s30, s30, 3
    s_bitcmp1_b32 s33, s30
    s_cbranch_scc1 lvx_379
lv_378:
    s_mov_b64 exec, 0xf
    buffer_load_dword v60, v2, s[8:11], s37 offen sc1
    s_add_u32 s72, s72, 1
    s_waitcnt vmcnt(0)
    v_bfe_u32 v60, v60, v61, 1
    v_cmp_eq_u32 vcc, 1, v60
    s_mov_b64 exec, -1
    s_mov_b32 s33, vcc_lo
    s_cmp_gt_u32 s72, 524288
    s_cbranch_scc1 lvx_379
    s_bitcmp1_b32 s33, s30
    s_cbranch_scc0 lv_378
lvx_379:
    buffer_load_dwordx4 v[80:83], v2, s[8:11], s44 offen offset:0 sc1
    buffer_load_dwordx4 v[84:87], v2, s[8:11], s44 offen offset:1024 sc1
    buffer_load_dwordx4 v[88:91], v2, s[8:11], s44 offen offset:2048 sc1
    buffer_load_dwordx4 v[92:95], v2, s[8:11], s44 offen offset:3072 sc1
    s_sub_u32 s30, s71, 3
    s_and_b32 s30, s30, 3
    s_bitcmp1_b32 s33, s30
    s_cbranch_scc1 lvx_381
lv_380:
    s_mov_b64 exec, 0xf
    buffer_load_dword v60, v2, s[8:11], s37 offen sc1
    s_add_u32 s72, s72, 1
    s_waitcnt vmcnt(0)
    v_bfe_u32 v60, v60, v61, 1
    v_cmp_eq_u32 vcc, 1, v60
    s_mov_b64 exec, -1
    s_mov_b32 s33, vcc_lo
    s_cmp_gt_u32 s72, 524288
    s_cbranch_scc1 lvx_381
    s_bitcmp1_b32 s33, s30
    s_cbranch_scc0 lv_380
lvx_381:
    buffer_load_dwordx4 v[64:67], v2, s[8:11], s43 offen offset:0 sc1
    buffer_load_dwordx4 v[68:71], v2, s[8:11], s43 offen offset:1024 sc1
    buffer_load_dwordx4 v[72:75], v2, s[8:11], s43 offen offset:2048 sc1
    buffer_load_dwordx4 v[76:79], v2, s[8:11], s43 offen offset:3072 sc1
    s_waitcnt vmcnt(8)
    v_lshlrev_b32 v40, 16, v96
    v_and_b32 v41, 0xffff0000, v96
    v_lshlrev_b32 v42, 16, v97
    v_and_b32 v43, 0xffff0000, v97
    v_lshlrev_b32 v44, 16, v98
    v_and_b32 v45, 0xffff0000, v98
    v_lshlrev_b32 v46, 16, v99
    v_and_b32 v47, 0xffff0000, v99
    v_pk_add_f32 v[116:117], v[116:117], v[40:41]
    v_pk_add_f32 v[118:119], v[118:119], v[42:43]
    v_pk_add_f32 v[148:149], v[148:149], v[44:45]
    v_pk_add_f32 v[150:151], v[150:151], v[46:47]
    v_lshlrev_b32 v40, 16, v100
    v_and_b32 v41, 0xffff0000, v100
    v_lshlrev_b32 v42, 16, v101
    v_and_b32 v43, 0xffff0000, v101
    v_lshlrev_b32 v44, 16, v102
    v_and_b32 v45, 0xffff0000, v102
    v_lshlrev_b32 v46, 16, v103
    v_and_b32 v47, 0xffff0000, v103
    v_pk_add_f32 v[180:181], v[180:181], v[40:41]
    v_pk_add_f32 v[182:183], v[182:183], v[42:43]
    v_pk_add_f32 v[212:213], v[212:213], v[44:45]
    v_pk_add_f32 v[214:215], v[214:215], v[46:47]
    v_lshlrev_b32 v40, 16, v104
    v_and_b32 v41, 0xffff0000, v104
    v_lshlrev_b32 v42, 16, v105
    v_and_b32 v43, 0xffff0000, v105
    v_lshlrev_b32 v44, 16, v106
    v_and_b32 v45, 0xffff0000, v106
    v_lshlrev_b32 v46, 16, v107
    v_and_b32 v47, 0xffff0000, v107
    v_pk_add_f32 v[120:121], v[120:121], v[40:41]
    v_pk_add_f32 v[122:123], v[122:123], v[42:43]
    v_pk_add_f32 v[152:153], v[152:153], v[44:45]
    v_pk_add_f32 v[154:155], v[154:155], v[46:47]
    v_lshlrev_b32 v40, 16, v108
    v_and_b32 v41, 0xffff0000, v108
    v_lshlrev_b32 v42, 16, v109
    v_and_b32 v43, 0xffff0000, v109
    v_lshlrev_b32 v44, 16, v110
    v_and_b32 v45, 0xffff0000, v110
    v_lshlrev_b32 v46, 16, v111
    v_and_b32 v47, 0xffff0000, v111
    v_pk_add_f32 v[184:185], v[184:185], v[40:41]
    v_pk_add_f32 v[186:187], v[186:187], v[42:43]
    v_pk_add_f32 v[216:217], v[216:217], v[44:45]
    v_pk_add_f32 v[218:219], v[218:219], v[46:47]
    s_waitcnt vmcnt(4)
    v_lshlrev_b32 v40, 16, v80
    v_and_b32 v41, 0xffff0000, v80
    v_lshlrev_b32 v42, 16, v81
    v_and_b32 v43, 0xffff0000, v81
    v_lshlrev_b32 v44, 16, v82
    v_and_b32 v45, 0xffff0000, v82
    v_lshlrev_b32 v46, 16, v83
    v_and_b32 v47, 0xffff0000, v83
    v_pk_add_f32 v[116:117], v[116:117], v[40:41]
    v_pk_add_f32 v[118:119], v[118:119], v[42:43]
    v_pk_add_f32 v[148:149], v[148:149], v[44:45]
    v_pk_add_f32 v[150:151], v[150:151], v[46:47]
    v_lshlrev_b32 v40, 16, v84
    v_and_b32 v41, 0xffff0000, v84
    v_lshlrev_b32 v42, 16, v85
    v_and_b32 v43, 0xffff0000, v85
    v_lshlrev_b32 v44, 16, v86
    v_and_b32 v45, 0xffff0000, v86
    v_lshlrev_b32 v46, 16, v87
    v_and_b32 v47, 0xffff0000, v87
    v_pk_add_f32 v[180:181], v[180:181], v[40:41]
    v_pk_add_f32 v[182:183], v[182:183], v[42:43]
    v_pk_add_f32 v[212:213], v[212:213], v[44:45]
    v_pk_add_f32 v[214:215], v[214:215], v[46:47]
    v_lshlrev_b32 v40, 16, v88
    v_and_b32 v41, 0xffff0000, v88
    v_lshlrev_b32 v42, 16, v89
    v_and_b32 v43, 0xffff0000, v89
    v_lshlrev_b32 v44, 16, v90
    v_and_b32 v45, 0xffff0000, v90
    v_lshlrev_b32 v46, 16, v91
    v_and_b32 v47, 0xffff0000, v91
    v_pk_add_f32 v[120:121], v[120:121], v[40:41]
    v_pk_add_f32 v[122:123], v[122:123], v[42:43]
    v_pk_add_f32 v[152:153], v[152:153], v[44:45]
    v_pk_add_f32 v[154:155], v[154:155], v[46:47]
    v_lshlrev_b32 v40, 16, v92
    v_and_b32 v41, 0xffff0000, v92
    v_lshlrev_b32 v42, 16, v93
    v_and_b32 v43, 0xffff0000, v93
    v_lshlrev_b32 v44, 16, v94
    v_and_b32 v45, 0xffff0000, v94
    v_lshlrev_b32 v46, 16, v95
    v_and_b32 v47, 0xffff0000, v95
    v_pk_add_f32 v[184:185], v[184:185], v[40:41]
    v_pk_add_f32 v[186:187], v[186:187], v[42:43]
    v_pk_add_f32 v[216:217], v[216:217], v[44:45]
    v_pk_add_f32 v[218:219], v[218:219], v[46:47]
    s_waitcnt vmcnt(0)
    v_lshlrev_b32 v40, 16, v64
    v_and_b32 v41, 0xffff0000, v64
    v_lshlrev_b32 v42, 16, v65
    v_and_b32 v43, 0xffff0000, v65
    v_lshlrev_b32 v44, 16, v66
    v_and_b32 v45, 0xffff0000, v66
    v_lshlrev_b32 v46, 16, v67
    v_and_b32 v47, 0xffff0000, v67
    v_pk_add_f32 v[116:117], v[116:117], v[40:41]
    v_pk_add_f32 v[118:119], v[118:119], v[42:43]
    v_pk_add_f32 v[148:149], v[148:149], v[44:45]
    v_pk_add_f32 v[150:151], v[150:151], v[46:47]
    v_lshlrev_b32 v40, 16, v68
    v_and_b32 v41, 0xffff0000, v68
    v_lshlrev_b32 v42, 16, v69
    v_and_b32 v43, 0xffff0000, v69
    v_lshlrev_b32 v44, 16, v70
    v_and_b32 v45, 0xffff0000, v70
    v_lshlrev_b32 v46, 16, v71
    v_and_b32 v47, 0xffff0000, v71
    v_pk_add_f32 v[180:181], v[180:181], v[40:41]
    v_pk_add_f32 v[182:183], v[182:183], v[42:43]
    v_pk_add_f32 v[212:213], v[212:213], v[44:45]
    v_pk_add_f32 v[214:215], v[214:215], v[46:47]
    v_lshlrev_b32 v40, 16, v72
    v_and_b32 v41, 0xffff0000, v72
    v_lshlrev_b32 v42, 16, v73
    v_and_b32 v43, 0xffff0000, v73
    v_lshlrev_b32 v44, 16, v74
    v_and_b32 v45, 0xffff0000, v74
    v_lshlrev_b32 v46, 16, v75
    v_and_b32 v47, 0xffff0000, v75
    v_pk_add_f32 v[120:121], v[120:121], v[40:41]
    v_pk_add_f32 v[122:123], v[122:123], v[42:43]
    v_pk_add_f32 v[152:153], v[152:153], v[44:45]
    v_pk_add_f32 v[154:155], v[154:155], v[46:47]
    v_lshlrev_b32 v40, 16, v76
    v_and_b32 v41, 0xffff0000, v76
    v_lshlrev_b32 v42, 16, v77
    v_and_b32 v43, 0xffff0000, v77
    v_lshlrev_b32 v44, 16, v78
    v_and_b32 v45, 0xffff0000, v78
    v_lshlrev_b32 v46, 16, v79
    v_and_b32 v47, 0xffff0000, v79
    v_pk_add_f32 v[184:185], v[184:185], v[40:41]
    v_pk_add_f32 v[186:187], v[186:187], v[42:43]
    v_pk_add_f32 v[216:217], v[216:217], v[44:45]
    v_pk_add_f32 v[218:219], v[218:219], v[46:47]
    v_cvt_pk_bf16_f32 v156, v116, v117
    v_cvt_pk_bf16_f32 v157, v118, v119
    v_cvt_pk_bf16_f32 v158, v148, v149
    v_cvt_pk_bf16_f32 v159, v150, v151
    s_nop 0
    v_permlane16_swap_b32 v156, v158
    v_permlane16_swap_b32 v157, v159
    s_add_u32 s31, s46, 0
    buffer_store_dwordx4 v[156:159], v62, s[16:19], s31 offen offset:0 nt
    v_cvt_pk_bf16_f32 v220, v180, v181
    v_cvt_pk_bf16_f32 v221, v182, v183
    v_cvt_pk_bf16_f32 v222, v212, v213
    v_cvt_pk_bf16_f32 v223, v214, v215
    s_nop 0
    v_permlane16_swap_b32 v220, v222
    v_permlane16_swap_b32 v221, v223
    s_add_u32 s31, s46, 0
    buffer_store_dwordx4 v[220:223], v62, s[16:19], s31 offen offset:64 nt
    v_cvt_pk_bf16_f32 v160, v120, v121
    v_cvt_pk_bf16_f32 v161, v122, v123
    v_cvt_pk_bf16_f32 v162, v152, v153
    v_cvt_pk_bf16_f32 v163, v154, v155
    s_nop 0
    v_permlane16_swap_b32 v160, v162
    v_permlane16_swap_b32 v161, v163
    s_add_u32 s31, s46, 32768
    buffer_store_dwordx4 v[160:163], v62, s[16:19], s31 offen offset:0 nt
    v_cvt_pk_bf16_f32 v224, v184, v185
    v_cvt_pk_bf16_f32 v225, v186, v187
    v_cvt_pk_bf16_f32 v226, v216, v217
    v_cvt_pk_bf16_f32 v227, v218, v219
    s_nop 0
    v_permlane16_swap_b32 v224, v226
    v_permlane16_swap_b32 v225, v227
    s_add_u32 s31, s46, 32768
    buffer_store_dwordx4 v[224:227], v62, s[16:19], s31 offen offset:64 nt
    s_endpgm
.fill (90112 - (. - sequential_preLN__sliding_block__dense_activation_silu__prompt_kernel)) / 4, 4, 0xbf810000
.section .rodata,"a"
.p2align 6
.amdhsa_kernel sequential_preLN__sliding_block__dense_activation_silu__prompt_kernel
  .amdhsa_next_free_vgpr 256
  .amdhsa_next_free_sgpr 102
  .amdhsa_accum_offset 256
  .amdhsa_group_segment_fixed_size 0
  .amdhsa_kernarg_size 72
  .amdhsa_user_sgpr_count 2
  .amdhsa_user_sgpr_kernarg_segment_ptr 1
  .amdhsa_system_sgpr_workgroup_id_x 1
.end_amdhsa_kernel
```
